```python
import torch

def _softmax(x, axis=-1):
    return torch.softmax(x, dim=axis)
def _gelu(x):
    return torch.nn.functional.gelu(x, approximate="tanh")
def _silu(x):
    return torch.nn.functional.silu(x)
def _sigmoid(x):
    return torch.sigmoid(x)
def _layernorm(x, axis=-1, eps=1e-5):
    m = x.mean(dim=axis, keepdim=True)
    v = x.var(dim=axis, keepdim=True, unbiased=False)
    return (x - m) / torch.sqrt(v + eps)
def _scatter_add(tgt, idx, src, axis=0):
    return tgt.clone().index_add_(axis, idx, src)
def _segment_sum(src, seg, n):
    out = torch.zeros((n,) + src.shape[1:], dtype=src.dtype)
    return out.index_add_(0, seg, src)
def _pad(x, pw):
    flat = tuple(v for pair in reversed(pw) for v in pair)
    return torch.nn.functional.pad(x, flat)

kernel_name = 'interleave_layers__mha_block_cached__dense_activation_silu__decode'

def setup_inputs():

    _w = (lambda a: (lambda t: t.to(torch.bfloat16) if t.is_floating_point() else t)(torch.as_tensor(a)))
    def _A_setup():
        B, Sq, D = 8, 1, 512
        H, Sk, Dh = 32, 4096, 128
        return {
            "x": _w((lambda *s: torch.randn(*s, dtype=torch.bfloat16) * 0.1)(B, Sq, D)),
            "k_cache": _w((lambda *s: torch.randn(*s, dtype=torch.bfloat16) * 0.8)(B, H, Sk, Dh)),
            "v_cache": _w((lambda *s: torch.randn(*s, dtype=torch.bfloat16) * 3.2)(B, H, Sk, Dh)),
            "wq": _w((lambda *s: torch.randn(*s, dtype=torch.bfloat16) * 0.8)(D, H * Dh) * (D ** -0.5)),
            "wo": _w((lambda *s: torch.randn(*s, dtype=torch.bfloat16) * 3.2)(H * Dh, D) * ((H * Dh) ** -0.5)),
        }
    _A_in = _A_setup()

    def _B_setup():
        B, S, D, F = 8, 1, 512, 1792
        return {
            "x": _w((lambda *s: torch.randn(*s, dtype=torch.bfloat16) * 0.1)(B, S, D)),
            "w1": _w((lambda *s: torch.randn(*s, dtype=torch.bfloat16) * 1.6)(D, F) * (D ** -0.5)),
            "w2": _w((lambda *s: torch.randn(*s, dtype=torch.bfloat16) * 0.4)(F, D) * (F ** -0.5)),
        }
    _B_in = _B_setup()

    return {
        "A_x": _A_in["x"],
        "A_k_cache": _A_in["k_cache"],
        "A_v_cache": _A_in["v_cache"],
        "A_wq": _A_in["wq"],
        "A_wo": _A_in["wo"],
        "B_x": _B_in["x"],
        "B_w1": _B_in["w1"],
        "B_w2": _B_in["w2"],
    }

def reference(A_x, A_k_cache, A_v_cache, A_wq, A_wo, B_x, B_w1, B_w2):
    def _A_ref(x, k_cache, v_cache, wq, wo):
        B, Sq, D = x.shape
        H, Dh = 32, 128
        q = (lambda x, *d: x.permute(*d))((x @ wq).reshape(B, Sq, H, Dh), 0, 2, 1, 3)
        scores = torch.einsum("bhqd,bhkd->bhqk", q, k_cache) * (Dh ** -0.5)
        p = _softmax(scores, axis=-1)
        o = torch.einsum("bhqk,bhkd->bhqd", p, v_cache)
        return (lambda x, *d: x.permute(*d))(o, 0, 2, 1, 3).reshape(B, Sq, H * Dh) @ wo

    def _B_ref(x, w1, w2):
        h = torch.einsum("bsd,df->bsf", x, w1)
        h = _silu(h)
        out = torch.einsum("bsf,fd->bsd", h, w2)
        return out

    x = A_x
    x = x + _A_ref(_layernorm(x, axis=-1), A_k_cache, A_v_cache, A_wq, A_wo)
    x = x + _B_ref(_layernorm(x, axis=-1), B_w1, B_w2)
    x = x + _A_ref(_layernorm(x, axis=-1), A_k_cache, A_v_cache, A_wq, A_wo)
    x = x + _B_ref(_layernorm(x, axis=-1), B_w1, B_w2)
    return x
```

```asm
; @launch grid=(256,1,1) block=(256,1,1) lds=162816
.amdgcn_target "amdgcn-amd-amdhsa--gfx950"
.text
.globl interleave_layers__mha_block_cached__dense_activation_silu__decode_kernel
.p2align 8
.type interleave_layers__mha_block_cached__dense_activation_silu__decode_kernel,@function
interleave_layers__mha_block_cached__dense_activation_silu__decode_kernel:
    s_cmp_ge_u32 s2, 256
    s_cbranch_scc1 L_END
    s_load_dwordx16 s[48:63], s[0:1], 0
    s_load_dwordx4 s[64:67], s[0:1], 64
    s_load_dwordx2 s[68:69], s[0:1], 80
    s_and_b32 s6, s2, 7
    s_lshl_b32 s6, s6, 2
    s_lshr_b32 s7, s2, 3
    s_and_b32 s4, s7, 3
    s_add_u32 s4, s4, s6
    s_lshr_b32 s3, s7, 2
    v_lshrrev_b32 v1, 6, v0
    v_and_b32 v0, 63, v0
    v_readfirstlane_b32 s5, v1
    s_waitcnt lgkmcnt(0)
    s_lshl_b32 s6, s3, 5
    s_add_u32 s6, s6, s4
    s_lshl_b32 s6, s6, 20
    s_add_u32 s8, s50, s6
    s_addc_u32 s9, s51, 0
    s_and_b32 s9, s9, 0xffff
    s_mov_b32 s10, 1048576
    s_mov_b32 s11, 0x00020000
    s_add_u32 s12, s52, s6
    s_addc_u32 s13, s53, 0
    s_and_b32 s13, s13, 0xffff
    s_mov_b32 s14, 1048576
    s_mov_b32 s15, 0x00020000
    s_lshl_b32 s6, s4, 8
    s_sub_u32 s7, 4194304, s6
    s_add_u32 s16, s54, s6
    s_addc_u32 s17, s55, 0
    s_and_b32 s17, s17, 0xffff
    s_mov_b32 s18, s7
    s_mov_b32 s19, 0x00020000
    s_lshl_b32 s6, s4, 17
    s_add_u32 s20, s56, s6
    s_addc_u32 s21, s57, 0
    s_and_b32 s21, s21, 0xffff
    s_mov_b32 s22, 131072
    s_mov_b32 s23, 0x00020000
    s_mul_i32 s6, s4, 112
    s_sub_u32 s7, 1835008, s6
    s_add_u32 s24, s60, s6
    s_addc_u32 s25, s61, 0
    s_and_b32 s25, s25, 0xffff
    s_mov_b32 s26, s7
    s_mov_b32 s27, 0x00020000
    s_mul_i32 s6, s4, 57344
    s_add_u32 s28, s62, s6
    s_addc_u32 s29, s63, 0
    s_and_b32 s29, s29, 0xffff
    s_mov_b32 s30, 57344
    s_mov_b32 s31, 0x00020000
    s_mov_b32 s32, s68
    s_and_b32 s33, s69, 0xffff
    s_mov_b32 s34, 33554432
    s_mov_b32 s35, 0x00020000
    s_lshl_b32 s6, s3, 10
    s_add_u32 s36, s48, s6
    s_addc_u32 s37, s49, 0
    s_and_b32 s37, s37, 0xffff
    s_mov_b32 s38, 1024
    s_mov_b32 s39, 0x00020000
    s_lshl_b32 s7, s4, 5
    s_add_u32 s6, s6, s7
    s_add_u32 s40, s64, s6
    s_addc_u32 s41, s65, 0
    s_and_b32 s41, s41, 0xffff
    s_mov_b32 s42, 32
    s_mov_b32 s43, 0x00020000
    s_mov_b32 s44, s66
    s_and_b32 s45, s67, 0xffff
    s_mov_b32 s46, 256
    s_mov_b32 s47, 0x00020000
    s_lshl_b32 s6, s5, 4
    s_mov_b64 s[70:71], 0xffff
    s_lshl_b64 s[70:71], s[70:71], s6
    s_mov_b32 s72, 0xcccccccc
    s_mov_b32 s73, 0xcccccccc
    s_mov_b32 s74, 0xaaaaaaaa
    s_mov_b32 s75, 0xaaaaaaaa
    s_mul_i32 s79, s5, 35840
    s_add_u32 s79, s79, 19456
    v_lshl_add_u32 v53, v0, 4, s79
    s_lshl_b32 s6, s5, 10
    v_lshl_add_u32 v1, v0, 4, s6
    s_lshl_b32 s6, s5, 15
    v_lshl_add_u32 v3, v0, 4, s6
    s_mul_i32 s6, s5, 14336
    v_lshl_add_u32 v5, v0, 4, s6
    s_lshl_b32 s6, s5, 11
    v_lshl_add_u32 v6, v0, 5, s6
    v_lshrrev_b32 v7, 4, v0
    v_lshlrev_b32 v7, 13, v7
    v_and_b32 v55, 15, v0
    v_lshl_add_u32 v7, v55, 4, v7
    s_lshl_b32 s6, s5, 20
    v_add_u32 v2, s6, v7
    v_lshrrev_b32 v7, 3, v0
    v_lshlrev_b32 v7, 4, v7
    s_lshl_b32 s6, s5, 7
    v_add_u32 v7, s6, v7
    s_movk_i32 s6, 3584
    v_mul_lo_u32 v7, v7, s6
    v_and_b32 v55, 7, v0
    v_lshl_add_u32 v4, v55, 4, v7
    v_lshlrev_b32 v7, 4, v0
    buffer_load_dwordx4 v[20:23], v7, s[36:39], 0 offen
    v_and_b32 v55, 3, v0
    v_lshlrev_b32 v55, 3, v55
    s_lshl_b32 s6, s4, 5
    buffer_load_dwordx2 v[24:25], v55, s[36:39], s6 offen
    s_lshl_b32 s48, s3, 12
    s_mul_i32 s49, s3, 1792
    s_mul_i32 s50, s3, 7168
    s_add_u32 s51, s50, 3584
    s_lshl_b32 s52, s3, 17
    s_add_u32 s53, s52, 32768
    s_add_u32 s54, s52, 65536
    s_add_u32 s55, s52, 98304
    s_mul_i32 s56, s2, 0
    s_and_b32 s56, s56, 255
    s_lshl_b32 s56, s56, 12
    buffer_load_dwordx4 v[128:131], v2, s[16:19], 0 offen
    s_mov_b32 s6, 32768
    buffer_load_dwordx4 v[132:135], v2, s[16:19], s6 offen
    s_mov_b32 s6, 65536
    buffer_load_dwordx4 v[136:139], v2, s[16:19], s6 offen
    s_mov_b32 s6, 98304
    buffer_load_dwordx4 v[140:143], v2, s[16:19], s6 offen
    s_mov_b32 s6, 131072
    buffer_load_dwordx4 v[144:147], v2, s[16:19], s6 offen
    s_mov_b32 s6, 163840
    buffer_load_dwordx4 v[148:151], v2, s[16:19], s6 offen
    s_mov_b32 s6, 196608
    buffer_load_dwordx4 v[152:155], v2, s[16:19], s6 offen
    s_mov_b32 s6, 229376
    buffer_load_dwordx4 v[156:159], v2, s[16:19], s6 offen
    s_mov_b32 s6, 262144
    buffer_load_dwordx4 v[160:163], v2, s[16:19], s6 offen
    s_mov_b32 s6, 294912
    buffer_load_dwordx4 v[164:167], v2, s[16:19], s6 offen
    s_mov_b32 s6, 327680
    buffer_load_dwordx4 v[168:171], v2, s[16:19], s6 offen
    s_mov_b32 s6, 360448
    buffer_load_dwordx4 v[172:175], v2, s[16:19], s6 offen
    s_mov_b32 s6, 393216
    buffer_load_dwordx4 v[176:179], v2, s[16:19], s6 offen
    s_mov_b32 s6, 425984
    buffer_load_dwordx4 v[180:183], v2, s[16:19], s6 offen
    s_mov_b32 s6, 458752
    buffer_load_dwordx4 v[184:187], v2, s[16:19], s6 offen
    s_mov_b32 s6, 491520
    buffer_load_dwordx4 v[188:191], v2, s[16:19], s6 offen
    s_mov_b32 s6, 524288
    buffer_load_dwordx4 v[192:195], v2, s[16:19], s6 offen
    s_mov_b32 s6, 557056
    buffer_load_dwordx4 v[196:199], v2, s[16:19], s6 offen
    s_mov_b32 s6, 589824
    buffer_load_dwordx4 v[200:203], v2, s[16:19], s6 offen
    s_mov_b32 s6, 622592
    buffer_load_dwordx4 v[204:207], v2, s[16:19], s6 offen
    s_mov_b32 s6, 655360
    buffer_load_dwordx4 v[208:211], v2, s[16:19], s6 offen
    s_mov_b32 s6, 688128
    buffer_load_dwordx4 v[212:215], v2, s[16:19], s6 offen
    s_mov_b32 s6, 720896
    buffer_load_dwordx4 v[216:219], v2, s[16:19], s6 offen
    s_mov_b32 s6, 753664
    buffer_load_dwordx4 v[220:223], v2, s[16:19], s6 offen
    s_mov_b32 s6, 786432
    buffer_load_dwordx4 v[224:227], v2, s[16:19], s6 offen
    s_mov_b32 s6, 819200
    buffer_load_dwordx4 v[228:231], v2, s[16:19], s6 offen
    s_mov_b32 s6, 851968
    buffer_load_dwordx4 v[232:235], v2, s[16:19], s6 offen
    s_mov_b32 s6, 884736
    buffer_load_dwordx4 v[236:239], v2, s[16:19], s6 offen
    s_mov_b32 s6, 917504
    buffer_load_dwordx4 v[240:243], v2, s[16:19], s6 offen
    s_mov_b32 s6, 950272
    buffer_load_dwordx4 v[244:247], v2, s[16:19], s6 offen
    s_mov_b32 s6, 983040
    buffer_load_dwordx4 v[248:251], v2, s[16:19], s6 offen
    s_mov_b32 s6, 1015808
    buffer_load_dwordx4 v[252:255], v2, s[16:19], s6 offen
    s_add_u32 s6, s56, 0
    s_and_b32 s6, s6, 0xfffff
    buffer_load_dwordx4 v[64:67], v1, s[8:11], s6 offen nt
    s_add_u32 s6, s56, 4096
    s_and_b32 s6, s6, 0xfffff
    buffer_load_dwordx4 v[68:71], v1, s[8:11], s6 offen nt
    s_add_u32 s6, s56, 8192
    s_and_b32 s6, s6, 0xfffff
    buffer_load_dwordx4 v[72:75], v1, s[8:11], s6 offen nt
    s_add_u32 s6, s56, 12288
    s_and_b32 s6, s6, 0xfffff
    buffer_load_dwordx4 v[76:79], v1, s[8:11], s6 offen nt
    s_add_u32 s6, s56, 16384
    s_and_b32 s6, s6, 0xfffff
    buffer_load_dwordx4 v[80:83], v1, s[8:11], s6 offen nt
    s_add_u32 s6, s56, 20480
    s_and_b32 s6, s6, 0xfffff
    buffer_load_dwordx4 v[84:87], v1, s[8:11], s6 offen nt
    s_add_u32 s6, s56, 24576
    s_and_b32 s6, s6, 0xfffff
    buffer_load_dwordx4 v[88:91], v1, s[8:11], s6 offen nt
    s_add_u32 s6, s56, 28672
    s_and_b32 s6, s6, 0xfffff
    buffer_load_dwordx4 v[92:95], v1, s[8:11], s6 offen nt
    s_add_u32 s6, s56, 32768
    s_and_b32 s6, s6, 0xfffff
    buffer_load_dwordx4 v[96:99], v1, s[8:11], s6 offen nt
    s_add_u32 s6, s56, 36864
    s_and_b32 s6, s6, 0xfffff
    buffer_load_dwordx4 v[100:103], v1, s[8:11], s6 offen nt
    s_add_u32 s6, s56, 40960
    s_and_b32 s6, s6, 0xfffff
    buffer_load_dwordx4 v[104:107], v1, s[8:11], s6 offen nt
    s_add_u32 s6, s56, 45056
    s_and_b32 s6, s6, 0xfffff
    buffer_load_dwordx4 v[108:111], v1, s[8:11], s6 offen nt
    s_waitcnt vmcnt(44)
    v_lshlrev_b32 v36, 16, v20
    v_and_b32 v37, 0xffff0000, v20
    v_lshlrev_b32 v38, 16, v21
    v_and_b32 v39, 0xffff0000, v21
    v_lshlrev_b32 v40, 16, v22
    v_and_b32 v41, 0xffff0000, v22
    v_lshlrev_b32 v42, 16, v23
    v_and_b32 v43, 0xffff0000, v23
    v_lshlrev_b32 v56, 16, v24
    v_and_b32 v57, 0xffff0000, v24
    v_lshlrev_b32 v58, 16, v25
    v_and_b32 v59, 0xffff0000, v25
    v_add_f32 v60, v36, v37
    v_add_f32 v60, v60, v38
    v_add_f32 v60, v60, v39
    v_add_f32 v60, v60, v40
    v_add_f32 v60, v60, v41
    v_add_f32 v60, v60, v42
    v_add_f32 v60, v60, v43
    s_nop 1
    v_add_f32_dpp v60, v60, v60 row_ror:8 row_mask:0xf bank_mask:0xf
    s_nop 1
    v_add_f32_dpp v60, v60, v60 row_ror:4 row_mask:0xf bank_mask:0xf
    s_nop 1
    v_add_f32_dpp v60, v60, v60 row_ror:2 row_mask:0xf bank_mask:0xf
    s_nop 1
    v_add_f32_dpp v60, v60, v60 row_ror:1 row_mask:0xf bank_mask:0xf
    v_mov_b32 v61, v60
    s_nop 1
    v_permlane16_swap_b32 v61, v60
    s_nop 1
    v_add_f32 v60, v60, v61
    v_mov_b32 v61, v60
    s_nop 1
    v_permlane32_swap_b32 v61, v60
    s_nop 1
    v_add_f32 v60, v60, v61
    v_mul_f32 v60, 0x3b000000, v60
    v_sub_f32 v36, v36, v60
    v_sub_f32 v37, v37, v60
    v_sub_f32 v38, v38, v60
    v_sub_f32 v39, v39, v60
    v_sub_f32 v40, v40, v60
    v_sub_f32 v41, v41, v60
    v_sub_f32 v42, v42, v60
    v_sub_f32 v43, v43, v60
    v_mul_f32 v60, v36, v36
    v_fma_f32 v60, v37, v37, v60
    v_fma_f32 v60, v38, v38, v60
    v_fma_f32 v60, v39, v39, v60
    v_fma_f32 v60, v40, v40, v60
    v_fma_f32 v60, v41, v41, v60
    v_fma_f32 v60, v42, v42, v60
    v_fma_f32 v60, v43, v43, v60
    s_nop 1
    v_add_f32_dpp v60, v60, v60 row_ror:8 row_mask:0xf bank_mask:0xf
    s_nop 1
    v_add_f32_dpp v60, v60, v60 row_ror:4 row_mask:0xf bank_mask:0xf
    s_nop 1
    v_add_f32_dpp v60, v60, v60 row_ror:2 row_mask:0xf bank_mask:0xf
    s_nop 1
    v_add_f32_dpp v60, v60, v60 row_ror:1 row_mask:0xf bank_mask:0xf
    v_mov_b32 v61, v60
    s_nop 1
    v_permlane16_swap_b32 v61, v60
    s_nop 1
    v_add_f32 v60, v60, v61
    v_mov_b32 v61, v60
    s_nop 1
    v_permlane32_swap_b32 v61, v60
    s_nop 1
    v_add_f32 v60, v60, v61
    v_mov_b32 v61, 0x3727c5ac
    v_fmac_f32 v61, 0x3b000000, v60
    v_rsq_f32 v60, v61
    s_nop 0
    v_mul_f32 v36, v36, v60
    v_mul_f32 v37, v37, v60
    v_mul_f32 v38, v38, v60
    v_mul_f32 v39, v39, v60
    v_mul_f32 v40, v40, v60
    v_mul_f32 v41, v41, v60
    v_mul_f32 v42, v42, v60
    v_mul_f32 v43, v43, v60
    v_cvt_pk_bf16_f32 v36, v36, 0
    v_cvt_pk_bf16_f32 v37, v37, 0
    v_cvt_pk_bf16_f32 v38, v38, 0
    v_cvt_pk_bf16_f32 v39, v39, 0
    v_cvt_pk_bf16_f32 v40, v40, 0
    v_cvt_pk_bf16_f32 v41, v41, 0
    v_cvt_pk_bf16_f32 v42, v42, 0
    v_cvt_pk_bf16_f32 v43, v43, 0
    v_lshlrev_b32 v7, 5, v0
    s_mov_b64 exec, s[70:71]
    ds_write_b128 v7, v[36:39] offset:16384
    ds_write_b128 v7, v[40:43] offset:16400
    s_mov_b64 exec, -1
    s_waitcnt lgkmcnt(0)
    s_add_u32 s6, s56, 49152
    s_and_b32 s6, s6, 0xfffff
    buffer_load_dwordx4 v[112:115], v1, s[8:11], s6 offen nt
    s_add_u32 s6, s56, 53248
    s_and_b32 s6, s6, 0xfffff
    buffer_load_dwordx4 v[116:119], v1, s[8:11], s6 offen nt
    s_add_u32 s6, s56, 57344
    s_and_b32 s6, s6, 0xfffff
    buffer_load_dwordx4 v[120:123], v1, s[8:11], s6 offen nt
    s_add_u32 s6, s56, 61440
    s_and_b32 s6, s6, 0xfffff
    buffer_load_dwordx4 v[124:127], v1, s[8:11], s6 offen nt
    s_add_u32 s6, s56, 65536
    s_and_b32 s6, s6, 0xfffff
    buffer_load_dwordx4 a[0:3], v1, s[8:11], s6 offen nt
    s_add_u32 s6, s56, 69632
    s_and_b32 s6, s6, 0xfffff
    buffer_load_dwordx4 a[4:7], v1, s[8:11], s6 offen nt
    s_add_u32 s6, s56, 73728
    s_and_b32 s6, s6, 0xfffff
    buffer_load_dwordx4 a[8:11], v1, s[8:11], s6 offen nt
    s_add_u32 s6, s56, 77824
    s_and_b32 s6, s6, 0xfffff
    buffer_load_dwordx4 a[12:15], v1, s[8:11], s6 offen nt
    s_add_u32 s6, s56, 81920
    s_and_b32 s6, s6, 0xfffff
    buffer_load_dwordx4 a[16:19], v1, s[8:11], s6 offen nt
    s_add_u32 s6, s56, 86016
    s_and_b32 s6, s6, 0xfffff
    buffer_load_dwordx4 a[20:23], v1, s[8:11], s6 offen nt
    s_add_u32 s6, s56, 90112
    s_and_b32 s6, s6, 0xfffff
    buffer_load_dwordx4 a[24:27], v1, s[8:11], s6 offen nt
    s_add_u32 s6, s56, 94208
    s_and_b32 s6, s6, 0xfffff
    buffer_load_dwordx4 a[28:31], v1, s[8:11], s6 offen nt
    s_add_u32 s6, s56, 98304
    s_and_b32 s6, s6, 0xfffff
    buffer_load_dwordx4 a[32:35], v1, s[8:11], s6 offen nt
    s_add_u32 s6, s56, 102400
    s_and_b32 s6, s6, 0xfffff
    buffer_load_dwordx4 a[36:39], v1, s[8:11], s6 offen nt
    s_add_u32 s6, s56, 106496
    s_and_b32 s6, s6, 0xfffff
    buffer_load_dwordx4 a[40:43], v1, s[8:11], s6 offen nt
    s_add_u32 s6, s56, 110592
    s_and_b32 s6, s6, 0xfffff
    buffer_load_dwordx4 a[44:47], v1, s[8:11], s6 offen nt
    v_and_b32 v7, 15, v0
    v_lshlrev_b32 v7, 4, v7
    v_lshrrev_b32 v55, 4, v0
    v_lshl_add_u32 v7, v55, 2, v7
    s_lshl_b32 s7, s5, 9
    v_add_u32 v7, s7, v7
    ds_read_b32 v60, v7 offset:16384
    ds_read_b32 v61, v7 offset:16640
    v_mov_b32 v12, 0
    v_mov_b32 v13, 0
    v_mov_b32 v14, 0
    v_mov_b32 v15, 0
    v_mov_b32 v16, 0
    v_mov_b32 v17, 0
    v_mov_b32 v18, 0
    v_mov_b32 v19, 0
    s_waitcnt lgkmcnt(0)
    v_lshlrev_b32 v62, 16, v60
    v_lshlrev_b32 v63, 16, v61
    s_nop 1
    s_waitcnt vmcnt(59)
    v_dot2c_f32_bf16_dpp v12, v60, v128 row_newbcast:0 row_mask:0xf bank_mask:0xf
    v_dot2c_f32_bf16_dpp v13, v62, v128 row_newbcast:0 row_mask:0xf bank_mask:0xf
    v_dot2c_f32_bf16_dpp v14, v60, v129 row_newbcast:0 row_mask:0xf bank_mask:0xf
    v_dot2c_f32_bf16_dpp v15, v62, v129 row_newbcast:0 row_mask:0xf bank_mask:0xf
    v_dot2c_f32_bf16_dpp v16, v60, v130 row_newbcast:0 row_mask:0xf bank_mask:0xf
    v_dot2c_f32_bf16_dpp v17, v62, v130 row_newbcast:0 row_mask:0xf bank_mask:0xf
    v_dot2c_f32_bf16_dpp v18, v60, v131 row_newbcast:0 row_mask:0xf bank_mask:0xf
    v_dot2c_f32_bf16_dpp v19, v62, v131 row_newbcast:0 row_mask:0xf bank_mask:0xf
    s_add_u32 s6, s56, 114688
    s_and_b32 s6, s6, 0xfffff
    buffer_load_dwordx4 a[48:51], v1, s[8:11], s6 offen nt
    s_waitcnt vmcnt(59)
    v_dot2c_f32_bf16_dpp v12, v60, v132 row_newbcast:1 row_mask:0xf bank_mask:0xf
    v_dot2c_f32_bf16_dpp v13, v62, v132 row_newbcast:1 row_mask:0xf bank_mask:0xf
    v_dot2c_f32_bf16_dpp v14, v60, v133 row_newbcast:1 row_mask:0xf bank_mask:0xf
    v_dot2c_f32_bf16_dpp v15, v62, v133 row_newbcast:1 row_mask:0xf bank_mask:0xf
    v_dot2c_f32_bf16_dpp v16, v60, v134 row_newbcast:1 row_mask:0xf bank_mask:0xf
    v_dot2c_f32_bf16_dpp v17, v62, v134 row_newbcast:1 row_mask:0xf bank_mask:0xf
    v_dot2c_f32_bf16_dpp v18, v60, v135 row_newbcast:1 row_mask:0xf bank_mask:0xf
    v_dot2c_f32_bf16_dpp v19, v62, v135 row_newbcast:1 row_mask:0xf bank_mask:0xf
    s_add_u32 s6, s56, 118784
    s_and_b32 s6, s6, 0xfffff
    buffer_load_dwordx4 a[52:55], v1, s[8:11], s6 offen nt
    s_waitcnt vmcnt(59)
    v_dot2c_f32_bf16_dpp v12, v60, v136 row_newbcast:2 row_mask:0xf bank_mask:0xf
    v_dot2c_f32_bf16_dpp v13, v62, v136 row_newbcast:2 row_mask:0xf bank_mask:0xf
    v_dot2c_f32_bf16_dpp v14, v60, v137 row_newbcast:2 row_mask:0xf bank_mask:0xf
    v_dot2c_f32_bf16_dpp v15, v62, v137 row_newbcast:2 row_mask:0xf bank_mask:0xf
    v_dot2c_f32_bf16_dpp v16, v60, v138 row_newbcast:2 row_mask:0xf bank_mask:0xf
    v_dot2c_f32_bf16_dpp v17, v62, v138 row_newbcast:2 row_mask:0xf bank_mask:0xf
    v_dot2c_f32_bf16_dpp v18, v60, v139 row_newbcast:2 row_mask:0xf bank_mask:0xf
    v_dot2c_f32_bf16_dpp v19, v62, v139 row_newbcast:2 row_mask:0xf bank_mask:0xf
    s_add_u32 s6, s56, 122880
    s_and_b32 s6, s6, 0xfffff
    buffer_load_dwordx4 a[56:59], v1, s[8:11], s6 offen nt
    s_waitcnt vmcnt(59)
    v_dot2c_f32_bf16_dpp v12, v60, v140 row_newbcast:3 row_mask:0xf bank_mask:0xf
    v_dot2c_f32_bf16_dpp v13, v62, v140 row_newbcast:3 row_mask:0xf bank_mask:0xf
    v_dot2c_f32_bf16_dpp v14, v60, v141 row_newbcast:3 row_mask:0xf bank_mask:0xf
    v_dot2c_f32_bf16_dpp v15, v62, v141 row_newbcast:3 row_mask:0xf bank_mask:0xf
    v_dot2c_f32_bf16_dpp v16, v60, v142 row_newbcast:3 row_mask:0xf bank_mask:0xf
    v_dot2c_f32_bf16_dpp v17, v62, v142 row_newbcast:3 row_mask:0xf bank_mask:0xf
    v_dot2c_f32_bf16_dpp v18, v60, v143 row_newbcast:3 row_mask:0xf bank_mask:0xf
    v_dot2c_f32_bf16_dpp v19, v62, v143 row_newbcast:3 row_mask:0xf bank_mask:0xf
    s_add_u32 s6, s56, 126976
    s_and_b32 s6, s6, 0xfffff
    buffer_load_dwordx4 a[60:63], v1, s[8:11], s6 offen nt
    s_waitcnt vmcnt(59)
    v_dot2c_f32_bf16_dpp v12, v60, v144 row_newbcast:4 row_mask:0xf bank_mask:0xf
    v_dot2c_f32_bf16_dpp v13, v62, v144 row_newbcast:4 row_mask:0xf bank_mask:0xf
    v_dot2c_f32_bf16_dpp v14, v60, v145 row_newbcast:4 row_mask:0xf bank_mask:0xf
    v_dot2c_f32_bf16_dpp v15, v62, v145 row_newbcast:4 row_mask:0xf bank_mask:0xf
    v_dot2c_f32_bf16_dpp v16, v60, v146 row_newbcast:4 row_mask:0xf bank_mask:0xf
    v_dot2c_f32_bf16_dpp v17, v62, v146 row_newbcast:4 row_mask:0xf bank_mask:0xf
    v_dot2c_f32_bf16_dpp v18, v60, v147 row_newbcast:4 row_mask:0xf bank_mask:0xf
    v_dot2c_f32_bf16_dpp v19, v62, v147 row_newbcast:4 row_mask:0xf bank_mask:0xf
    s_waitcnt vmcnt(58)
    v_dot2c_f32_bf16_dpp v12, v60, v148 row_newbcast:5 row_mask:0xf bank_mask:0xf
    v_dot2c_f32_bf16_dpp v13, v62, v148 row_newbcast:5 row_mask:0xf bank_mask:0xf
    v_dot2c_f32_bf16_dpp v14, v60, v149 row_newbcast:5 row_mask:0xf bank_mask:0xf
    v_dot2c_f32_bf16_dpp v15, v62, v149 row_newbcast:5 row_mask:0xf bank_mask:0xf
    v_dot2c_f32_bf16_dpp v16, v60, v150 row_newbcast:5 row_mask:0xf bank_mask:0xf
    v_dot2c_f32_bf16_dpp v17, v62, v150 row_newbcast:5 row_mask:0xf bank_mask:0xf
    v_dot2c_f32_bf16_dpp v18, v60, v151 row_newbcast:5 row_mask:0xf bank_mask:0xf
    v_dot2c_f32_bf16_dpp v19, v62, v151 row_newbcast:5 row_mask:0xf bank_mask:0xf
    s_waitcnt vmcnt(57)
    v_dot2c_f32_bf16_dpp v12, v60, v152 row_newbcast:6 row_mask:0xf bank_mask:0xf
    v_dot2c_f32_bf16_dpp v13, v62, v152 row_newbcast:6 row_mask:0xf bank_mask:0xf
    v_dot2c_f32_bf16_dpp v14, v60, v153 row_newbcast:6 row_mask:0xf bank_mask:0xf
    v_dot2c_f32_bf16_dpp v15, v62, v153 row_newbcast:6 row_mask:0xf bank_mask:0xf
    v_dot2c_f32_bf16_dpp v16, v60, v154 row_newbcast:6 row_mask:0xf bank_mask:0xf
    v_dot2c_f32_bf16_dpp v17, v62, v154 row_newbcast:6 row_mask:0xf bank_mask:0xf
    v_dot2c_f32_bf16_dpp v18, v60, v155 row_newbcast:6 row_mask:0xf bank_mask:0xf
    v_dot2c_f32_bf16_dpp v19, v62, v155 row_newbcast:6 row_mask:0xf bank_mask:0xf
    s_waitcnt vmcnt(56)
    v_dot2c_f32_bf16_dpp v12, v60, v156 row_newbcast:7 row_mask:0xf bank_mask:0xf
    v_dot2c_f32_bf16_dpp v13, v62, v156 row_newbcast:7 row_mask:0xf bank_mask:0xf
    v_dot2c_f32_bf16_dpp v14, v60, v157 row_newbcast:7 row_mask:0xf bank_mask:0xf
    v_dot2c_f32_bf16_dpp v15, v62, v157 row_newbcast:7 row_mask:0xf bank_mask:0xf
    v_dot2c_f32_bf16_dpp v16, v60, v158 row_newbcast:7 row_mask:0xf bank_mask:0xf
    v_dot2c_f32_bf16_dpp v17, v62, v158 row_newbcast:7 row_mask:0xf bank_mask:0xf
    v_dot2c_f32_bf16_dpp v18, v60, v159 row_newbcast:7 row_mask:0xf bank_mask:0xf
    v_dot2c_f32_bf16_dpp v19, v62, v159 row_newbcast:7 row_mask:0xf bank_mask:0xf
    s_waitcnt vmcnt(55)
    v_dot2c_f32_bf16_dpp v12, v60, v160 row_newbcast:8 row_mask:0xf bank_mask:0xf
    v_dot2c_f32_bf16_dpp v13, v62, v160 row_newbcast:8 row_mask:0xf bank_mask:0xf
    v_dot2c_f32_bf16_dpp v14, v60, v161 row_newbcast:8 row_mask:0xf bank_mask:0xf
    v_dot2c_f32_bf16_dpp v15, v62, v161 row_newbcast:8 row_mask:0xf bank_mask:0xf
    v_dot2c_f32_bf16_dpp v16, v60, v162 row_newbcast:8 row_mask:0xf bank_mask:0xf
    v_dot2c_f32_bf16_dpp v17, v62, v162 row_newbcast:8 row_mask:0xf bank_mask:0xf
    v_dot2c_f32_bf16_dpp v18, v60, v163 row_newbcast:8 row_mask:0xf bank_mask:0xf
    v_dot2c_f32_bf16_dpp v19, v62, v163 row_newbcast:8 row_mask:0xf bank_mask:0xf
    s_waitcnt vmcnt(54)
    v_dot2c_f32_bf16_dpp v12, v60, v164 row_newbcast:9 row_mask:0xf bank_mask:0xf
    v_dot2c_f32_bf16_dpp v13, v62, v164 row_newbcast:9 row_mask:0xf bank_mask:0xf
    v_dot2c_f32_bf16_dpp v14, v60, v165 row_newbcast:9 row_mask:0xf bank_mask:0xf
    v_dot2c_f32_bf16_dpp v15, v62, v165 row_newbcast:9 row_mask:0xf bank_mask:0xf
    v_dot2c_f32_bf16_dpp v16, v60, v166 row_newbcast:9 row_mask:0xf bank_mask:0xf
    v_dot2c_f32_bf16_dpp v17, v62, v166 row_newbcast:9 row_mask:0xf bank_mask:0xf
    v_dot2c_f32_bf16_dpp v18, v60, v167 row_newbcast:9 row_mask:0xf bank_mask:0xf
    v_dot2c_f32_bf16_dpp v19, v62, v167 row_newbcast:9 row_mask:0xf bank_mask:0xf
    s_waitcnt vmcnt(53)
    v_dot2c_f32_bf16_dpp v12, v60, v168 row_newbcast:10 row_mask:0xf bank_mask:0xf
    v_dot2c_f32_bf16_dpp v13, v62, v168 row_newbcast:10 row_mask:0xf bank_mask:0xf
    v_dot2c_f32_bf16_dpp v14, v60, v169 row_newbcast:10 row_mask:0xf bank_mask:0xf
    v_dot2c_f32_bf16_dpp v15, v62, v169 row_newbcast:10 row_mask:0xf bank_mask:0xf
    v_dot2c_f32_bf16_dpp v16, v60, v170 row_newbcast:10 row_mask:0xf bank_mask:0xf
    v_dot2c_f32_bf16_dpp v17, v62, v170 row_newbcast:10 row_mask:0xf bank_mask:0xf
    v_dot2c_f32_bf16_dpp v18, v60, v171 row_newbcast:10 row_mask:0xf bank_mask:0xf
    v_dot2c_f32_bf16_dpp v19, v62, v171 row_newbcast:10 row_mask:0xf bank_mask:0xf
    s_waitcnt vmcnt(52)
    v_dot2c_f32_bf16_dpp v12, v60, v172 row_newbcast:11 row_mask:0xf bank_mask:0xf
    v_dot2c_f32_bf16_dpp v13, v62, v172 row_newbcast:11 row_mask:0xf bank_mask:0xf
    v_dot2c_f32_bf16_dpp v14, v60, v173 row_newbcast:11 row_mask:0xf bank_mask:0xf
    v_dot2c_f32_bf16_dpp v15, v62, v173 row_newbcast:11 row_mask:0xf bank_mask:0xf
    v_dot2c_f32_bf16_dpp v16, v60, v174 row_newbcast:11 row_mask:0xf bank_mask:0xf
    v_dot2c_f32_bf16_dpp v17, v62, v174 row_newbcast:11 row_mask:0xf bank_mask:0xf
    v_dot2c_f32_bf16_dpp v18, v60, v175 row_newbcast:11 row_mask:0xf bank_mask:0xf
    v_dot2c_f32_bf16_dpp v19, v62, v175 row_newbcast:11 row_mask:0xf bank_mask:0xf
    s_waitcnt vmcnt(51)
    v_dot2c_f32_bf16_dpp v12, v60, v176 row_newbcast:12 row_mask:0xf bank_mask:0xf
    v_dot2c_f32_bf16_dpp v13, v62, v176 row_newbcast:12 row_mask:0xf bank_mask:0xf
    v_dot2c_f32_bf16_dpp v14, v60, v177 row_newbcast:12 row_mask:0xf bank_mask:0xf
    v_dot2c_f32_bf16_dpp v15, v62, v177 row_newbcast:12 row_mask:0xf bank_mask:0xf
    v_dot2c_f32_bf16_dpp v16, v60, v178 row_newbcast:12 row_mask:0xf bank_mask:0xf
    v_dot2c_f32_bf16_dpp v17, v62, v178 row_newbcast:12 row_mask:0xf bank_mask:0xf
    v_dot2c_f32_bf16_dpp v18, v60, v179 row_newbcast:12 row_mask:0xf bank_mask:0xf
    v_dot2c_f32_bf16_dpp v19, v62, v179 row_newbcast:12 row_mask:0xf bank_mask:0xf
    s_waitcnt vmcnt(50)
    v_dot2c_f32_bf16_dpp v12, v60, v180 row_newbcast:13 row_mask:0xf bank_mask:0xf
    v_dot2c_f32_bf16_dpp v13, v62, v180 row_newbcast:13 row_mask:0xf bank_mask:0xf
    v_dot2c_f32_bf16_dpp v14, v60, v181 row_newbcast:13 row_mask:0xf bank_mask:0xf
    v_dot2c_f32_bf16_dpp v15, v62, v181 row_newbcast:13 row_mask:0xf bank_mask:0xf
    v_dot2c_f32_bf16_dpp v16, v60, v182 row_newbcast:13 row_mask:0xf bank_mask:0xf
    v_dot2c_f32_bf16_dpp v17, v62, v182 row_newbcast:13 row_mask:0xf bank_mask:0xf
    v_dot2c_f32_bf16_dpp v18, v60, v183 row_newbcast:13 row_mask:0xf bank_mask:0xf
    v_dot2c_f32_bf16_dpp v19, v62, v183 row_newbcast:13 row_mask:0xf bank_mask:0xf
    s_waitcnt vmcnt(49)
    v_dot2c_f32_bf16_dpp v12, v60, v184 row_newbcast:14 row_mask:0xf bank_mask:0xf
    v_dot2c_f32_bf16_dpp v13, v62, v184 row_newbcast:14 row_mask:0xf bank_mask:0xf
    v_dot2c_f32_bf16_dpp v14, v60, v185 row_newbcast:14 row_mask:0xf bank_mask:0xf
    v_dot2c_f32_bf16_dpp v15, v62, v185 row_newbcast:14 row_mask:0xf bank_mask:0xf
    v_dot2c_f32_bf16_dpp v16, v60, v186 row_newbcast:14 row_mask:0xf bank_mask:0xf
    v_dot2c_f32_bf16_dpp v17, v62, v186 row_newbcast:14 row_mask:0xf bank_mask:0xf
    v_dot2c_f32_bf16_dpp v18, v60, v187 row_newbcast:14 row_mask:0xf bank_mask:0xf
    v_dot2c_f32_bf16_dpp v19, v62, v187 row_newbcast:14 row_mask:0xf bank_mask:0xf
    s_waitcnt vmcnt(48)
    v_dot2c_f32_bf16_dpp v12, v60, v188 row_newbcast:15 row_mask:0xf bank_mask:0xf
    v_dot2c_f32_bf16_dpp v13, v62, v188 row_newbcast:15 row_mask:0xf bank_mask:0xf
    v_dot2c_f32_bf16_dpp v14, v60, v189 row_newbcast:15 row_mask:0xf bank_mask:0xf
    v_dot2c_f32_bf16_dpp v15, v62, v189 row_newbcast:15 row_mask:0xf bank_mask:0xf
    v_dot2c_f32_bf16_dpp v16, v60, v190 row_newbcast:15 row_mask:0xf bank_mask:0xf
    v_dot2c_f32_bf16_dpp v17, v62, v190 row_newbcast:15 row_mask:0xf bank_mask:0xf
    v_dot2c_f32_bf16_dpp v18, v60, v191 row_newbcast:15 row_mask:0xf bank_mask:0xf
    v_dot2c_f32_bf16_dpp v19, v62, v191 row_newbcast:15 row_mask:0xf bank_mask:0xf
    s_waitcnt vmcnt(47)
    v_dot2c_f32_bf16_dpp v12, v61, v192 row_newbcast:0 row_mask:0xf bank_mask:0xf
    v_dot2c_f32_bf16_dpp v13, v63, v192 row_newbcast:0 row_mask:0xf bank_mask:0xf
    v_dot2c_f32_bf16_dpp v14, v61, v193 row_newbcast:0 row_mask:0xf bank_mask:0xf
    v_dot2c_f32_bf16_dpp v15, v63, v193 row_newbcast:0 row_mask:0xf bank_mask:0xf
    v_dot2c_f32_bf16_dpp v16, v61, v194 row_newbcast:0 row_mask:0xf bank_mask:0xf
    v_dot2c_f32_bf16_dpp v17, v63, v194 row_newbcast:0 row_mask:0xf bank_mask:0xf
    v_dot2c_f32_bf16_dpp v18, v61, v195 row_newbcast:0 row_mask:0xf bank_mask:0xf
    v_dot2c_f32_bf16_dpp v19, v63, v195 row_newbcast:0 row_mask:0xf bank_mask:0xf
    s_waitcnt vmcnt(46)
    v_dot2c_f32_bf16_dpp v12, v61, v196 row_newbcast:1 row_mask:0xf bank_mask:0xf
    v_dot2c_f32_bf16_dpp v13, v63, v196 row_newbcast:1 row_mask:0xf bank_mask:0xf
    v_dot2c_f32_bf16_dpp v14, v61, v197 row_newbcast:1 row_mask:0xf bank_mask:0xf
    v_dot2c_f32_bf16_dpp v15, v63, v197 row_newbcast:1 row_mask:0xf bank_mask:0xf
    v_dot2c_f32_bf16_dpp v16, v61, v198 row_newbcast:1 row_mask:0xf bank_mask:0xf
    v_dot2c_f32_bf16_dpp v17, v63, v198 row_newbcast:1 row_mask:0xf bank_mask:0xf
    v_dot2c_f32_bf16_dpp v18, v61, v199 row_newbcast:1 row_mask:0xf bank_mask:0xf
    v_dot2c_f32_bf16_dpp v19, v63, v199 row_newbcast:1 row_mask:0xf bank_mask:0xf
    s_waitcnt vmcnt(45)
    v_dot2c_f32_bf16_dpp v12, v61, v200 row_newbcast:2 row_mask:0xf bank_mask:0xf
    v_dot2c_f32_bf16_dpp v13, v63, v200 row_newbcast:2 row_mask:0xf bank_mask:0xf
    v_dot2c_f32_bf16_dpp v14, v61, v201 row_newbcast:2 row_mask:0xf bank_mask:0xf
    v_dot2c_f32_bf16_dpp v15, v63, v201 row_newbcast:2 row_mask:0xf bank_mask:0xf
    v_dot2c_f32_bf16_dpp v16, v61, v202 row_newbcast:2 row_mask:0xf bank_mask:0xf
    v_dot2c_f32_bf16_dpp v17, v63, v202 row_newbcast:2 row_mask:0xf bank_mask:0xf
    v_dot2c_f32_bf16_dpp v18, v61, v203 row_newbcast:2 row_mask:0xf bank_mask:0xf
    v_dot2c_f32_bf16_dpp v19, v63, v203 row_newbcast:2 row_mask:0xf bank_mask:0xf
    s_waitcnt vmcnt(44)
    v_dot2c_f32_bf16_dpp v12, v61, v204 row_newbcast:3 row_mask:0xf bank_mask:0xf
    v_dot2c_f32_bf16_dpp v13, v63, v204 row_newbcast:3 row_mask:0xf bank_mask:0xf
    v_dot2c_f32_bf16_dpp v14, v61, v205 row_newbcast:3 row_mask:0xf bank_mask:0xf
    v_dot2c_f32_bf16_dpp v15, v63, v205 row_newbcast:3 row_mask:0xf bank_mask:0xf
    v_dot2c_f32_bf16_dpp v16, v61, v206 row_newbcast:3 row_mask:0xf bank_mask:0xf
    v_dot2c_f32_bf16_dpp v17, v63, v206 row_newbcast:3 row_mask:0xf bank_mask:0xf
    v_dot2c_f32_bf16_dpp v18, v61, v207 row_newbcast:3 row_mask:0xf bank_mask:0xf
    v_dot2c_f32_bf16_dpp v19, v63, v207 row_newbcast:3 row_mask:0xf bank_mask:0xf
    s_waitcnt vmcnt(43)
    v_dot2c_f32_bf16_dpp v12, v61, v208 row_newbcast:4 row_mask:0xf bank_mask:0xf
    v_dot2c_f32_bf16_dpp v13, v63, v208 row_newbcast:4 row_mask:0xf bank_mask:0xf
    v_dot2c_f32_bf16_dpp v14, v61, v209 row_newbcast:4 row_mask:0xf bank_mask:0xf
    v_dot2c_f32_bf16_dpp v15, v63, v209 row_newbcast:4 row_mask:0xf bank_mask:0xf
    v_dot2c_f32_bf16_dpp v16, v61, v210 row_newbcast:4 row_mask:0xf bank_mask:0xf
    v_dot2c_f32_bf16_dpp v17, v63, v210 row_newbcast:4 row_mask:0xf bank_mask:0xf
    v_dot2c_f32_bf16_dpp v18, v61, v211 row_newbcast:4 row_mask:0xf bank_mask:0xf
    v_dot2c_f32_bf16_dpp v19, v63, v211 row_newbcast:4 row_mask:0xf bank_mask:0xf
    s_waitcnt vmcnt(42)
    v_dot2c_f32_bf16_dpp v12, v61, v212 row_newbcast:5 row_mask:0xf bank_mask:0xf
    v_dot2c_f32_bf16_dpp v13, v63, v212 row_newbcast:5 row_mask:0xf bank_mask:0xf
    v_dot2c_f32_bf16_dpp v14, v61, v213 row_newbcast:5 row_mask:0xf bank_mask:0xf
    v_dot2c_f32_bf16_dpp v15, v63, v213 row_newbcast:5 row_mask:0xf bank_mask:0xf
    v_dot2c_f32_bf16_dpp v16, v61, v214 row_newbcast:5 row_mask:0xf bank_mask:0xf
    v_dot2c_f32_bf16_dpp v17, v63, v214 row_newbcast:5 row_mask:0xf bank_mask:0xf
    v_dot2c_f32_bf16_dpp v18, v61, v215 row_newbcast:5 row_mask:0xf bank_mask:0xf
    v_dot2c_f32_bf16_dpp v19, v63, v215 row_newbcast:5 row_mask:0xf bank_mask:0xf
    s_waitcnt vmcnt(41)
    v_dot2c_f32_bf16_dpp v12, v61, v216 row_newbcast:6 row_mask:0xf bank_mask:0xf
    v_dot2c_f32_bf16_dpp v13, v63, v216 row_newbcast:6 row_mask:0xf bank_mask:0xf
    v_dot2c_f32_bf16_dpp v14, v61, v217 row_newbcast:6 row_mask:0xf bank_mask:0xf
    v_dot2c_f32_bf16_dpp v15, v63, v217 row_newbcast:6 row_mask:0xf bank_mask:0xf
    v_dot2c_f32_bf16_dpp v16, v61, v218 row_newbcast:6 row_mask:0xf bank_mask:0xf
    v_dot2c_f32_bf16_dpp v17, v63, v218 row_newbcast:6 row_mask:0xf bank_mask:0xf
    v_dot2c_f32_bf16_dpp v18, v61, v219 row_newbcast:6 row_mask:0xf bank_mask:0xf
    v_dot2c_f32_bf16_dpp v19, v63, v219 row_newbcast:6 row_mask:0xf bank_mask:0xf
    s_waitcnt vmcnt(40)
    v_dot2c_f32_bf16_dpp v12, v61, v220 row_newbcast:7 row_mask:0xf bank_mask:0xf
    v_dot2c_f32_bf16_dpp v13, v63, v220 row_newbcast:7 row_mask:0xf bank_mask:0xf
    v_dot2c_f32_bf16_dpp v14, v61, v221 row_newbcast:7 row_mask:0xf bank_mask:0xf
    v_dot2c_f32_bf16_dpp v15, v63, v221 row_newbcast:7 row_mask:0xf bank_mask:0xf
    v_dot2c_f32_bf16_dpp v16, v61, v222 row_newbcast:7 row_mask:0xf bank_mask:0xf
    v_dot2c_f32_bf16_dpp v17, v63, v222 row_newbcast:7 row_mask:0xf bank_mask:0xf
    v_dot2c_f32_bf16_dpp v18, v61, v223 row_newbcast:7 row_mask:0xf bank_mask:0xf
    v_dot2c_f32_bf16_dpp v19, v63, v223 row_newbcast:7 row_mask:0xf bank_mask:0xf
    s_waitcnt vmcnt(39)
    v_dot2c_f32_bf16_dpp v12, v61, v224 row_newbcast:8 row_mask:0xf bank_mask:0xf
    v_dot2c_f32_bf16_dpp v13, v63, v224 row_newbcast:8 row_mask:0xf bank_mask:0xf
    v_dot2c_f32_bf16_dpp v14, v61, v225 row_newbcast:8 row_mask:0xf bank_mask:0xf
    v_dot2c_f32_bf16_dpp v15, v63, v225 row_newbcast:8 row_mask:0xf bank_mask:0xf
    v_dot2c_f32_bf16_dpp v16, v61, v226 row_newbcast:8 row_mask:0xf bank_mask:0xf
    v_dot2c_f32_bf16_dpp v17, v63, v226 row_newbcast:8 row_mask:0xf bank_mask:0xf
    v_dot2c_f32_bf16_dpp v18, v61, v227 row_newbcast:8 row_mask:0xf bank_mask:0xf
    v_dot2c_f32_bf16_dpp v19, v63, v227 row_newbcast:8 row_mask:0xf bank_mask:0xf
    s_waitcnt vmcnt(38)
    v_dot2c_f32_bf16_dpp v12, v61, v228 row_newbcast:9 row_mask:0xf bank_mask:0xf
    v_dot2c_f32_bf16_dpp v13, v63, v228 row_newbcast:9 row_mask:0xf bank_mask:0xf
    v_dot2c_f32_bf16_dpp v14, v61, v229 row_newbcast:9 row_mask:0xf bank_mask:0xf
    v_dot2c_f32_bf16_dpp v15, v63, v229 row_newbcast:9 row_mask:0xf bank_mask:0xf
    v_dot2c_f32_bf16_dpp v16, v61, v230 row_newbcast:9 row_mask:0xf bank_mask:0xf
    v_dot2c_f32_bf16_dpp v17, v63, v230 row_newbcast:9 row_mask:0xf bank_mask:0xf
    v_dot2c_f32_bf16_dpp v18, v61, v231 row_newbcast:9 row_mask:0xf bank_mask:0xf
    v_dot2c_f32_bf16_dpp v19, v63, v231 row_newbcast:9 row_mask:0xf bank_mask:0xf
    s_waitcnt vmcnt(37)
    v_dot2c_f32_bf16_dpp v12, v61, v232 row_newbcast:10 row_mask:0xf bank_mask:0xf
    v_dot2c_f32_bf16_dpp v13, v63, v232 row_newbcast:10 row_mask:0xf bank_mask:0xf
    v_dot2c_f32_bf16_dpp v14, v61, v233 row_newbcast:10 row_mask:0xf bank_mask:0xf
    v_dot2c_f32_bf16_dpp v15, v63, v233 row_newbcast:10 row_mask:0xf bank_mask:0xf
    v_dot2c_f32_bf16_dpp v16, v61, v234 row_newbcast:10 row_mask:0xf bank_mask:0xf
    v_dot2c_f32_bf16_dpp v17, v63, v234 row_newbcast:10 row_mask:0xf bank_mask:0xf
    v_dot2c_f32_bf16_dpp v18, v61, v235 row_newbcast:10 row_mask:0xf bank_mask:0xf
    v_dot2c_f32_bf16_dpp v19, v63, v235 row_newbcast:10 row_mask:0xf bank_mask:0xf
    s_waitcnt vmcnt(36)
    v_dot2c_f32_bf16_dpp v12, v61, v236 row_newbcast:11 row_mask:0xf bank_mask:0xf
    v_dot2c_f32_bf16_dpp v13, v63, v236 row_newbcast:11 row_mask:0xf bank_mask:0xf
    v_dot2c_f32_bf16_dpp v14, v61, v237 row_newbcast:11 row_mask:0xf bank_mask:0xf
    v_dot2c_f32_bf16_dpp v15, v63, v237 row_newbcast:11 row_mask:0xf bank_mask:0xf
    v_dot2c_f32_bf16_dpp v16, v61, v238 row_newbcast:11 row_mask:0xf bank_mask:0xf
    v_dot2c_f32_bf16_dpp v17, v63, v238 row_newbcast:11 row_mask:0xf bank_mask:0xf
    v_dot2c_f32_bf16_dpp v18, v61, v239 row_newbcast:11 row_mask:0xf bank_mask:0xf
    v_dot2c_f32_bf16_dpp v19, v63, v239 row_newbcast:11 row_mask:0xf bank_mask:0xf
    s_waitcnt vmcnt(35)
    v_dot2c_f32_bf16_dpp v12, v61, v240 row_newbcast:12 row_mask:0xf bank_mask:0xf
    v_dot2c_f32_bf16_dpp v13, v63, v240 row_newbcast:12 row_mask:0xf bank_mask:0xf
    v_dot2c_f32_bf16_dpp v14, v61, v241 row_newbcast:12 row_mask:0xf bank_mask:0xf
    v_dot2c_f32_bf16_dpp v15, v63, v241 row_newbcast:12 row_mask:0xf bank_mask:0xf
    v_dot2c_f32_bf16_dpp v16, v61, v242 row_newbcast:12 row_mask:0xf bank_mask:0xf
    v_dot2c_f32_bf16_dpp v17, v63, v242 row_newbcast:12 row_mask:0xf bank_mask:0xf
    v_dot2c_f32_bf16_dpp v18, v61, v243 row_newbcast:12 row_mask:0xf bank_mask:0xf
    v_dot2c_f32_bf16_dpp v19, v63, v243 row_newbcast:12 row_mask:0xf bank_mask:0xf
    s_waitcnt vmcnt(34)
    v_dot2c_f32_bf16_dpp v12, v61, v244 row_newbcast:13 row_mask:0xf bank_mask:0xf
    v_dot2c_f32_bf16_dpp v13, v63, v244 row_newbcast:13 row_mask:0xf bank_mask:0xf
    v_dot2c_f32_bf16_dpp v14, v61, v245 row_newbcast:13 row_mask:0xf bank_mask:0xf
    v_dot2c_f32_bf16_dpp v15, v63, v245 row_newbcast:13 row_mask:0xf bank_mask:0xf
    v_dot2c_f32_bf16_dpp v16, v61, v246 row_newbcast:13 row_mask:0xf bank_mask:0xf
    v_dot2c_f32_bf16_dpp v17, v63, v246 row_newbcast:13 row_mask:0xf bank_mask:0xf
    v_dot2c_f32_bf16_dpp v18, v61, v247 row_newbcast:13 row_mask:0xf bank_mask:0xf
    v_dot2c_f32_bf16_dpp v19, v63, v247 row_newbcast:13 row_mask:0xf bank_mask:0xf
    s_waitcnt vmcnt(33)
    v_dot2c_f32_bf16_dpp v12, v61, v248 row_newbcast:14 row_mask:0xf bank_mask:0xf
    v_dot2c_f32_bf16_dpp v13, v63, v248 row_newbcast:14 row_mask:0xf bank_mask:0xf
    v_dot2c_f32_bf16_dpp v14, v61, v249 row_newbcast:14 row_mask:0xf bank_mask:0xf
    v_dot2c_f32_bf16_dpp v15, v63, v249 row_newbcast:14 row_mask:0xf bank_mask:0xf
    v_dot2c_f32_bf16_dpp v16, v61, v250 row_newbcast:14 row_mask:0xf bank_mask:0xf
    v_dot2c_f32_bf16_dpp v17, v63, v250 row_newbcast:14 row_mask:0xf bank_mask:0xf
    v_dot2c_f32_bf16_dpp v18, v61, v251 row_newbcast:14 row_mask:0xf bank_mask:0xf
    v_dot2c_f32_bf16_dpp v19, v63, v251 row_newbcast:14 row_mask:0xf bank_mask:0xf
    s_waitcnt vmcnt(32)
    v_dot2c_f32_bf16_dpp v12, v61, v252 row_newbcast:15 row_mask:0xf bank_mask:0xf
    v_dot2c_f32_bf16_dpp v13, v63, v252 row_newbcast:15 row_mask:0xf bank_mask:0xf
    v_dot2c_f32_bf16_dpp v14, v61, v253 row_newbcast:15 row_mask:0xf bank_mask:0xf
    v_dot2c_f32_bf16_dpp v15, v63, v253 row_newbcast:15 row_mask:0xf bank_mask:0xf
    v_dot2c_f32_bf16_dpp v16, v61, v254 row_newbcast:15 row_mask:0xf bank_mask:0xf
    v_dot2c_f32_bf16_dpp v17, v63, v254 row_newbcast:15 row_mask:0xf bank_mask:0xf
    v_dot2c_f32_bf16_dpp v18, v61, v255 row_newbcast:15 row_mask:0xf bank_mask:0xf
    v_dot2c_f32_bf16_dpp v19, v63, v255 row_newbcast:15 row_mask:0xf bank_mask:0xf
    s_nop 2
    ds_write_b128 v6, v[12:15] offset:0
    ds_write_b128 v6, v[16:19] offset:16
    s_waitcnt lgkmcnt(0)
    s_barrier
    v_lshrrev_b32 v7, 4, v0
    v_lshlrev_b32 v7, 11, v7
    v_and_b32 v55, 15, v0
    v_lshl_add_u32 v7, v55, 5, v7
    ds_read_b128 v[36:39], v7 offset:0
    ds_read_b128 v[40:43], v7 offset:512
    ds_read_b128 v[44:47], v7 offset:1024
    ds_read_b128 v[48:51], v7 offset:1536
    s_waitcnt lgkmcnt(0)
    v_add_f32 v36, v36, v40
    v_add_f32 v44, v44, v48
    v_add_f32 v37, v37, v41
    v_add_f32 v45, v45, v49
    v_add_f32 v38, v38, v42
    v_add_f32 v46, v46, v50
    v_add_f32 v39, v39, v43
    v_add_f32 v47, v47, v51
    v_add_f32 v12, v36, v44
    v_add_f32 v13, v37, v45
    v_add_f32 v14, v38, v46
    v_add_f32 v15, v39, v47
    ds_read_b128 v[36:39], v7 offset:16
    ds_read_b128 v[40:43], v7 offset:528
    ds_read_b128 v[44:47], v7 offset:1040
    ds_read_b128 v[48:51], v7 offset:1552
    s_waitcnt lgkmcnt(0)
    v_add_f32 v36, v36, v40
    v_add_f32 v44, v44, v48
    v_add_f32 v37, v37, v41
    v_add_f32 v45, v45, v49
    v_add_f32 v38, v38, v42
    v_add_f32 v46, v46, v50
    v_add_f32 v39, v39, v43
    v_add_f32 v47, v47, v51
    v_add_f32 v16, v36, v44
    v_add_f32 v17, v37, v45
    v_add_f32 v18, v38, v46
    v_add_f32 v19, v39, v47
    v_mov_b32 v36, v12
    v_mov_b32 v37, v13
    v_mov_b32 v38, v14
    v_mov_b32 v39, v15
    v_mov_b32 v40, v16
    v_mov_b32 v41, v17
    v_mov_b32 v42, v18
    v_mov_b32 v43, v19
    s_nop 1
    v_permlane16_swap_b32 v36, v12
    v_permlane16_swap_b32 v37, v13
    v_permlane16_swap_b32 v38, v14
    v_permlane16_swap_b32 v39, v15
    v_permlane16_swap_b32 v40, v16
    v_permlane16_swap_b32 v41, v17
    v_permlane16_swap_b32 v42, v18
    v_permlane16_swap_b32 v43, v19
    s_nop 1
    v_add_f32 v12, v12, v36
    v_add_f32 v13, v13, v37
    v_add_f32 v14, v14, v38
    v_add_f32 v15, v15, v39
    v_add_f32 v16, v16, v40
    v_add_f32 v17, v17, v41
    v_add_f32 v18, v18, v42
    v_add_f32 v19, v19, v43
    v_mov_b32 v36, v12
    v_mov_b32 v37, v13
    v_mov_b32 v38, v14
    v_mov_b32 v39, v15
    v_mov_b32 v40, v16
    v_mov_b32 v41, v17
    v_mov_b32 v42, v18
    v_mov_b32 v43, v19
    s_nop 1
    v_permlane32_swap_b32 v36, v12
    v_permlane32_swap_b32 v37, v13
    v_permlane32_swap_b32 v38, v14
    v_permlane32_swap_b32 v39, v15
    v_permlane32_swap_b32 v40, v16
    v_permlane32_swap_b32 v41, v17
    v_permlane32_swap_b32 v42, v18
    v_permlane32_swap_b32 v43, v19
    s_nop 1
    v_add_f32 v12, v12, v36
    v_add_f32 v13, v13, v37
    v_add_f32 v14, v14, v38
    v_add_f32 v15, v15, v39
    v_add_f32 v16, v16, v40
    v_add_f32 v17, v17, v41
    v_add_f32 v18, v18, v42
    v_add_f32 v19, v19, v43
    v_cvt_pk_bf16_f32 v8, v12, v13
    v_cvt_pk_bf16_f32 v9, v14, v15
    v_cvt_pk_bf16_f32 v10, v16, v17
    v_cvt_pk_bf16_f32 v11, v18, v19
    v_lshlrev_b32 v7, 4, v0
    s_cmp_lg_u32 s5, 0
    s_cbranch_scc1 NOINIT_1
    v_mov_b32 v36, -1
    v_mov_b32 v37, -1
    v_mov_b32 v38, -1
    v_mov_b32 v39, -1
    s_lshl_b32 s6, s3, 16
    s_lshl_b32 s7, s4, 11
    s_add_u32 s6, s6, s7
    buffer_store_dwordx4 v[36:39], v7, s[32:35], s6 offen sc0 sc1
    buffer_store_dwordx4 v[36:39], v7, s[32:35], s6 offen offset:1024 sc0 sc1
    s_add_u32 s6, s6, 524288
    buffer_store_dwordx4 v[36:39], v7, s[32:35], s6 offen sc0 sc1
    buffer_store_dwordx4 v[36:39], v7, s[32:35], s6 offen offset:1024 sc0 sc1
    s_add_u32 s6, s6, 524288
    buffer_store_dwordx4 v[36:39], v7, s[32:35], s6 offen sc0 sc1
    buffer_store_dwordx4 v[36:39], v7, s[32:35], s6 offen offset:1024 sc0 sc1
    s_add_u32 s6, s6, 524288
    buffer_store_dwordx4 v[36:39], v7, s[32:35], s6 offen sc0 sc1
    buffer_store_dwordx4 v[36:39], v7, s[32:35], s6 offen offset:1024 sc0 sc1
    s_add_u32 s6, s6, 524288
    buffer_store_dwordx4 v[36:39], v7, s[32:35], s6 offen sc0 sc1
    buffer_store_dwordx4 v[36:39], v7, s[32:35], s6 offen offset:1024 sc0 sc1
    s_add_u32 s6, s6, 524288
    buffer_store_dwordx4 v[36:39], v7, s[32:35], s6 offen sc0 sc1
    buffer_store_dwordx4 v[36:39], v7, s[32:35], s6 offen offset:1024 sc0 sc1
    s_add_u32 s6, s6, 524288
    buffer_store_dwordx4 v[36:39], v7, s[32:35], s6 offen sc0 sc1
    buffer_store_dwordx4 v[36:39], v7, s[32:35], s6 offen offset:1024 sc0 sc1
    s_add_u32 s6, s6, 524288
NOINIT_1:
    s_mov_b32 s57, 0
    s_and_b32 s58, s2, 255
    s_waitcnt vmcnt(31)
    v_dot2_f32_bf16 v36, v64, v8, 0
    v_dot2_f32_bf16 v36, v65, v9, v36
    v_dot2_f32_bf16 v36, v66, v10, v36
    v_dot2_f32_bf16 v36, v67, v11, v36
    s_add_u32 s6, s56, 131072
    s_and_b32 s6, s6, 0xfffff
    s_waitcnt vmcnt(4)
    s_cmp_lt_u32 s3, 4
    s_cbranch_scc1 W_2
    s_waitcnt vmcnt(3)
W_2:
    buffer_load_dwordx4 v[64:67], v1, s[8:11], s6 offen nt
    s_waitcnt vmcnt(31)
    v_dot2_f32_bf16 v37, v68, v8, 0
    v_dot2_f32_bf16 v37, v69, v9, v37
    v_dot2_f32_bf16 v37, v70, v10, v37
    v_dot2_f32_bf16 v37, v71, v11, v37
    s_add_u32 s6, s56, 135168
    s_and_b32 s6, s6, 0xfffff
    s_waitcnt vmcnt(5)
    s_cmp_lt_u32 s3, 4
    s_cbranch_scc1 W_3
    s_waitcnt vmcnt(4)
W_3:
    buffer_load_dwordx4 v[68:71], v1, s[8:11], s6 offen nt
    s_waitcnt vmcnt(31)
    v_dot2_f32_bf16 v38, v72, v8, 0
    v_dot2_f32_bf16 v38, v73, v9, v38
    v_dot2_f32_bf16 v38, v74, v10, v38
    v_dot2_f32_bf16 v38, v75, v11, v38
    s_add_u32 s6, s56, 139264
    s_and_b32 s6, s6, 0xfffff
    s_waitcnt vmcnt(4)
    s_cmp_lt_u32 s3, 4
    s_cbranch_scc1 W_4
    s_waitcnt vmcnt(3)
W_4:
    buffer_load_dwordx4 v[72:75], v1, s[8:11], s6 offen nt
    s_waitcnt vmcnt(31)
    v_dot2_f32_bf16 v39, v76, v8, 0
    v_dot2_f32_bf16 v39, v77, v9, v39
    v_dot2_f32_bf16 v39, v78, v10, v39
    v_dot2_f32_bf16 v39, v79, v11, v39
    s_add_u32 s6, s56, 143360
    s_and_b32 s6, s6, 0xfffff
    s_waitcnt vmcnt(5)
    s_cmp_lt_u32 s3, 4
    s_cbranch_scc1 W_5
    s_waitcnt vmcnt(4)
W_5:
    buffer_load_dwordx4 v[76:79], v1, s[8:11], s6 offen nt
    s_waitcnt vmcnt(31)
    v_dot2_f32_bf16 v40, v80, v8, 0
    v_dot2_f32_bf16 v40, v81, v9, v40
    v_dot2_f32_bf16 v40, v82, v10, v40
    v_dot2_f32_bf16 v40, v83, v11, v40
    s_add_u32 s6, s56, 147456
    s_and_b32 s6, s6, 0xfffff
    s_waitcnt vmcnt(4)
    s_cmp_lt_u32 s3, 4
    s_cbranch_scc1 W_6
    s_waitcnt vmcnt(3)
W_6:
    buffer_load_dwordx4 v[80:83], v1, s[8:11], s6 offen nt
    s_waitcnt vmcnt(31)
    v_dot2_f32_bf16 v41, v84, v8, 0
    v_dot2_f32_bf16 v41, v85, v9, v41
    v_dot2_f32_bf16 v41, v86, v10, v41
    v_dot2_f32_bf16 v41, v87, v11, v41
    s_add_u32 s6, s56, 151552
    s_and_b32 s6, s6, 0xfffff
    s_waitcnt vmcnt(5)
    s_cmp_lt_u32 s3, 4
    s_cbranch_scc1 W_7
    s_waitcnt vmcnt(4)
W_7:
    buffer_load_dwordx4 v[84:87], v1, s[8:11], s6 offen nt
    s_waitcnt vmcnt(31)
    v_dot2_f32_bf16 v42, v88, v8, 0
    v_dot2_f32_bf16 v42, v89, v9, v42
    v_dot2_f32_bf16 v42, v90, v10, v42
    v_dot2_f32_bf16 v42, v91, v11, v42
    s_add_u32 s6, s56, 155648
    s_and_b32 s6, s6, 0xfffff
    s_waitcnt vmcnt(4)
    s_cmp_lt_u32 s3, 4
    s_cbranch_scc1 W_8
    s_waitcnt vmcnt(3)
W_8:
    buffer_load_dwordx4 v[88:91], v1, s[8:11], s6 offen nt
    s_waitcnt vmcnt(31)
    v_dot2_f32_bf16 v43, v92, v8, 0
    v_dot2_f32_bf16 v43, v93, v9, v43
    v_dot2_f32_bf16 v43, v94, v10, v43
    v_dot2_f32_bf16 v43, v95, v11, v43
    s_add_u32 s6, s56, 159744
    s_and_b32 s6, s6, 0xfffff
    s_waitcnt vmcnt(5)
    s_cmp_lt_u32 s3, 4
    s_cbranch_scc1 W_9
    s_waitcnt vmcnt(4)
W_9:
    buffer_load_dwordx4 v[92:95], v1, s[8:11], s6 offen nt
    s_waitcnt vmcnt(31)
    v_dot2_f32_bf16 v44, v96, v8, 0
    v_dot2_f32_bf16 v44, v97, v9, v44
    v_dot2_f32_bf16 v44, v98, v10, v44
    v_dot2_f32_bf16 v44, v99, v11, v44
    s_add_u32 s6, s56, 163840
    s_and_b32 s6, s6, 0xfffff
    s_waitcnt vmcnt(4)
    s_cmp_lt_u32 s3, 4
    s_cbranch_scc1 W_10
    s_waitcnt vmcnt(3)
W_10:
    buffer_load_dwordx4 v[96:99], v1, s[8:11], s6 offen nt
    s_waitcnt vmcnt(31)
    v_dot2_f32_bf16 v45, v100, v8, 0
    v_dot2_f32_bf16 v45, v101, v9, v45
    v_dot2_f32_bf16 v45, v102, v10, v45
    v_dot2_f32_bf16 v45, v103, v11, v45
    s_add_u32 s6, s56, 167936
    s_and_b32 s6, s6, 0xfffff
    s_waitcnt vmcnt(5)
    s_cmp_lt_u32 s3, 4
    s_cbranch_scc1 W_11
    s_waitcnt vmcnt(4)
W_11:
    buffer_load_dwordx4 v[100:103], v1, s[8:11], s6 offen nt
    s_waitcnt vmcnt(31)
    v_dot2_f32_bf16 v46, v104, v8, 0
    v_dot2_f32_bf16 v46, v105, v9, v46
    v_dot2_f32_bf16 v46, v106, v10, v46
    v_dot2_f32_bf16 v46, v107, v11, v46
    s_add_u32 s6, s56, 172032
    s_and_b32 s6, s6, 0xfffff
    s_waitcnt vmcnt(4)
    s_cmp_lt_u32 s3, 4
    s_cbranch_scc1 W_12
    s_waitcnt vmcnt(3)
W_12:
    buffer_load_dwordx4 v[104:107], v1, s[8:11], s6 offen nt
    s_waitcnt vmcnt(31)
    v_dot2_f32_bf16 v47, v108, v8, 0
    v_dot2_f32_bf16 v47, v109, v9, v47
    v_dot2_f32_bf16 v47, v110, v10, v47
    v_dot2_f32_bf16 v47, v111, v11, v47
    s_add_u32 s6, s56, 176128
    s_and_b32 s6, s6, 0xfffff
    s_waitcnt vmcnt(5)
    s_cmp_lt_u32 s3, 4
    s_cbranch_scc1 W_13
    s_waitcnt vmcnt(4)
W_13:
    buffer_load_dwordx4 v[108:111], v1, s[8:11], s6 offen nt
    s_waitcnt vmcnt(31)
    v_dot2_f32_bf16 v48, v112, v8, 0
    v_dot2_f32_bf16 v48, v113, v9, v48
    v_dot2_f32_bf16 v48, v114, v10, v48
    v_dot2_f32_bf16 v48, v115, v11, v48
    s_waitcnt vmcnt(30)
    v_dot2_f32_bf16 v49, v116, v8, 0
    v_dot2_f32_bf16 v49, v117, v9, v49
    v_dot2_f32_bf16 v49, v118, v10, v49
    v_dot2_f32_bf16 v49, v119, v11, v49
    s_waitcnt vmcnt(29)
    v_dot2_f32_bf16 v50, v120, v8, 0
    v_dot2_f32_bf16 v50, v121, v9, v50
    v_dot2_f32_bf16 v50, v122, v10, v50
    v_dot2_f32_bf16 v50, v123, v11, v50
    s_waitcnt vmcnt(28)
    v_dot2_f32_bf16 v51, v124, v8, 0
    v_dot2_f32_bf16 v51, v125, v9, v51
    v_dot2_f32_bf16 v51, v126, v10, v51
    v_dot2_f32_bf16 v51, v127, v11, v51
    s_nop 2
    v_add_f32_dpp v36, v36, v36 row_ror:8 row_mask:0xf bank_mask:0x3
    v_add_f32_dpp v37, v37, v37 row_ror:8 row_mask:0xf bank_mask:0x3
    v_add_f32_dpp v38, v38, v38 row_ror:8 row_mask:0xf bank_mask:0x3
    v_add_f32_dpp v39, v39, v39 row_ror:8 row_mask:0xf bank_mask:0x3
    v_add_f32_dpp v40, v40, v40 row_ror:8 row_mask:0xf bank_mask:0x3
    v_add_f32_dpp v41, v41, v41 row_ror:8 row_mask:0xf bank_mask:0x3
    v_add_f32_dpp v42, v42, v42 row_ror:8 row_mask:0xf bank_mask:0x3
    v_add_f32_dpp v43, v43, v43 row_ror:8 row_mask:0xf bank_mask:0x3
    v_add_f32_dpp v36, v44, v44 row_ror:8 row_mask:0xf bank_mask:0xc
    v_add_f32_dpp v37, v45, v45 row_ror:8 row_mask:0xf bank_mask:0xc
    v_add_f32_dpp v38, v46, v46 row_ror:8 row_mask:0xf bank_mask:0xc
    v_add_f32_dpp v39, v47, v47 row_ror:8 row_mask:0xf bank_mask:0xc
    v_add_f32_dpp v40, v48, v48 row_ror:8 row_mask:0xf bank_mask:0xc
    v_add_f32_dpp v41, v49, v49 row_ror:8 row_mask:0xf bank_mask:0xc
    v_add_f32_dpp v42, v50, v50 row_ror:8 row_mask:0xf bank_mask:0xc
    v_add_f32_dpp v43, v51, v51 row_ror:8 row_mask:0xf bank_mask:0xc
    v_add_f32_dpp v36, v36, v36 row_half_mirror row_mask:0xf bank_mask:0x5
    v_add_f32_dpp v37, v37, v37 row_half_mirror row_mask:0xf bank_mask:0x5
    v_add_f32_dpp v38, v38, v38 row_half_mirror row_mask:0xf bank_mask:0x5
    v_add_f32_dpp v39, v39, v39 row_half_mirror row_mask:0xf bank_mask:0x5
    v_add_f32_dpp v36, v40, v40 row_half_mirror row_mask:0xf bank_mask:0xa
    v_add_f32_dpp v37, v41, v41 row_half_mirror row_mask:0xf bank_mask:0xa
    v_add_f32_dpp v38, v42, v42 row_half_mirror row_mask:0xf bank_mask:0xa
    v_add_f32_dpp v39, v43, v43 row_half_mirror row_mask:0xf bank_mask:0xa
    s_nop 1
    v_add_f32_dpp v36, v36, v36 quad_perm:[2,3,0,1] row_mask:0xf bank_mask:0xf
    v_add_f32_dpp v37, v37, v37 quad_perm:[2,3,0,1] row_mask:0xf bank_mask:0xf
    v_add_f32_dpp v38, v38, v38 quad_perm:[2,3,0,1] row_mask:0xf bank_mask:0xf
    v_add_f32_dpp v39, v39, v39 quad_perm:[2,3,0,1] row_mask:0xf bank_mask:0xf
    v_cndmask_b32 v36, v36, v38, s[72:73]
    v_cndmask_b32 v37, v37, v39, s[72:73]
    s_nop 1
    v_add_f32_dpp v36, v36, v36 quad_perm:[1,0,3,2] row_mask:0xf bank_mask:0xf
    v_add_f32_dpp v37, v37, v37 quad_perm:[1,0,3,2] row_mask:0xf bank_mask:0xf
    v_mov_b32 v20, v21
    v_mov_b32 v21, v22
    v_mov_b32 v22, v23
    v_mov_b32 v23, v24
    v_mov_b32 v24, v25
    v_mov_b32 v25, v26
    v_mov_b32 v26, v27
    v_mov_b32 v27, v28
    v_mov_b32 v28, v29
    v_mov_b32 v29, v30
    v_mov_b32 v30, v31
    v_mov_b32 v31, v32
    v_mov_b32 v32, v33
    v_mov_b32 v33, v34
    v_mov_b32 v34, v35
    v_cndmask_b32 v35, v36, v37, s[74:75]
    s_waitcnt vmcnt(27)
    v_accvgpr_read_b32 v12, a0
    v_accvgpr_read_b32 v13, a1
    v_accvgpr_read_b32 v14, a2
    v_accvgpr_read_b32 v15, a3
    v_dot2_f32_bf16 v36, v12, v8, 0
    v_dot2_f32_bf16 v36, v13, v9, v36
    v_dot2_f32_bf16 v36, v14, v10, v36
    v_dot2_f32_bf16 v36, v15, v11, v36
    s_waitcnt vmcnt(26)
    v_accvgpr_read_b32 v12, a4
    v_accvgpr_read_b32 v13, a5
    v_accvgpr_read_b32 v14, a6
    v_accvgpr_read_b32 v15, a7
    v_dot2_f32_bf16 v37, v12, v8, 0
    v_dot2_f32_bf16 v37, v13, v9, v37
    v_dot2_f32_bf16 v37, v14, v10, v37
    v_dot2_f32_bf16 v37, v15, v11, v37
    s_waitcnt vmcnt(25)
    v_accvgpr_read_b32 v12, a8
    v_accvgpr_read_b32 v13, a9
    v_accvgpr_read_b32 v14, a10
    v_accvgpr_read_b32 v15, a11
    v_dot2_f32_bf16 v38, v12, v8, 0
    v_dot2_f32_bf16 v38, v13, v9, v38
    v_dot2_f32_bf16 v38, v14, v10, v38
    v_dot2_f32_bf16 v38, v15, v11, v38
    s_waitcnt vmcnt(24)
    v_accvgpr_read_b32 v12, a12
    v_accvgpr_read_b32 v13, a13
    v_accvgpr_read_b32 v14, a14
    v_accvgpr_read_b32 v15, a15
    v_dot2_f32_bf16 v39, v12, v8, 0
    v_dot2_f32_bf16 v39, v13, v9, v39
    v_dot2_f32_bf16 v39, v14, v10, v39
    v_dot2_f32_bf16 v39, v15, v11, v39
    s_waitcnt vmcnt(23)
    v_accvgpr_read_b32 v12, a16
    v_accvgpr_read_b32 v13, a17
    v_accvgpr_read_b32 v14, a18
    v_accvgpr_read_b32 v15, a19
    v_dot2_f32_bf16 v40, v12, v8, 0
    v_dot2_f32_bf16 v40, v13, v9, v40
    v_dot2_f32_bf16 v40, v14, v10, v40
    v_dot2_f32_bf16 v40, v15, v11, v40
    s_waitcnt vmcnt(22)
    v_accvgpr_read_b32 v12, a20
    v_accvgpr_read_b32 v13, a21
    v_accvgpr_read_b32 v14, a22
    v_accvgpr_read_b32 v15, a23
    v_dot2_f32_bf16 v41, v12, v8, 0
    v_dot2_f32_bf16 v41, v13, v9, v41
    v_dot2_f32_bf16 v41, v14, v10, v41
    v_dot2_f32_bf16 v41, v15, v11, v41
    s_waitcnt vmcnt(21)
    v_accvgpr_read_b32 v12, a24
    v_accvgpr_read_b32 v13, a25
    v_accvgpr_read_b32 v14, a26
    v_accvgpr_read_b32 v15, a27
    v_dot2_f32_bf16 v42, v12, v8, 0
    v_dot2_f32_bf16 v42, v13, v9, v42
    v_dot2_f32_bf16 v42, v14, v10, v42
    v_dot2_f32_bf16 v42, v15, v11, v42
    s_waitcnt vmcnt(20)
    v_accvgpr_read_b32 v12, a28
    v_accvgpr_read_b32 v13, a29
    v_accvgpr_read_b32 v14, a30
    v_accvgpr_read_b32 v15, a31
    v_dot2_f32_bf16 v43, v12, v8, 0
    v_dot2_f32_bf16 v43, v13, v9, v43
    v_dot2_f32_bf16 v43, v14, v10, v43
    v_dot2_f32_bf16 v43, v15, v11, v43
    s_waitcnt vmcnt(19)
    v_accvgpr_read_b32 v12, a32
    v_accvgpr_read_b32 v13, a33
    v_accvgpr_read_b32 v14, a34
    v_accvgpr_read_b32 v15, a35
    v_dot2_f32_bf16 v44, v12, v8, 0
    v_dot2_f32_bf16 v44, v13, v9, v44
    v_dot2_f32_bf16 v44, v14, v10, v44
    v_dot2_f32_bf16 v44, v15, v11, v44
    s_waitcnt vmcnt(18)
    v_accvgpr_read_b32 v12, a36
    v_accvgpr_read_b32 v13, a37
    v_accvgpr_read_b32 v14, a38
    v_accvgpr_read_b32 v15, a39
    v_dot2_f32_bf16 v45, v12, v8, 0
    v_dot2_f32_bf16 v45, v13, v9, v45
    v_dot2_f32_bf16 v45, v14, v10, v45
    v_dot2_f32_bf16 v45, v15, v11, v45
    s_waitcnt vmcnt(17)
    v_accvgpr_read_b32 v12, a40
    v_accvgpr_read_b32 v13, a41
    v_accvgpr_read_b32 v14, a42
    v_accvgpr_read_b32 v15, a43
    v_dot2_f32_bf16 v46, v12, v8, 0
    v_dot2_f32_bf16 v46, v13, v9, v46
    v_dot2_f32_bf16 v46, v14, v10, v46
    v_dot2_f32_bf16 v46, v15, v11, v46
    s_waitcnt vmcnt(16)
    v_accvgpr_read_b32 v12, a44
    v_accvgpr_read_b32 v13, a45
    v_accvgpr_read_b32 v14, a46
    v_accvgpr_read_b32 v15, a47
    v_dot2_f32_bf16 v47, v12, v8, 0
    v_dot2_f32_bf16 v47, v13, v9, v47
    v_dot2_f32_bf16 v47, v14, v10, v47
    v_dot2_f32_bf16 v47, v15, v11, v47
    s_waitcnt vmcnt(15)
    v_accvgpr_read_b32 v12, a48
    v_accvgpr_read_b32 v13, a49
    v_accvgpr_read_b32 v14, a50
    v_accvgpr_read_b32 v15, a51
    v_dot2_f32_bf16 v48, v12, v8, 0
    v_dot2_f32_bf16 v48, v13, v9, v48
    v_dot2_f32_bf16 v48, v14, v10, v48
    v_dot2_f32_bf16 v48, v15, v11, v48
    s_waitcnt vmcnt(14)
    v_accvgpr_read_b32 v12, a52
    v_accvgpr_read_b32 v13, a53
    v_accvgpr_read_b32 v14, a54
    v_accvgpr_read_b32 v15, a55
    v_dot2_f32_bf16 v49, v12, v8, 0
    v_dot2_f32_bf16 v49, v13, v9, v49
    v_dot2_f32_bf16 v49, v14, v10, v49
    v_dot2_f32_bf16 v49, v15, v11, v49
    s_waitcnt vmcnt(13)
    v_accvgpr_read_b32 v12, a56
    v_accvgpr_read_b32 v13, a57
    v_accvgpr_read_b32 v14, a58
    v_accvgpr_read_b32 v15, a59
    v_dot2_f32_bf16 v50, v12, v8, 0
    v_dot2_f32_bf16 v50, v13, v9, v50
    v_dot2_f32_bf16 v50, v14, v10, v50
    v_dot2_f32_bf16 v50, v15, v11, v50
    s_waitcnt vmcnt(12)
    v_accvgpr_read_b32 v12, a60
    v_accvgpr_read_b32 v13, a61
    v_accvgpr_read_b32 v14, a62
    v_accvgpr_read_b32 v15, a63
    v_dot2_f32_bf16 v51, v12, v8, 0
    v_dot2_f32_bf16 v51, v13, v9, v51
    v_dot2_f32_bf16 v51, v14, v10, v51
    v_dot2_f32_bf16 v51, v15, v11, v51
    s_nop 2
    v_add_f32_dpp v36, v36, v36 row_ror:8 row_mask:0xf bank_mask:0x3
    v_add_f32_dpp v37, v37, v37 row_ror:8 row_mask:0xf bank_mask:0x3
    v_add_f32_dpp v38, v38, v38 row_ror:8 row_mask:0xf bank_mask:0x3
    v_add_f32_dpp v39, v39, v39 row_ror:8 row_mask:0xf bank_mask:0x3
    v_add_f32_dpp v40, v40, v40 row_ror:8 row_mask:0xf bank_mask:0x3
    v_add_f32_dpp v41, v41, v41 row_ror:8 row_mask:0xf bank_mask:0x3
    v_add_f32_dpp v42, v42, v42 row_ror:8 row_mask:0xf bank_mask:0x3
    v_add_f32_dpp v43, v43, v43 row_ror:8 row_mask:0xf bank_mask:0x3
    v_add_f32_dpp v36, v44, v44 row_ror:8 row_mask:0xf bank_mask:0xc
    v_add_f32_dpp v37, v45, v45 row_ror:8 row_mask:0xf bank_mask:0xc
    v_add_f32_dpp v38, v46, v46 row_ror:8 row_mask:0xf bank_mask:0xc
    v_add_f32_dpp v39, v47, v47 row_ror:8 row_mask:0xf bank_mask:0xc
    v_add_f32_dpp v40, v48, v48 row_ror:8 row_mask:0xf bank_mask:0xc
    v_add_f32_dpp v41, v49, v49 row_ror:8 row_mask:0xf bank_mask:0xc
    v_add_f32_dpp v42, v50, v50 row_ror:8 row_mask:0xf bank_mask:0xc
    v_add_f32_dpp v43, v51, v51 row_ror:8 row_mask:0xf bank_mask:0xc
    v_add_f32_dpp v36, v36, v36 row_half_mirror row_mask:0xf bank_mask:0x5
    v_add_f32_dpp v37, v37, v37 row_half_mirror row_mask:0xf bank_mask:0x5
    v_add_f32_dpp v38, v38, v38 row_half_mirror row_mask:0xf bank_mask:0x5
    v_add_f32_dpp v39, v39, v39 row_half_mirror row_mask:0xf bank_mask:0x5
    v_add_f32_dpp v36, v40, v40 row_half_mirror row_mask:0xf bank_mask:0xa
    v_add_f32_dpp v37, v41, v41 row_half_mirror row_mask:0xf bank_mask:0xa
    v_add_f32_dpp v38, v42, v42 row_half_mirror row_mask:0xf bank_mask:0xa
    v_add_f32_dpp v39, v43, v43 row_half_mirror row_mask:0xf bank_mask:0xa
    s_nop 1
    v_add_f32_dpp v36, v36, v36 quad_perm:[2,3,0,1] row_mask:0xf bank_mask:0xf
    v_add_f32_dpp v37, v37, v37 quad_perm:[2,3,0,1] row_mask:0xf bank_mask:0xf
    v_add_f32_dpp v38, v38, v38 quad_perm:[2,3,0,1] row_mask:0xf bank_mask:0xf
    v_add_f32_dpp v39, v39, v39 quad_perm:[2,3,0,1] row_mask:0xf bank_mask:0xf
    v_cndmask_b32 v36, v36, v38, s[72:73]
    v_cndmask_b32 v37, v37, v39, s[72:73]
    s_nop 1
    v_add_f32_dpp v36, v36, v36 quad_perm:[1,0,3,2] row_mask:0xf bank_mask:0xf
    v_add_f32_dpp v37, v37, v37 quad_perm:[1,0,3,2] row_mask:0xf bank_mask:0xf
    v_mov_b32 v20, v21
    v_mov_b32 v21, v22
    v_mov_b32 v22, v23
    v_mov_b32 v23, v24
    v_mov_b32 v24, v25
    v_mov_b32 v25, v26
    v_mov_b32 v26, v27
    v_mov_b32 v27, v28
    v_mov_b32 v28, v29
    v_mov_b32 v29, v30
    v_mov_b32 v30, v31
    v_mov_b32 v31, v32
    v_mov_b32 v32, v33
    v_mov_b32 v33, v34
    v_mov_b32 v34, v35
    v_cndmask_b32 v35, v36, v37, s[74:75]
    s_add_u32 s76, s56, 131072
    s_mov_b32 s77, 13
KLOOP_14:
    s_cmp_gt_u32 s77, 8
    s_cselect_b32 s59, 0, 1
    s_cmp_lt_u32 s3, 4
    s_cselect_b32 s59, s59, 2
    s_waitcnt vmcnt(11)
    v_dot2_f32_bf16 v36, v64, v8, 0
    v_dot2_f32_bf16 v36, v65, v9, v36
    v_dot2_f32_bf16 v36, v66, v10, v36
    v_dot2_f32_bf16 v36, v67, v11, v36
    s_add_u32 s6, s76, 49152
    s_and_b32 s6, s6, 0xfffff
    s_waitcnt vmcnt(4)
    s_cmp_lg_u32 s59, 2
    s_cbranch_scc1 W_15
    s_waitcnt vmcnt(3)
W_15:
    buffer_load_dwordx4 v[112:115], v1, s[8:11], s6 offen nt
    s_waitcnt vmcnt(11)
    v_dot2_f32_bf16 v37, v68, v8, 0
    v_dot2_f32_bf16 v37, v69, v9, v37
    v_dot2_f32_bf16 v37, v70, v10, v37
    v_dot2_f32_bf16 v37, v71, v11, v37
    s_add_u32 s6, s76, 53248
    s_and_b32 s6, s6, 0xfffff
    s_waitcnt vmcnt(5)
    s_cmp_lg_u32 s59, 2
    s_cbranch_scc1 W_16
    s_waitcnt vmcnt(4)
W_16:
    buffer_load_dwordx4 v[116:119], v1, s[8:11], s6 offen nt
    s_waitcnt vmcnt(11)
    v_dot2_f32_bf16 v38, v72, v8, 0
    v_dot2_f32_bf16 v38, v73, v9, v38
    v_dot2_f32_bf16 v38, v74, v10, v38
    v_dot2_f32_bf16 v38, v75, v11, v38
    s_add_u32 s6, s76, 57344
    s_and_b32 s6, s6, 0xfffff
    s_waitcnt vmcnt(4)
    s_cmp_lg_u32 s59, 2
    s_cbranch_scc1 W_17
    s_waitcnt vmcnt(3)
W_17:
    buffer_load_dwordx4 v[120:123], v1, s[8:11], s6 offen nt
    s_waitcnt vmcnt(11)
    v_dot2_f32_bf16 v39, v76, v8, 0
    v_dot2_f32_bf16 v39, v77, v9, v39
    v_dot2_f32_bf16 v39, v78, v10, v39
    v_dot2_f32_bf16 v39, v79, v11, v39
    s_add_u32 s6, s76, 61440
    s_and_b32 s6, s6, 0xfffff
    s_waitcnt vmcnt(5)
    s_cmp_lg_u32 s59, 2
    s_cbranch_scc1 W_18
    s_waitcnt vmcnt(4)
W_18:
    buffer_load_dwordx4 v[124:127], v1, s[8:11], s6 offen nt
    s_waitcnt vmcnt(11)
    v_dot2_f32_bf16 v40, v80, v8, 0
    v_dot2_f32_bf16 v40, v81, v9, v40
    v_dot2_f32_bf16 v40, v82, v10, v40
    v_dot2_f32_bf16 v40, v83, v11, v40
    s_add_u32 s6, s76, 65536
    s_and_b32 s6, s6, 0xfffff
    s_waitcnt vmcnt(4)
    s_cmp_lg_u32 s59, 2
    s_cbranch_scc1 W_19
    s_waitcnt vmcnt(3)
W_19:
    buffer_load_dwordx4 v[64:67], v1, s[8:11], s6 offen nt
    s_waitcnt vmcnt(11)
    v_dot2_f32_bf16 v41, v84, v8, 0
    v_dot2_f32_bf16 v41, v85, v9, v41
    v_dot2_f32_bf16 v41, v86, v10, v41
    v_dot2_f32_bf16 v41, v87, v11, v41
    s_add_u32 s6, s76, 69632
    s_and_b32 s6, s6, 0xfffff
    s_waitcnt vmcnt(5)
    s_cmp_lg_u32 s59, 2
    s_cbranch_scc1 W_20
    s_waitcnt vmcnt(4)
W_20:
    buffer_load_dwordx4 v[68:71], v1, s[8:11], s6 offen nt
    s_waitcnt vmcnt(11)
    v_dot2_f32_bf16 v42, v88, v8, 0
    v_dot2_f32_bf16 v42, v89, v9, v42
    v_dot2_f32_bf16 v42, v90, v10, v42
    v_dot2_f32_bf16 v42, v91, v11, v42
    s_add_u32 s6, s76, 73728
    s_and_b32 s6, s6, 0xfffff
    s_waitcnt vmcnt(4)
    s_cmp_lg_u32 s59, 2
    s_cbranch_scc1 W_21
    s_waitcnt vmcnt(3)
W_21:
    buffer_load_dwordx4 v[72:75], v1, s[8:11], s6 offen nt
    s_waitcnt vmcnt(11)
    v_dot2_f32_bf16 v43, v92, v8, 0
    v_dot2_f32_bf16 v43, v93, v9, v43
    v_dot2_f32_bf16 v43, v94, v10, v43
    v_dot2_f32_bf16 v43, v95, v11, v43
    s_add_u32 s6, s76, 77824
    s_and_b32 s6, s6, 0xfffff
    s_waitcnt vmcnt(5)
    s_cmp_lg_u32 s59, 2
    s_cbranch_scc1 W_22
    s_waitcnt vmcnt(4)
W_22:
    buffer_load_dwordx4 v[76:79], v1, s[8:11], s6 offen nt
    s_waitcnt vmcnt(11)
    v_dot2_f32_bf16 v44, v96, v8, 0
    v_dot2_f32_bf16 v44, v97, v9, v44
    v_dot2_f32_bf16 v44, v98, v10, v44
    v_dot2_f32_bf16 v44, v99, v11, v44
    s_add_u32 s6, s76, 81920
    s_and_b32 s6, s6, 0xfffff
    s_waitcnt vmcnt(4)
    s_cmp_lg_u32 s59, 2
    s_cbranch_scc1 W_23
    s_waitcnt vmcnt(3)
W_23:
    buffer_load_dwordx4 v[80:83], v1, s[8:11], s6 offen nt
    s_waitcnt vmcnt(11)
    v_dot2_f32_bf16 v45, v100, v8, 0
    v_dot2_f32_bf16 v45, v101, v9, v45
    v_dot2_f32_bf16 v45, v102, v10, v45
    v_dot2_f32_bf16 v45, v103, v11, v45
    s_add_u32 s6, s76, 86016
    s_and_b32 s6, s6, 0xfffff
    s_waitcnt vmcnt(5)
    s_cmp_lg_u32 s59, 2
    s_cbranch_scc1 W_24
    s_waitcnt vmcnt(4)
W_24:
    buffer_load_dwordx4 v[84:87], v1, s[8:11], s6 offen nt
    s_waitcnt vmcnt(11)
    v_dot2_f32_bf16 v46, v104, v8, 0
    v_dot2_f32_bf16 v46, v105, v9, v46
    v_dot2_f32_bf16 v46, v106, v10, v46
    v_dot2_f32_bf16 v46, v107, v11, v46
    s_add_u32 s6, s76, 90112
    s_and_b32 s6, s6, 0xfffff
    s_waitcnt vmcnt(4)
    s_cmp_lg_u32 s59, 2
    s_cbranch_scc1 W_25
    s_waitcnt vmcnt(3)
W_25:
    buffer_load_dwordx4 v[88:91], v1, s[8:11], s6 offen nt
    s_waitcnt vmcnt(11)
    v_dot2_f32_bf16 v47, v108, v8, 0
    v_dot2_f32_bf16 v47, v109, v9, v47
    v_dot2_f32_bf16 v47, v110, v10, v47
    v_dot2_f32_bf16 v47, v111, v11, v47
    s_add_u32 s6, s76, 94208
    s_and_b32 s6, s6, 0xfffff
    s_waitcnt vmcnt(5)
    s_cmp_lg_u32 s59, 2
    s_cbranch_scc1 W_26
    s_waitcnt vmcnt(4)
W_26:
    buffer_load_dwordx4 v[92:95], v1, s[8:11], s6 offen nt
    s_waitcnt vmcnt(11)
    v_dot2_f32_bf16 v48, v112, v8, 0
    v_dot2_f32_bf16 v48, v113, v9, v48
    v_dot2_f32_bf16 v48, v114, v10, v48
    v_dot2_f32_bf16 v48, v115, v11, v48
    s_add_u32 s6, s76, 98304
    s_and_b32 s6, s6, 0xfffff
    s_waitcnt vmcnt(4)
    s_cmp_lg_u32 s59, 2
    s_cbranch_scc1 W_27
    s_waitcnt vmcnt(3)
W_27:
    buffer_load_dwordx4 v[96:99], v1, s[8:11], s6 offen nt
    s_waitcnt vmcnt(11)
    v_dot2_f32_bf16 v49, v116, v8, 0
    v_dot2_f32_bf16 v49, v117, v9, v49
    v_dot2_f32_bf16 v49, v118, v10, v49
    v_dot2_f32_bf16 v49, v119, v11, v49
    s_add_u32 s6, s76, 102400
    s_and_b32 s6, s6, 0xfffff
    s_waitcnt vmcnt(5)
    s_cmp_lg_u32 s59, 2
    s_cbranch_scc1 W_28
    s_waitcnt vmcnt(4)
W_28:
    buffer_load_dwordx4 v[100:103], v1, s[8:11], s6 offen nt
    s_waitcnt vmcnt(11)
    v_dot2_f32_bf16 v50, v120, v8, 0
    v_dot2_f32_bf16 v50, v121, v9, v50
    v_dot2_f32_bf16 v50, v122, v10, v50
    v_dot2_f32_bf16 v50, v123, v11, v50
    s_add_u32 s6, s76, 106496
    s_and_b32 s6, s6, 0xfffff
    s_waitcnt vmcnt(4)
    s_cmp_lg_u32 s59, 2
    s_cbranch_scc1 W_29
    s_waitcnt vmcnt(3)
W_29:
    buffer_load_dwordx4 v[104:107], v1, s[8:11], s6 offen nt
    s_waitcnt vmcnt(11)
    v_dot2_f32_bf16 v51, v124, v8, 0
    v_dot2_f32_bf16 v51, v125, v9, v51
    v_dot2_f32_bf16 v51, v126, v10, v51
    v_dot2_f32_bf16 v51, v127, v11, v51
    s_add_u32 s6, s76, 110592
    s_and_b32 s6, s6, 0xfffff
    s_waitcnt vmcnt(5)
    s_cmp_lg_u32 s59, 2
    s_cbranch_scc1 W_30
    s_waitcnt vmcnt(4)
W_30:
    buffer_load_dwordx4 v[108:111], v1, s[8:11], s6 offen nt
    s_nop 2
    v_add_f32_dpp v36, v36, v36 row_ror:8 row_mask:0xf bank_mask:0x3
    v_add_f32_dpp v37, v37, v37 row_ror:8 row_mask:0xf bank_mask:0x3
    v_add_f32_dpp v38, v38, v38 row_ror:8 row_mask:0xf bank_mask:0x3
    v_add_f32_dpp v39, v39, v39 row_ror:8 row_mask:0xf bank_mask:0x3
    v_add_f32_dpp v40, v40, v40 row_ror:8 row_mask:0xf bank_mask:0x3
    v_add_f32_dpp v41, v41, v41 row_ror:8 row_mask:0xf bank_mask:0x3
    v_add_f32_dpp v42, v42, v42 row_ror:8 row_mask:0xf bank_mask:0x3
    v_add_f32_dpp v43, v43, v43 row_ror:8 row_mask:0xf bank_mask:0x3
    v_add_f32_dpp v36, v44, v44 row_ror:8 row_mask:0xf bank_mask:0xc
    v_add_f32_dpp v37, v45, v45 row_ror:8 row_mask:0xf bank_mask:0xc
    v_add_f32_dpp v38, v46, v46 row_ror:8 row_mask:0xf bank_mask:0xc
    v_add_f32_dpp v39, v47, v47 row_ror:8 row_mask:0xf bank_mask:0xc
    v_add_f32_dpp v40, v48, v48 row_ror:8 row_mask:0xf bank_mask:0xc
    v_add_f32_dpp v41, v49, v49 row_ror:8 row_mask:0xf bank_mask:0xc
    v_add_f32_dpp v42, v50, v50 row_ror:8 row_mask:0xf bank_mask:0xc
    v_add_f32_dpp v43, v51, v51 row_ror:8 row_mask:0xf bank_mask:0xc
    v_add_f32_dpp v36, v36, v36 row_half_mirror row_mask:0xf bank_mask:0x5
    v_add_f32_dpp v37, v37, v37 row_half_mirror row_mask:0xf bank_mask:0x5
    v_add_f32_dpp v38, v38, v38 row_half_mirror row_mask:0xf bank_mask:0x5
    v_add_f32_dpp v39, v39, v39 row_half_mirror row_mask:0xf bank_mask:0x5
    v_add_f32_dpp v36, v40, v40 row_half_mirror row_mask:0xf bank_mask:0xa
    v_add_f32_dpp v37, v41, v41 row_half_mirror row_mask:0xf bank_mask:0xa
    v_add_f32_dpp v38, v42, v42 row_half_mirror row_mask:0xf bank_mask:0xa
    v_add_f32_dpp v39, v43, v43 row_half_mirror row_mask:0xf bank_mask:0xa
    s_nop 1
    v_add_f32_dpp v36, v36, v36 quad_perm:[2,3,0,1] row_mask:0xf bank_mask:0xf
    v_add_f32_dpp v37, v37, v37 quad_perm:[2,3,0,1] row_mask:0xf bank_mask:0xf
    v_add_f32_dpp v38, v38, v38 quad_perm:[2,3,0,1] row_mask:0xf bank_mask:0xf
    v_add_f32_dpp v39, v39, v39 quad_perm:[2,3,0,1] row_mask:0xf bank_mask:0xf
    v_cndmask_b32 v36, v36, v38, s[72:73]
    v_cndmask_b32 v37, v37, v39, s[72:73]
    s_nop 1
    v_add_f32_dpp v36, v36, v36 quad_perm:[1,0,3,2] row_mask:0xf bank_mask:0xf
    v_add_f32_dpp v37, v37, v37 quad_perm:[1,0,3,2] row_mask:0xf bank_mask:0xf
    v_mov_b32 v20, v21
    v_mov_b32 v21, v22
    v_mov_b32 v22, v23
    v_mov_b32 v23, v24
    v_mov_b32 v24, v25
    v_mov_b32 v25, v26
    v_mov_b32 v26, v27
    v_mov_b32 v27, v28
    v_mov_b32 v28, v29
    v_mov_b32 v29, v30
    v_mov_b32 v30, v31
    v_mov_b32 v31, v32
    v_mov_b32 v32, v33
    v_mov_b32 v33, v34
    v_mov_b32 v34, v35
    v_cndmask_b32 v35, v36, v37, s[74:75]
    s_add_u32 s76, s76, 65536
    s_sub_u32 s77, s77, 1
    s_cmp_lg_u32 s77, 0
    s_cbranch_scc1 KLOOP_14
    s_waitcnt vmcnt(11)
    v_dot2_f32_bf16 v36, v64, v8, 0
    v_dot2_f32_bf16 v36, v65, v9, v36
    v_dot2_f32_bf16 v36, v66, v10, v36
    v_dot2_f32_bf16 v36, v67, v11, v36
    s_add_u32 s6, s56, 1032192
    s_and_b32 s6, s6, 0xfffff
    s_waitcnt vmcnt(4)
    s_cmp_lt_u32 s3, 4
    s_cbranch_scc1 W_31
    s_waitcnt vmcnt(3)
W_31:
    buffer_load_dwordx4 v[112:115], v1, s[8:11], s6 offen nt
    s_waitcnt vmcnt(11)
    v_dot2_f32_bf16 v37, v68, v8, 0
    v_dot2_f32_bf16 v37, v69, v9, v37
    v_dot2_f32_bf16 v37, v70, v10, v37
    v_dot2_f32_bf16 v37, v71, v11, v37
    s_add_u32 s6, s56, 1036288
    s_and_b32 s6, s6, 0xfffff
    s_waitcnt vmcnt(5)
    s_cmp_lt_u32 s3, 4
    s_cbranch_scc1 W_32
    s_waitcnt vmcnt(4)
W_32:
    buffer_load_dwordx4 v[116:119], v1, s[8:11], s6 offen nt
    s_waitcnt vmcnt(11)
    v_dot2_f32_bf16 v38, v72, v8, 0
    v_dot2_f32_bf16 v38, v73, v9, v38
    v_dot2_f32_bf16 v38, v74, v10, v38
    v_dot2_f32_bf16 v38, v75, v11, v38
    s_add_u32 s6, s56, 1040384
    s_and_b32 s6, s6, 0xfffff
    s_waitcnt vmcnt(4)
    s_cmp_lt_u32 s3, 4
    s_cbranch_scc1 W_33
    s_waitcnt vmcnt(3)
W_33:
    buffer_load_dwordx4 v[120:123], v1, s[8:11], s6 offen nt
    s_waitcnt vmcnt(11)
    v_dot2_f32_bf16 v39, v76, v8, 0
    v_dot2_f32_bf16 v39, v77, v9, v39
    v_dot2_f32_bf16 v39, v78, v10, v39
    v_dot2_f32_bf16 v39, v79, v11, v39
    s_add_u32 s6, s56, 1044480
    s_and_b32 s6, s6, 0xfffff
    s_waitcnt vmcnt(5)
    s_cmp_lt_u32 s3, 4
    s_cbranch_scc1 W_34
    s_waitcnt vmcnt(4)
W_34:
    buffer_load_dwordx4 v[124:127], v1, s[8:11], s6 offen nt
    s_waitcnt vmcnt(11)
    v_dot2_f32_bf16 v40, v80, v8, 0
    v_dot2_f32_bf16 v40, v81, v9, v40
    v_dot2_f32_bf16 v40, v82, v10, v40
    v_dot2_f32_bf16 v40, v83, v11, v40
    s_add_u32 s6, s56, 0
    s_and_b32 s6, s6, 0xfffff
    s_waitcnt vmcnt(4)
    s_cmp_lt_u32 s3, 4
    s_cbranch_scc1 W_35
    s_waitcnt vmcnt(3)
W_35:
    buffer_load_dwordx4 v[64:67], v1, s[12:15], s6 offen nt
    s_waitcnt vmcnt(11)
    v_dot2_f32_bf16 v41, v84, v8, 0
    v_dot2_f32_bf16 v41, v85, v9, v41
    v_dot2_f32_bf16 v41, v86, v10, v41
    v_dot2_f32_bf16 v41, v87, v11, v41
    s_add_u32 s6, s56, 4096
    s_and_b32 s6, s6, 0xfffff
    s_waitcnt vmcnt(5)
    s_cmp_lt_u32 s3, 4
    s_cbranch_scc1 W_36
    s_waitcnt vmcnt(4)
W_36:
    buffer_load_dwordx4 v[68:71], v1, s[12:15], s6 offen nt
    s_waitcnt vmcnt(11)
    v_dot2_f32_bf16 v42, v88, v8, 0
    v_dot2_f32_bf16 v42, v89, v9, v42
    v_dot2_f32_bf16 v42, v90, v10, v42
    v_dot2_f32_bf16 v42, v91, v11, v42
    s_add_u32 s6, s56, 8192
    s_and_b32 s6, s6, 0xfffff
    s_waitcnt vmcnt(4)
    s_cmp_lt_u32 s3, 4
    s_cbranch_scc1 W_37
    s_waitcnt vmcnt(3)
W_37:
    buffer_load_dwordx4 v[72:75], v1, s[12:15], s6 offen nt
    s_waitcnt vmcnt(11)
    v_dot2_f32_bf16 v43, v92, v8, 0
    v_dot2_f32_bf16 v43, v93, v9, v43
    v_dot2_f32_bf16 v43, v94, v10, v43
    v_dot2_f32_bf16 v43, v95, v11, v43
    s_add_u32 s6, s56, 12288
    s_and_b32 s6, s6, 0xfffff
    s_waitcnt vmcnt(5)
    s_cmp_lt_u32 s3, 4
    s_cbranch_scc1 W_38
    s_waitcnt vmcnt(4)
W_38:
    buffer_load_dwordx4 v[76:79], v1, s[12:15], s6 offen nt
    s_waitcnt vmcnt(11)
    v_dot2_f32_bf16 v44, v96, v8, 0
    v_dot2_f32_bf16 v44, v97, v9, v44
    v_dot2_f32_bf16 v44, v98, v10, v44
    v_dot2_f32_bf16 v44, v99, v11, v44
    s_add_u32 s6, s56, 16384
    s_and_b32 s6, s6, 0xfffff
    s_waitcnt vmcnt(4)
    s_cmp_lt_u32 s3, 4
    s_cbranch_scc1 W_39
    s_waitcnt vmcnt(3)
W_39:
    buffer_load_dwordx4 v[80:83], v1, s[12:15], s6 offen nt
    s_waitcnt vmcnt(11)
    v_dot2_f32_bf16 v45, v100, v8, 0
    v_dot2_f32_bf16 v45, v101, v9, v45
    v_dot2_f32_bf16 v45, v102, v10, v45
    v_dot2_f32_bf16 v45, v103, v11, v45
    s_add_u32 s6, s56, 20480
    s_and_b32 s6, s6, 0xfffff
    s_waitcnt vmcnt(5)
    s_cmp_lt_u32 s3, 4
    s_cbranch_scc1 W_40
    s_waitcnt vmcnt(4)
W_40:
    buffer_load_dwordx4 v[84:87], v1, s[12:15], s6 offen nt
    s_waitcnt vmcnt(11)
    v_dot2_f32_bf16 v46, v104, v8, 0
    v_dot2_f32_bf16 v46, v105, v9, v46
    v_dot2_f32_bf16 v46, v106, v10, v46
    v_dot2_f32_bf16 v46, v107, v11, v46
    s_add_u32 s6, s56, 24576
    s_and_b32 s6, s6, 0xfffff
    s_waitcnt vmcnt(4)
    s_cmp_lt_u32 s3, 4
    s_cbranch_scc1 W_41
    s_waitcnt vmcnt(3)
W_41:
    buffer_load_dwordx4 v[88:91], v1, s[12:15], s6 offen nt
    s_waitcnt vmcnt(11)
    v_dot2_f32_bf16 v47, v108, v8, 0
    v_dot2_f32_bf16 v47, v109, v9, v47
    v_dot2_f32_bf16 v47, v110, v10, v47
    v_dot2_f32_bf16 v47, v111, v11, v47
    s_add_u32 s6, s56, 28672
    s_and_b32 s6, s6, 0xfffff
    s_waitcnt vmcnt(5)
    s_cmp_lt_u32 s3, 4
    s_cbranch_scc1 W_42
    s_waitcnt vmcnt(4)
W_42:
    buffer_load_dwordx4 v[92:95], v1, s[12:15], s6 offen nt
    s_waitcnt vmcnt(11)
    v_dot2_f32_bf16 v48, v112, v8, 0
    v_dot2_f32_bf16 v48, v113, v9, v48
    v_dot2_f32_bf16 v48, v114, v10, v48
    v_dot2_f32_bf16 v48, v115, v11, v48
    s_add_u32 s6, s56, 32768
    s_and_b32 s6, s6, 0xfffff
    s_waitcnt vmcnt(4)
    s_cmp_lt_u32 s3, 4
    s_cbranch_scc1 W_43
    s_waitcnt vmcnt(3)
W_43:
    buffer_load_dwordx4 v[96:99], v1, s[12:15], s6 offen nt
    s_waitcnt vmcnt(11)
    v_dot2_f32_bf16 v49, v116, v8, 0
    v_dot2_f32_bf16 v49, v117, v9, v49
    v_dot2_f32_bf16 v49, v118, v10, v49
    v_dot2_f32_bf16 v49, v119, v11, v49
    s_add_u32 s6, s56, 36864
    s_and_b32 s6, s6, 0xfffff
    s_waitcnt vmcnt(5)
    s_cmp_lt_u32 s3, 4
    s_cbranch_scc1 W_44
    s_waitcnt vmcnt(4)
W_44:
    buffer_load_dwordx4 v[100:103], v1, s[12:15], s6 offen nt
    s_waitcnt vmcnt(11)
    v_dot2_f32_bf16 v50, v120, v8, 0
    v_dot2_f32_bf16 v50, v121, v9, v50
    v_dot2_f32_bf16 v50, v122, v10, v50
    v_dot2_f32_bf16 v50, v123, v11, v50
    s_add_u32 s6, s56, 40960
    s_and_b32 s6, s6, 0xfffff
    s_waitcnt vmcnt(4)
    s_cmp_lt_u32 s3, 4
    s_cbranch_scc1 W_45
    s_waitcnt vmcnt(3)
W_45:
    buffer_load_dwordx4 v[104:107], v1, s[12:15], s6 offen nt
    s_waitcnt vmcnt(11)
    v_dot2_f32_bf16 v51, v124, v8, 0
    v_dot2_f32_bf16 v51, v125, v9, v51
    v_dot2_f32_bf16 v51, v126, v10, v51
    v_dot2_f32_bf16 v51, v127, v11, v51
    s_add_u32 s6, s56, 45056
    s_and_b32 s6, s6, 0xfffff
    s_waitcnt vmcnt(5)
    s_cmp_lt_u32 s3, 4
    s_cbranch_scc1 W_46
    s_waitcnt vmcnt(4)
W_46:
    buffer_load_dwordx4 v[108:111], v1, s[12:15], s6 offen nt
    s_nop 2
    v_add_f32_dpp v36, v36, v36 row_ror:8 row_mask:0xf bank_mask:0x3
    v_add_f32_dpp v37, v37, v37 row_ror:8 row_mask:0xf bank_mask:0x3
    v_add_f32_dpp v38, v38, v38 row_ror:8 row_mask:0xf bank_mask:0x3
    v_add_f32_dpp v39, v39, v39 row_ror:8 row_mask:0xf bank_mask:0x3
    v_add_f32_dpp v40, v40, v40 row_ror:8 row_mask:0xf bank_mask:0x3
    v_add_f32_dpp v41, v41, v41 row_ror:8 row_mask:0xf bank_mask:0x3
    v_add_f32_dpp v42, v42, v42 row_ror:8 row_mask:0xf bank_mask:0x3
    v_add_f32_dpp v43, v43, v43 row_ror:8 row_mask:0xf bank_mask:0x3
    v_add_f32_dpp v36, v44, v44 row_ror:8 row_mask:0xf bank_mask:0xc
    v_add_f32_dpp v37, v45, v45 row_ror:8 row_mask:0xf bank_mask:0xc
    v_add_f32_dpp v38, v46, v46 row_ror:8 row_mask:0xf bank_mask:0xc
    v_add_f32_dpp v39, v47, v47 row_ror:8 row_mask:0xf bank_mask:0xc
    v_add_f32_dpp v40, v48, v48 row_ror:8 row_mask:0xf bank_mask:0xc
    v_add_f32_dpp v41, v49, v49 row_ror:8 row_mask:0xf bank_mask:0xc
    v_add_f32_dpp v42, v50, v50 row_ror:8 row_mask:0xf bank_mask:0xc
    v_add_f32_dpp v43, v51, v51 row_ror:8 row_mask:0xf bank_mask:0xc
    v_add_f32_dpp v36, v36, v36 row_half_mirror row_mask:0xf bank_mask:0x5
    v_add_f32_dpp v37, v37, v37 row_half_mirror row_mask:0xf bank_mask:0x5
    v_add_f32_dpp v38, v38, v38 row_half_mirror row_mask:0xf bank_mask:0x5
    v_add_f32_dpp v39, v39, v39 row_half_mirror row_mask:0xf bank_mask:0x5
    v_add_f32_dpp v36, v40, v40 row_half_mirror row_mask:0xf bank_mask:0xa
    v_add_f32_dpp v37, v41, v41 row_half_mirror row_mask:0xf bank_mask:0xa
    v_add_f32_dpp v38, v42, v42 row_half_mirror row_mask:0xf bank_mask:0xa
    v_add_f32_dpp v39, v43, v43 row_half_mirror row_mask:0xf bank_mask:0xa
    s_nop 1
    v_add_f32_dpp v36, v36, v36 quad_perm:[2,3,0,1] row_mask:0xf bank_mask:0xf
    v_add_f32_dpp v37, v37, v37 quad_perm:[2,3,0,1] row_mask:0xf bank_mask:0xf
    v_add_f32_dpp v38, v38, v38 quad_perm:[2,3,0,1] row_mask:0xf bank_mask:0xf
    v_add_f32_dpp v39, v39, v39 quad_perm:[2,3,0,1] row_mask:0xf bank_mask:0xf
    v_cndmask_b32 v36, v36, v38, s[72:73]
    v_cndmask_b32 v37, v37, v39, s[72:73]
    s_nop 1
    v_add_f32_dpp v36, v36, v36 quad_perm:[1,0,3,2] row_mask:0xf bank_mask:0xf
    v_add_f32_dpp v37, v37, v37 quad_perm:[1,0,3,2] row_mask:0xf bank_mask:0xf
    v_mov_b32 v20, v21
    v_mov_b32 v21, v22
    v_mov_b32 v22, v23
    v_mov_b32 v23, v24
    v_mov_b32 v24, v25
    v_mov_b32 v25, v26
    v_mov_b32 v26, v27
    v_mov_b32 v27, v28
    v_mov_b32 v28, v29
    v_mov_b32 v29, v30
    v_mov_b32 v30, v31
    v_mov_b32 v31, v32
    v_mov_b32 v32, v33
    v_mov_b32 v33, v34
    v_mov_b32 v34, v35
    v_cndmask_b32 v35, v36, v37, s[74:75]
    s_cmp_lg_u32 s5, 0
    s_cbranch_scc1 NOSIG_47
    s_lshl_b32 s7, s3, 5
    v_mov_b32 v7, s7
    v_mov_b32 v55, 1
    s_mov_b64 exec, 1
    buffer_atomic_add v55, v7, s[44:47], 0 offen sc1
    s_mov_b64 exec, -1
NOSIG_47:
    s_mov_b32 s80, 0x3e0293ee
    v_max3_f32 v60, v20, v21, v22
    v_max3_f32 v60, v60, v23, v24
    v_max3_f32 v60, v60, v25, v26
    v_max3_f32 v60, v60, v27, v28
    v_max3_f32 v60, v60, v29, v30
    v_max3_f32 v60, v60, v31, v32
    v_max3_f32 v60, v60, v33, v34
    v_max_f32 v60, v60, v35
    s_nop 1
    v_max_f32_dpp v60, v60, v60 row_ror:8 row_mask:0xf bank_mask:0xf
    s_nop 1
    v_max_f32_dpp v60, v60, v60 row_ror:4 row_mask:0xf bank_mask:0xf
    s_nop 1
    v_max_f32_dpp v60, v60, v60 row_ror:2 row_mask:0xf bank_mask:0xf
    s_nop 1
    v_max_f32_dpp v60, v60, v60 row_ror:1 row_mask:0xf bank_mask:0xf
    v_mov_b32 v61, v60
    s_nop 1
    v_permlane16_swap_b32 v61, v60
    s_nop 1
    v_max_f32 v60, v60, v61
    v_mov_b32 v61, v60
    s_nop 1
    v_permlane32_swap_b32 v61, v60
    s_nop 1
    v_max_f32 v60, v60, v61
    v_mul_f32 v60, s80, v60
    v_fma_f32 v20, v20, s80, -v60
    v_fma_f32 v21, v21, s80, -v60
    v_fma_f32 v22, v22, s80, -v60
    v_fma_f32 v23, v23, s80, -v60
    v_fma_f32 v24, v24, s80, -v60
    v_fma_f32 v25, v25, s80, -v60
    v_fma_f32 v26, v26, s80, -v60
    v_fma_f32 v27, v27, s80, -v60
    v_fma_f32 v28, v28, s80, -v60
    v_fma_f32 v29, v29, s80, -v60
    v_fma_f32 v30, v30, s80, -v60
    v_fma_f32 v31, v31, s80, -v60
    v_fma_f32 v32, v32, s80, -v60
    v_fma_f32 v33, v33, s80, -v60
    v_fma_f32 v34, v34, s80, -v60
    v_fma_f32 v35, v35, s80, -v60
    v_exp_f32 v20, v20
    v_exp_f32 v21, v21
    v_exp_f32 v22, v22
    v_exp_f32 v23, v23
    v_exp_f32 v24, v24
    v_exp_f32 v25, v25
    v_exp_f32 v26, v26
    v_exp_f32 v27, v27
    v_exp_f32 v28, v28
    v_exp_f32 v29, v29
    v_exp_f32 v30, v30
    v_exp_f32 v31, v31
    v_exp_f32 v32, v32
    v_exp_f32 v33, v33
    v_exp_f32 v34, v34
    v_exp_f32 v35, v35
    s_nop 0
    v_cvt_pk_bf16_f32 v20, v20, 0
    v_cvt_pk_bf16_f32 v21, v21, 0
    v_cvt_pk_bf16_f32 v22, v22, 0
    v_cvt_pk_bf16_f32 v23, v23, 0
    v_cvt_pk_bf16_f32 v24, v24, 0
    v_cvt_pk_bf16_f32 v25, v25, 0
    v_cvt_pk_bf16_f32 v26, v26, 0
    v_cvt_pk_bf16_f32 v27, v27, 0
    v_cvt_pk_bf16_f32 v28, v28, 0
    v_cvt_pk_bf16_f32 v29, v29, 0
    v_cvt_pk_bf16_f32 v30, v30, 0
    v_cvt_pk_bf16_f32 v31, v31, 0
    v_cvt_pk_bf16_f32 v32, v32, 0
    v_cvt_pk_bf16_f32 v33, v33, 0
    v_cvt_pk_bf16_f32 v34, v34, 0
    v_cvt_pk_bf16_f32 v35, v35, 0
    v_mov_b32 v61, 0
    v_lshlrev_b32 v62, 16, v20
    v_add_f32 v61, v61, v62
    v_lshlrev_b32 v62, 16, v21
    v_add_f32 v61, v61, v62
    v_lshlrev_b32 v62, 16, v22
    v_add_f32 v61, v61, v62
    v_lshlrev_b32 v62, 16, v23
    v_add_f32 v61, v61, v62
    v_lshlrev_b32 v62, 16, v24
    v_add_f32 v61, v61, v62
    v_lshlrev_b32 v62, 16, v25
    v_add_f32 v61, v61, v62
    v_lshlrev_b32 v62, 16, v26
    v_add_f32 v61, v61, v62
    v_lshlrev_b32 v62, 16, v27
    v_add_f32 v61, v61, v62
    v_lshlrev_b32 v62, 16, v28
    v_add_f32 v61, v61, v62
    v_lshlrev_b32 v62, 16, v29
    v_add_f32 v61, v61, v62
    v_lshlrev_b32 v62, 16, v30
    v_add_f32 v61, v61, v62
    v_lshlrev_b32 v62, 16, v31
    v_add_f32 v61, v61, v62
    v_lshlrev_b32 v62, 16, v32
    v_add_f32 v61, v61, v62
    v_lshlrev_b32 v62, 16, v33
    v_add_f32 v61, v61, v62
    v_lshlrev_b32 v62, 16, v34
    v_add_f32 v61, v61, v62
    v_lshlrev_b32 v62, 16, v35
    v_add_f32 v61, v61, v62
    s_nop 1
    v_add_f32_dpp v61, v61, v61 row_ror:8 row_mask:0xf bank_mask:0xf
    s_nop 1
    v_add_f32_dpp v61, v61, v61 row_ror:4 row_mask:0xf bank_mask:0xf
    s_nop 1
    v_add_f32_dpp v61, v61, v61 row_ror:2 row_mask:0xf bank_mask:0xf
    s_nop 1
    v_add_f32_dpp v61, v61, v61 row_ror:1 row_mask:0xf bank_mask:0xf
    v_mov_b32 v62, v61
    s_nop 1
    v_permlane16_swap_b32 v62, v61
    s_nop 1
    v_add_f32 v61, v61, v62
    v_mov_b32 v62, v61
    s_nop 1
    v_permlane32_swap_b32 v62, v61
    s_nop 1
    v_add_f32 v61, v61, v62
    v_mov_b32 v12, 0
    v_mov_b32 v13, 0
    v_mov_b32 v14, 0
    v_mov_b32 v15, 0
    v_mov_b32 v16, 0
    v_mov_b32 v17, 0
    v_mov_b32 v18, 0
    v_mov_b32 v19, 0
    v_lshlrev_b32 v52, 16, v20
    s_nop 1
    s_waitcnt vmcnt(11)
    v_dot2c_f32_bf16_dpp v12, v20, v64 row_newbcast:0 row_mask:0xf bank_mask:0xf
    v_dot2c_f32_bf16_dpp v13, v52, v64 row_newbcast:0 row_mask:0xf bank_mask:0xf
    v_dot2c_f32_bf16_dpp v14, v20, v65 row_newbcast:0 row_mask:0xf bank_mask:0xf
    v_dot2c_f32_bf16_dpp v15, v52, v65 row_newbcast:0 row_mask:0xf bank_mask:0xf
    v_dot2c_f32_bf16_dpp v16, v20, v66 row_newbcast:0 row_mask:0xf bank_mask:0xf
    v_dot2c_f32_bf16_dpp v17, v52, v66 row_newbcast:0 row_mask:0xf bank_mask:0xf
    v_dot2c_f32_bf16_dpp v18, v20, v67 row_newbcast:0 row_mask:0xf bank_mask:0xf
    v_dot2c_f32_bf16_dpp v19, v52, v67 row_newbcast:0 row_mask:0xf bank_mask:0xf
    s_add_u32 s6, s56, 49152
    s_and_b32 s6, s6, 0xfffff
    s_waitcnt vmcnt(4)
    s_cmp_lt_u32 s3, 4
    s_cbranch_scc1 W_48
    s_waitcnt vmcnt(3)
W_48:
    buffer_load_dwordx4 v[112:115], v1, s[12:15], s6 offen nt
    s_waitcnt vmcnt(11)
    v_dot2c_f32_bf16_dpp v12, v20, v68 row_newbcast:1 row_mask:0xf bank_mask:0xf
    v_dot2c_f32_bf16_dpp v13, v52, v68 row_newbcast:1 row_mask:0xf bank_mask:0xf
    v_dot2c_f32_bf16_dpp v14, v20, v69 row_newbcast:1 row_mask:0xf bank_mask:0xf
    v_dot2c_f32_bf16_dpp v15, v52, v69 row_newbcast:1 row_mask:0xf bank_mask:0xf
    v_dot2c_f32_bf16_dpp v16, v20, v70 row_newbcast:1 row_mask:0xf bank_mask:0xf
    v_dot2c_f32_bf16_dpp v17, v52, v70 row_newbcast:1 row_mask:0xf bank_mask:0xf
    v_dot2c_f32_bf16_dpp v18, v20, v71 row_newbcast:1 row_mask:0xf bank_mask:0xf
    v_dot2c_f32_bf16_dpp v19, v52, v71 row_newbcast:1 row_mask:0xf bank_mask:0xf
    s_add_u32 s6, s56, 53248
    s_and_b32 s6, s6, 0xfffff
    s_waitcnt vmcnt(5)
    s_cmp_lt_u32 s3, 4
    s_cbranch_scc1 W_49
    s_waitcnt vmcnt(4)
W_49:
    buffer_load_dwordx4 v[116:119], v1, s[12:15], s6 offen nt
    s_waitcnt vmcnt(11)
    v_dot2c_f32_bf16_dpp v12, v20, v72 row_newbcast:2 row_mask:0xf bank_mask:0xf
    v_dot2c_f32_bf16_dpp v13, v52, v72 row_newbcast:2 row_mask:0xf bank_mask:0xf
    v_dot2c_f32_bf16_dpp v14, v20, v73 row_newbcast:2 row_mask:0xf bank_mask:0xf
    v_dot2c_f32_bf16_dpp v15, v52, v73 row_newbcast:2 row_mask:0xf bank_mask:0xf
    v_dot2c_f32_bf16_dpp v16, v20, v74 row_newbcast:2 row_mask:0xf bank_mask:0xf
    v_dot2c_f32_bf16_dpp v17, v52, v74 row_newbcast:2 row_mask:0xf bank_mask:0xf
    v_dot2c_f32_bf16_dpp v18, v20, v75 row_newbcast:2 row_mask:0xf bank_mask:0xf
    v_dot2c_f32_bf16_dpp v19, v52, v75 row_newbcast:2 row_mask:0xf bank_mask:0xf
    s_add_u32 s6, s56, 57344
    s_and_b32 s6, s6, 0xfffff
    s_waitcnt vmcnt(4)
    s_cmp_lt_u32 s3, 4
    s_cbranch_scc1 W_50
    s_waitcnt vmcnt(3)
W_50:
    buffer_load_dwordx4 v[120:123], v1, s[12:15], s6 offen nt
    s_waitcnt vmcnt(11)
    v_dot2c_f32_bf16_dpp v12, v20, v76 row_newbcast:3 row_mask:0xf bank_mask:0xf
    v_dot2c_f32_bf16_dpp v13, v52, v76 row_newbcast:3 row_mask:0xf bank_mask:0xf
    v_dot2c_f32_bf16_dpp v14, v20, v77 row_newbcast:3 row_mask:0xf bank_mask:0xf
    v_dot2c_f32_bf16_dpp v15, v52, v77 row_newbcast:3 row_mask:0xf bank_mask:0xf
    v_dot2c_f32_bf16_dpp v16, v20, v78 row_newbcast:3 row_mask:0xf bank_mask:0xf
    v_dot2c_f32_bf16_dpp v17, v52, v78 row_newbcast:3 row_mask:0xf bank_mask:0xf
    v_dot2c_f32_bf16_dpp v18, v20, v79 row_newbcast:3 row_mask:0xf bank_mask:0xf
    v_dot2c_f32_bf16_dpp v19, v52, v79 row_newbcast:3 row_mask:0xf bank_mask:0xf
    s_add_u32 s6, s56, 61440
    s_and_b32 s6, s6, 0xfffff
    s_waitcnt vmcnt(5)
    s_cmp_lt_u32 s3, 4
    s_cbranch_scc1 W_51
    s_waitcnt vmcnt(4)
W_51:
    buffer_load_dwordx4 v[124:127], v1, s[12:15], s6 offen nt
    s_waitcnt vmcnt(11)
    v_dot2c_f32_bf16_dpp v12, v20, v80 row_newbcast:4 row_mask:0xf bank_mask:0xf
    v_dot2c_f32_bf16_dpp v13, v52, v80 row_newbcast:4 row_mask:0xf bank_mask:0xf
    v_dot2c_f32_bf16_dpp v14, v20, v81 row_newbcast:4 row_mask:0xf bank_mask:0xf
    v_dot2c_f32_bf16_dpp v15, v52, v81 row_newbcast:4 row_mask:0xf bank_mask:0xf
    v_dot2c_f32_bf16_dpp v16, v20, v82 row_newbcast:4 row_mask:0xf bank_mask:0xf
    v_dot2c_f32_bf16_dpp v17, v52, v82 row_newbcast:4 row_mask:0xf bank_mask:0xf
    v_dot2c_f32_bf16_dpp v18, v20, v83 row_newbcast:4 row_mask:0xf bank_mask:0xf
    v_dot2c_f32_bf16_dpp v19, v52, v83 row_newbcast:4 row_mask:0xf bank_mask:0xf
    s_add_u32 s6, s56, 65536
    s_and_b32 s6, s6, 0xfffff
    s_waitcnt vmcnt(4)
    s_cmp_lt_u32 s3, 4
    s_cbranch_scc1 W_52
    s_waitcnt vmcnt(3)
W_52:
    buffer_load_dwordx4 v[64:67], v1, s[12:15], s6 offen nt
    s_waitcnt vmcnt(11)
    v_dot2c_f32_bf16_dpp v12, v20, v84 row_newbcast:5 row_mask:0xf bank_mask:0xf
    v_dot2c_f32_bf16_dpp v13, v52, v84 row_newbcast:5 row_mask:0xf bank_mask:0xf
    v_dot2c_f32_bf16_dpp v14, v20, v85 row_newbcast:5 row_mask:0xf bank_mask:0xf
    v_dot2c_f32_bf16_dpp v15, v52, v85 row_newbcast:5 row_mask:0xf bank_mask:0xf
    v_dot2c_f32_bf16_dpp v16, v20, v86 row_newbcast:5 row_mask:0xf bank_mask:0xf
    v_dot2c_f32_bf16_dpp v17, v52, v86 row_newbcast:5 row_mask:0xf bank_mask:0xf
    v_dot2c_f32_bf16_dpp v18, v20, v87 row_newbcast:5 row_mask:0xf bank_mask:0xf
    v_dot2c_f32_bf16_dpp v19, v52, v87 row_newbcast:5 row_mask:0xf bank_mask:0xf
    s_add_u32 s6, s56, 69632
    s_and_b32 s6, s6, 0xfffff
    s_waitcnt vmcnt(5)
    s_cmp_lt_u32 s3, 4
    s_cbranch_scc1 W_53
    s_waitcnt vmcnt(4)
W_53:
    buffer_load_dwordx4 v[68:71], v1, s[12:15], s6 offen nt
    s_waitcnt vmcnt(11)
    v_dot2c_f32_bf16_dpp v12, v20, v88 row_newbcast:6 row_mask:0xf bank_mask:0xf
    v_dot2c_f32_bf16_dpp v13, v52, v88 row_newbcast:6 row_mask:0xf bank_mask:0xf
    v_dot2c_f32_bf16_dpp v14, v20, v89 row_newbcast:6 row_mask:0xf bank_mask:0xf
    v_dot2c_f32_bf16_dpp v15, v52, v89 row_newbcast:6 row_mask:0xf bank_mask:0xf
    v_dot2c_f32_bf16_dpp v16, v20, v90 row_newbcast:6 row_mask:0xf bank_mask:0xf
    v_dot2c_f32_bf16_dpp v17, v52, v90 row_newbcast:6 row_mask:0xf bank_mask:0xf
    v_dot2c_f32_bf16_dpp v18, v20, v91 row_newbcast:6 row_mask:0xf bank_mask:0xf
    v_dot2c_f32_bf16_dpp v19, v52, v91 row_newbcast:6 row_mask:0xf bank_mask:0xf
    s_add_u32 s6, s56, 73728
    s_and_b32 s6, s6, 0xfffff
    s_waitcnt vmcnt(4)
    s_cmp_lt_u32 s3, 4
    s_cbranch_scc1 W_54
    s_waitcnt vmcnt(3)
W_54:
    buffer_load_dwordx4 v[72:75], v1, s[12:15], s6 offen nt
    s_waitcnt vmcnt(11)
    v_dot2c_f32_bf16_dpp v12, v20, v92 row_newbcast:7 row_mask:0xf bank_mask:0xf
    v_dot2c_f32_bf16_dpp v13, v52, v92 row_newbcast:7 row_mask:0xf bank_mask:0xf
    v_dot2c_f32_bf16_dpp v14, v20, v93 row_newbcast:7 row_mask:0xf bank_mask:0xf
    v_dot2c_f32_bf16_dpp v15, v52, v93 row_newbcast:7 row_mask:0xf bank_mask:0xf
    v_dot2c_f32_bf16_dpp v16, v20, v94 row_newbcast:7 row_mask:0xf bank_mask:0xf
    v_dot2c_f32_bf16_dpp v17, v52, v94 row_newbcast:7 row_mask:0xf bank_mask:0xf
    v_dot2c_f32_bf16_dpp v18, v20, v95 row_newbcast:7 row_mask:0xf bank_mask:0xf
    v_dot2c_f32_bf16_dpp v19, v52, v95 row_newbcast:7 row_mask:0xf bank_mask:0xf
    s_add_u32 s6, s56, 77824
    s_and_b32 s6, s6, 0xfffff
    s_waitcnt vmcnt(5)
    s_cmp_lt_u32 s3, 4
    s_cbranch_scc1 W_55
    s_waitcnt vmcnt(4)
W_55:
    buffer_load_dwordx4 v[76:79], v1, s[12:15], s6 offen nt
    s_waitcnt vmcnt(11)
    v_dot2c_f32_bf16_dpp v12, v20, v96 row_newbcast:8 row_mask:0xf bank_mask:0xf
    v_dot2c_f32_bf16_dpp v13, v52, v96 row_newbcast:8 row_mask:0xf bank_mask:0xf
    v_dot2c_f32_bf16_dpp v14, v20, v97 row_newbcast:8 row_mask:0xf bank_mask:0xf
    v_dot2c_f32_bf16_dpp v15, v52, v97 row_newbcast:8 row_mask:0xf bank_mask:0xf
    v_dot2c_f32_bf16_dpp v16, v20, v98 row_newbcast:8 row_mask:0xf bank_mask:0xf
    v_dot2c_f32_bf16_dpp v17, v52, v98 row_newbcast:8 row_mask:0xf bank_mask:0xf
    v_dot2c_f32_bf16_dpp v18, v20, v99 row_newbcast:8 row_mask:0xf bank_mask:0xf
    v_dot2c_f32_bf16_dpp v19, v52, v99 row_newbcast:8 row_mask:0xf bank_mask:0xf
    s_add_u32 s6, s56, 81920
    s_and_b32 s6, s6, 0xfffff
    s_waitcnt vmcnt(4)
    s_cmp_lt_u32 s3, 4
    s_cbranch_scc1 W_56
    s_waitcnt vmcnt(3)
W_56:
    buffer_load_dwordx4 v[80:83], v1, s[12:15], s6 offen nt
    s_waitcnt vmcnt(11)
    v_dot2c_f32_bf16_dpp v12, v20, v100 row_newbcast:9 row_mask:0xf bank_mask:0xf
    v_dot2c_f32_bf16_dpp v13, v52, v100 row_newbcast:9 row_mask:0xf bank_mask:0xf
    v_dot2c_f32_bf16_dpp v14, v20, v101 row_newbcast:9 row_mask:0xf bank_mask:0xf
    v_dot2c_f32_bf16_dpp v15, v52, v101 row_newbcast:9 row_mask:0xf bank_mask:0xf
    v_dot2c_f32_bf16_dpp v16, v20, v102 row_newbcast:9 row_mask:0xf bank_mask:0xf
    v_dot2c_f32_bf16_dpp v17, v52, v102 row_newbcast:9 row_mask:0xf bank_mask:0xf
    v_dot2c_f32_bf16_dpp v18, v20, v103 row_newbcast:9 row_mask:0xf bank_mask:0xf
    v_dot2c_f32_bf16_dpp v19, v52, v103 row_newbcast:9 row_mask:0xf bank_mask:0xf
    s_add_u32 s6, s56, 86016
    s_and_b32 s6, s6, 0xfffff
    s_waitcnt vmcnt(5)
    s_cmp_lt_u32 s3, 4
    s_cbranch_scc1 W_57
    s_waitcnt vmcnt(4)
W_57:
    buffer_load_dwordx4 v[84:87], v1, s[12:15], s6 offen nt
    s_waitcnt vmcnt(11)
    v_dot2c_f32_bf16_dpp v12, v20, v104 row_newbcast:10 row_mask:0xf bank_mask:0xf
    v_dot2c_f32_bf16_dpp v13, v52, v104 row_newbcast:10 row_mask:0xf bank_mask:0xf
    v_dot2c_f32_bf16_dpp v14, v20, v105 row_newbcast:10 row_mask:0xf bank_mask:0xf
    v_dot2c_f32_bf16_dpp v15, v52, v105 row_newbcast:10 row_mask:0xf bank_mask:0xf
    v_dot2c_f32_bf16_dpp v16, v20, v106 row_newbcast:10 row_mask:0xf bank_mask:0xf
    v_dot2c_f32_bf16_dpp v17, v52, v106 row_newbcast:10 row_mask:0xf bank_mask:0xf
    v_dot2c_f32_bf16_dpp v18, v20, v107 row_newbcast:10 row_mask:0xf bank_mask:0xf
    v_dot2c_f32_bf16_dpp v19, v52, v107 row_newbcast:10 row_mask:0xf bank_mask:0xf
    s_add_u32 s6, s56, 90112
    s_and_b32 s6, s6, 0xfffff
    s_waitcnt vmcnt(4)
    s_cmp_lt_u32 s3, 4
    s_cbranch_scc1 W_58
    s_waitcnt vmcnt(3)
W_58:
    buffer_load_dwordx4 v[88:91], v1, s[12:15], s6 offen nt
    s_waitcnt vmcnt(11)
    v_dot2c_f32_bf16_dpp v12, v20, v108 row_newbcast:11 row_mask:0xf bank_mask:0xf
    v_dot2c_f32_bf16_dpp v13, v52, v108 row_newbcast:11 row_mask:0xf bank_mask:0xf
    v_dot2c_f32_bf16_dpp v14, v20, v109 row_newbcast:11 row_mask:0xf bank_mask:0xf
    v_dot2c_f32_bf16_dpp v15, v52, v109 row_newbcast:11 row_mask:0xf bank_mask:0xf
    v_dot2c_f32_bf16_dpp v16, v20, v110 row_newbcast:11 row_mask:0xf bank_mask:0xf
    v_dot2c_f32_bf16_dpp v17, v52, v110 row_newbcast:11 row_mask:0xf bank_mask:0xf
    v_dot2c_f32_bf16_dpp v18, v20, v111 row_newbcast:11 row_mask:0xf bank_mask:0xf
    v_dot2c_f32_bf16_dpp v19, v52, v111 row_newbcast:11 row_mask:0xf bank_mask:0xf
    s_add_u32 s6, s56, 94208
    s_and_b32 s6, s6, 0xfffff
    s_waitcnt vmcnt(5)
    s_cmp_lt_u32 s3, 4
    s_cbranch_scc1 W_59
    s_waitcnt vmcnt(4)
W_59:
    buffer_load_dwordx4 v[92:95], v1, s[12:15], s6 offen nt
    s_waitcnt vmcnt(11)
    v_dot2c_f32_bf16_dpp v12, v20, v112 row_newbcast:12 row_mask:0xf bank_mask:0xf
    v_dot2c_f32_bf16_dpp v13, v52, v112 row_newbcast:12 row_mask:0xf bank_mask:0xf
    v_dot2c_f32_bf16_dpp v14, v20, v113 row_newbcast:12 row_mask:0xf bank_mask:0xf
    v_dot2c_f32_bf16_dpp v15, v52, v113 row_newbcast:12 row_mask:0xf bank_mask:0xf
    v_dot2c_f32_bf16_dpp v16, v20, v114 row_newbcast:12 row_mask:0xf bank_mask:0xf
    v_dot2c_f32_bf16_dpp v17, v52, v114 row_newbcast:12 row_mask:0xf bank_mask:0xf
    v_dot2c_f32_bf16_dpp v18, v20, v115 row_newbcast:12 row_mask:0xf bank_mask:0xf
    v_dot2c_f32_bf16_dpp v19, v52, v115 row_newbcast:12 row_mask:0xf bank_mask:0xf
    s_add_u32 s6, s56, 98304
    s_and_b32 s6, s6, 0xfffff
    s_waitcnt vmcnt(4)
    s_cmp_lt_u32 s3, 4
    s_cbranch_scc1 W_60
    s_waitcnt vmcnt(3)
W_60:
    buffer_load_dwordx4 v[96:99], v1, s[12:15], s6 offen nt
    s_waitcnt vmcnt(11)
    v_dot2c_f32_bf16_dpp v12, v20, v116 row_newbcast:13 row_mask:0xf bank_mask:0xf
    v_dot2c_f32_bf16_dpp v13, v52, v116 row_newbcast:13 row_mask:0xf bank_mask:0xf
    v_dot2c_f32_bf16_dpp v14, v20, v117 row_newbcast:13 row_mask:0xf bank_mask:0xf
    v_dot2c_f32_bf16_dpp v15, v52, v117 row_newbcast:13 row_mask:0xf bank_mask:0xf
    v_dot2c_f32_bf16_dpp v16, v20, v118 row_newbcast:13 row_mask:0xf bank_mask:0xf
    v_dot2c_f32_bf16_dpp v17, v52, v118 row_newbcast:13 row_mask:0xf bank_mask:0xf
    v_dot2c_f32_bf16_dpp v18, v20, v119 row_newbcast:13 row_mask:0xf bank_mask:0xf
    v_dot2c_f32_bf16_dpp v19, v52, v119 row_newbcast:13 row_mask:0xf bank_mask:0xf
    s_add_u32 s6, s56, 102400
    s_and_b32 s6, s6, 0xfffff
    s_waitcnt vmcnt(5)
    s_cmp_lt_u32 s3, 4
    s_cbranch_scc1 W_61
    s_waitcnt vmcnt(4)
W_61:
    buffer_load_dwordx4 v[100:103], v1, s[12:15], s6 offen nt
    s_waitcnt vmcnt(11)
    v_dot2c_f32_bf16_dpp v12, v20, v120 row_newbcast:14 row_mask:0xf bank_mask:0xf
    v_dot2c_f32_bf16_dpp v13, v52, v120 row_newbcast:14 row_mask:0xf bank_mask:0xf
    v_dot2c_f32_bf16_dpp v14, v20, v121 row_newbcast:14 row_mask:0xf bank_mask:0xf
    v_dot2c_f32_bf16_dpp v15, v52, v121 row_newbcast:14 row_mask:0xf bank_mask:0xf
    v_dot2c_f32_bf16_dpp v16, v20, v122 row_newbcast:14 row_mask:0xf bank_mask:0xf
    v_dot2c_f32_bf16_dpp v17, v52, v122 row_newbcast:14 row_mask:0xf bank_mask:0xf
    v_dot2c_f32_bf16_dpp v18, v20, v123 row_newbcast:14 row_mask:0xf bank_mask:0xf
    v_dot2c_f32_bf16_dpp v19, v52, v123 row_newbcast:14 row_mask:0xf bank_mask:0xf
    s_add_u32 s6, s56, 106496
    s_and_b32 s6, s6, 0xfffff
    s_waitcnt vmcnt(4)
    s_cmp_lt_u32 s3, 4
    s_cbranch_scc1 W_62
    s_waitcnt vmcnt(3)
W_62:
    buffer_load_dwordx4 v[104:107], v1, s[12:15], s6 offen nt
    s_waitcnt vmcnt(11)
    v_dot2c_f32_bf16_dpp v12, v20, v124 row_newbcast:15 row_mask:0xf bank_mask:0xf
    v_dot2c_f32_bf16_dpp v13, v52, v124 row_newbcast:15 row_mask:0xf bank_mask:0xf
    v_dot2c_f32_bf16_dpp v14, v20, v125 row_newbcast:15 row_mask:0xf bank_mask:0xf
    v_dot2c_f32_bf16_dpp v15, v52, v125 row_newbcast:15 row_mask:0xf bank_mask:0xf
    v_dot2c_f32_bf16_dpp v16, v20, v126 row_newbcast:15 row_mask:0xf bank_mask:0xf
    v_dot2c_f32_bf16_dpp v17, v52, v126 row_newbcast:15 row_mask:0xf bank_mask:0xf
    v_dot2c_f32_bf16_dpp v18, v20, v127 row_newbcast:15 row_mask:0xf bank_mask:0xf
    v_dot2c_f32_bf16_dpp v19, v52, v127 row_newbcast:15 row_mask:0xf bank_mask:0xf
    s_add_u32 s6, s56, 110592
    s_and_b32 s6, s6, 0xfffff
    s_waitcnt vmcnt(5)
    s_cmp_lt_u32 s3, 4
    s_cbranch_scc1 W_63
    s_waitcnt vmcnt(4)
W_63:
    buffer_load_dwordx4 v[108:111], v1, s[12:15], s6 offen nt
    v_lshlrev_b32 v54, 16, v21
    s_nop 1
    s_waitcnt vmcnt(11)
    v_dot2c_f32_bf16_dpp v12, v21, v64 row_newbcast:0 row_mask:0xf bank_mask:0xf
    v_dot2c_f32_bf16_dpp v13, v54, v64 row_newbcast:0 row_mask:0xf bank_mask:0xf
    v_dot2c_f32_bf16_dpp v14, v21, v65 row_newbcast:0 row_mask:0xf bank_mask:0xf
    v_dot2c_f32_bf16_dpp v15, v54, v65 row_newbcast:0 row_mask:0xf bank_mask:0xf
    v_dot2c_f32_bf16_dpp v16, v21, v66 row_newbcast:0 row_mask:0xf bank_mask:0xf
    v_dot2c_f32_bf16_dpp v17, v54, v66 row_newbcast:0 row_mask:0xf bank_mask:0xf
    v_dot2c_f32_bf16_dpp v18, v21, v67 row_newbcast:0 row_mask:0xf bank_mask:0xf
    v_dot2c_f32_bf16_dpp v19, v54, v67 row_newbcast:0 row_mask:0xf bank_mask:0xf
    s_add_u32 s6, s56, 114688
    s_and_b32 s6, s6, 0xfffff
    s_waitcnt vmcnt(4)
    s_cmp_lt_u32 s3, 4
    s_cbranch_scc1 W_64
    s_waitcnt vmcnt(3)
W_64:
    buffer_load_dwordx4 v[112:115], v1, s[12:15], s6 offen nt
    s_waitcnt vmcnt(11)
    v_dot2c_f32_bf16_dpp v12, v21, v68 row_newbcast:1 row_mask:0xf bank_mask:0xf
    v_dot2c_f32_bf16_dpp v13, v54, v68 row_newbcast:1 row_mask:0xf bank_mask:0xf
    v_dot2c_f32_bf16_dpp v14, v21, v69 row_newbcast:1 row_mask:0xf bank_mask:0xf
    v_dot2c_f32_bf16_dpp v15, v54, v69 row_newbcast:1 row_mask:0xf bank_mask:0xf
    v_dot2c_f32_bf16_dpp v16, v21, v70 row_newbcast:1 row_mask:0xf bank_mask:0xf
    v_dot2c_f32_bf16_dpp v17, v54, v70 row_newbcast:1 row_mask:0xf bank_mask:0xf
    v_dot2c_f32_bf16_dpp v18, v21, v71 row_newbcast:1 row_mask:0xf bank_mask:0xf
    v_dot2c_f32_bf16_dpp v19, v54, v71 row_newbcast:1 row_mask:0xf bank_mask:0xf
    s_add_u32 s6, s56, 118784
    s_and_b32 s6, s6, 0xfffff
    s_waitcnt vmcnt(5)
    s_cmp_lt_u32 s3, 4
    s_cbranch_scc1 W_65
    s_waitcnt vmcnt(4)
W_65:
    buffer_load_dwordx4 v[116:119], v1, s[12:15], s6 offen nt
    s_waitcnt vmcnt(11)
    v_dot2c_f32_bf16_dpp v12, v21, v72 row_newbcast:2 row_mask:0xf bank_mask:0xf
    v_dot2c_f32_bf16_dpp v13, v54, v72 row_newbcast:2 row_mask:0xf bank_mask:0xf
    v_dot2c_f32_bf16_dpp v14, v21, v73 row_newbcast:2 row_mask:0xf bank_mask:0xf
    v_dot2c_f32_bf16_dpp v15, v54, v73 row_newbcast:2 row_mask:0xf bank_mask:0xf
    v_dot2c_f32_bf16_dpp v16, v21, v74 row_newbcast:2 row_mask:0xf bank_mask:0xf
    v_dot2c_f32_bf16_dpp v17, v54, v74 row_newbcast:2 row_mask:0xf bank_mask:0xf
    v_dot2c_f32_bf16_dpp v18, v21, v75 row_newbcast:2 row_mask:0xf bank_mask:0xf
    v_dot2c_f32_bf16_dpp v19, v54, v75 row_newbcast:2 row_mask:0xf bank_mask:0xf
    s_add_u32 s6, s56, 122880
    s_and_b32 s6, s6, 0xfffff
    s_waitcnt vmcnt(4)
    s_cmp_lt_u32 s3, 4
    s_cbranch_scc1 W_66
    s_waitcnt vmcnt(3)
W_66:
    buffer_load_dwordx4 v[120:123], v1, s[12:15], s6 offen nt
    s_waitcnt vmcnt(11)
    v_dot2c_f32_bf16_dpp v12, v21, v76 row_newbcast:3 row_mask:0xf bank_mask:0xf
    v_dot2c_f32_bf16_dpp v13, v54, v76 row_newbcast:3 row_mask:0xf bank_mask:0xf
    v_dot2c_f32_bf16_dpp v14, v21, v77 row_newbcast:3 row_mask:0xf bank_mask:0xf
    v_dot2c_f32_bf16_dpp v15, v54, v77 row_newbcast:3 row_mask:0xf bank_mask:0xf
    v_dot2c_f32_bf16_dpp v16, v21, v78 row_newbcast:3 row_mask:0xf bank_mask:0xf
    v_dot2c_f32_bf16_dpp v17, v54, v78 row_newbcast:3 row_mask:0xf bank_mask:0xf
    v_dot2c_f32_bf16_dpp v18, v21, v79 row_newbcast:3 row_mask:0xf bank_mask:0xf
    v_dot2c_f32_bf16_dpp v19, v54, v79 row_newbcast:3 row_mask:0xf bank_mask:0xf
    s_add_u32 s6, s56, 126976
    s_and_b32 s6, s6, 0xfffff
    s_waitcnt vmcnt(5)
    s_cmp_lt_u32 s3, 4
    s_cbranch_scc1 W_67
    s_waitcnt vmcnt(4)
W_67:
    buffer_load_dwordx4 v[124:127], v1, s[12:15], s6 offen nt
    s_waitcnt vmcnt(11)
    v_dot2c_f32_bf16_dpp v12, v21, v80 row_newbcast:4 row_mask:0xf bank_mask:0xf
    v_dot2c_f32_bf16_dpp v13, v54, v80 row_newbcast:4 row_mask:0xf bank_mask:0xf
    v_dot2c_f32_bf16_dpp v14, v21, v81 row_newbcast:4 row_mask:0xf bank_mask:0xf
    v_dot2c_f32_bf16_dpp v15, v54, v81 row_newbcast:4 row_mask:0xf bank_mask:0xf
    v_dot2c_f32_bf16_dpp v16, v21, v82 row_newbcast:4 row_mask:0xf bank_mask:0xf
    v_dot2c_f32_bf16_dpp v17, v54, v82 row_newbcast:4 row_mask:0xf bank_mask:0xf
    v_dot2c_f32_bf16_dpp v18, v21, v83 row_newbcast:4 row_mask:0xf bank_mask:0xf
    v_dot2c_f32_bf16_dpp v19, v54, v83 row_newbcast:4 row_mask:0xf bank_mask:0xf
    s_add_u32 s6, s56, 131072
    s_and_b32 s6, s6, 0xfffff
    s_waitcnt vmcnt(4)
    s_cmp_lt_u32 s3, 4
    s_cbranch_scc1 W_68
    s_waitcnt vmcnt(3)
W_68:
    buffer_load_dwordx4 v[64:67], v1, s[12:15], s6 offen nt
    s_waitcnt vmcnt(11)
    v_dot2c_f32_bf16_dpp v12, v21, v84 row_newbcast:5 row_mask:0xf bank_mask:0xf
    v_dot2c_f32_bf16_dpp v13, v54, v84 row_newbcast:5 row_mask:0xf bank_mask:0xf
    v_dot2c_f32_bf16_dpp v14, v21, v85 row_newbcast:5 row_mask:0xf bank_mask:0xf
    v_dot2c_f32_bf16_dpp v15, v54, v85 row_newbcast:5 row_mask:0xf bank_mask:0xf
    v_dot2c_f32_bf16_dpp v16, v21, v86 row_newbcast:5 row_mask:0xf bank_mask:0xf
    v_dot2c_f32_bf16_dpp v17, v54, v86 row_newbcast:5 row_mask:0xf bank_mask:0xf
    v_dot2c_f32_bf16_dpp v18, v21, v87 row_newbcast:5 row_mask:0xf bank_mask:0xf
    v_dot2c_f32_bf16_dpp v19, v54, v87 row_newbcast:5 row_mask:0xf bank_mask:0xf
    s_add_u32 s6, s56, 135168
    s_and_b32 s6, s6, 0xfffff
    s_waitcnt vmcnt(5)
    s_cmp_lt_u32 s3, 4
    s_cbranch_scc1 W_69
    s_waitcnt vmcnt(4)
W_69:
    buffer_load_dwordx4 v[68:71], v1, s[12:15], s6 offen nt
    s_waitcnt vmcnt(11)
    v_dot2c_f32_bf16_dpp v12, v21, v88 row_newbcast:6 row_mask:0xf bank_mask:0xf
    v_dot2c_f32_bf16_dpp v13, v54, v88 row_newbcast:6 row_mask:0xf bank_mask:0xf
    v_dot2c_f32_bf16_dpp v14, v21, v89 row_newbcast:6 row_mask:0xf bank_mask:0xf
    v_dot2c_f32_bf16_dpp v15, v54, v89 row_newbcast:6 row_mask:0xf bank_mask:0xf
    v_dot2c_f32_bf16_dpp v16, v21, v90 row_newbcast:6 row_mask:0xf bank_mask:0xf
    v_dot2c_f32_bf16_dpp v17, v54, v90 row_newbcast:6 row_mask:0xf bank_mask:0xf
    v_dot2c_f32_bf16_dpp v18, v21, v91 row_newbcast:6 row_mask:0xf bank_mask:0xf
    v_dot2c_f32_bf16_dpp v19, v54, v91 row_newbcast:6 row_mask:0xf bank_mask:0xf
    s_add_u32 s6, s56, 139264
    s_and_b32 s6, s6, 0xfffff
    s_waitcnt vmcnt(4)
    s_cmp_lt_u32 s3, 4
    s_cbranch_scc1 W_70
    s_waitcnt vmcnt(3)
W_70:
    buffer_load_dwordx4 v[72:75], v1, s[12:15], s6 offen nt
    s_waitcnt vmcnt(11)
    v_dot2c_f32_bf16_dpp v12, v21, v92 row_newbcast:7 row_mask:0xf bank_mask:0xf
    v_dot2c_f32_bf16_dpp v13, v54, v92 row_newbcast:7 row_mask:0xf bank_mask:0xf
    v_dot2c_f32_bf16_dpp v14, v21, v93 row_newbcast:7 row_mask:0xf bank_mask:0xf
    v_dot2c_f32_bf16_dpp v15, v54, v93 row_newbcast:7 row_mask:0xf bank_mask:0xf
    v_dot2c_f32_bf16_dpp v16, v21, v94 row_newbcast:7 row_mask:0xf bank_mask:0xf
    v_dot2c_f32_bf16_dpp v17, v54, v94 row_newbcast:7 row_mask:0xf bank_mask:0xf
    v_dot2c_f32_bf16_dpp v18, v21, v95 row_newbcast:7 row_mask:0xf bank_mask:0xf
    v_dot2c_f32_bf16_dpp v19, v54, v95 row_newbcast:7 row_mask:0xf bank_mask:0xf
    s_add_u32 s6, s56, 143360
    s_and_b32 s6, s6, 0xfffff
    s_waitcnt vmcnt(5)
    s_cmp_lt_u32 s3, 4
    s_cbranch_scc1 W_71
    s_waitcnt vmcnt(4)
W_71:
    buffer_load_dwordx4 v[76:79], v1, s[12:15], s6 offen nt
    s_waitcnt vmcnt(11)
    v_dot2c_f32_bf16_dpp v12, v21, v96 row_newbcast:8 row_mask:0xf bank_mask:0xf
    v_dot2c_f32_bf16_dpp v13, v54, v96 row_newbcast:8 row_mask:0xf bank_mask:0xf
    v_dot2c_f32_bf16_dpp v14, v21, v97 row_newbcast:8 row_mask:0xf bank_mask:0xf
    v_dot2c_f32_bf16_dpp v15, v54, v97 row_newbcast:8 row_mask:0xf bank_mask:0xf
    v_dot2c_f32_bf16_dpp v16, v21, v98 row_newbcast:8 row_mask:0xf bank_mask:0xf
    v_dot2c_f32_bf16_dpp v17, v54, v98 row_newbcast:8 row_mask:0xf bank_mask:0xf
    v_dot2c_f32_bf16_dpp v18, v21, v99 row_newbcast:8 row_mask:0xf bank_mask:0xf
    v_dot2c_f32_bf16_dpp v19, v54, v99 row_newbcast:8 row_mask:0xf bank_mask:0xf
    s_add_u32 s6, s56, 147456
    s_and_b32 s6, s6, 0xfffff
    s_waitcnt vmcnt(4)
    s_cmp_lt_u32 s3, 4
    s_cbranch_scc1 W_72
    s_waitcnt vmcnt(3)
W_72:
    buffer_load_dwordx4 v[80:83], v1, s[12:15], s6 offen nt
    s_waitcnt vmcnt(11)
    v_dot2c_f32_bf16_dpp v12, v21, v100 row_newbcast:9 row_mask:0xf bank_mask:0xf
    v_dot2c_f32_bf16_dpp v13, v54, v100 row_newbcast:9 row_mask:0xf bank_mask:0xf
    v_dot2c_f32_bf16_dpp v14, v21, v101 row_newbcast:9 row_mask:0xf bank_mask:0xf
    v_dot2c_f32_bf16_dpp v15, v54, v101 row_newbcast:9 row_mask:0xf bank_mask:0xf
    v_dot2c_f32_bf16_dpp v16, v21, v102 row_newbcast:9 row_mask:0xf bank_mask:0xf
    v_dot2c_f32_bf16_dpp v17, v54, v102 row_newbcast:9 row_mask:0xf bank_mask:0xf
    v_dot2c_f32_bf16_dpp v18, v21, v103 row_newbcast:9 row_mask:0xf bank_mask:0xf
    v_dot2c_f32_bf16_dpp v19, v54, v103 row_newbcast:9 row_mask:0xf bank_mask:0xf
    s_add_u32 s6, s56, 151552
    s_and_b32 s6, s6, 0xfffff
    s_waitcnt vmcnt(5)
    s_cmp_lt_u32 s3, 4
    s_cbranch_scc1 W_73
    s_waitcnt vmcnt(4)
W_73:
    buffer_load_dwordx4 v[84:87], v1, s[12:15], s6 offen nt
    s_waitcnt vmcnt(11)
    v_dot2c_f32_bf16_dpp v12, v21, v104 row_newbcast:10 row_mask:0xf bank_mask:0xf
    v_dot2c_f32_bf16_dpp v13, v54, v104 row_newbcast:10 row_mask:0xf bank_mask:0xf
    v_dot2c_f32_bf16_dpp v14, v21, v105 row_newbcast:10 row_mask:0xf bank_mask:0xf
    v_dot2c_f32_bf16_dpp v15, v54, v105 row_newbcast:10 row_mask:0xf bank_mask:0xf
    v_dot2c_f32_bf16_dpp v16, v21, v106 row_newbcast:10 row_mask:0xf bank_mask:0xf
    v_dot2c_f32_bf16_dpp v17, v54, v106 row_newbcast:10 row_mask:0xf bank_mask:0xf
    v_dot2c_f32_bf16_dpp v18, v21, v107 row_newbcast:10 row_mask:0xf bank_mask:0xf
    v_dot2c_f32_bf16_dpp v19, v54, v107 row_newbcast:10 row_mask:0xf bank_mask:0xf
    s_add_u32 s6, s56, 155648
    s_and_b32 s6, s6, 0xfffff
    s_waitcnt vmcnt(4)
    s_cmp_lt_u32 s3, 4
    s_cbranch_scc1 W_74
    s_waitcnt vmcnt(3)
W_74:
    buffer_load_dwordx4 v[88:91], v1, s[12:15], s6 offen nt
    s_waitcnt vmcnt(11)
    v_dot2c_f32_bf16_dpp v12, v21, v108 row_newbcast:11 row_mask:0xf bank_mask:0xf
    v_dot2c_f32_bf16_dpp v13, v54, v108 row_newbcast:11 row_mask:0xf bank_mask:0xf
    v_dot2c_f32_bf16_dpp v14, v21, v109 row_newbcast:11 row_mask:0xf bank_mask:0xf
    v_dot2c_f32_bf16_dpp v15, v54, v109 row_newbcast:11 row_mask:0xf bank_mask:0xf
    v_dot2c_f32_bf16_dpp v16, v21, v110 row_newbcast:11 row_mask:0xf bank_mask:0xf
    v_dot2c_f32_bf16_dpp v17, v54, v110 row_newbcast:11 row_mask:0xf bank_mask:0xf
    v_dot2c_f32_bf16_dpp v18, v21, v111 row_newbcast:11 row_mask:0xf bank_mask:0xf
    v_dot2c_f32_bf16_dpp v19, v54, v111 row_newbcast:11 row_mask:0xf bank_mask:0xf
    s_add_u32 s6, s56, 159744
    s_and_b32 s6, s6, 0xfffff
    s_waitcnt vmcnt(5)
    s_cmp_lt_u32 s3, 4
    s_cbranch_scc1 W_75
    s_waitcnt vmcnt(4)
W_75:
    buffer_load_dwordx4 v[92:95], v1, s[12:15], s6 offen nt
    s_waitcnt vmcnt(11)
    v_dot2c_f32_bf16_dpp v12, v21, v112 row_newbcast:12 row_mask:0xf bank_mask:0xf
    v_dot2c_f32_bf16_dpp v13, v54, v112 row_newbcast:12 row_mask:0xf bank_mask:0xf
    v_dot2c_f32_bf16_dpp v14, v21, v113 row_newbcast:12 row_mask:0xf bank_mask:0xf
    v_dot2c_f32_bf16_dpp v15, v54, v113 row_newbcast:12 row_mask:0xf bank_mask:0xf
    v_dot2c_f32_bf16_dpp v16, v21, v114 row_newbcast:12 row_mask:0xf bank_mask:0xf
    v_dot2c_f32_bf16_dpp v17, v54, v114 row_newbcast:12 row_mask:0xf bank_mask:0xf
    v_dot2c_f32_bf16_dpp v18, v21, v115 row_newbcast:12 row_mask:0xf bank_mask:0xf
    v_dot2c_f32_bf16_dpp v19, v54, v115 row_newbcast:12 row_mask:0xf bank_mask:0xf
    s_add_u32 s6, s56, 163840
    s_and_b32 s6, s6, 0xfffff
    s_waitcnt vmcnt(4)
    s_cmp_lt_u32 s3, 4
    s_cbranch_scc1 W_76
    s_waitcnt vmcnt(3)
W_76:
    buffer_load_dwordx4 v[96:99], v1, s[12:15], s6 offen nt
    s_waitcnt vmcnt(11)
    v_dot2c_f32_bf16_dpp v12, v21, v116 row_newbcast:13 row_mask:0xf bank_mask:0xf
    v_dot2c_f32_bf16_dpp v13, v54, v116 row_newbcast:13 row_mask:0xf bank_mask:0xf
    v_dot2c_f32_bf16_dpp v14, v21, v117 row_newbcast:13 row_mask:0xf bank_mask:0xf
    v_dot2c_f32_bf16_dpp v15, v54, v117 row_newbcast:13 row_mask:0xf bank_mask:0xf
    v_dot2c_f32_bf16_dpp v16, v21, v118 row_newbcast:13 row_mask:0xf bank_mask:0xf
    v_dot2c_f32_bf16_dpp v17, v54, v118 row_newbcast:13 row_mask:0xf bank_mask:0xf
    v_dot2c_f32_bf16_dpp v18, v21, v119 row_newbcast:13 row_mask:0xf bank_mask:0xf
    v_dot2c_f32_bf16_dpp v19, v54, v119 row_newbcast:13 row_mask:0xf bank_mask:0xf
    s_add_u32 s6, s56, 167936
    s_and_b32 s6, s6, 0xfffff
    s_waitcnt vmcnt(5)
    s_cmp_lt_u32 s3, 4
    s_cbranch_scc1 W_77
    s_waitcnt vmcnt(4)
W_77:
    buffer_load_dwordx4 v[100:103], v1, s[12:15], s6 offen nt
    s_waitcnt vmcnt(11)
    v_dot2c_f32_bf16_dpp v12, v21, v120 row_newbcast:14 row_mask:0xf bank_mask:0xf
    v_dot2c_f32_bf16_dpp v13, v54, v120 row_newbcast:14 row_mask:0xf bank_mask:0xf
    v_dot2c_f32_bf16_dpp v14, v21, v121 row_newbcast:14 row_mask:0xf bank_mask:0xf
    v_dot2c_f32_bf16_dpp v15, v54, v121 row_newbcast:14 row_mask:0xf bank_mask:0xf
    v_dot2c_f32_bf16_dpp v16, v21, v122 row_newbcast:14 row_mask:0xf bank_mask:0xf
    v_dot2c_f32_bf16_dpp v17, v54, v122 row_newbcast:14 row_mask:0xf bank_mask:0xf
    v_dot2c_f32_bf16_dpp v18, v21, v123 row_newbcast:14 row_mask:0xf bank_mask:0xf
    v_dot2c_f32_bf16_dpp v19, v54, v123 row_newbcast:14 row_mask:0xf bank_mask:0xf
    s_add_u32 s6, s56, 172032
    s_and_b32 s6, s6, 0xfffff
    s_waitcnt vmcnt(4)
    s_cmp_lt_u32 s3, 4
    s_cbranch_scc1 W_78
    s_waitcnt vmcnt(3)
W_78:
    buffer_load_dwordx4 v[104:107], v1, s[12:15], s6 offen nt
    s_waitcnt vmcnt(11)
    v_dot2c_f32_bf16_dpp v12, v21, v124 row_newbcast:15 row_mask:0xf bank_mask:0xf
    v_dot2c_f32_bf16_dpp v13, v54, v124 row_newbcast:15 row_mask:0xf bank_mask:0xf
    v_dot2c_f32_bf16_dpp v14, v21, v125 row_newbcast:15 row_mask:0xf bank_mask:0xf
    v_dot2c_f32_bf16_dpp v15, v54, v125 row_newbcast:15 row_mask:0xf bank_mask:0xf
    v_dot2c_f32_bf16_dpp v16, v21, v126 row_newbcast:15 row_mask:0xf bank_mask:0xf
    v_dot2c_f32_bf16_dpp v17, v54, v126 row_newbcast:15 row_mask:0xf bank_mask:0xf
    v_dot2c_f32_bf16_dpp v18, v21, v127 row_newbcast:15 row_mask:0xf bank_mask:0xf
    v_dot2c_f32_bf16_dpp v19, v54, v127 row_newbcast:15 row_mask:0xf bank_mask:0xf
    s_add_u32 s6, s56, 176128
    s_and_b32 s6, s6, 0xfffff
    s_waitcnt vmcnt(5)
    s_cmp_lt_u32 s3, 4
    s_cbranch_scc1 W_79
    s_waitcnt vmcnt(4)
W_79:
    buffer_load_dwordx4 v[108:111], v1, s[12:15], s6 offen nt
    v_lshlrev_b32 v52, 16, v22
    s_nop 1
    s_waitcnt vmcnt(11)
    v_dot2c_f32_bf16_dpp v12, v22, v64 row_newbcast:0 row_mask:0xf bank_mask:0xf
    v_dot2c_f32_bf16_dpp v13, v52, v64 row_newbcast:0 row_mask:0xf bank_mask:0xf
    v_dot2c_f32_bf16_dpp v14, v22, v65 row_newbcast:0 row_mask:0xf bank_mask:0xf
    v_dot2c_f32_bf16_dpp v15, v52, v65 row_newbcast:0 row_mask:0xf bank_mask:0xf
    v_dot2c_f32_bf16_dpp v16, v22, v66 row_newbcast:0 row_mask:0xf bank_mask:0xf
    v_dot2c_f32_bf16_dpp v17, v52, v66 row_newbcast:0 row_mask:0xf bank_mask:0xf
    v_dot2c_f32_bf16_dpp v18, v22, v67 row_newbcast:0 row_mask:0xf bank_mask:0xf
    v_dot2c_f32_bf16_dpp v19, v52, v67 row_newbcast:0 row_mask:0xf bank_mask:0xf
    s_add_u32 s6, s56, 180224
    s_and_b32 s6, s6, 0xfffff
    s_waitcnt vmcnt(4)
    s_cmp_lt_u32 s3, 4
    s_cbranch_scc1 W_80
    s_waitcnt vmcnt(3)
W_80:
    buffer_load_dwordx4 v[112:115], v1, s[12:15], s6 offen nt
    s_waitcnt vmcnt(11)
    v_dot2c_f32_bf16_dpp v12, v22, v68 row_newbcast:1 row_mask:0xf bank_mask:0xf
    v_dot2c_f32_bf16_dpp v13, v52, v68 row_newbcast:1 row_mask:0xf bank_mask:0xf
    v_dot2c_f32_bf16_dpp v14, v22, v69 row_newbcast:1 row_mask:0xf bank_mask:0xf
    v_dot2c_f32_bf16_dpp v15, v52, v69 row_newbcast:1 row_mask:0xf bank_mask:0xf
    v_dot2c_f32_bf16_dpp v16, v22, v70 row_newbcast:1 row_mask:0xf bank_mask:0xf
    v_dot2c_f32_bf16_dpp v17, v52, v70 row_newbcast:1 row_mask:0xf bank_mask:0xf
    v_dot2c_f32_bf16_dpp v18, v22, v71 row_newbcast:1 row_mask:0xf bank_mask:0xf
    v_dot2c_f32_bf16_dpp v19, v52, v71 row_newbcast:1 row_mask:0xf bank_mask:0xf
    s_add_u32 s6, s56, 184320
    s_and_b32 s6, s6, 0xfffff
    s_waitcnt vmcnt(5)
    s_cmp_lt_u32 s3, 4
    s_cbranch_scc1 W_81
    s_waitcnt vmcnt(4)
W_81:
    buffer_load_dwordx4 v[116:119], v1, s[12:15], s6 offen nt
    s_waitcnt vmcnt(11)
    v_dot2c_f32_bf16_dpp v12, v22, v72 row_newbcast:2 row_mask:0xf bank_mask:0xf
    v_dot2c_f32_bf16_dpp v13, v52, v72 row_newbcast:2 row_mask:0xf bank_mask:0xf
    v_dot2c_f32_bf16_dpp v14, v22, v73 row_newbcast:2 row_mask:0xf bank_mask:0xf
    v_dot2c_f32_bf16_dpp v15, v52, v73 row_newbcast:2 row_mask:0xf bank_mask:0xf
    v_dot2c_f32_bf16_dpp v16, v22, v74 row_newbcast:2 row_mask:0xf bank_mask:0xf
    v_dot2c_f32_bf16_dpp v17, v52, v74 row_newbcast:2 row_mask:0xf bank_mask:0xf
    v_dot2c_f32_bf16_dpp v18, v22, v75 row_newbcast:2 row_mask:0xf bank_mask:0xf
    v_dot2c_f32_bf16_dpp v19, v52, v75 row_newbcast:2 row_mask:0xf bank_mask:0xf
    s_add_u32 s6, s56, 188416
    s_and_b32 s6, s6, 0xfffff
    s_waitcnt vmcnt(4)
    s_cmp_lt_u32 s3, 4
    s_cbranch_scc1 W_82
    s_waitcnt vmcnt(3)
W_82:
    buffer_load_dwordx4 v[120:123], v1, s[12:15], s6 offen nt
    s_waitcnt vmcnt(11)
    v_dot2c_f32_bf16_dpp v12, v22, v76 row_newbcast:3 row_mask:0xf bank_mask:0xf
    v_dot2c_f32_bf16_dpp v13, v52, v76 row_newbcast:3 row_mask:0xf bank_mask:0xf
    v_dot2c_f32_bf16_dpp v14, v22, v77 row_newbcast:3 row_mask:0xf bank_mask:0xf
    v_dot2c_f32_bf16_dpp v15, v52, v77 row_newbcast:3 row_mask:0xf bank_mask:0xf
    v_dot2c_f32_bf16_dpp v16, v22, v78 row_newbcast:3 row_mask:0xf bank_mask:0xf
    v_dot2c_f32_bf16_dpp v17, v52, v78 row_newbcast:3 row_mask:0xf bank_mask:0xf
    v_dot2c_f32_bf16_dpp v18, v22, v79 row_newbcast:3 row_mask:0xf bank_mask:0xf
    v_dot2c_f32_bf16_dpp v19, v52, v79 row_newbcast:3 row_mask:0xf bank_mask:0xf
    s_add_u32 s6, s56, 192512
    s_and_b32 s6, s6, 0xfffff
    s_waitcnt vmcnt(5)
    s_cmp_lt_u32 s3, 4
    s_cbranch_scc1 W_83
    s_waitcnt vmcnt(4)
W_83:
    buffer_load_dwordx4 v[124:127], v1, s[12:15], s6 offen nt
    s_waitcnt vmcnt(11)
    v_dot2c_f32_bf16_dpp v12, v22, v80 row_newbcast:4 row_mask:0xf bank_mask:0xf
    v_dot2c_f32_bf16_dpp v13, v52, v80 row_newbcast:4 row_mask:0xf bank_mask:0xf
    v_dot2c_f32_bf16_dpp v14, v22, v81 row_newbcast:4 row_mask:0xf bank_mask:0xf
    v_dot2c_f32_bf16_dpp v15, v52, v81 row_newbcast:4 row_mask:0xf bank_mask:0xf
    v_dot2c_f32_bf16_dpp v16, v22, v82 row_newbcast:4 row_mask:0xf bank_mask:0xf
    v_dot2c_f32_bf16_dpp v17, v52, v82 row_newbcast:4 row_mask:0xf bank_mask:0xf
    v_dot2c_f32_bf16_dpp v18, v22, v83 row_newbcast:4 row_mask:0xf bank_mask:0xf
    v_dot2c_f32_bf16_dpp v19, v52, v83 row_newbcast:4 row_mask:0xf bank_mask:0xf
    s_add_u32 s6, s56, 196608
    s_and_b32 s6, s6, 0xfffff
    s_waitcnt vmcnt(4)
    s_cmp_lt_u32 s3, 4
    s_cbranch_scc1 W_84
    s_waitcnt vmcnt(3)
W_84:
    buffer_load_dwordx4 v[64:67], v1, s[12:15], s6 offen nt
    s_waitcnt vmcnt(11)
    v_dot2c_f32_bf16_dpp v12, v22, v84 row_newbcast:5 row_mask:0xf bank_mask:0xf
    v_dot2c_f32_bf16_dpp v13, v52, v84 row_newbcast:5 row_mask:0xf bank_mask:0xf
    v_dot2c_f32_bf16_dpp v14, v22, v85 row_newbcast:5 row_mask:0xf bank_mask:0xf
    v_dot2c_f32_bf16_dpp v15, v52, v85 row_newbcast:5 row_mask:0xf bank_mask:0xf
    v_dot2c_f32_bf16_dpp v16, v22, v86 row_newbcast:5 row_mask:0xf bank_mask:0xf
    v_dot2c_f32_bf16_dpp v17, v52, v86 row_newbcast:5 row_mask:0xf bank_mask:0xf
    v_dot2c_f32_bf16_dpp v18, v22, v87 row_newbcast:5 row_mask:0xf bank_mask:0xf
    v_dot2c_f32_bf16_dpp v19, v52, v87 row_newbcast:5 row_mask:0xf bank_mask:0xf
    s_add_u32 s6, s56, 200704
    s_and_b32 s6, s6, 0xfffff
    s_waitcnt vmcnt(5)
    s_cmp_lt_u32 s3, 4
    s_cbranch_scc1 W_85
    s_waitcnt vmcnt(4)
W_85:
    buffer_load_dwordx4 v[68:71], v1, s[12:15], s6 offen nt
    s_waitcnt vmcnt(11)
    v_dot2c_f32_bf16_dpp v12, v22, v88 row_newbcast:6 row_mask:0xf bank_mask:0xf
    v_dot2c_f32_bf16_dpp v13, v52, v88 row_newbcast:6 row_mask:0xf bank_mask:0xf
    v_dot2c_f32_bf16_dpp v14, v22, v89 row_newbcast:6 row_mask:0xf bank_mask:0xf
    v_dot2c_f32_bf16_dpp v15, v52, v89 row_newbcast:6 row_mask:0xf bank_mask:0xf
    v_dot2c_f32_bf16_dpp v16, v22, v90 row_newbcast:6 row_mask:0xf bank_mask:0xf
    v_dot2c_f32_bf16_dpp v17, v52, v90 row_newbcast:6 row_mask:0xf bank_mask:0xf
    v_dot2c_f32_bf16_dpp v18, v22, v91 row_newbcast:6 row_mask:0xf bank_mask:0xf
    v_dot2c_f32_bf16_dpp v19, v52, v91 row_newbcast:6 row_mask:0xf bank_mask:0xf
    s_add_u32 s6, s56, 204800
    s_and_b32 s6, s6, 0xfffff
    s_waitcnt vmcnt(4)
    s_cmp_lt_u32 s3, 4
    s_cbranch_scc1 W_86
    s_waitcnt vmcnt(3)
W_86:
    buffer_load_dwordx4 v[72:75], v1, s[12:15], s6 offen nt
    s_waitcnt vmcnt(11)
    v_dot2c_f32_bf16_dpp v12, v22, v92 row_newbcast:7 row_mask:0xf bank_mask:0xf
    v_dot2c_f32_bf16_dpp v13, v52, v92 row_newbcast:7 row_mask:0xf bank_mask:0xf
    v_dot2c_f32_bf16_dpp v14, v22, v93 row_newbcast:7 row_mask:0xf bank_mask:0xf
    v_dot2c_f32_bf16_dpp v15, v52, v93 row_newbcast:7 row_mask:0xf bank_mask:0xf
    v_dot2c_f32_bf16_dpp v16, v22, v94 row_newbcast:7 row_mask:0xf bank_mask:0xf
    v_dot2c_f32_bf16_dpp v17, v52, v94 row_newbcast:7 row_mask:0xf bank_mask:0xf
    v_dot2c_f32_bf16_dpp v18, v22, v95 row_newbcast:7 row_mask:0xf bank_mask:0xf
    v_dot2c_f32_bf16_dpp v19, v52, v95 row_newbcast:7 row_mask:0xf bank_mask:0xf
    s_add_u32 s6, s56, 208896
    s_and_b32 s6, s6, 0xfffff
    s_waitcnt vmcnt(5)
    s_cmp_lt_u32 s3, 4
    s_cbranch_scc1 W_87
    s_waitcnt vmcnt(4)
W_87:
    buffer_load_dwordx4 v[76:79], v1, s[12:15], s6 offen nt
    s_waitcnt vmcnt(11)
    v_dot2c_f32_bf16_dpp v12, v22, v96 row_newbcast:8 row_mask:0xf bank_mask:0xf
    v_dot2c_f32_bf16_dpp v13, v52, v96 row_newbcast:8 row_mask:0xf bank_mask:0xf
    v_dot2c_f32_bf16_dpp v14, v22, v97 row_newbcast:8 row_mask:0xf bank_mask:0xf
    v_dot2c_f32_bf16_dpp v15, v52, v97 row_newbcast:8 row_mask:0xf bank_mask:0xf
    v_dot2c_f32_bf16_dpp v16, v22, v98 row_newbcast:8 row_mask:0xf bank_mask:0xf
    v_dot2c_f32_bf16_dpp v17, v52, v98 row_newbcast:8 row_mask:0xf bank_mask:0xf
    v_dot2c_f32_bf16_dpp v18, v22, v99 row_newbcast:8 row_mask:0xf bank_mask:0xf
    v_dot2c_f32_bf16_dpp v19, v52, v99 row_newbcast:8 row_mask:0xf bank_mask:0xf
    s_add_u32 s6, s56, 212992
    s_and_b32 s6, s6, 0xfffff
    s_waitcnt vmcnt(4)
    s_cmp_lt_u32 s3, 4
    s_cbranch_scc1 W_88
    s_waitcnt vmcnt(3)
W_88:
    buffer_load_dwordx4 v[80:83], v1, s[12:15], s6 offen nt
    s_waitcnt vmcnt(11)
    v_dot2c_f32_bf16_dpp v12, v22, v100 row_newbcast:9 row_mask:0xf bank_mask:0xf
    v_dot2c_f32_bf16_dpp v13, v52, v100 row_newbcast:9 row_mask:0xf bank_mask:0xf
    v_dot2c_f32_bf16_dpp v14, v22, v101 row_newbcast:9 row_mask:0xf bank_mask:0xf
    v_dot2c_f32_bf16_dpp v15, v52, v101 row_newbcast:9 row_mask:0xf bank_mask:0xf
    v_dot2c_f32_bf16_dpp v16, v22, v102 row_newbcast:9 row_mask:0xf bank_mask:0xf
    v_dot2c_f32_bf16_dpp v17, v52, v102 row_newbcast:9 row_mask:0xf bank_mask:0xf
    v_dot2c_f32_bf16_dpp v18, v22, v103 row_newbcast:9 row_mask:0xf bank_mask:0xf
    v_dot2c_f32_bf16_dpp v19, v52, v103 row_newbcast:9 row_mask:0xf bank_mask:0xf
    s_add_u32 s6, s56, 217088
    s_and_b32 s6, s6, 0xfffff
    s_waitcnt vmcnt(5)
    s_cmp_lt_u32 s3, 4
    s_cbranch_scc1 W_89
    s_waitcnt vmcnt(4)
W_89:
    buffer_load_dwordx4 v[84:87], v1, s[12:15], s6 offen nt
    s_waitcnt vmcnt(11)
    v_dot2c_f32_bf16_dpp v12, v22, v104 row_newbcast:10 row_mask:0xf bank_mask:0xf
    v_dot2c_f32_bf16_dpp v13, v52, v104 row_newbcast:10 row_mask:0xf bank_mask:0xf
    v_dot2c_f32_bf16_dpp v14, v22, v105 row_newbcast:10 row_mask:0xf bank_mask:0xf
    v_dot2c_f32_bf16_dpp v15, v52, v105 row_newbcast:10 row_mask:0xf bank_mask:0xf
    v_dot2c_f32_bf16_dpp v16, v22, v106 row_newbcast:10 row_mask:0xf bank_mask:0xf
    v_dot2c_f32_bf16_dpp v17, v52, v106 row_newbcast:10 row_mask:0xf bank_mask:0xf
    v_dot2c_f32_bf16_dpp v18, v22, v107 row_newbcast:10 row_mask:0xf bank_mask:0xf
    v_dot2c_f32_bf16_dpp v19, v52, v107 row_newbcast:10 row_mask:0xf bank_mask:0xf
    s_add_u32 s6, s56, 221184
    s_and_b32 s6, s6, 0xfffff
    s_waitcnt vmcnt(4)
    s_cmp_lt_u32 s3, 4
    s_cbranch_scc1 W_90
    s_waitcnt vmcnt(3)
W_90:
    buffer_load_dwordx4 v[88:91], v1, s[12:15], s6 offen nt
    s_waitcnt vmcnt(11)
    v_dot2c_f32_bf16_dpp v12, v22, v108 row_newbcast:11 row_mask:0xf bank_mask:0xf
    v_dot2c_f32_bf16_dpp v13, v52, v108 row_newbcast:11 row_mask:0xf bank_mask:0xf
    v_dot2c_f32_bf16_dpp v14, v22, v109 row_newbcast:11 row_mask:0xf bank_mask:0xf
    v_dot2c_f32_bf16_dpp v15, v52, v109 row_newbcast:11 row_mask:0xf bank_mask:0xf
    v_dot2c_f32_bf16_dpp v16, v22, v110 row_newbcast:11 row_mask:0xf bank_mask:0xf
    v_dot2c_f32_bf16_dpp v17, v52, v110 row_newbcast:11 row_mask:0xf bank_mask:0xf
    v_dot2c_f32_bf16_dpp v18, v22, v111 row_newbcast:11 row_mask:0xf bank_mask:0xf
    v_dot2c_f32_bf16_dpp v19, v52, v111 row_newbcast:11 row_mask:0xf bank_mask:0xf
    s_add_u32 s6, s56, 225280
    s_and_b32 s6, s6, 0xfffff
    s_waitcnt vmcnt(5)
    s_cmp_lt_u32 s3, 4
    s_cbranch_scc1 W_91
    s_waitcnt vmcnt(4)
W_91:
    buffer_load_dwordx4 v[92:95], v1, s[12:15], s6 offen nt
    s_waitcnt vmcnt(11)
    v_dot2c_f32_bf16_dpp v12, v22, v112 row_newbcast:12 row_mask:0xf bank_mask:0xf
    v_dot2c_f32_bf16_dpp v13, v52, v112 row_newbcast:12 row_mask:0xf bank_mask:0xf
    v_dot2c_f32_bf16_dpp v14, v22, v113 row_newbcast:12 row_mask:0xf bank_mask:0xf
    v_dot2c_f32_bf16_dpp v15, v52, v113 row_newbcast:12 row_mask:0xf bank_mask:0xf
    v_dot2c_f32_bf16_dpp v16, v22, v114 row_newbcast:12 row_mask:0xf bank_mask:0xf
    v_dot2c_f32_bf16_dpp v17, v52, v114 row_newbcast:12 row_mask:0xf bank_mask:0xf
    v_dot2c_f32_bf16_dpp v18, v22, v115 row_newbcast:12 row_mask:0xf bank_mask:0xf
    v_dot2c_f32_bf16_dpp v19, v52, v115 row_newbcast:12 row_mask:0xf bank_mask:0xf
    s_add_u32 s6, s56, 229376
    s_and_b32 s6, s6, 0xfffff
    s_waitcnt vmcnt(4)
    s_cmp_lt_u32 s3, 4
    s_cbranch_scc1 W_92
    s_waitcnt vmcnt(3)
W_92:
    buffer_load_dwordx4 v[96:99], v1, s[12:15], s6 offen nt
    s_waitcnt vmcnt(11)
    v_dot2c_f32_bf16_dpp v12, v22, v116 row_newbcast:13 row_mask:0xf bank_mask:0xf
    v_dot2c_f32_bf16_dpp v13, v52, v116 row_newbcast:13 row_mask:0xf bank_mask:0xf
    v_dot2c_f32_bf16_dpp v14, v22, v117 row_newbcast:13 row_mask:0xf bank_mask:0xf
    v_dot2c_f32_bf16_dpp v15, v52, v117 row_newbcast:13 row_mask:0xf bank_mask:0xf
    v_dot2c_f32_bf16_dpp v16, v22, v118 row_newbcast:13 row_mask:0xf bank_mask:0xf
    v_dot2c_f32_bf16_dpp v17, v52, v118 row_newbcast:13 row_mask:0xf bank_mask:0xf
    v_dot2c_f32_bf16_dpp v18, v22, v119 row_newbcast:13 row_mask:0xf bank_mask:0xf
    v_dot2c_f32_bf16_dpp v19, v52, v119 row_newbcast:13 row_mask:0xf bank_mask:0xf
    s_add_u32 s6, s56, 233472
    s_and_b32 s6, s6, 0xfffff
    s_waitcnt vmcnt(5)
    s_cmp_lt_u32 s3, 4
    s_cbranch_scc1 W_93
    s_waitcnt vmcnt(4)
W_93:
    buffer_load_dwordx4 v[100:103], v1, s[12:15], s6 offen nt
    s_waitcnt vmcnt(11)
    v_dot2c_f32_bf16_dpp v12, v22, v120 row_newbcast:14 row_mask:0xf bank_mask:0xf
    v_dot2c_f32_bf16_dpp v13, v52, v120 row_newbcast:14 row_mask:0xf bank_mask:0xf
    v_dot2c_f32_bf16_dpp v14, v22, v121 row_newbcast:14 row_mask:0xf bank_mask:0xf
    v_dot2c_f32_bf16_dpp v15, v52, v121 row_newbcast:14 row_mask:0xf bank_mask:0xf
    v_dot2c_f32_bf16_dpp v16, v22, v122 row_newbcast:14 row_mask:0xf bank_mask:0xf
    v_dot2c_f32_bf16_dpp v17, v52, v122 row_newbcast:14 row_mask:0xf bank_mask:0xf
    v_dot2c_f32_bf16_dpp v18, v22, v123 row_newbcast:14 row_mask:0xf bank_mask:0xf
    v_dot2c_f32_bf16_dpp v19, v52, v123 row_newbcast:14 row_mask:0xf bank_mask:0xf
    s_add_u32 s6, s56, 237568
    s_and_b32 s6, s6, 0xfffff
    s_waitcnt vmcnt(4)
    s_cmp_lt_u32 s3, 4
    s_cbranch_scc1 W_94
    s_waitcnt vmcnt(3)
W_94:
    buffer_load_dwordx4 v[104:107], v1, s[12:15], s6 offen nt
    s_waitcnt vmcnt(11)
    v_dot2c_f32_bf16_dpp v12, v22, v124 row_newbcast:15 row_mask:0xf bank_mask:0xf
    v_dot2c_f32_bf16_dpp v13, v52, v124 row_newbcast:15 row_mask:0xf bank_mask:0xf
    v_dot2c_f32_bf16_dpp v14, v22, v125 row_newbcast:15 row_mask:0xf bank_mask:0xf
    v_dot2c_f32_bf16_dpp v15, v52, v125 row_newbcast:15 row_mask:0xf bank_mask:0xf
    v_dot2c_f32_bf16_dpp v16, v22, v126 row_newbcast:15 row_mask:0xf bank_mask:0xf
    v_dot2c_f32_bf16_dpp v17, v52, v126 row_newbcast:15 row_mask:0xf bank_mask:0xf
    v_dot2c_f32_bf16_dpp v18, v22, v127 row_newbcast:15 row_mask:0xf bank_mask:0xf
    v_dot2c_f32_bf16_dpp v19, v52, v127 row_newbcast:15 row_mask:0xf bank_mask:0xf
    s_add_u32 s6, s56, 241664
    s_and_b32 s6, s6, 0xfffff
    s_waitcnt vmcnt(5)
    s_cmp_lt_u32 s3, 4
    s_cbranch_scc1 W_95
    s_waitcnt vmcnt(4)
W_95:
    buffer_load_dwordx4 v[108:111], v1, s[12:15], s6 offen nt
    v_lshlrev_b32 v54, 16, v23
    s_nop 1
    s_waitcnt vmcnt(11)
    v_dot2c_f32_bf16_dpp v12, v23, v64 row_newbcast:0 row_mask:0xf bank_mask:0xf
    v_dot2c_f32_bf16_dpp v13, v54, v64 row_newbcast:0 row_mask:0xf bank_mask:0xf
    v_dot2c_f32_bf16_dpp v14, v23, v65 row_newbcast:0 row_mask:0xf bank_mask:0xf
    v_dot2c_f32_bf16_dpp v15, v54, v65 row_newbcast:0 row_mask:0xf bank_mask:0xf
    v_dot2c_f32_bf16_dpp v16, v23, v66 row_newbcast:0 row_mask:0xf bank_mask:0xf
    v_dot2c_f32_bf16_dpp v17, v54, v66 row_newbcast:0 row_mask:0xf bank_mask:0xf
    v_dot2c_f32_bf16_dpp v18, v23, v67 row_newbcast:0 row_mask:0xf bank_mask:0xf
    v_dot2c_f32_bf16_dpp v19, v54, v67 row_newbcast:0 row_mask:0xf bank_mask:0xf
    s_add_u32 s6, s56, 245760
    s_and_b32 s6, s6, 0xfffff
    s_waitcnt vmcnt(4)
    s_cmp_lt_u32 s3, 4
    s_cbranch_scc1 W_96
    s_waitcnt vmcnt(3)
W_96:
    buffer_load_dwordx4 v[112:115], v1, s[12:15], s6 offen nt
    s_waitcnt vmcnt(11)
    v_dot2c_f32_bf16_dpp v12, v23, v68 row_newbcast:1 row_mask:0xf bank_mask:0xf
    v_dot2c_f32_bf16_dpp v13, v54, v68 row_newbcast:1 row_mask:0xf bank_mask:0xf
    v_dot2c_f32_bf16_dpp v14, v23, v69 row_newbcast:1 row_mask:0xf bank_mask:0xf
    v_dot2c_f32_bf16_dpp v15, v54, v69 row_newbcast:1 row_mask:0xf bank_mask:0xf
    v_dot2c_f32_bf16_dpp v16, v23, v70 row_newbcast:1 row_mask:0xf bank_mask:0xf
    v_dot2c_f32_bf16_dpp v17, v54, v70 row_newbcast:1 row_mask:0xf bank_mask:0xf
    v_dot2c_f32_bf16_dpp v18, v23, v71 row_newbcast:1 row_mask:0xf bank_mask:0xf
    v_dot2c_f32_bf16_dpp v19, v54, v71 row_newbcast:1 row_mask:0xf bank_mask:0xf
    s_add_u32 s6, s56, 249856
    s_and_b32 s6, s6, 0xfffff
    s_waitcnt vmcnt(5)
    s_cmp_lt_u32 s3, 4
    s_cbranch_scc1 W_97
    s_waitcnt vmcnt(4)
W_97:
    buffer_load_dwordx4 v[116:119], v1, s[12:15], s6 offen nt
    s_waitcnt vmcnt(11)
    v_dot2c_f32_bf16_dpp v12, v23, v72 row_newbcast:2 row_mask:0xf bank_mask:0xf
    v_dot2c_f32_bf16_dpp v13, v54, v72 row_newbcast:2 row_mask:0xf bank_mask:0xf
    v_dot2c_f32_bf16_dpp v14, v23, v73 row_newbcast:2 row_mask:0xf bank_mask:0xf
    v_dot2c_f32_bf16_dpp v15, v54, v73 row_newbcast:2 row_mask:0xf bank_mask:0xf
    v_dot2c_f32_bf16_dpp v16, v23, v74 row_newbcast:2 row_mask:0xf bank_mask:0xf
    v_dot2c_f32_bf16_dpp v17, v54, v74 row_newbcast:2 row_mask:0xf bank_mask:0xf
    v_dot2c_f32_bf16_dpp v18, v23, v75 row_newbcast:2 row_mask:0xf bank_mask:0xf
    v_dot2c_f32_bf16_dpp v19, v54, v75 row_newbcast:2 row_mask:0xf bank_mask:0xf
    s_add_u32 s6, s56, 253952
    s_and_b32 s6, s6, 0xfffff
    s_waitcnt vmcnt(4)
    s_cmp_lt_u32 s3, 4
    s_cbranch_scc1 W_98
    s_waitcnt vmcnt(3)
W_98:
    buffer_load_dwordx4 v[120:123], v1, s[12:15], s6 offen nt
    s_waitcnt vmcnt(11)
    v_dot2c_f32_bf16_dpp v12, v23, v76 row_newbcast:3 row_mask:0xf bank_mask:0xf
    v_dot2c_f32_bf16_dpp v13, v54, v76 row_newbcast:3 row_mask:0xf bank_mask:0xf
    v_dot2c_f32_bf16_dpp v14, v23, v77 row_newbcast:3 row_mask:0xf bank_mask:0xf
    v_dot2c_f32_bf16_dpp v15, v54, v77 row_newbcast:3 row_mask:0xf bank_mask:0xf
    v_dot2c_f32_bf16_dpp v16, v23, v78 row_newbcast:3 row_mask:0xf bank_mask:0xf
    v_dot2c_f32_bf16_dpp v17, v54, v78 row_newbcast:3 row_mask:0xf bank_mask:0xf
    v_dot2c_f32_bf16_dpp v18, v23, v79 row_newbcast:3 row_mask:0xf bank_mask:0xf
    v_dot2c_f32_bf16_dpp v19, v54, v79 row_newbcast:3 row_mask:0xf bank_mask:0xf
    s_add_u32 s6, s56, 258048
    s_and_b32 s6, s6, 0xfffff
    s_waitcnt vmcnt(5)
    s_cmp_lt_u32 s3, 4
    s_cbranch_scc1 W_99
    s_waitcnt vmcnt(4)
W_99:
    buffer_load_dwordx4 v[124:127], v1, s[12:15], s6 offen nt
    s_waitcnt vmcnt(11)
    v_dot2c_f32_bf16_dpp v12, v23, v80 row_newbcast:4 row_mask:0xf bank_mask:0xf
    v_dot2c_f32_bf16_dpp v13, v54, v80 row_newbcast:4 row_mask:0xf bank_mask:0xf
    v_dot2c_f32_bf16_dpp v14, v23, v81 row_newbcast:4 row_mask:0xf bank_mask:0xf
    v_dot2c_f32_bf16_dpp v15, v54, v81 row_newbcast:4 row_mask:0xf bank_mask:0xf
    v_dot2c_f32_bf16_dpp v16, v23, v82 row_newbcast:4 row_mask:0xf bank_mask:0xf
    v_dot2c_f32_bf16_dpp v17, v54, v82 row_newbcast:4 row_mask:0xf bank_mask:0xf
    v_dot2c_f32_bf16_dpp v18, v23, v83 row_newbcast:4 row_mask:0xf bank_mask:0xf
    v_dot2c_f32_bf16_dpp v19, v54, v83 row_newbcast:4 row_mask:0xf bank_mask:0xf
    s_add_u32 s6, s56, 262144
    s_and_b32 s6, s6, 0xfffff
    s_waitcnt vmcnt(4)
    s_cmp_lt_u32 s3, 4
    s_cbranch_scc1 W_100
    s_waitcnt vmcnt(3)
W_100:
    buffer_load_dwordx4 v[64:67], v1, s[12:15], s6 offen nt
    s_waitcnt vmcnt(11)
    v_dot2c_f32_bf16_dpp v12, v23, v84 row_newbcast:5 row_mask:0xf bank_mask:0xf
    v_dot2c_f32_bf16_dpp v13, v54, v84 row_newbcast:5 row_mask:0xf bank_mask:0xf
    v_dot2c_f32_bf16_dpp v14, v23, v85 row_newbcast:5 row_mask:0xf bank_mask:0xf
    v_dot2c_f32_bf16_dpp v15, v54, v85 row_newbcast:5 row_mask:0xf bank_mask:0xf
    v_dot2c_f32_bf16_dpp v16, v23, v86 row_newbcast:5 row_mask:0xf bank_mask:0xf
    v_dot2c_f32_bf16_dpp v17, v54, v86 row_newbcast:5 row_mask:0xf bank_mask:0xf
    v_dot2c_f32_bf16_dpp v18, v23, v87 row_newbcast:5 row_mask:0xf bank_mask:0xf
    v_dot2c_f32_bf16_dpp v19, v54, v87 row_newbcast:5 row_mask:0xf bank_mask:0xf
    s_add_u32 s6, s56, 266240
    s_and_b32 s6, s6, 0xfffff
    s_waitcnt vmcnt(5)
    s_cmp_lt_u32 s3, 4
    s_cbranch_scc1 W_101
    s_waitcnt vmcnt(4)
W_101:
    buffer_load_dwordx4 v[68:71], v1, s[12:15], s6 offen nt
    s_waitcnt vmcnt(11)
    v_dot2c_f32_bf16_dpp v12, v23, v88 row_newbcast:6 row_mask:0xf bank_mask:0xf
    v_dot2c_f32_bf16_dpp v13, v54, v88 row_newbcast:6 row_mask:0xf bank_mask:0xf
    v_dot2c_f32_bf16_dpp v14, v23, v89 row_newbcast:6 row_mask:0xf bank_mask:0xf
    v_dot2c_f32_bf16_dpp v15, v54, v89 row_newbcast:6 row_mask:0xf bank_mask:0xf
    v_dot2c_f32_bf16_dpp v16, v23, v90 row_newbcast:6 row_mask:0xf bank_mask:0xf
    v_dot2c_f32_bf16_dpp v17, v54, v90 row_newbcast:6 row_mask:0xf bank_mask:0xf
    v_dot2c_f32_bf16_dpp v18, v23, v91 row_newbcast:6 row_mask:0xf bank_mask:0xf
    v_dot2c_f32_bf16_dpp v19, v54, v91 row_newbcast:6 row_mask:0xf bank_mask:0xf
    s_add_u32 s6, s56, 270336
    s_and_b32 s6, s6, 0xfffff
    s_waitcnt vmcnt(4)
    s_cmp_lt_u32 s3, 4
    s_cbranch_scc1 W_102
    s_waitcnt vmcnt(3)
W_102:
    buffer_load_dwordx4 v[72:75], v1, s[12:15], s6 offen nt
    s_waitcnt vmcnt(11)
    v_dot2c_f32_bf16_dpp v12, v23, v92 row_newbcast:7 row_mask:0xf bank_mask:0xf
    v_dot2c_f32_bf16_dpp v13, v54, v92 row_newbcast:7 row_mask:0xf bank_mask:0xf
    v_dot2c_f32_bf16_dpp v14, v23, v93 row_newbcast:7 row_mask:0xf bank_mask:0xf
    v_dot2c_f32_bf16_dpp v15, v54, v93 row_newbcast:7 row_mask:0xf bank_mask:0xf
    v_dot2c_f32_bf16_dpp v16, v23, v94 row_newbcast:7 row_mask:0xf bank_mask:0xf
    v_dot2c_f32_bf16_dpp v17, v54, v94 row_newbcast:7 row_mask:0xf bank_mask:0xf
    v_dot2c_f32_bf16_dpp v18, v23, v95 row_newbcast:7 row_mask:0xf bank_mask:0xf
    v_dot2c_f32_bf16_dpp v19, v54, v95 row_newbcast:7 row_mask:0xf bank_mask:0xf
    s_add_u32 s6, s56, 274432
    s_and_b32 s6, s6, 0xfffff
    s_waitcnt vmcnt(5)
    s_cmp_lt_u32 s3, 4
    s_cbranch_scc1 W_103
    s_waitcnt vmcnt(4)
W_103:
    buffer_load_dwordx4 v[76:79], v1, s[12:15], s6 offen nt
    s_waitcnt vmcnt(11)
    v_dot2c_f32_bf16_dpp v12, v23, v96 row_newbcast:8 row_mask:0xf bank_mask:0xf
    v_dot2c_f32_bf16_dpp v13, v54, v96 row_newbcast:8 row_mask:0xf bank_mask:0xf
    v_dot2c_f32_bf16_dpp v14, v23, v97 row_newbcast:8 row_mask:0xf bank_mask:0xf
    v_dot2c_f32_bf16_dpp v15, v54, v97 row_newbcast:8 row_mask:0xf bank_mask:0xf
    v_dot2c_f32_bf16_dpp v16, v23, v98 row_newbcast:8 row_mask:0xf bank_mask:0xf
    v_dot2c_f32_bf16_dpp v17, v54, v98 row_newbcast:8 row_mask:0xf bank_mask:0xf
    v_dot2c_f32_bf16_dpp v18, v23, v99 row_newbcast:8 row_mask:0xf bank_mask:0xf
    v_dot2c_f32_bf16_dpp v19, v54, v99 row_newbcast:8 row_mask:0xf bank_mask:0xf
    s_add_u32 s6, s56, 278528
    s_and_b32 s6, s6, 0xfffff
    s_waitcnt vmcnt(4)
    s_cmp_lt_u32 s3, 4
    s_cbranch_scc1 W_104
    s_waitcnt vmcnt(3)
W_104:
    buffer_load_dwordx4 v[80:83], v1, s[12:15], s6 offen nt
    s_waitcnt vmcnt(11)
    v_dot2c_f32_bf16_dpp v12, v23, v100 row_newbcast:9 row_mask:0xf bank_mask:0xf
    v_dot2c_f32_bf16_dpp v13, v54, v100 row_newbcast:9 row_mask:0xf bank_mask:0xf
    v_dot2c_f32_bf16_dpp v14, v23, v101 row_newbcast:9 row_mask:0xf bank_mask:0xf
    v_dot2c_f32_bf16_dpp v15, v54, v101 row_newbcast:9 row_mask:0xf bank_mask:0xf
    v_dot2c_f32_bf16_dpp v16, v23, v102 row_newbcast:9 row_mask:0xf bank_mask:0xf
    v_dot2c_f32_bf16_dpp v17, v54, v102 row_newbcast:9 row_mask:0xf bank_mask:0xf
    v_dot2c_f32_bf16_dpp v18, v23, v103 row_newbcast:9 row_mask:0xf bank_mask:0xf
    v_dot2c_f32_bf16_dpp v19, v54, v103 row_newbcast:9 row_mask:0xf bank_mask:0xf
    s_add_u32 s6, s56, 282624
    s_and_b32 s6, s6, 0xfffff
    s_waitcnt vmcnt(5)
    s_cmp_lt_u32 s3, 4
    s_cbranch_scc1 W_105
    s_waitcnt vmcnt(4)
W_105:
    buffer_load_dwordx4 v[84:87], v1, s[12:15], s6 offen nt
    s_waitcnt vmcnt(11)
    v_dot2c_f32_bf16_dpp v12, v23, v104 row_newbcast:10 row_mask:0xf bank_mask:0xf
    v_dot2c_f32_bf16_dpp v13, v54, v104 row_newbcast:10 row_mask:0xf bank_mask:0xf
    v_dot2c_f32_bf16_dpp v14, v23, v105 row_newbcast:10 row_mask:0xf bank_mask:0xf
    v_dot2c_f32_bf16_dpp v15, v54, v105 row_newbcast:10 row_mask:0xf bank_mask:0xf
    v_dot2c_f32_bf16_dpp v16, v23, v106 row_newbcast:10 row_mask:0xf bank_mask:0xf
    v_dot2c_f32_bf16_dpp v17, v54, v106 row_newbcast:10 row_mask:0xf bank_mask:0xf
    v_dot2c_f32_bf16_dpp v18, v23, v107 row_newbcast:10 row_mask:0xf bank_mask:0xf
    v_dot2c_f32_bf16_dpp v19, v54, v107 row_newbcast:10 row_mask:0xf bank_mask:0xf
    s_add_u32 s6, s56, 286720
    s_and_b32 s6, s6, 0xfffff
    s_waitcnt vmcnt(4)
    s_cmp_lt_u32 s3, 4
    s_cbranch_scc1 W_106
    s_waitcnt vmcnt(3)
W_106:
    buffer_load_dwordx4 v[88:91], v1, s[12:15], s6 offen nt
    s_waitcnt vmcnt(11)
    v_dot2c_f32_bf16_dpp v12, v23, v108 row_newbcast:11 row_mask:0xf bank_mask:0xf
    v_dot2c_f32_bf16_dpp v13, v54, v108 row_newbcast:11 row_mask:0xf bank_mask:0xf
    v_dot2c_f32_bf16_dpp v14, v23, v109 row_newbcast:11 row_mask:0xf bank_mask:0xf
    v_dot2c_f32_bf16_dpp v15, v54, v109 row_newbcast:11 row_mask:0xf bank_mask:0xf
    v_dot2c_f32_bf16_dpp v16, v23, v110 row_newbcast:11 row_mask:0xf bank_mask:0xf
    v_dot2c_f32_bf16_dpp v17, v54, v110 row_newbcast:11 row_mask:0xf bank_mask:0xf
    v_dot2c_f32_bf16_dpp v18, v23, v111 row_newbcast:11 row_mask:0xf bank_mask:0xf
    v_dot2c_f32_bf16_dpp v19, v54, v111 row_newbcast:11 row_mask:0xf bank_mask:0xf
    s_add_u32 s6, s56, 290816
    s_and_b32 s6, s6, 0xfffff
    s_waitcnt vmcnt(5)
    s_cmp_lt_u32 s3, 4
    s_cbranch_scc1 W_107
    s_waitcnt vmcnt(4)
W_107:
    buffer_load_dwordx4 v[92:95], v1, s[12:15], s6 offen nt
    s_waitcnt vmcnt(11)
    v_dot2c_f32_bf16_dpp v12, v23, v112 row_newbcast:12 row_mask:0xf bank_mask:0xf
    v_dot2c_f32_bf16_dpp v13, v54, v112 row_newbcast:12 row_mask:0xf bank_mask:0xf
    v_dot2c_f32_bf16_dpp v14, v23, v113 row_newbcast:12 row_mask:0xf bank_mask:0xf
    v_dot2c_f32_bf16_dpp v15, v54, v113 row_newbcast:12 row_mask:0xf bank_mask:0xf
    v_dot2c_f32_bf16_dpp v16, v23, v114 row_newbcast:12 row_mask:0xf bank_mask:0xf
    v_dot2c_f32_bf16_dpp v17, v54, v114 row_newbcast:12 row_mask:0xf bank_mask:0xf
    v_dot2c_f32_bf16_dpp v18, v23, v115 row_newbcast:12 row_mask:0xf bank_mask:0xf
    v_dot2c_f32_bf16_dpp v19, v54, v115 row_newbcast:12 row_mask:0xf bank_mask:0xf
    s_add_u32 s6, s56, 294912
    s_and_b32 s6, s6, 0xfffff
    s_waitcnt vmcnt(4)
    s_cmp_lt_u32 s3, 4
    s_cbranch_scc1 W_108
    s_waitcnt vmcnt(3)
W_108:
    buffer_load_dwordx4 v[96:99], v1, s[12:15], s6 offen nt
    s_waitcnt vmcnt(11)
    v_dot2c_f32_bf16_dpp v12, v23, v116 row_newbcast:13 row_mask:0xf bank_mask:0xf
    v_dot2c_f32_bf16_dpp v13, v54, v116 row_newbcast:13 row_mask:0xf bank_mask:0xf
    v_dot2c_f32_bf16_dpp v14, v23, v117 row_newbcast:13 row_mask:0xf bank_mask:0xf
    v_dot2c_f32_bf16_dpp v15, v54, v117 row_newbcast:13 row_mask:0xf bank_mask:0xf
    v_dot2c_f32_bf16_dpp v16, v23, v118 row_newbcast:13 row_mask:0xf bank_mask:0xf
    v_dot2c_f32_bf16_dpp v17, v54, v118 row_newbcast:13 row_mask:0xf bank_mask:0xf
    v_dot2c_f32_bf16_dpp v18, v23, v119 row_newbcast:13 row_mask:0xf bank_mask:0xf
    v_dot2c_f32_bf16_dpp v19, v54, v119 row_newbcast:13 row_mask:0xf bank_mask:0xf
    s_add_u32 s6, s56, 299008
    s_and_b32 s6, s6, 0xfffff
    s_waitcnt vmcnt(5)
    s_cmp_lt_u32 s3, 4
    s_cbranch_scc1 W_109
    s_waitcnt vmcnt(4)
W_109:
    buffer_load_dwordx4 v[100:103], v1, s[12:15], s6 offen nt
    s_waitcnt vmcnt(11)
    v_dot2c_f32_bf16_dpp v12, v23, v120 row_newbcast:14 row_mask:0xf bank_mask:0xf
    v_dot2c_f32_bf16_dpp v13, v54, v120 row_newbcast:14 row_mask:0xf bank_mask:0xf
    v_dot2c_f32_bf16_dpp v14, v23, v121 row_newbcast:14 row_mask:0xf bank_mask:0xf
    v_dot2c_f32_bf16_dpp v15, v54, v121 row_newbcast:14 row_mask:0xf bank_mask:0xf
    v_dot2c_f32_bf16_dpp v16, v23, v122 row_newbcast:14 row_mask:0xf bank_mask:0xf
    v_dot2c_f32_bf16_dpp v17, v54, v122 row_newbcast:14 row_mask:0xf bank_mask:0xf
    v_dot2c_f32_bf16_dpp v18, v23, v123 row_newbcast:14 row_mask:0xf bank_mask:0xf
    v_dot2c_f32_bf16_dpp v19, v54, v123 row_newbcast:14 row_mask:0xf bank_mask:0xf
    s_add_u32 s6, s56, 303104
    s_and_b32 s6, s6, 0xfffff
    s_waitcnt vmcnt(4)
    s_cmp_lt_u32 s3, 4
    s_cbranch_scc1 W_110
    s_waitcnt vmcnt(3)
W_110:
    buffer_load_dwordx4 v[104:107], v1, s[12:15], s6 offen nt
    s_waitcnt vmcnt(11)
    v_dot2c_f32_bf16_dpp v12, v23, v124 row_newbcast:15 row_mask:0xf bank_mask:0xf
    v_dot2c_f32_bf16_dpp v13, v54, v124 row_newbcast:15 row_mask:0xf bank_mask:0xf
    v_dot2c_f32_bf16_dpp v14, v23, v125 row_newbcast:15 row_mask:0xf bank_mask:0xf
    v_dot2c_f32_bf16_dpp v15, v54, v125 row_newbcast:15 row_mask:0xf bank_mask:0xf
    v_dot2c_f32_bf16_dpp v16, v23, v126 row_newbcast:15 row_mask:0xf bank_mask:0xf
    v_dot2c_f32_bf16_dpp v17, v54, v126 row_newbcast:15 row_mask:0xf bank_mask:0xf
    v_dot2c_f32_bf16_dpp v18, v23, v127 row_newbcast:15 row_mask:0xf bank_mask:0xf
    v_dot2c_f32_bf16_dpp v19, v54, v127 row_newbcast:15 row_mask:0xf bank_mask:0xf
    s_add_u32 s6, s56, 307200
    s_and_b32 s6, s6, 0xfffff
    s_waitcnt vmcnt(5)
    s_cmp_lt_u32 s3, 4
    s_cbranch_scc1 W_111
    s_waitcnt vmcnt(4)
W_111:
    buffer_load_dwordx4 v[108:111], v1, s[12:15], s6 offen nt
    v_lshlrev_b32 v52, 16, v24
    s_nop 1
    s_waitcnt vmcnt(11)
    v_dot2c_f32_bf16_dpp v12, v24, v64 row_newbcast:0 row_mask:0xf bank_mask:0xf
    v_dot2c_f32_bf16_dpp v13, v52, v64 row_newbcast:0 row_mask:0xf bank_mask:0xf
    v_dot2c_f32_bf16_dpp v14, v24, v65 row_newbcast:0 row_mask:0xf bank_mask:0xf
    v_dot2c_f32_bf16_dpp v15, v52, v65 row_newbcast:0 row_mask:0xf bank_mask:0xf
    v_dot2c_f32_bf16_dpp v16, v24, v66 row_newbcast:0 row_mask:0xf bank_mask:0xf
    v_dot2c_f32_bf16_dpp v17, v52, v66 row_newbcast:0 row_mask:0xf bank_mask:0xf
    v_dot2c_f32_bf16_dpp v18, v24, v67 row_newbcast:0 row_mask:0xf bank_mask:0xf
    v_dot2c_f32_bf16_dpp v19, v52, v67 row_newbcast:0 row_mask:0xf bank_mask:0xf
    s_add_u32 s6, s56, 311296
    s_and_b32 s6, s6, 0xfffff
    s_waitcnt vmcnt(4)
    s_cmp_lt_u32 s3, 4
    s_cbranch_scc1 W_112
    s_waitcnt vmcnt(3)
W_112:
    buffer_load_dwordx4 v[112:115], v1, s[12:15], s6 offen nt
    s_waitcnt vmcnt(11)
    v_dot2c_f32_bf16_dpp v12, v24, v68 row_newbcast:1 row_mask:0xf bank_mask:0xf
    v_dot2c_f32_bf16_dpp v13, v52, v68 row_newbcast:1 row_mask:0xf bank_mask:0xf
    v_dot2c_f32_bf16_dpp v14, v24, v69 row_newbcast:1 row_mask:0xf bank_mask:0xf
    v_dot2c_f32_bf16_dpp v15, v52, v69 row_newbcast:1 row_mask:0xf bank_mask:0xf
    v_dot2c_f32_bf16_dpp v16, v24, v70 row_newbcast:1 row_mask:0xf bank_mask:0xf
    v_dot2c_f32_bf16_dpp v17, v52, v70 row_newbcast:1 row_mask:0xf bank_mask:0xf
    v_dot2c_f32_bf16_dpp v18, v24, v71 row_newbcast:1 row_mask:0xf bank_mask:0xf
    v_dot2c_f32_bf16_dpp v19, v52, v71 row_newbcast:1 row_mask:0xf bank_mask:0xf
    s_add_u32 s6, s56, 315392
    s_and_b32 s6, s6, 0xfffff
    s_waitcnt vmcnt(5)
    s_cmp_lt_u32 s3, 4
    s_cbranch_scc1 W_113
    s_waitcnt vmcnt(4)
W_113:
    buffer_load_dwordx4 v[116:119], v1, s[12:15], s6 offen nt
    s_waitcnt vmcnt(11)
    v_dot2c_f32_bf16_dpp v12, v24, v72 row_newbcast:2 row_mask:0xf bank_mask:0xf
    v_dot2c_f32_bf16_dpp v13, v52, v72 row_newbcast:2 row_mask:0xf bank_mask:0xf
    v_dot2c_f32_bf16_dpp v14, v24, v73 row_newbcast:2 row_mask:0xf bank_mask:0xf
    v_dot2c_f32_bf16_dpp v15, v52, v73 row_newbcast:2 row_mask:0xf bank_mask:0xf
    v_dot2c_f32_bf16_dpp v16, v24, v74 row_newbcast:2 row_mask:0xf bank_mask:0xf
    v_dot2c_f32_bf16_dpp v17, v52, v74 row_newbcast:2 row_mask:0xf bank_mask:0xf
    v_dot2c_f32_bf16_dpp v18, v24, v75 row_newbcast:2 row_mask:0xf bank_mask:0xf
    v_dot2c_f32_bf16_dpp v19, v52, v75 row_newbcast:2 row_mask:0xf bank_mask:0xf
    s_add_u32 s6, s56, 319488
    s_and_b32 s6, s6, 0xfffff
    s_waitcnt vmcnt(4)
    s_cmp_lt_u32 s3, 4
    s_cbranch_scc1 W_114
    s_waitcnt vmcnt(3)
W_114:
    buffer_load_dwordx4 v[120:123], v1, s[12:15], s6 offen nt
    s_waitcnt vmcnt(11)
    v_dot2c_f32_bf16_dpp v12, v24, v76 row_newbcast:3 row_mask:0xf bank_mask:0xf
    v_dot2c_f32_bf16_dpp v13, v52, v76 row_newbcast:3 row_mask:0xf bank_mask:0xf
    v_dot2c_f32_bf16_dpp v14, v24, v77 row_newbcast:3 row_mask:0xf bank_mask:0xf
    v_dot2c_f32_bf16_dpp v15, v52, v77 row_newbcast:3 row_mask:0xf bank_mask:0xf
    v_dot2c_f32_bf16_dpp v16, v24, v78 row_newbcast:3 row_mask:0xf bank_mask:0xf
    v_dot2c_f32_bf16_dpp v17, v52, v78 row_newbcast:3 row_mask:0xf bank_mask:0xf
    v_dot2c_f32_bf16_dpp v18, v24, v79 row_newbcast:3 row_mask:0xf bank_mask:0xf
    v_dot2c_f32_bf16_dpp v19, v52, v79 row_newbcast:3 row_mask:0xf bank_mask:0xf
    s_add_u32 s6, s56, 323584
    s_and_b32 s6, s6, 0xfffff
    s_waitcnt vmcnt(5)
    s_cmp_lt_u32 s3, 4
    s_cbranch_scc1 W_115
    s_waitcnt vmcnt(4)
W_115:
    buffer_load_dwordx4 v[124:127], v1, s[12:15], s6 offen nt
    s_waitcnt vmcnt(11)
    v_dot2c_f32_bf16_dpp v12, v24, v80 row_newbcast:4 row_mask:0xf bank_mask:0xf
    v_dot2c_f32_bf16_dpp v13, v52, v80 row_newbcast:4 row_mask:0xf bank_mask:0xf
    v_dot2c_f32_bf16_dpp v14, v24, v81 row_newbcast:4 row_mask:0xf bank_mask:0xf
    v_dot2c_f32_bf16_dpp v15, v52, v81 row_newbcast:4 row_mask:0xf bank_mask:0xf
    v_dot2c_f32_bf16_dpp v16, v24, v82 row_newbcast:4 row_mask:0xf bank_mask:0xf
    v_dot2c_f32_bf16_dpp v17, v52, v82 row_newbcast:4 row_mask:0xf bank_mask:0xf
    v_dot2c_f32_bf16_dpp v18, v24, v83 row_newbcast:4 row_mask:0xf bank_mask:0xf
    v_dot2c_f32_bf16_dpp v19, v52, v83 row_newbcast:4 row_mask:0xf bank_mask:0xf
    s_add_u32 s6, s56, 327680
    s_and_b32 s6, s6, 0xfffff
    s_waitcnt vmcnt(4)
    s_cmp_lt_u32 s3, 4
    s_cbranch_scc1 W_116
    s_waitcnt vmcnt(3)
W_116:
    buffer_load_dwordx4 v[64:67], v1, s[12:15], s6 offen nt
    s_waitcnt vmcnt(11)
    v_dot2c_f32_bf16_dpp v12, v24, v84 row_newbcast:5 row_mask:0xf bank_mask:0xf
    v_dot2c_f32_bf16_dpp v13, v52, v84 row_newbcast:5 row_mask:0xf bank_mask:0xf
    v_dot2c_f32_bf16_dpp v14, v24, v85 row_newbcast:5 row_mask:0xf bank_mask:0xf
    v_dot2c_f32_bf16_dpp v15, v52, v85 row_newbcast:5 row_mask:0xf bank_mask:0xf
    v_dot2c_f32_bf16_dpp v16, v24, v86 row_newbcast:5 row_mask:0xf bank_mask:0xf
    v_dot2c_f32_bf16_dpp v17, v52, v86 row_newbcast:5 row_mask:0xf bank_mask:0xf
    v_dot2c_f32_bf16_dpp v18, v24, v87 row_newbcast:5 row_mask:0xf bank_mask:0xf
    v_dot2c_f32_bf16_dpp v19, v52, v87 row_newbcast:5 row_mask:0xf bank_mask:0xf
    s_add_u32 s6, s56, 331776
    s_and_b32 s6, s6, 0xfffff
    s_waitcnt vmcnt(5)
    s_cmp_lt_u32 s3, 4
    s_cbranch_scc1 W_117
    s_waitcnt vmcnt(4)
W_117:
    buffer_load_dwordx4 v[68:71], v1, s[12:15], s6 offen nt
    s_waitcnt vmcnt(11)
    v_dot2c_f32_bf16_dpp v12, v24, v88 row_newbcast:6 row_mask:0xf bank_mask:0xf
    v_dot2c_f32_bf16_dpp v13, v52, v88 row_newbcast:6 row_mask:0xf bank_mask:0xf
    v_dot2c_f32_bf16_dpp v14, v24, v89 row_newbcast:6 row_mask:0xf bank_mask:0xf
    v_dot2c_f32_bf16_dpp v15, v52, v89 row_newbcast:6 row_mask:0xf bank_mask:0xf
    v_dot2c_f32_bf16_dpp v16, v24, v90 row_newbcast:6 row_mask:0xf bank_mask:0xf
    v_dot2c_f32_bf16_dpp v17, v52, v90 row_newbcast:6 row_mask:0xf bank_mask:0xf
    v_dot2c_f32_bf16_dpp v18, v24, v91 row_newbcast:6 row_mask:0xf bank_mask:0xf
    v_dot2c_f32_bf16_dpp v19, v52, v91 row_newbcast:6 row_mask:0xf bank_mask:0xf
    s_add_u32 s6, s56, 335872
    s_and_b32 s6, s6, 0xfffff
    s_waitcnt vmcnt(4)
    s_cmp_lt_u32 s3, 4
    s_cbranch_scc1 W_118
    s_waitcnt vmcnt(3)
W_118:
    buffer_load_dwordx4 v[72:75], v1, s[12:15], s6 offen nt
    s_waitcnt vmcnt(11)
    v_dot2c_f32_bf16_dpp v12, v24, v92 row_newbcast:7 row_mask:0xf bank_mask:0xf
    v_dot2c_f32_bf16_dpp v13, v52, v92 row_newbcast:7 row_mask:0xf bank_mask:0xf
    v_dot2c_f32_bf16_dpp v14, v24, v93 row_newbcast:7 row_mask:0xf bank_mask:0xf
    v_dot2c_f32_bf16_dpp v15, v52, v93 row_newbcast:7 row_mask:0xf bank_mask:0xf
    v_dot2c_f32_bf16_dpp v16, v24, v94 row_newbcast:7 row_mask:0xf bank_mask:0xf
    v_dot2c_f32_bf16_dpp v17, v52, v94 row_newbcast:7 row_mask:0xf bank_mask:0xf
    v_dot2c_f32_bf16_dpp v18, v24, v95 row_newbcast:7 row_mask:0xf bank_mask:0xf
    v_dot2c_f32_bf16_dpp v19, v52, v95 row_newbcast:7 row_mask:0xf bank_mask:0xf
    s_add_u32 s6, s56, 339968
    s_and_b32 s6, s6, 0xfffff
    s_waitcnt vmcnt(5)
    s_cmp_lt_u32 s3, 4
    s_cbranch_scc1 W_119
    s_waitcnt vmcnt(4)
W_119:
    buffer_load_dwordx4 v[76:79], v1, s[12:15], s6 offen nt
    s_waitcnt vmcnt(11)
    v_dot2c_f32_bf16_dpp v12, v24, v96 row_newbcast:8 row_mask:0xf bank_mask:0xf
    v_dot2c_f32_bf16_dpp v13, v52, v96 row_newbcast:8 row_mask:0xf bank_mask:0xf
    v_dot2c_f32_bf16_dpp v14, v24, v97 row_newbcast:8 row_mask:0xf bank_mask:0xf
    v_dot2c_f32_bf16_dpp v15, v52, v97 row_newbcast:8 row_mask:0xf bank_mask:0xf
    v_dot2c_f32_bf16_dpp v16, v24, v98 row_newbcast:8 row_mask:0xf bank_mask:0xf
    v_dot2c_f32_bf16_dpp v17, v52, v98 row_newbcast:8 row_mask:0xf bank_mask:0xf
    v_dot2c_f32_bf16_dpp v18, v24, v99 row_newbcast:8 row_mask:0xf bank_mask:0xf
    v_dot2c_f32_bf16_dpp v19, v52, v99 row_newbcast:8 row_mask:0xf bank_mask:0xf
    s_add_u32 s6, s56, 344064
    s_and_b32 s6, s6, 0xfffff
    s_waitcnt vmcnt(4)
    s_cmp_lt_u32 s3, 4
    s_cbranch_scc1 W_120
    s_waitcnt vmcnt(3)
W_120:
    buffer_load_dwordx4 v[80:83], v1, s[12:15], s6 offen nt
    s_waitcnt vmcnt(11)
    v_dot2c_f32_bf16_dpp v12, v24, v100 row_newbcast:9 row_mask:0xf bank_mask:0xf
    v_dot2c_f32_bf16_dpp v13, v52, v100 row_newbcast:9 row_mask:0xf bank_mask:0xf
    v_dot2c_f32_bf16_dpp v14, v24, v101 row_newbcast:9 row_mask:0xf bank_mask:0xf
    v_dot2c_f32_bf16_dpp v15, v52, v101 row_newbcast:9 row_mask:0xf bank_mask:0xf
    v_dot2c_f32_bf16_dpp v16, v24, v102 row_newbcast:9 row_mask:0xf bank_mask:0xf
    v_dot2c_f32_bf16_dpp v17, v52, v102 row_newbcast:9 row_mask:0xf bank_mask:0xf
    v_dot2c_f32_bf16_dpp v18, v24, v103 row_newbcast:9 row_mask:0xf bank_mask:0xf
    v_dot2c_f32_bf16_dpp v19, v52, v103 row_newbcast:9 row_mask:0xf bank_mask:0xf
    s_add_u32 s6, s56, 348160
    s_and_b32 s6, s6, 0xfffff
    s_waitcnt vmcnt(5)
    s_cmp_lt_u32 s3, 4
    s_cbranch_scc1 W_121
    s_waitcnt vmcnt(4)
W_121:
    buffer_load_dwordx4 v[84:87], v1, s[12:15], s6 offen nt
    s_waitcnt vmcnt(11)
    v_dot2c_f32_bf16_dpp v12, v24, v104 row_newbcast:10 row_mask:0xf bank_mask:0xf
    v_dot2c_f32_bf16_dpp v13, v52, v104 row_newbcast:10 row_mask:0xf bank_mask:0xf
    v_dot2c_f32_bf16_dpp v14, v24, v105 row_newbcast:10 row_mask:0xf bank_mask:0xf
    v_dot2c_f32_bf16_dpp v15, v52, v105 row_newbcast:10 row_mask:0xf bank_mask:0xf
    v_dot2c_f32_bf16_dpp v16, v24, v106 row_newbcast:10 row_mask:0xf bank_mask:0xf
    v_dot2c_f32_bf16_dpp v17, v52, v106 row_newbcast:10 row_mask:0xf bank_mask:0xf
    v_dot2c_f32_bf16_dpp v18, v24, v107 row_newbcast:10 row_mask:0xf bank_mask:0xf
    v_dot2c_f32_bf16_dpp v19, v52, v107 row_newbcast:10 row_mask:0xf bank_mask:0xf
    s_add_u32 s6, s56, 352256
    s_and_b32 s6, s6, 0xfffff
    s_waitcnt vmcnt(4)
    s_cmp_lt_u32 s3, 4
    s_cbranch_scc1 W_122
    s_waitcnt vmcnt(3)
W_122:
    buffer_load_dwordx4 v[88:91], v1, s[12:15], s6 offen nt
    s_waitcnt vmcnt(11)
    v_dot2c_f32_bf16_dpp v12, v24, v108 row_newbcast:11 row_mask:0xf bank_mask:0xf
    v_dot2c_f32_bf16_dpp v13, v52, v108 row_newbcast:11 row_mask:0xf bank_mask:0xf
    v_dot2c_f32_bf16_dpp v14, v24, v109 row_newbcast:11 row_mask:0xf bank_mask:0xf
    v_dot2c_f32_bf16_dpp v15, v52, v109 row_newbcast:11 row_mask:0xf bank_mask:0xf
    v_dot2c_f32_bf16_dpp v16, v24, v110 row_newbcast:11 row_mask:0xf bank_mask:0xf
    v_dot2c_f32_bf16_dpp v17, v52, v110 row_newbcast:11 row_mask:0xf bank_mask:0xf
    v_dot2c_f32_bf16_dpp v18, v24, v111 row_newbcast:11 row_mask:0xf bank_mask:0xf
    v_dot2c_f32_bf16_dpp v19, v52, v111 row_newbcast:11 row_mask:0xf bank_mask:0xf
    s_add_u32 s6, s56, 356352
    s_and_b32 s6, s6, 0xfffff
    s_waitcnt vmcnt(5)
    s_cmp_lt_u32 s3, 4
    s_cbranch_scc1 W_123
    s_waitcnt vmcnt(4)
W_123:
    buffer_load_dwordx4 v[92:95], v1, s[12:15], s6 offen nt
    s_waitcnt vmcnt(11)
    v_dot2c_f32_bf16_dpp v12, v24, v112 row_newbcast:12 row_mask:0xf bank_mask:0xf
    v_dot2c_f32_bf16_dpp v13, v52, v112 row_newbcast:12 row_mask:0xf bank_mask:0xf
    v_dot2c_f32_bf16_dpp v14, v24, v113 row_newbcast:12 row_mask:0xf bank_mask:0xf
    v_dot2c_f32_bf16_dpp v15, v52, v113 row_newbcast:12 row_mask:0xf bank_mask:0xf
    v_dot2c_f32_bf16_dpp v16, v24, v114 row_newbcast:12 row_mask:0xf bank_mask:0xf
    v_dot2c_f32_bf16_dpp v17, v52, v114 row_newbcast:12 row_mask:0xf bank_mask:0xf
    v_dot2c_f32_bf16_dpp v18, v24, v115 row_newbcast:12 row_mask:0xf bank_mask:0xf
    v_dot2c_f32_bf16_dpp v19, v52, v115 row_newbcast:12 row_mask:0xf bank_mask:0xf
    s_add_u32 s6, s56, 360448
    s_and_b32 s6, s6, 0xfffff
    s_waitcnt vmcnt(4)
    s_cmp_lt_u32 s3, 4
    s_cbranch_scc1 W_124
    s_waitcnt vmcnt(3)
W_124:
    buffer_load_dwordx4 v[96:99], v1, s[12:15], s6 offen nt
    s_waitcnt vmcnt(11)
    v_dot2c_f32_bf16_dpp v12, v24, v116 row_newbcast:13 row_mask:0xf bank_mask:0xf
    v_dot2c_f32_bf16_dpp v13, v52, v116 row_newbcast:13 row_mask:0xf bank_mask:0xf
    v_dot2c_f32_bf16_dpp v14, v24, v117 row_newbcast:13 row_mask:0xf bank_mask:0xf
    v_dot2c_f32_bf16_dpp v15, v52, v117 row_newbcast:13 row_mask:0xf bank_mask:0xf
    v_dot2c_f32_bf16_dpp v16, v24, v118 row_newbcast:13 row_mask:0xf bank_mask:0xf
    v_dot2c_f32_bf16_dpp v17, v52, v118 row_newbcast:13 row_mask:0xf bank_mask:0xf
    v_dot2c_f32_bf16_dpp v18, v24, v119 row_newbcast:13 row_mask:0xf bank_mask:0xf
    v_dot2c_f32_bf16_dpp v19, v52, v119 row_newbcast:13 row_mask:0xf bank_mask:0xf
    s_add_u32 s6, s56, 364544
    s_and_b32 s6, s6, 0xfffff
    s_waitcnt vmcnt(5)
    s_cmp_lt_u32 s3, 4
    s_cbranch_scc1 W_125
    s_waitcnt vmcnt(4)
W_125:
    buffer_load_dwordx4 v[100:103], v1, s[12:15], s6 offen nt
    s_waitcnt vmcnt(11)
    v_dot2c_f32_bf16_dpp v12, v24, v120 row_newbcast:14 row_mask:0xf bank_mask:0xf
    v_dot2c_f32_bf16_dpp v13, v52, v120 row_newbcast:14 row_mask:0xf bank_mask:0xf
    v_dot2c_f32_bf16_dpp v14, v24, v121 row_newbcast:14 row_mask:0xf bank_mask:0xf
    v_dot2c_f32_bf16_dpp v15, v52, v121 row_newbcast:14 row_mask:0xf bank_mask:0xf
    v_dot2c_f32_bf16_dpp v16, v24, v122 row_newbcast:14 row_mask:0xf bank_mask:0xf
    v_dot2c_f32_bf16_dpp v17, v52, v122 row_newbcast:14 row_mask:0xf bank_mask:0xf
    v_dot2c_f32_bf16_dpp v18, v24, v123 row_newbcast:14 row_mask:0xf bank_mask:0xf
    v_dot2c_f32_bf16_dpp v19, v52, v123 row_newbcast:14 row_mask:0xf bank_mask:0xf
    s_add_u32 s6, s56, 368640
    s_and_b32 s6, s6, 0xfffff
    s_waitcnt vmcnt(4)
    s_cmp_lt_u32 s3, 4
    s_cbranch_scc1 W_126
    s_waitcnt vmcnt(3)
W_126:
    buffer_load_dwordx4 v[104:107], v1, s[12:15], s6 offen nt
    s_waitcnt vmcnt(11)
    v_dot2c_f32_bf16_dpp v12, v24, v124 row_newbcast:15 row_mask:0xf bank_mask:0xf
    v_dot2c_f32_bf16_dpp v13, v52, v124 row_newbcast:15 row_mask:0xf bank_mask:0xf
    v_dot2c_f32_bf16_dpp v14, v24, v125 row_newbcast:15 row_mask:0xf bank_mask:0xf
    v_dot2c_f32_bf16_dpp v15, v52, v125 row_newbcast:15 row_mask:0xf bank_mask:0xf
    v_dot2c_f32_bf16_dpp v16, v24, v126 row_newbcast:15 row_mask:0xf bank_mask:0xf
    v_dot2c_f32_bf16_dpp v17, v52, v126 row_newbcast:15 row_mask:0xf bank_mask:0xf
    v_dot2c_f32_bf16_dpp v18, v24, v127 row_newbcast:15 row_mask:0xf bank_mask:0xf
    v_dot2c_f32_bf16_dpp v19, v52, v127 row_newbcast:15 row_mask:0xf bank_mask:0xf
    s_add_u32 s6, s56, 372736
    s_and_b32 s6, s6, 0xfffff
    s_waitcnt vmcnt(5)
    s_cmp_lt_u32 s3, 4
    s_cbranch_scc1 W_127
    s_waitcnt vmcnt(4)
W_127:
    buffer_load_dwordx4 v[108:111], v1, s[12:15], s6 offen nt
    v_lshlrev_b32 v54, 16, v25
    s_nop 1
    s_waitcnt vmcnt(11)
    v_dot2c_f32_bf16_dpp v12, v25, v64 row_newbcast:0 row_mask:0xf bank_mask:0xf
    v_dot2c_f32_bf16_dpp v13, v54, v64 row_newbcast:0 row_mask:0xf bank_mask:0xf
    v_dot2c_f32_bf16_dpp v14, v25, v65 row_newbcast:0 row_mask:0xf bank_mask:0xf
    v_dot2c_f32_bf16_dpp v15, v54, v65 row_newbcast:0 row_mask:0xf bank_mask:0xf
    v_dot2c_f32_bf16_dpp v16, v25, v66 row_newbcast:0 row_mask:0xf bank_mask:0xf
    v_dot2c_f32_bf16_dpp v17, v54, v66 row_newbcast:0 row_mask:0xf bank_mask:0xf
    v_dot2c_f32_bf16_dpp v18, v25, v67 row_newbcast:0 row_mask:0xf bank_mask:0xf
    v_dot2c_f32_bf16_dpp v19, v54, v67 row_newbcast:0 row_mask:0xf bank_mask:0xf
    s_add_u32 s6, s56, 376832
    s_and_b32 s6, s6, 0xfffff
    s_waitcnt vmcnt(4)
    s_cmp_lt_u32 s3, 4
    s_cbranch_scc1 W_128
    s_waitcnt vmcnt(3)
W_128:
    buffer_load_dwordx4 v[112:115], v1, s[12:15], s6 offen nt
    s_waitcnt vmcnt(11)
    v_dot2c_f32_bf16_dpp v12, v25, v68 row_newbcast:1 row_mask:0xf bank_mask:0xf
    v_dot2c_f32_bf16_dpp v13, v54, v68 row_newbcast:1 row_mask:0xf bank_mask:0xf
    v_dot2c_f32_bf16_dpp v14, v25, v69 row_newbcast:1 row_mask:0xf bank_mask:0xf
    v_dot2c_f32_bf16_dpp v15, v54, v69 row_newbcast:1 row_mask:0xf bank_mask:0xf
    v_dot2c_f32_bf16_dpp v16, v25, v70 row_newbcast:1 row_mask:0xf bank_mask:0xf
    v_dot2c_f32_bf16_dpp v17, v54, v70 row_newbcast:1 row_mask:0xf bank_mask:0xf
    v_dot2c_f32_bf16_dpp v18, v25, v71 row_newbcast:1 row_mask:0xf bank_mask:0xf
    v_dot2c_f32_bf16_dpp v19, v54, v71 row_newbcast:1 row_mask:0xf bank_mask:0xf
    s_add_u32 s6, s56, 380928
    s_and_b32 s6, s6, 0xfffff
    s_waitcnt vmcnt(5)
    s_cmp_lt_u32 s3, 4
    s_cbranch_scc1 W_129
    s_waitcnt vmcnt(4)
W_129:
    buffer_load_dwordx4 v[116:119], v1, s[12:15], s6 offen nt
    s_waitcnt vmcnt(11)
    v_dot2c_f32_bf16_dpp v12, v25, v72 row_newbcast:2 row_mask:0xf bank_mask:0xf
    v_dot2c_f32_bf16_dpp v13, v54, v72 row_newbcast:2 row_mask:0xf bank_mask:0xf
    v_dot2c_f32_bf16_dpp v14, v25, v73 row_newbcast:2 row_mask:0xf bank_mask:0xf
    v_dot2c_f32_bf16_dpp v15, v54, v73 row_newbcast:2 row_mask:0xf bank_mask:0xf
    v_dot2c_f32_bf16_dpp v16, v25, v74 row_newbcast:2 row_mask:0xf bank_mask:0xf
    v_dot2c_f32_bf16_dpp v17, v54, v74 row_newbcast:2 row_mask:0xf bank_mask:0xf
    v_dot2c_f32_bf16_dpp v18, v25, v75 row_newbcast:2 row_mask:0xf bank_mask:0xf
    v_dot2c_f32_bf16_dpp v19, v54, v75 row_newbcast:2 row_mask:0xf bank_mask:0xf
    s_add_u32 s6, s56, 385024
    s_and_b32 s6, s6, 0xfffff
    s_waitcnt vmcnt(4)
    s_cmp_lt_u32 s3, 4
    s_cbranch_scc1 W_130
    s_waitcnt vmcnt(3)
W_130:
    buffer_load_dwordx4 v[120:123], v1, s[12:15], s6 offen nt
    s_waitcnt vmcnt(11)
    v_dot2c_f32_bf16_dpp v12, v25, v76 row_newbcast:3 row_mask:0xf bank_mask:0xf
    v_dot2c_f32_bf16_dpp v13, v54, v76 row_newbcast:3 row_mask:0xf bank_mask:0xf
    v_dot2c_f32_bf16_dpp v14, v25, v77 row_newbcast:3 row_mask:0xf bank_mask:0xf
    v_dot2c_f32_bf16_dpp v15, v54, v77 row_newbcast:3 row_mask:0xf bank_mask:0xf
    v_dot2c_f32_bf16_dpp v16, v25, v78 row_newbcast:3 row_mask:0xf bank_mask:0xf
    v_dot2c_f32_bf16_dpp v17, v54, v78 row_newbcast:3 row_mask:0xf bank_mask:0xf
    v_dot2c_f32_bf16_dpp v18, v25, v79 row_newbcast:3 row_mask:0xf bank_mask:0xf
    v_dot2c_f32_bf16_dpp v19, v54, v79 row_newbcast:3 row_mask:0xf bank_mask:0xf
    s_add_u32 s6, s56, 389120
    s_and_b32 s6, s6, 0xfffff
    s_waitcnt vmcnt(5)
    s_cmp_lt_u32 s3, 4
    s_cbranch_scc1 W_131
    s_waitcnt vmcnt(4)
W_131:
    buffer_load_dwordx4 v[124:127], v1, s[12:15], s6 offen nt
    s_waitcnt vmcnt(11)
    v_dot2c_f32_bf16_dpp v12, v25, v80 row_newbcast:4 row_mask:0xf bank_mask:0xf
    v_dot2c_f32_bf16_dpp v13, v54, v80 row_newbcast:4 row_mask:0xf bank_mask:0xf
    v_dot2c_f32_bf16_dpp v14, v25, v81 row_newbcast:4 row_mask:0xf bank_mask:0xf
    v_dot2c_f32_bf16_dpp v15, v54, v81 row_newbcast:4 row_mask:0xf bank_mask:0xf
    v_dot2c_f32_bf16_dpp v16, v25, v82 row_newbcast:4 row_mask:0xf bank_mask:0xf
    v_dot2c_f32_bf16_dpp v17, v54, v82 row_newbcast:4 row_mask:0xf bank_mask:0xf
    v_dot2c_f32_bf16_dpp v18, v25, v83 row_newbcast:4 row_mask:0xf bank_mask:0xf
    v_dot2c_f32_bf16_dpp v19, v54, v83 row_newbcast:4 row_mask:0xf bank_mask:0xf
    s_add_u32 s6, s56, 393216
    s_and_b32 s6, s6, 0xfffff
    s_waitcnt vmcnt(4)
    s_cmp_lt_u32 s3, 4
    s_cbranch_scc1 W_132
    s_waitcnt vmcnt(3)
W_132:
    buffer_load_dwordx4 v[64:67], v1, s[12:15], s6 offen nt
    s_waitcnt vmcnt(11)
    v_dot2c_f32_bf16_dpp v12, v25, v84 row_newbcast:5 row_mask:0xf bank_mask:0xf
    v_dot2c_f32_bf16_dpp v13, v54, v84 row_newbcast:5 row_mask:0xf bank_mask:0xf
    v_dot2c_f32_bf16_dpp v14, v25, v85 row_newbcast:5 row_mask:0xf bank_mask:0xf
    v_dot2c_f32_bf16_dpp v15, v54, v85 row_newbcast:5 row_mask:0xf bank_mask:0xf
    v_dot2c_f32_bf16_dpp v16, v25, v86 row_newbcast:5 row_mask:0xf bank_mask:0xf
    v_dot2c_f32_bf16_dpp v17, v54, v86 row_newbcast:5 row_mask:0xf bank_mask:0xf
    v_dot2c_f32_bf16_dpp v18, v25, v87 row_newbcast:5 row_mask:0xf bank_mask:0xf
    v_dot2c_f32_bf16_dpp v19, v54, v87 row_newbcast:5 row_mask:0xf bank_mask:0xf
    s_add_u32 s6, s56, 397312
    s_and_b32 s6, s6, 0xfffff
    s_waitcnt vmcnt(5)
    s_cmp_lt_u32 s3, 4
    s_cbranch_scc1 W_133
    s_waitcnt vmcnt(4)
W_133:
    buffer_load_dwordx4 v[68:71], v1, s[12:15], s6 offen nt
    s_waitcnt vmcnt(11)
    v_dot2c_f32_bf16_dpp v12, v25, v88 row_newbcast:6 row_mask:0xf bank_mask:0xf
    v_dot2c_f32_bf16_dpp v13, v54, v88 row_newbcast:6 row_mask:0xf bank_mask:0xf
    v_dot2c_f32_bf16_dpp v14, v25, v89 row_newbcast:6 row_mask:0xf bank_mask:0xf
    v_dot2c_f32_bf16_dpp v15, v54, v89 row_newbcast:6 row_mask:0xf bank_mask:0xf
    v_dot2c_f32_bf16_dpp v16, v25, v90 row_newbcast:6 row_mask:0xf bank_mask:0xf
    v_dot2c_f32_bf16_dpp v17, v54, v90 row_newbcast:6 row_mask:0xf bank_mask:0xf
    v_dot2c_f32_bf16_dpp v18, v25, v91 row_newbcast:6 row_mask:0xf bank_mask:0xf
    v_dot2c_f32_bf16_dpp v19, v54, v91 row_newbcast:6 row_mask:0xf bank_mask:0xf
    s_add_u32 s6, s56, 401408
    s_and_b32 s6, s6, 0xfffff
    s_waitcnt vmcnt(4)
    s_cmp_lt_u32 s3, 4
    s_cbranch_scc1 W_134
    s_waitcnt vmcnt(3)
W_134:
    buffer_load_dwordx4 v[72:75], v1, s[12:15], s6 offen nt
    s_waitcnt vmcnt(11)
    v_dot2c_f32_bf16_dpp v12, v25, v92 row_newbcast:7 row_mask:0xf bank_mask:0xf
    v_dot2c_f32_bf16_dpp v13, v54, v92 row_newbcast:7 row_mask:0xf bank_mask:0xf
    v_dot2c_f32_bf16_dpp v14, v25, v93 row_newbcast:7 row_mask:0xf bank_mask:0xf
    v_dot2c_f32_bf16_dpp v15, v54, v93 row_newbcast:7 row_mask:0xf bank_mask:0xf
    v_dot2c_f32_bf16_dpp v16, v25, v94 row_newbcast:7 row_mask:0xf bank_mask:0xf
    v_dot2c_f32_bf16_dpp v17, v54, v94 row_newbcast:7 row_mask:0xf bank_mask:0xf
    v_dot2c_f32_bf16_dpp v18, v25, v95 row_newbcast:7 row_mask:0xf bank_mask:0xf
    v_dot2c_f32_bf16_dpp v19, v54, v95 row_newbcast:7 row_mask:0xf bank_mask:0xf
    s_add_u32 s6, s56, 405504
    s_and_b32 s6, s6, 0xfffff
    s_waitcnt vmcnt(5)
    s_cmp_lt_u32 s3, 4
    s_cbranch_scc1 W_135
    s_waitcnt vmcnt(4)
W_135:
    buffer_load_dwordx4 v[76:79], v1, s[12:15], s6 offen nt
    s_waitcnt vmcnt(11)
    v_dot2c_f32_bf16_dpp v12, v25, v96 row_newbcast:8 row_mask:0xf bank_mask:0xf
    v_dot2c_f32_bf16_dpp v13, v54, v96 row_newbcast:8 row_mask:0xf bank_mask:0xf
    v_dot2c_f32_bf16_dpp v14, v25, v97 row_newbcast:8 row_mask:0xf bank_mask:0xf
    v_dot2c_f32_bf16_dpp v15, v54, v97 row_newbcast:8 row_mask:0xf bank_mask:0xf
    v_dot2c_f32_bf16_dpp v16, v25, v98 row_newbcast:8 row_mask:0xf bank_mask:0xf
    v_dot2c_f32_bf16_dpp v17, v54, v98 row_newbcast:8 row_mask:0xf bank_mask:0xf
    v_dot2c_f32_bf16_dpp v18, v25, v99 row_newbcast:8 row_mask:0xf bank_mask:0xf
    v_dot2c_f32_bf16_dpp v19, v54, v99 row_newbcast:8 row_mask:0xf bank_mask:0xf
    s_add_u32 s6, s56, 409600
    s_and_b32 s6, s6, 0xfffff
    s_waitcnt vmcnt(4)
    s_cmp_lt_u32 s3, 4
    s_cbranch_scc1 W_136
    s_waitcnt vmcnt(3)
W_136:
    buffer_load_dwordx4 v[80:83], v1, s[12:15], s6 offen nt
    s_waitcnt vmcnt(11)
    v_dot2c_f32_bf16_dpp v12, v25, v100 row_newbcast:9 row_mask:0xf bank_mask:0xf
    v_dot2c_f32_bf16_dpp v13, v54, v100 row_newbcast:9 row_mask:0xf bank_mask:0xf
    v_dot2c_f32_bf16_dpp v14, v25, v101 row_newbcast:9 row_mask:0xf bank_mask:0xf
    v_dot2c_f32_bf16_dpp v15, v54, v101 row_newbcast:9 row_mask:0xf bank_mask:0xf
    v_dot2c_f32_bf16_dpp v16, v25, v102 row_newbcast:9 row_mask:0xf bank_mask:0xf
    v_dot2c_f32_bf16_dpp v17, v54, v102 row_newbcast:9 row_mask:0xf bank_mask:0xf
    v_dot2c_f32_bf16_dpp v18, v25, v103 row_newbcast:9 row_mask:0xf bank_mask:0xf
    v_dot2c_f32_bf16_dpp v19, v54, v103 row_newbcast:9 row_mask:0xf bank_mask:0xf
    s_add_u32 s6, s56, 413696
    s_and_b32 s6, s6, 0xfffff
    s_waitcnt vmcnt(5)
    s_cmp_lt_u32 s3, 4
    s_cbranch_scc1 W_137
    s_waitcnt vmcnt(4)
W_137:
    buffer_load_dwordx4 v[84:87], v1, s[12:15], s6 offen nt
    s_waitcnt vmcnt(11)
    v_dot2c_f32_bf16_dpp v12, v25, v104 row_newbcast:10 row_mask:0xf bank_mask:0xf
    v_dot2c_f32_bf16_dpp v13, v54, v104 row_newbcast:10 row_mask:0xf bank_mask:0xf
    v_dot2c_f32_bf16_dpp v14, v25, v105 row_newbcast:10 row_mask:0xf bank_mask:0xf
    v_dot2c_f32_bf16_dpp v15, v54, v105 row_newbcast:10 row_mask:0xf bank_mask:0xf
    v_dot2c_f32_bf16_dpp v16, v25, v106 row_newbcast:10 row_mask:0xf bank_mask:0xf
    v_dot2c_f32_bf16_dpp v17, v54, v106 row_newbcast:10 row_mask:0xf bank_mask:0xf
    v_dot2c_f32_bf16_dpp v18, v25, v107 row_newbcast:10 row_mask:0xf bank_mask:0xf
    v_dot2c_f32_bf16_dpp v19, v54, v107 row_newbcast:10 row_mask:0xf bank_mask:0xf
    s_add_u32 s6, s56, 417792
    s_and_b32 s6, s6, 0xfffff
    s_waitcnt vmcnt(4)
    s_cmp_lt_u32 s3, 4
    s_cbranch_scc1 W_138
    s_waitcnt vmcnt(3)
W_138:
    buffer_load_dwordx4 v[88:91], v1, s[12:15], s6 offen nt
    s_waitcnt vmcnt(11)
    v_dot2c_f32_bf16_dpp v12, v25, v108 row_newbcast:11 row_mask:0xf bank_mask:0xf
    v_dot2c_f32_bf16_dpp v13, v54, v108 row_newbcast:11 row_mask:0xf bank_mask:0xf
    v_dot2c_f32_bf16_dpp v14, v25, v109 row_newbcast:11 row_mask:0xf bank_mask:0xf
    v_dot2c_f32_bf16_dpp v15, v54, v109 row_newbcast:11 row_mask:0xf bank_mask:0xf
    v_dot2c_f32_bf16_dpp v16, v25, v110 row_newbcast:11 row_mask:0xf bank_mask:0xf
    v_dot2c_f32_bf16_dpp v17, v54, v110 row_newbcast:11 row_mask:0xf bank_mask:0xf
    v_dot2c_f32_bf16_dpp v18, v25, v111 row_newbcast:11 row_mask:0xf bank_mask:0xf
    v_dot2c_f32_bf16_dpp v19, v54, v111 row_newbcast:11 row_mask:0xf bank_mask:0xf
    s_add_u32 s6, s56, 421888
    s_and_b32 s6, s6, 0xfffff
    s_waitcnt vmcnt(5)
    s_cmp_lt_u32 s3, 4
    s_cbranch_scc1 W_139
    s_waitcnt vmcnt(4)
W_139:
    buffer_load_dwordx4 v[92:95], v1, s[12:15], s6 offen nt
    s_waitcnt vmcnt(11)
    v_dot2c_f32_bf16_dpp v12, v25, v112 row_newbcast:12 row_mask:0xf bank_mask:0xf
    v_dot2c_f32_bf16_dpp v13, v54, v112 row_newbcast:12 row_mask:0xf bank_mask:0xf
    v_dot2c_f32_bf16_dpp v14, v25, v113 row_newbcast:12 row_mask:0xf bank_mask:0xf
    v_dot2c_f32_bf16_dpp v15, v54, v113 row_newbcast:12 row_mask:0xf bank_mask:0xf
    v_dot2c_f32_bf16_dpp v16, v25, v114 row_newbcast:12 row_mask:0xf bank_mask:0xf
    v_dot2c_f32_bf16_dpp v17, v54, v114 row_newbcast:12 row_mask:0xf bank_mask:0xf
    v_dot2c_f32_bf16_dpp v18, v25, v115 row_newbcast:12 row_mask:0xf bank_mask:0xf
    v_dot2c_f32_bf16_dpp v19, v54, v115 row_newbcast:12 row_mask:0xf bank_mask:0xf
    s_add_u32 s6, s56, 425984
    s_and_b32 s6, s6, 0xfffff
    s_waitcnt vmcnt(4)
    s_cmp_lt_u32 s3, 4
    s_cbranch_scc1 W_140
    s_waitcnt vmcnt(3)
W_140:
    buffer_load_dwordx4 v[96:99], v1, s[12:15], s6 offen nt
    s_waitcnt vmcnt(11)
    v_dot2c_f32_bf16_dpp v12, v25, v116 row_newbcast:13 row_mask:0xf bank_mask:0xf
    v_dot2c_f32_bf16_dpp v13, v54, v116 row_newbcast:13 row_mask:0xf bank_mask:0xf
    v_dot2c_f32_bf16_dpp v14, v25, v117 row_newbcast:13 row_mask:0xf bank_mask:0xf
    v_dot2c_f32_bf16_dpp v15, v54, v117 row_newbcast:13 row_mask:0xf bank_mask:0xf
    v_dot2c_f32_bf16_dpp v16, v25, v118 row_newbcast:13 row_mask:0xf bank_mask:0xf
    v_dot2c_f32_bf16_dpp v17, v54, v118 row_newbcast:13 row_mask:0xf bank_mask:0xf
    v_dot2c_f32_bf16_dpp v18, v25, v119 row_newbcast:13 row_mask:0xf bank_mask:0xf
    v_dot2c_f32_bf16_dpp v19, v54, v119 row_newbcast:13 row_mask:0xf bank_mask:0xf
    s_add_u32 s6, s56, 430080
    s_and_b32 s6, s6, 0xfffff
    s_waitcnt vmcnt(5)
    s_cmp_lt_u32 s3, 4
    s_cbranch_scc1 W_141
    s_waitcnt vmcnt(4)
W_141:
    buffer_load_dwordx4 v[100:103], v1, s[12:15], s6 offen nt
    s_waitcnt vmcnt(11)
    v_dot2c_f32_bf16_dpp v12, v25, v120 row_newbcast:14 row_mask:0xf bank_mask:0xf
    v_dot2c_f32_bf16_dpp v13, v54, v120 row_newbcast:14 row_mask:0xf bank_mask:0xf
    v_dot2c_f32_bf16_dpp v14, v25, v121 row_newbcast:14 row_mask:0xf bank_mask:0xf
    v_dot2c_f32_bf16_dpp v15, v54, v121 row_newbcast:14 row_mask:0xf bank_mask:0xf
    v_dot2c_f32_bf16_dpp v16, v25, v122 row_newbcast:14 row_mask:0xf bank_mask:0xf
    v_dot2c_f32_bf16_dpp v17, v54, v122 row_newbcast:14 row_mask:0xf bank_mask:0xf
    v_dot2c_f32_bf16_dpp v18, v25, v123 row_newbcast:14 row_mask:0xf bank_mask:0xf
    v_dot2c_f32_bf16_dpp v19, v54, v123 row_newbcast:14 row_mask:0xf bank_mask:0xf
    s_add_u32 s6, s56, 434176
    s_and_b32 s6, s6, 0xfffff
    s_waitcnt vmcnt(4)
    s_cmp_lt_u32 s3, 4
    s_cbranch_scc1 W_142
    s_waitcnt vmcnt(3)
W_142:
    buffer_load_dwordx4 v[104:107], v1, s[12:15], s6 offen nt
    s_waitcnt vmcnt(11)
    v_dot2c_f32_bf16_dpp v12, v25, v124 row_newbcast:15 row_mask:0xf bank_mask:0xf
    v_dot2c_f32_bf16_dpp v13, v54, v124 row_newbcast:15 row_mask:0xf bank_mask:0xf
    v_dot2c_f32_bf16_dpp v14, v25, v125 row_newbcast:15 row_mask:0xf bank_mask:0xf
    v_dot2c_f32_bf16_dpp v15, v54, v125 row_newbcast:15 row_mask:0xf bank_mask:0xf
    v_dot2c_f32_bf16_dpp v16, v25, v126 row_newbcast:15 row_mask:0xf bank_mask:0xf
    v_dot2c_f32_bf16_dpp v17, v54, v126 row_newbcast:15 row_mask:0xf bank_mask:0xf
    v_dot2c_f32_bf16_dpp v18, v25, v127 row_newbcast:15 row_mask:0xf bank_mask:0xf
    v_dot2c_f32_bf16_dpp v19, v54, v127 row_newbcast:15 row_mask:0xf bank_mask:0xf
    s_add_u32 s6, s56, 438272
    s_and_b32 s6, s6, 0xfffff
    s_waitcnt vmcnt(5)
    s_cmp_lt_u32 s3, 4
    s_cbranch_scc1 W_143
    s_waitcnt vmcnt(4)
W_143:
    buffer_load_dwordx4 v[108:111], v1, s[12:15], s6 offen nt
    v_lshlrev_b32 v52, 16, v26
    s_nop 1
    s_waitcnt vmcnt(11)
    v_dot2c_f32_bf16_dpp v12, v26, v64 row_newbcast:0 row_mask:0xf bank_mask:0xf
    v_dot2c_f32_bf16_dpp v13, v52, v64 row_newbcast:0 row_mask:0xf bank_mask:0xf
    v_dot2c_f32_bf16_dpp v14, v26, v65 row_newbcast:0 row_mask:0xf bank_mask:0xf
    v_dot2c_f32_bf16_dpp v15, v52, v65 row_newbcast:0 row_mask:0xf bank_mask:0xf
    v_dot2c_f32_bf16_dpp v16, v26, v66 row_newbcast:0 row_mask:0xf bank_mask:0xf
    v_dot2c_f32_bf16_dpp v17, v52, v66 row_newbcast:0 row_mask:0xf bank_mask:0xf
    v_dot2c_f32_bf16_dpp v18, v26, v67 row_newbcast:0 row_mask:0xf bank_mask:0xf
    v_dot2c_f32_bf16_dpp v19, v52, v67 row_newbcast:0 row_mask:0xf bank_mask:0xf
    s_add_u32 s6, s56, 442368
    s_and_b32 s6, s6, 0xfffff
    s_waitcnt vmcnt(4)
    s_cmp_lt_u32 s3, 4
    s_cbranch_scc1 W_144
    s_waitcnt vmcnt(3)
W_144:
    buffer_load_dwordx4 v[112:115], v1, s[12:15], s6 offen nt
    s_waitcnt vmcnt(11)
    v_dot2c_f32_bf16_dpp v12, v26, v68 row_newbcast:1 row_mask:0xf bank_mask:0xf
    v_dot2c_f32_bf16_dpp v13, v52, v68 row_newbcast:1 row_mask:0xf bank_mask:0xf
    v_dot2c_f32_bf16_dpp v14, v26, v69 row_newbcast:1 row_mask:0xf bank_mask:0xf
    v_dot2c_f32_bf16_dpp v15, v52, v69 row_newbcast:1 row_mask:0xf bank_mask:0xf
    v_dot2c_f32_bf16_dpp v16, v26, v70 row_newbcast:1 row_mask:0xf bank_mask:0xf
    v_dot2c_f32_bf16_dpp v17, v52, v70 row_newbcast:1 row_mask:0xf bank_mask:0xf
    v_dot2c_f32_bf16_dpp v18, v26, v71 row_newbcast:1 row_mask:0xf bank_mask:0xf
    v_dot2c_f32_bf16_dpp v19, v52, v71 row_newbcast:1 row_mask:0xf bank_mask:0xf
    s_add_u32 s6, s56, 446464
    s_and_b32 s6, s6, 0xfffff
    s_waitcnt vmcnt(5)
    s_cmp_lt_u32 s3, 4
    s_cbranch_scc1 W_145
    s_waitcnt vmcnt(4)
W_145:
    buffer_load_dwordx4 v[116:119], v1, s[12:15], s6 offen nt
    s_waitcnt vmcnt(11)
    v_dot2c_f32_bf16_dpp v12, v26, v72 row_newbcast:2 row_mask:0xf bank_mask:0xf
    v_dot2c_f32_bf16_dpp v13, v52, v72 row_newbcast:2 row_mask:0xf bank_mask:0xf
    v_dot2c_f32_bf16_dpp v14, v26, v73 row_newbcast:2 row_mask:0xf bank_mask:0xf
    v_dot2c_f32_bf16_dpp v15, v52, v73 row_newbcast:2 row_mask:0xf bank_mask:0xf
    v_dot2c_f32_bf16_dpp v16, v26, v74 row_newbcast:2 row_mask:0xf bank_mask:0xf
    v_dot2c_f32_bf16_dpp v17, v52, v74 row_newbcast:2 row_mask:0xf bank_mask:0xf
    v_dot2c_f32_bf16_dpp v18, v26, v75 row_newbcast:2 row_mask:0xf bank_mask:0xf
    v_dot2c_f32_bf16_dpp v19, v52, v75 row_newbcast:2 row_mask:0xf bank_mask:0xf
    s_add_u32 s6, s56, 450560
    s_and_b32 s6, s6, 0xfffff
    s_cmp_lt_u32 s3, 4
    s_cbranch_scc0 W_146
    s_waitcnt vmcnt(4)
W_146:
    buffer_load_dwordx4 v[120:123], v1, s[12:15], s6 offen nt
    s_waitcnt vmcnt(11)
    v_dot2c_f32_bf16_dpp v12, v26, v76 row_newbcast:3 row_mask:0xf bank_mask:0xf
    v_dot2c_f32_bf16_dpp v13, v52, v76 row_newbcast:3 row_mask:0xf bank_mask:0xf
    v_dot2c_f32_bf16_dpp v14, v26, v77 row_newbcast:3 row_mask:0xf bank_mask:0xf
    v_dot2c_f32_bf16_dpp v15, v52, v77 row_newbcast:3 row_mask:0xf bank_mask:0xf
    v_dot2c_f32_bf16_dpp v16, v26, v78 row_newbcast:3 row_mask:0xf bank_mask:0xf
    v_dot2c_f32_bf16_dpp v17, v52, v78 row_newbcast:3 row_mask:0xf bank_mask:0xf
    v_dot2c_f32_bf16_dpp v18, v26, v79 row_newbcast:3 row_mask:0xf bank_mask:0xf
    v_dot2c_f32_bf16_dpp v19, v52, v79 row_newbcast:3 row_mask:0xf bank_mask:0xf
    s_add_u32 s6, s56, 454656
    s_and_b32 s6, s6, 0xfffff
    s_cmp_lt_u32 s3, 4
    s_cbranch_scc0 W_147
    s_waitcnt vmcnt(5)
W_147:
    buffer_load_dwordx4 v[124:127], v1, s[12:15], s6 offen nt
    s_waitcnt vmcnt(11)
    v_dot2c_f32_bf16_dpp v12, v26, v80 row_newbcast:4 row_mask:0xf bank_mask:0xf
    v_dot2c_f32_bf16_dpp v13, v52, v80 row_newbcast:4 row_mask:0xf bank_mask:0xf
    v_dot2c_f32_bf16_dpp v14, v26, v81 row_newbcast:4 row_mask:0xf bank_mask:0xf
    v_dot2c_f32_bf16_dpp v15, v52, v81 row_newbcast:4 row_mask:0xf bank_mask:0xf
    v_dot2c_f32_bf16_dpp v16, v26, v82 row_newbcast:4 row_mask:0xf bank_mask:0xf
    v_dot2c_f32_bf16_dpp v17, v52, v82 row_newbcast:4 row_mask:0xf bank_mask:0xf
    v_dot2c_f32_bf16_dpp v18, v26, v83 row_newbcast:4 row_mask:0xf bank_mask:0xf
    v_dot2c_f32_bf16_dpp v19, v52, v83 row_newbcast:4 row_mask:0xf bank_mask:0xf
    s_add_u32 s6, s56, 458752
    s_and_b32 s6, s6, 0xfffff
    s_cmp_lt_u32 s3, 4
    s_cbranch_scc0 W_148
    s_waitcnt vmcnt(4)
W_148:
    buffer_load_dwordx4 v[64:67], v1, s[12:15], s6 offen nt
    s_waitcnt vmcnt(11)
    v_dot2c_f32_bf16_dpp v12, v26, v84 row_newbcast:5 row_mask:0xf bank_mask:0xf
    v_dot2c_f32_bf16_dpp v13, v52, v84 row_newbcast:5 row_mask:0xf bank_mask:0xf
    v_dot2c_f32_bf16_dpp v14, v26, v85 row_newbcast:5 row_mask:0xf bank_mask:0xf
    v_dot2c_f32_bf16_dpp v15, v52, v85 row_newbcast:5 row_mask:0xf bank_mask:0xf
    v_dot2c_f32_bf16_dpp v16, v26, v86 row_newbcast:5 row_mask:0xf bank_mask:0xf
    v_dot2c_f32_bf16_dpp v17, v52, v86 row_newbcast:5 row_mask:0xf bank_mask:0xf
    v_dot2c_f32_bf16_dpp v18, v26, v87 row_newbcast:5 row_mask:0xf bank_mask:0xf
    v_dot2c_f32_bf16_dpp v19, v52, v87 row_newbcast:5 row_mask:0xf bank_mask:0xf
    s_add_u32 s6, s56, 462848
    s_and_b32 s6, s6, 0xfffff
    s_cmp_lt_u32 s3, 4
    s_cbranch_scc0 W_149
    s_waitcnt vmcnt(5)
W_149:
    buffer_load_dwordx4 v[68:71], v1, s[12:15], s6 offen nt
    s_waitcnt vmcnt(11)
    v_dot2c_f32_bf16_dpp v12, v26, v88 row_newbcast:6 row_mask:0xf bank_mask:0xf
    v_dot2c_f32_bf16_dpp v13, v52, v88 row_newbcast:6 row_mask:0xf bank_mask:0xf
    v_dot2c_f32_bf16_dpp v14, v26, v89 row_newbcast:6 row_mask:0xf bank_mask:0xf
    v_dot2c_f32_bf16_dpp v15, v52, v89 row_newbcast:6 row_mask:0xf bank_mask:0xf
    v_dot2c_f32_bf16_dpp v16, v26, v90 row_newbcast:6 row_mask:0xf bank_mask:0xf
    v_dot2c_f32_bf16_dpp v17, v52, v90 row_newbcast:6 row_mask:0xf bank_mask:0xf
    v_dot2c_f32_bf16_dpp v18, v26, v91 row_newbcast:6 row_mask:0xf bank_mask:0xf
    v_dot2c_f32_bf16_dpp v19, v52, v91 row_newbcast:6 row_mask:0xf bank_mask:0xf
    s_add_u32 s6, s56, 466944
    s_and_b32 s6, s6, 0xfffff
    s_cmp_lt_u32 s3, 4
    s_cbranch_scc0 W_150
    s_waitcnt vmcnt(4)
W_150:
    buffer_load_dwordx4 v[72:75], v1, s[12:15], s6 offen nt
    s_waitcnt vmcnt(11)
    v_dot2c_f32_bf16_dpp v12, v26, v92 row_newbcast:7 row_mask:0xf bank_mask:0xf
    v_dot2c_f32_bf16_dpp v13, v52, v92 row_newbcast:7 row_mask:0xf bank_mask:0xf
    v_dot2c_f32_bf16_dpp v14, v26, v93 row_newbcast:7 row_mask:0xf bank_mask:0xf
    v_dot2c_f32_bf16_dpp v15, v52, v93 row_newbcast:7 row_mask:0xf bank_mask:0xf
    v_dot2c_f32_bf16_dpp v16, v26, v94 row_newbcast:7 row_mask:0xf bank_mask:0xf
    v_dot2c_f32_bf16_dpp v17, v52, v94 row_newbcast:7 row_mask:0xf bank_mask:0xf
    v_dot2c_f32_bf16_dpp v18, v26, v95 row_newbcast:7 row_mask:0xf bank_mask:0xf
    v_dot2c_f32_bf16_dpp v19, v52, v95 row_newbcast:7 row_mask:0xf bank_mask:0xf
    s_add_u32 s6, s56, 471040
    s_and_b32 s6, s6, 0xfffff
    s_cmp_lt_u32 s3, 4
    s_cbranch_scc0 W_151
    s_waitcnt vmcnt(5)
W_151:
    buffer_load_dwordx4 v[76:79], v1, s[12:15], s6 offen nt
    s_waitcnt vmcnt(11)
    v_dot2c_f32_bf16_dpp v12, v26, v96 row_newbcast:8 row_mask:0xf bank_mask:0xf
    v_dot2c_f32_bf16_dpp v13, v52, v96 row_newbcast:8 row_mask:0xf bank_mask:0xf
    v_dot2c_f32_bf16_dpp v14, v26, v97 row_newbcast:8 row_mask:0xf bank_mask:0xf
    v_dot2c_f32_bf16_dpp v15, v52, v97 row_newbcast:8 row_mask:0xf bank_mask:0xf
    v_dot2c_f32_bf16_dpp v16, v26, v98 row_newbcast:8 row_mask:0xf bank_mask:0xf
    v_dot2c_f32_bf16_dpp v17, v52, v98 row_newbcast:8 row_mask:0xf bank_mask:0xf
    v_dot2c_f32_bf16_dpp v18, v26, v99 row_newbcast:8 row_mask:0xf bank_mask:0xf
    v_dot2c_f32_bf16_dpp v19, v52, v99 row_newbcast:8 row_mask:0xf bank_mask:0xf
    s_add_u32 s6, s56, 475136
    s_and_b32 s6, s6, 0xfffff
    s_cmp_lt_u32 s3, 4
    s_cbranch_scc0 W_152
    s_waitcnt vmcnt(4)
W_152:
    buffer_load_dwordx4 v[80:83], v1, s[12:15], s6 offen nt
    s_waitcnt vmcnt(11)
    v_dot2c_f32_bf16_dpp v12, v26, v100 row_newbcast:9 row_mask:0xf bank_mask:0xf
    v_dot2c_f32_bf16_dpp v13, v52, v100 row_newbcast:9 row_mask:0xf bank_mask:0xf
    v_dot2c_f32_bf16_dpp v14, v26, v101 row_newbcast:9 row_mask:0xf bank_mask:0xf
    v_dot2c_f32_bf16_dpp v15, v52, v101 row_newbcast:9 row_mask:0xf bank_mask:0xf
    v_dot2c_f32_bf16_dpp v16, v26, v102 row_newbcast:9 row_mask:0xf bank_mask:0xf
    v_dot2c_f32_bf16_dpp v17, v52, v102 row_newbcast:9 row_mask:0xf bank_mask:0xf
    v_dot2c_f32_bf16_dpp v18, v26, v103 row_newbcast:9 row_mask:0xf bank_mask:0xf
    v_dot2c_f32_bf16_dpp v19, v52, v103 row_newbcast:9 row_mask:0xf bank_mask:0xf
    s_add_u32 s6, s56, 479232
    s_and_b32 s6, s6, 0xfffff
    s_cmp_lt_u32 s3, 4
    s_cbranch_scc0 W_153
    s_waitcnt vmcnt(5)
W_153:
    buffer_load_dwordx4 v[84:87], v1, s[12:15], s6 offen nt
    s_waitcnt vmcnt(11)
    v_dot2c_f32_bf16_dpp v12, v26, v104 row_newbcast:10 row_mask:0xf bank_mask:0xf
    v_dot2c_f32_bf16_dpp v13, v52, v104 row_newbcast:10 row_mask:0xf bank_mask:0xf
    v_dot2c_f32_bf16_dpp v14, v26, v105 row_newbcast:10 row_mask:0xf bank_mask:0xf
    v_dot2c_f32_bf16_dpp v15, v52, v105 row_newbcast:10 row_mask:0xf bank_mask:0xf
    v_dot2c_f32_bf16_dpp v16, v26, v106 row_newbcast:10 row_mask:0xf bank_mask:0xf
    v_dot2c_f32_bf16_dpp v17, v52, v106 row_newbcast:10 row_mask:0xf bank_mask:0xf
    v_dot2c_f32_bf16_dpp v18, v26, v107 row_newbcast:10 row_mask:0xf bank_mask:0xf
    v_dot2c_f32_bf16_dpp v19, v52, v107 row_newbcast:10 row_mask:0xf bank_mask:0xf
    s_add_u32 s6, s56, 483328
    s_and_b32 s6, s6, 0xfffff
    s_cmp_lt_u32 s3, 4
    s_cbranch_scc0 W_154
    s_waitcnt vmcnt(4)
W_154:
    buffer_load_dwordx4 v[88:91], v1, s[12:15], s6 offen nt
    s_waitcnt vmcnt(11)
    v_dot2c_f32_bf16_dpp v12, v26, v108 row_newbcast:11 row_mask:0xf bank_mask:0xf
    v_dot2c_f32_bf16_dpp v13, v52, v108 row_newbcast:11 row_mask:0xf bank_mask:0xf
    v_dot2c_f32_bf16_dpp v14, v26, v109 row_newbcast:11 row_mask:0xf bank_mask:0xf
    v_dot2c_f32_bf16_dpp v15, v52, v109 row_newbcast:11 row_mask:0xf bank_mask:0xf
    v_dot2c_f32_bf16_dpp v16, v26, v110 row_newbcast:11 row_mask:0xf bank_mask:0xf
    v_dot2c_f32_bf16_dpp v17, v52, v110 row_newbcast:11 row_mask:0xf bank_mask:0xf
    v_dot2c_f32_bf16_dpp v18, v26, v111 row_newbcast:11 row_mask:0xf bank_mask:0xf
    v_dot2c_f32_bf16_dpp v19, v52, v111 row_newbcast:11 row_mask:0xf bank_mask:0xf
    s_add_u32 s6, s56, 487424
    s_and_b32 s6, s6, 0xfffff
    s_cmp_lt_u32 s3, 4
    s_cbranch_scc0 W_155
    s_waitcnt vmcnt(5)
W_155:
    buffer_load_dwordx4 v[92:95], v1, s[12:15], s6 offen nt
    s_waitcnt vmcnt(11)
    v_dot2c_f32_bf16_dpp v12, v26, v112 row_newbcast:12 row_mask:0xf bank_mask:0xf
    v_dot2c_f32_bf16_dpp v13, v52, v112 row_newbcast:12 row_mask:0xf bank_mask:0xf
    v_dot2c_f32_bf16_dpp v14, v26, v113 row_newbcast:12 row_mask:0xf bank_mask:0xf
    v_dot2c_f32_bf16_dpp v15, v52, v113 row_newbcast:12 row_mask:0xf bank_mask:0xf
    v_dot2c_f32_bf16_dpp v16, v26, v114 row_newbcast:12 row_mask:0xf bank_mask:0xf
    v_dot2c_f32_bf16_dpp v17, v52, v114 row_newbcast:12 row_mask:0xf bank_mask:0xf
    v_dot2c_f32_bf16_dpp v18, v26, v115 row_newbcast:12 row_mask:0xf bank_mask:0xf
    v_dot2c_f32_bf16_dpp v19, v52, v115 row_newbcast:12 row_mask:0xf bank_mask:0xf
    s_add_u32 s6, s56, 491520
    s_and_b32 s6, s6, 0xfffff
    s_cmp_lt_u32 s3, 4
    s_cbranch_scc0 W_156
    s_waitcnt vmcnt(4)
W_156:
    buffer_load_dwordx4 v[96:99], v1, s[12:15], s6 offen nt
    s_waitcnt vmcnt(11)
    v_dot2c_f32_bf16_dpp v12, v26, v116 row_newbcast:13 row_mask:0xf bank_mask:0xf
    v_dot2c_f32_bf16_dpp v13, v52, v116 row_newbcast:13 row_mask:0xf bank_mask:0xf
    v_dot2c_f32_bf16_dpp v14, v26, v117 row_newbcast:13 row_mask:0xf bank_mask:0xf
    v_dot2c_f32_bf16_dpp v15, v52, v117 row_newbcast:13 row_mask:0xf bank_mask:0xf
    v_dot2c_f32_bf16_dpp v16, v26, v118 row_newbcast:13 row_mask:0xf bank_mask:0xf
    v_dot2c_f32_bf16_dpp v17, v52, v118 row_newbcast:13 row_mask:0xf bank_mask:0xf
    v_dot2c_f32_bf16_dpp v18, v26, v119 row_newbcast:13 row_mask:0xf bank_mask:0xf
    v_dot2c_f32_bf16_dpp v19, v52, v119 row_newbcast:13 row_mask:0xf bank_mask:0xf
    s_add_u32 s6, s56, 495616
    s_and_b32 s6, s6, 0xfffff
    s_cmp_lt_u32 s3, 4
    s_cbranch_scc0 W_157
    s_waitcnt vmcnt(5)
W_157:
    buffer_load_dwordx4 v[100:103], v1, s[12:15], s6 offen nt
    s_waitcnt vmcnt(11)
    v_dot2c_f32_bf16_dpp v12, v26, v120 row_newbcast:14 row_mask:0xf bank_mask:0xf
    v_dot2c_f32_bf16_dpp v13, v52, v120 row_newbcast:14 row_mask:0xf bank_mask:0xf
    v_dot2c_f32_bf16_dpp v14, v26, v121 row_newbcast:14 row_mask:0xf bank_mask:0xf
    v_dot2c_f32_bf16_dpp v15, v52, v121 row_newbcast:14 row_mask:0xf bank_mask:0xf
    v_dot2c_f32_bf16_dpp v16, v26, v122 row_newbcast:14 row_mask:0xf bank_mask:0xf
    v_dot2c_f32_bf16_dpp v17, v52, v122 row_newbcast:14 row_mask:0xf bank_mask:0xf
    v_dot2c_f32_bf16_dpp v18, v26, v123 row_newbcast:14 row_mask:0xf bank_mask:0xf
    v_dot2c_f32_bf16_dpp v19, v52, v123 row_newbcast:14 row_mask:0xf bank_mask:0xf
    s_add_u32 s6, s56, 499712
    s_and_b32 s6, s6, 0xfffff
    s_cmp_lt_u32 s3, 4
    s_cbranch_scc0 W_158
    s_waitcnt vmcnt(4)
W_158:
    buffer_load_dwordx4 v[104:107], v1, s[12:15], s6 offen nt
    s_waitcnt vmcnt(11)
    v_dot2c_f32_bf16_dpp v12, v26, v124 row_newbcast:15 row_mask:0xf bank_mask:0xf
    v_dot2c_f32_bf16_dpp v13, v52, v124 row_newbcast:15 row_mask:0xf bank_mask:0xf
    v_dot2c_f32_bf16_dpp v14, v26, v125 row_newbcast:15 row_mask:0xf bank_mask:0xf
    v_dot2c_f32_bf16_dpp v15, v52, v125 row_newbcast:15 row_mask:0xf bank_mask:0xf
    v_dot2c_f32_bf16_dpp v16, v26, v126 row_newbcast:15 row_mask:0xf bank_mask:0xf
    v_dot2c_f32_bf16_dpp v17, v52, v126 row_newbcast:15 row_mask:0xf bank_mask:0xf
    v_dot2c_f32_bf16_dpp v18, v26, v127 row_newbcast:15 row_mask:0xf bank_mask:0xf
    v_dot2c_f32_bf16_dpp v19, v52, v127 row_newbcast:15 row_mask:0xf bank_mask:0xf
    s_add_u32 s6, s56, 503808
    s_and_b32 s6, s6, 0xfffff
    s_cmp_lt_u32 s3, 4
    s_cbranch_scc0 W_159
    s_waitcnt vmcnt(5)
W_159:
    buffer_load_dwordx4 v[108:111], v1, s[12:15], s6 offen nt
    v_lshlrev_b32 v54, 16, v27
    s_nop 1
    s_waitcnt vmcnt(11)
    v_dot2c_f32_bf16_dpp v12, v27, v64 row_newbcast:0 row_mask:0xf bank_mask:0xf
    v_dot2c_f32_bf16_dpp v13, v54, v64 row_newbcast:0 row_mask:0xf bank_mask:0xf
    v_dot2c_f32_bf16_dpp v14, v27, v65 row_newbcast:0 row_mask:0xf bank_mask:0xf
    v_dot2c_f32_bf16_dpp v15, v54, v65 row_newbcast:0 row_mask:0xf bank_mask:0xf
    v_dot2c_f32_bf16_dpp v16, v27, v66 row_newbcast:0 row_mask:0xf bank_mask:0xf
    v_dot2c_f32_bf16_dpp v17, v54, v66 row_newbcast:0 row_mask:0xf bank_mask:0xf
    v_dot2c_f32_bf16_dpp v18, v27, v67 row_newbcast:0 row_mask:0xf bank_mask:0xf
    v_dot2c_f32_bf16_dpp v19, v54, v67 row_newbcast:0 row_mask:0xf bank_mask:0xf
    s_add_u32 s6, s56, 507904
    s_and_b32 s6, s6, 0xfffff
    s_cmp_lt_u32 s3, 4
    s_cbranch_scc0 W_160
    s_waitcnt vmcnt(4)
W_160:
    buffer_load_dwordx4 v[112:115], v1, s[12:15], s6 offen nt
    s_waitcnt vmcnt(11)
    v_dot2c_f32_bf16_dpp v12, v27, v68 row_newbcast:1 row_mask:0xf bank_mask:0xf
    v_dot2c_f32_bf16_dpp v13, v54, v68 row_newbcast:1 row_mask:0xf bank_mask:0xf
    v_dot2c_f32_bf16_dpp v14, v27, v69 row_newbcast:1 row_mask:0xf bank_mask:0xf
    v_dot2c_f32_bf16_dpp v15, v54, v69 row_newbcast:1 row_mask:0xf bank_mask:0xf
    v_dot2c_f32_bf16_dpp v16, v27, v70 row_newbcast:1 row_mask:0xf bank_mask:0xf
    v_dot2c_f32_bf16_dpp v17, v54, v70 row_newbcast:1 row_mask:0xf bank_mask:0xf
    v_dot2c_f32_bf16_dpp v18, v27, v71 row_newbcast:1 row_mask:0xf bank_mask:0xf
    v_dot2c_f32_bf16_dpp v19, v54, v71 row_newbcast:1 row_mask:0xf bank_mask:0xf
    s_add_u32 m0, s79, 0
    s_add_u32 s6, s56, 512000
    s_and_b32 s6, s6, 0xfffff
    s_cmp_lt_u32 s3, 4
    s_cbranch_scc0 W_161
    s_waitcnt vmcnt(5)
W_161:
    buffer_load_dwordx4 v1, s[12:15], s6 offen nt lds
    s_waitcnt vmcnt(11)
    v_dot2c_f32_bf16_dpp v12, v27, v72 row_newbcast:2 row_mask:0xf bank_mask:0xf
    v_dot2c_f32_bf16_dpp v13, v54, v72 row_newbcast:2 row_mask:0xf bank_mask:0xf
    v_dot2c_f32_bf16_dpp v14, v27, v73 row_newbcast:2 row_mask:0xf bank_mask:0xf
    v_dot2c_f32_bf16_dpp v15, v54, v73 row_newbcast:2 row_mask:0xf bank_mask:0xf
    v_dot2c_f32_bf16_dpp v16, v27, v74 row_newbcast:2 row_mask:0xf bank_mask:0xf
    v_dot2c_f32_bf16_dpp v17, v54, v74 row_newbcast:2 row_mask:0xf bank_mask:0xf
    v_dot2c_f32_bf16_dpp v18, v27, v75 row_newbcast:2 row_mask:0xf bank_mask:0xf
    v_dot2c_f32_bf16_dpp v19, v54, v75 row_newbcast:2 row_mask:0xf bank_mask:0xf
    s_add_u32 m0, s79, 1024
    s_add_u32 s6, s56, 516096
    s_and_b32 s6, s6, 0xfffff
    s_cmp_lt_u32 s3, 4
    s_cbranch_scc0 W_162
    s_waitcnt vmcnt(4)
W_162:
    buffer_load_dwordx4 v1, s[12:15], s6 offen nt lds
    s_waitcnt vmcnt(11)
    v_dot2c_f32_bf16_dpp v12, v27, v76 row_newbcast:3 row_mask:0xf bank_mask:0xf
    v_dot2c_f32_bf16_dpp v13, v54, v76 row_newbcast:3 row_mask:0xf bank_mask:0xf
    v_dot2c_f32_bf16_dpp v14, v27, v77 row_newbcast:3 row_mask:0xf bank_mask:0xf
    v_dot2c_f32_bf16_dpp v15, v54, v77 row_newbcast:3 row_mask:0xf bank_mask:0xf
    v_dot2c_f32_bf16_dpp v16, v27, v78 row_newbcast:3 row_mask:0xf bank_mask:0xf
    v_dot2c_f32_bf16_dpp v17, v54, v78 row_newbcast:3 row_mask:0xf bank_mask:0xf
    v_dot2c_f32_bf16_dpp v18, v27, v79 row_newbcast:3 row_mask:0xf bank_mask:0xf
    v_dot2c_f32_bf16_dpp v19, v54, v79 row_newbcast:3 row_mask:0xf bank_mask:0xf
    s_add_u32 m0, s79, 2048
    s_add_u32 s6, s56, 520192
    s_and_b32 s6, s6, 0xfffff
    s_cmp_lt_u32 s3, 4
    s_cbranch_scc0 W_163
    s_waitcnt vmcnt(5)
W_163:
    buffer_load_dwordx4 v1, s[12:15], s6 offen nt lds
    s_waitcnt vmcnt(11)
    v_dot2c_f32_bf16_dpp v12, v27, v80 row_newbcast:4 row_mask:0xf bank_mask:0xf
    v_dot2c_f32_bf16_dpp v13, v54, v80 row_newbcast:4 row_mask:0xf bank_mask:0xf
    v_dot2c_f32_bf16_dpp v14, v27, v81 row_newbcast:4 row_mask:0xf bank_mask:0xf
    v_dot2c_f32_bf16_dpp v15, v54, v81 row_newbcast:4 row_mask:0xf bank_mask:0xf
    v_dot2c_f32_bf16_dpp v16, v27, v82 row_newbcast:4 row_mask:0xf bank_mask:0xf
    v_dot2c_f32_bf16_dpp v17, v54, v82 row_newbcast:4 row_mask:0xf bank_mask:0xf
    v_dot2c_f32_bf16_dpp v18, v27, v83 row_newbcast:4 row_mask:0xf bank_mask:0xf
    v_dot2c_f32_bf16_dpp v19, v54, v83 row_newbcast:4 row_mask:0xf bank_mask:0xf
    s_add_u32 m0, s79, 3072
    s_add_u32 s6, s56, 524288
    s_and_b32 s6, s6, 0xfffff
    s_cmp_lt_u32 s3, 4
    s_cbranch_scc0 W_164
    s_waitcnt vmcnt(4)
W_164:
    buffer_load_dwordx4 v1, s[12:15], s6 offen nt lds
    s_waitcnt vmcnt(11)
    v_dot2c_f32_bf16_dpp v12, v27, v84 row_newbcast:5 row_mask:0xf bank_mask:0xf
    v_dot2c_f32_bf16_dpp v13, v54, v84 row_newbcast:5 row_mask:0xf bank_mask:0xf
    v_dot2c_f32_bf16_dpp v14, v27, v85 row_newbcast:5 row_mask:0xf bank_mask:0xf
    v_dot2c_f32_bf16_dpp v15, v54, v85 row_newbcast:5 row_mask:0xf bank_mask:0xf
    v_dot2c_f32_bf16_dpp v16, v27, v86 row_newbcast:5 row_mask:0xf bank_mask:0xf
    v_dot2c_f32_bf16_dpp v17, v54, v86 row_newbcast:5 row_mask:0xf bank_mask:0xf
    v_dot2c_f32_bf16_dpp v18, v27, v87 row_newbcast:5 row_mask:0xf bank_mask:0xf
    v_dot2c_f32_bf16_dpp v19, v54, v87 row_newbcast:5 row_mask:0xf bank_mask:0xf
    s_add_u32 m0, s79, 4096
    s_add_u32 s6, s56, 528384
    s_and_b32 s6, s6, 0xfffff
    s_cmp_lt_u32 s3, 4
    s_cbranch_scc0 W_165
    s_waitcnt vmcnt(5)
W_165:
    buffer_load_dwordx4 v1, s[12:15], s6 offen nt lds
    s_waitcnt vmcnt(11)
    v_dot2c_f32_bf16_dpp v12, v27, v88 row_newbcast:6 row_mask:0xf bank_mask:0xf
    v_dot2c_f32_bf16_dpp v13, v54, v88 row_newbcast:6 row_mask:0xf bank_mask:0xf
    v_dot2c_f32_bf16_dpp v14, v27, v89 row_newbcast:6 row_mask:0xf bank_mask:0xf
    v_dot2c_f32_bf16_dpp v15, v54, v89 row_newbcast:6 row_mask:0xf bank_mask:0xf
    v_dot2c_f32_bf16_dpp v16, v27, v90 row_newbcast:6 row_mask:0xf bank_mask:0xf
    v_dot2c_f32_bf16_dpp v17, v54, v90 row_newbcast:6 row_mask:0xf bank_mask:0xf
    v_dot2c_f32_bf16_dpp v18, v27, v91 row_newbcast:6 row_mask:0xf bank_mask:0xf
    v_dot2c_f32_bf16_dpp v19, v54, v91 row_newbcast:6 row_mask:0xf bank_mask:0xf
    s_add_u32 m0, s79, 5120
    s_add_u32 s6, s56, 532480
    s_and_b32 s6, s6, 0xfffff
    s_cmp_lt_u32 s3, 4
    s_cbranch_scc0 W_166
    s_waitcnt vmcnt(4)
W_166:
    buffer_load_dwordx4 v1, s[12:15], s6 offen nt lds
    s_waitcnt vmcnt(11)
    v_dot2c_f32_bf16_dpp v12, v27, v92 row_newbcast:7 row_mask:0xf bank_mask:0xf
    v_dot2c_f32_bf16_dpp v13, v54, v92 row_newbcast:7 row_mask:0xf bank_mask:0xf
    v_dot2c_f32_bf16_dpp v14, v27, v93 row_newbcast:7 row_mask:0xf bank_mask:0xf
    v_dot2c_f32_bf16_dpp v15, v54, v93 row_newbcast:7 row_mask:0xf bank_mask:0xf
    v_dot2c_f32_bf16_dpp v16, v27, v94 row_newbcast:7 row_mask:0xf bank_mask:0xf
    v_dot2c_f32_bf16_dpp v17, v54, v94 row_newbcast:7 row_mask:0xf bank_mask:0xf
    v_dot2c_f32_bf16_dpp v18, v27, v95 row_newbcast:7 row_mask:0xf bank_mask:0xf
    v_dot2c_f32_bf16_dpp v19, v54, v95 row_newbcast:7 row_mask:0xf bank_mask:0xf
    s_add_u32 m0, s79, 6144
    s_add_u32 s6, s56, 536576
    s_and_b32 s6, s6, 0xfffff
    s_cmp_lt_u32 s3, 4
    s_cbranch_scc0 W_167
    s_waitcnt vmcnt(5)
W_167:
    buffer_load_dwordx4 v1, s[12:15], s6 offen nt lds
    s_waitcnt vmcnt(11)
    v_dot2c_f32_bf16_dpp v12, v27, v96 row_newbcast:8 row_mask:0xf bank_mask:0xf
    v_dot2c_f32_bf16_dpp v13, v54, v96 row_newbcast:8 row_mask:0xf bank_mask:0xf
    v_dot2c_f32_bf16_dpp v14, v27, v97 row_newbcast:8 row_mask:0xf bank_mask:0xf
    v_dot2c_f32_bf16_dpp v15, v54, v97 row_newbcast:8 row_mask:0xf bank_mask:0xf
    v_dot2c_f32_bf16_dpp v16, v27, v98 row_newbcast:8 row_mask:0xf bank_mask:0xf
    v_dot2c_f32_bf16_dpp v17, v54, v98 row_newbcast:8 row_mask:0xf bank_mask:0xf
    v_dot2c_f32_bf16_dpp v18, v27, v99 row_newbcast:8 row_mask:0xf bank_mask:0xf
    v_dot2c_f32_bf16_dpp v19, v54, v99 row_newbcast:8 row_mask:0xf bank_mask:0xf
    s_add_u32 m0, s79, 7168
    s_add_u32 s6, s56, 540672
    s_and_b32 s6, s6, 0xfffff
    s_cmp_lt_u32 s3, 4
    s_cbranch_scc0 W_168
    s_waitcnt vmcnt(4)
W_168:
    buffer_load_dwordx4 v1, s[12:15], s6 offen nt lds
    s_waitcnt vmcnt(11)
    v_dot2c_f32_bf16_dpp v12, v27, v100 row_newbcast:9 row_mask:0xf bank_mask:0xf
    v_dot2c_f32_bf16_dpp v13, v54, v100 row_newbcast:9 row_mask:0xf bank_mask:0xf
    v_dot2c_f32_bf16_dpp v14, v27, v101 row_newbcast:9 row_mask:0xf bank_mask:0xf
    v_dot2c_f32_bf16_dpp v15, v54, v101 row_newbcast:9 row_mask:0xf bank_mask:0xf
    v_dot2c_f32_bf16_dpp v16, v27, v102 row_newbcast:9 row_mask:0xf bank_mask:0xf
    v_dot2c_f32_bf16_dpp v17, v54, v102 row_newbcast:9 row_mask:0xf bank_mask:0xf
    v_dot2c_f32_bf16_dpp v18, v27, v103 row_newbcast:9 row_mask:0xf bank_mask:0xf
    v_dot2c_f32_bf16_dpp v19, v54, v103 row_newbcast:9 row_mask:0xf bank_mask:0xf
    s_add_u32 m0, s79, 8192
    s_add_u32 s6, s56, 544768
    s_and_b32 s6, s6, 0xfffff
    s_cmp_lt_u32 s3, 4
    s_cbranch_scc0 W_169
    s_waitcnt vmcnt(5)
W_169:
    buffer_load_dwordx4 v1, s[12:15], s6 offen nt lds
    s_waitcnt vmcnt(11)
    v_dot2c_f32_bf16_dpp v12, v27, v104 row_newbcast:10 row_mask:0xf bank_mask:0xf
    v_dot2c_f32_bf16_dpp v13, v54, v104 row_newbcast:10 row_mask:0xf bank_mask:0xf
    v_dot2c_f32_bf16_dpp v14, v27, v105 row_newbcast:10 row_mask:0xf bank_mask:0xf
    v_dot2c_f32_bf16_dpp v15, v54, v105 row_newbcast:10 row_mask:0xf bank_mask:0xf
    v_dot2c_f32_bf16_dpp v16, v27, v106 row_newbcast:10 row_mask:0xf bank_mask:0xf
    v_dot2c_f32_bf16_dpp v17, v54, v106 row_newbcast:10 row_mask:0xf bank_mask:0xf
    v_dot2c_f32_bf16_dpp v18, v27, v107 row_newbcast:10 row_mask:0xf bank_mask:0xf
    v_dot2c_f32_bf16_dpp v19, v54, v107 row_newbcast:10 row_mask:0xf bank_mask:0xf
    s_add_u32 m0, s79, 9216
    s_add_u32 s6, s56, 548864
    s_and_b32 s6, s6, 0xfffff
    s_cmp_lt_u32 s3, 4
    s_cbranch_scc0 W_170
    s_waitcnt vmcnt(4)
W_170:
    buffer_load_dwordx4 v1, s[12:15], s6 offen nt lds
    s_waitcnt vmcnt(9)
    ds_read_b128 v[36:39], v53 offset:0
    v_dot2c_f32_bf16_dpp v12, v27, v108 row_newbcast:11 row_mask:0xf bank_mask:0xf
    v_dot2c_f32_bf16_dpp v13, v54, v108 row_newbcast:11 row_mask:0xf bank_mask:0xf
    v_dot2c_f32_bf16_dpp v14, v27, v109 row_newbcast:11 row_mask:0xf bank_mask:0xf
    v_dot2c_f32_bf16_dpp v15, v54, v109 row_newbcast:11 row_mask:0xf bank_mask:0xf
    v_dot2c_f32_bf16_dpp v16, v27, v110 row_newbcast:11 row_mask:0xf bank_mask:0xf
    v_dot2c_f32_bf16_dpp v17, v54, v110 row_newbcast:11 row_mask:0xf bank_mask:0xf
    v_dot2c_f32_bf16_dpp v18, v27, v111 row_newbcast:11 row_mask:0xf bank_mask:0xf
    v_dot2c_f32_bf16_dpp v19, v54, v111 row_newbcast:11 row_mask:0xf bank_mask:0xf
    s_add_u32 m0, s79, 10240
    s_add_u32 s6, s56, 552960
    s_and_b32 s6, s6, 0xfffff
    s_cmp_lt_u32 s3, 4
    s_cbranch_scc0 W_171
    s_waitcnt vmcnt(5)
W_171:
    buffer_load_dwordx4 v1, s[12:15], s6 offen nt lds
    s_waitcnt vmcnt(9)
    ds_read_b128 v[40:43], v53 offset:1024
    v_dot2c_f32_bf16_dpp v12, v27, v112 row_newbcast:12 row_mask:0xf bank_mask:0xf
    v_dot2c_f32_bf16_dpp v13, v54, v112 row_newbcast:12 row_mask:0xf bank_mask:0xf
    v_dot2c_f32_bf16_dpp v14, v27, v113 row_newbcast:12 row_mask:0xf bank_mask:0xf
    v_dot2c_f32_bf16_dpp v15, v54, v113 row_newbcast:12 row_mask:0xf bank_mask:0xf
    v_dot2c_f32_bf16_dpp v16, v27, v114 row_newbcast:12 row_mask:0xf bank_mask:0xf
    v_dot2c_f32_bf16_dpp v17, v54, v114 row_newbcast:12 row_mask:0xf bank_mask:0xf
    v_dot2c_f32_bf16_dpp v18, v27, v115 row_newbcast:12 row_mask:0xf bank_mask:0xf
    v_dot2c_f32_bf16_dpp v19, v54, v115 row_newbcast:12 row_mask:0xf bank_mask:0xf
    s_add_u32 m0, s79, 11264
    s_add_u32 s6, s56, 557056
    s_and_b32 s6, s6, 0xfffff
    s_cmp_lt_u32 s3, 4
    s_cbranch_scc0 W_172
    s_waitcnt vmcnt(4)
W_172:
    buffer_load_dwordx4 v1, s[12:15], s6 offen nt lds
    s_waitcnt vmcnt(9)
    ds_read_b128 v[44:47], v53 offset:2048
    s_waitcnt lgkmcnt(2)
    v_dot2c_f32_bf16_dpp v12, v27, v36 row_newbcast:13 row_mask:0xf bank_mask:0xf
    v_dot2c_f32_bf16_dpp v13, v54, v36 row_newbcast:13 row_mask:0xf bank_mask:0xf
    v_dot2c_f32_bf16_dpp v14, v27, v37 row_newbcast:13 row_mask:0xf bank_mask:0xf
    v_dot2c_f32_bf16_dpp v15, v54, v37 row_newbcast:13 row_mask:0xf bank_mask:0xf
    v_dot2c_f32_bf16_dpp v16, v27, v38 row_newbcast:13 row_mask:0xf bank_mask:0xf
    v_dot2c_f32_bf16_dpp v17, v54, v38 row_newbcast:13 row_mask:0xf bank_mask:0xf
    v_dot2c_f32_bf16_dpp v18, v27, v39 row_newbcast:13 row_mask:0xf bank_mask:0xf
    v_dot2c_f32_bf16_dpp v19, v54, v39 row_newbcast:13 row_mask:0xf bank_mask:0xf
    s_add_u32 m0, s79, 12288
    s_add_u32 s6, s56, 561152
    s_and_b32 s6, s6, 0xfffff
    s_cmp_lt_u32 s3, 4
    s_cbranch_scc0 W_173
    s_waitcnt vmcnt(5)
W_173:
    buffer_load_dwordx4 v1, s[12:15], s6 offen nt lds
    s_waitcnt vmcnt(9)
    ds_read_b128 v[36:39], v53 offset:3072
    s_waitcnt lgkmcnt(2)
    v_dot2c_f32_bf16_dpp v12, v27, v40 row_newbcast:14 row_mask:0xf bank_mask:0xf
    v_dot2c_f32_bf16_dpp v13, v54, v40 row_newbcast:14 row_mask:0xf bank_mask:0xf
    v_dot2c_f32_bf16_dpp v14, v27, v41 row_newbcast:14 row_mask:0xf bank_mask:0xf
    v_dot2c_f32_bf16_dpp v15, v54, v41 row_newbcast:14 row_mask:0xf bank_mask:0xf
    v_dot2c_f32_bf16_dpp v16, v27, v42 row_newbcast:14 row_mask:0xf bank_mask:0xf
    v_dot2c_f32_bf16_dpp v17, v54, v42 row_newbcast:14 row_mask:0xf bank_mask:0xf
    v_dot2c_f32_bf16_dpp v18, v27, v43 row_newbcast:14 row_mask:0xf bank_mask:0xf
    v_dot2c_f32_bf16_dpp v19, v54, v43 row_newbcast:14 row_mask:0xf bank_mask:0xf
    s_add_u32 m0, s79, 13312
    s_add_u32 s6, s56, 565248
    s_and_b32 s6, s6, 0xfffff
    s_cmp_lt_u32 s3, 4
    s_cbranch_scc0 W_174
    s_waitcnt vmcnt(4)
W_174:
    buffer_load_dwordx4 v1, s[12:15], s6 offen nt lds
    s_waitcnt vmcnt(9)
    ds_read_b128 v[40:43], v53 offset:4096
    s_waitcnt lgkmcnt(2)
    v_dot2c_f32_bf16_dpp v12, v27, v44 row_newbcast:15 row_mask:0xf bank_mask:0xf
    v_dot2c_f32_bf16_dpp v13, v54, v44 row_newbcast:15 row_mask:0xf bank_mask:0xf
    v_dot2c_f32_bf16_dpp v14, v27, v45 row_newbcast:15 row_mask:0xf bank_mask:0xf
    v_dot2c_f32_bf16_dpp v15, v54, v45 row_newbcast:15 row_mask:0xf bank_mask:0xf
    v_dot2c_f32_bf16_dpp v16, v27, v46 row_newbcast:15 row_mask:0xf bank_mask:0xf
    v_dot2c_f32_bf16_dpp v17, v54, v46 row_newbcast:15 row_mask:0xf bank_mask:0xf
    v_dot2c_f32_bf16_dpp v18, v27, v47 row_newbcast:15 row_mask:0xf bank_mask:0xf
    v_dot2c_f32_bf16_dpp v19, v54, v47 row_newbcast:15 row_mask:0xf bank_mask:0xf
    s_add_u32 m0, s79, 14336
    s_add_u32 s6, s56, 569344
    s_and_b32 s6, s6, 0xfffff
    s_cmp_lt_u32 s3, 4
    s_cbranch_scc0 W_175
    s_waitcnt vmcnt(5)
W_175:
    buffer_load_dwordx4 v1, s[12:15], s6 offen nt lds
    v_lshlrev_b32 v52, 16, v28
    s_nop 1
    s_waitcnt vmcnt(9)
    ds_read_b128 v[44:47], v53 offset:5120
    s_waitcnt lgkmcnt(2)
    v_dot2c_f32_bf16_dpp v12, v28, v36 row_newbcast:0 row_mask:0xf bank_mask:0xf
    v_dot2c_f32_bf16_dpp v13, v52, v36 row_newbcast:0 row_mask:0xf bank_mask:0xf
    v_dot2c_f32_bf16_dpp v14, v28, v37 row_newbcast:0 row_mask:0xf bank_mask:0xf
    v_dot2c_f32_bf16_dpp v15, v52, v37 row_newbcast:0 row_mask:0xf bank_mask:0xf
    v_dot2c_f32_bf16_dpp v16, v28, v38 row_newbcast:0 row_mask:0xf bank_mask:0xf
    v_dot2c_f32_bf16_dpp v17, v52, v38 row_newbcast:0 row_mask:0xf bank_mask:0xf
    v_dot2c_f32_bf16_dpp v18, v28, v39 row_newbcast:0 row_mask:0xf bank_mask:0xf
    v_dot2c_f32_bf16_dpp v19, v52, v39 row_newbcast:0 row_mask:0xf bank_mask:0xf
    s_add_u32 m0, s79, 15360
    s_add_u32 s6, s56, 573440
    s_and_b32 s6, s6, 0xfffff
    s_cmp_lt_u32 s3, 4
    s_cbranch_scc0 W_176
    s_waitcnt vmcnt(4)
W_176:
    buffer_load_dwordx4 v1, s[12:15], s6 offen nt lds
    s_waitcnt vmcnt(9)
    ds_read_b128 v[36:39], v53 offset:6144
    s_waitcnt lgkmcnt(2)
    v_dot2c_f32_bf16_dpp v12, v28, v40 row_newbcast:1 row_mask:0xf bank_mask:0xf
    v_dot2c_f32_bf16_dpp v13, v52, v40 row_newbcast:1 row_mask:0xf bank_mask:0xf
    v_dot2c_f32_bf16_dpp v14, v28, v41 row_newbcast:1 row_mask:0xf bank_mask:0xf
    v_dot2c_f32_bf16_dpp v15, v52, v41 row_newbcast:1 row_mask:0xf bank_mask:0xf
    v_dot2c_f32_bf16_dpp v16, v28, v42 row_newbcast:1 row_mask:0xf bank_mask:0xf
    v_dot2c_f32_bf16_dpp v17, v52, v42 row_newbcast:1 row_mask:0xf bank_mask:0xf
    v_dot2c_f32_bf16_dpp v18, v28, v43 row_newbcast:1 row_mask:0xf bank_mask:0xf
    v_dot2c_f32_bf16_dpp v19, v52, v43 row_newbcast:1 row_mask:0xf bank_mask:0xf
    s_add_u32 m0, s79, 16384
    s_add_u32 s6, s56, 577536
    s_and_b32 s6, s6, 0xfffff
    s_cmp_lt_u32 s3, 4
    s_cbranch_scc0 W_177
    s_waitcnt vmcnt(5)
W_177:
    buffer_load_dwordx4 v1, s[12:15], s6 offen nt lds
    s_waitcnt vmcnt(9)
    ds_read_b128 v[40:43], v53 offset:7168
    s_waitcnt lgkmcnt(2)
    v_dot2c_f32_bf16_dpp v12, v28, v44 row_newbcast:2 row_mask:0xf bank_mask:0xf
    v_dot2c_f32_bf16_dpp v13, v52, v44 row_newbcast:2 row_mask:0xf bank_mask:0xf
    v_dot2c_f32_bf16_dpp v14, v28, v45 row_newbcast:2 row_mask:0xf bank_mask:0xf
    v_dot2c_f32_bf16_dpp v15, v52, v45 row_newbcast:2 row_mask:0xf bank_mask:0xf
    v_dot2c_f32_bf16_dpp v16, v28, v46 row_newbcast:2 row_mask:0xf bank_mask:0xf
    v_dot2c_f32_bf16_dpp v17, v52, v46 row_newbcast:2 row_mask:0xf bank_mask:0xf
    v_dot2c_f32_bf16_dpp v18, v28, v47 row_newbcast:2 row_mask:0xf bank_mask:0xf
    v_dot2c_f32_bf16_dpp v19, v52, v47 row_newbcast:2 row_mask:0xf bank_mask:0xf
    s_add_u32 m0, s79, 17408
    s_add_u32 s6, s56, 581632
    s_and_b32 s6, s6, 0xfffff
    s_cmp_lt_u32 s3, 4
    s_cbranch_scc0 W_178
    s_waitcnt vmcnt(4)
W_178:
    buffer_load_dwordx4 v1, s[12:15], s6 offen nt lds
    s_waitcnt vmcnt(9)
    ds_read_b128 v[44:47], v53 offset:8192
    s_waitcnt lgkmcnt(2)
    v_dot2c_f32_bf16_dpp v12, v28, v36 row_newbcast:3 row_mask:0xf bank_mask:0xf
    v_dot2c_f32_bf16_dpp v13, v52, v36 row_newbcast:3 row_mask:0xf bank_mask:0xf
    v_dot2c_f32_bf16_dpp v14, v28, v37 row_newbcast:3 row_mask:0xf bank_mask:0xf
    v_dot2c_f32_bf16_dpp v15, v52, v37 row_newbcast:3 row_mask:0xf bank_mask:0xf
    v_dot2c_f32_bf16_dpp v16, v28, v38 row_newbcast:3 row_mask:0xf bank_mask:0xf
    v_dot2c_f32_bf16_dpp v17, v52, v38 row_newbcast:3 row_mask:0xf bank_mask:0xf
    v_dot2c_f32_bf16_dpp v18, v28, v39 row_newbcast:3 row_mask:0xf bank_mask:0xf
    v_dot2c_f32_bf16_dpp v19, v52, v39 row_newbcast:3 row_mask:0xf bank_mask:0xf
    s_add_u32 m0, s79, 18432
    s_add_u32 s6, s56, 585728
    s_and_b32 s6, s6, 0xfffff
    s_cmp_lt_u32 s3, 4
    s_cbranch_scc0 W_179
    s_waitcnt vmcnt(5)
W_179:
    buffer_load_dwordx4 v1, s[12:15], s6 offen nt lds
    s_waitcnt vmcnt(9)
    ds_read_b128 v[36:39], v53 offset:9216
    s_waitcnt lgkmcnt(2)
    v_dot2c_f32_bf16_dpp v12, v28, v40 row_newbcast:4 row_mask:0xf bank_mask:0xf
    v_dot2c_f32_bf16_dpp v13, v52, v40 row_newbcast:4 row_mask:0xf bank_mask:0xf
    v_dot2c_f32_bf16_dpp v14, v28, v41 row_newbcast:4 row_mask:0xf bank_mask:0xf
    v_dot2c_f32_bf16_dpp v15, v52, v41 row_newbcast:4 row_mask:0xf bank_mask:0xf
    v_dot2c_f32_bf16_dpp v16, v28, v42 row_newbcast:4 row_mask:0xf bank_mask:0xf
    v_dot2c_f32_bf16_dpp v17, v52, v42 row_newbcast:4 row_mask:0xf bank_mask:0xf
    v_dot2c_f32_bf16_dpp v18, v28, v43 row_newbcast:4 row_mask:0xf bank_mask:0xf
    v_dot2c_f32_bf16_dpp v19, v52, v43 row_newbcast:4 row_mask:0xf bank_mask:0xf
    s_add_u32 m0, s79, 19456
    s_add_u32 s6, s56, 589824
    s_and_b32 s6, s6, 0xfffff
    s_cmp_lt_u32 s3, 4
    s_cbranch_scc0 W_180
    s_waitcnt vmcnt(4)
W_180:
    buffer_load_dwordx4 v1, s[12:15], s6 offen nt lds
    s_waitcnt vmcnt(9)
    ds_read_b128 v[40:43], v53 offset:10240
    s_waitcnt lgkmcnt(2)
    v_dot2c_f32_bf16_dpp v12, v28, v44 row_newbcast:5 row_mask:0xf bank_mask:0xf
    v_dot2c_f32_bf16_dpp v13, v52, v44 row_newbcast:5 row_mask:0xf bank_mask:0xf
    v_dot2c_f32_bf16_dpp v14, v28, v45 row_newbcast:5 row_mask:0xf bank_mask:0xf
    v_dot2c_f32_bf16_dpp v15, v52, v45 row_newbcast:5 row_mask:0xf bank_mask:0xf
    v_dot2c_f32_bf16_dpp v16, v28, v46 row_newbcast:5 row_mask:0xf bank_mask:0xf
    v_dot2c_f32_bf16_dpp v17, v52, v46 row_newbcast:5 row_mask:0xf bank_mask:0xf
    v_dot2c_f32_bf16_dpp v18, v28, v47 row_newbcast:5 row_mask:0xf bank_mask:0xf
    v_dot2c_f32_bf16_dpp v19, v52, v47 row_newbcast:5 row_mask:0xf bank_mask:0xf
    s_add_u32 m0, s79, 20480
    s_add_u32 s6, s56, 593920
    s_and_b32 s6, s6, 0xfffff
    s_cmp_lt_u32 s3, 4
    s_cbranch_scc0 W_181
    s_waitcnt vmcnt(5)
W_181:
    buffer_load_dwordx4 v1, s[12:15], s6 offen nt lds
    s_waitcnt vmcnt(9)
    ds_read_b128 v[44:47], v53 offset:11264
    s_waitcnt lgkmcnt(2)
    v_dot2c_f32_bf16_dpp v12, v28, v36 row_newbcast:6 row_mask:0xf bank_mask:0xf
    v_dot2c_f32_bf16_dpp v13, v52, v36 row_newbcast:6 row_mask:0xf bank_mask:0xf
    v_dot2c_f32_bf16_dpp v14, v28, v37 row_newbcast:6 row_mask:0xf bank_mask:0xf
    v_dot2c_f32_bf16_dpp v15, v52, v37 row_newbcast:6 row_mask:0xf bank_mask:0xf
    v_dot2c_f32_bf16_dpp v16, v28, v38 row_newbcast:6 row_mask:0xf bank_mask:0xf
    v_dot2c_f32_bf16_dpp v17, v52, v38 row_newbcast:6 row_mask:0xf bank_mask:0xf
    v_dot2c_f32_bf16_dpp v18, v28, v39 row_newbcast:6 row_mask:0xf bank_mask:0xf
    v_dot2c_f32_bf16_dpp v19, v52, v39 row_newbcast:6 row_mask:0xf bank_mask:0xf
    s_add_u32 m0, s79, 21504
    s_add_u32 s6, s56, 598016
    s_and_b32 s6, s6, 0xfffff
    s_cmp_lt_u32 s3, 4
    s_cbranch_scc0 W_182
    s_waitcnt vmcnt(4)
W_182:
    buffer_load_dwordx4 v1, s[12:15], s6 offen nt lds
    s_waitcnt vmcnt(9)
    ds_read_b128 v[36:39], v53 offset:12288
    s_waitcnt lgkmcnt(2)
    v_dot2c_f32_bf16_dpp v12, v28, v40 row_newbcast:7 row_mask:0xf bank_mask:0xf
    v_dot2c_f32_bf16_dpp v13, v52, v40 row_newbcast:7 row_mask:0xf bank_mask:0xf
    v_dot2c_f32_bf16_dpp v14, v28, v41 row_newbcast:7 row_mask:0xf bank_mask:0xf
    v_dot2c_f32_bf16_dpp v15, v52, v41 row_newbcast:7 row_mask:0xf bank_mask:0xf
    v_dot2c_f32_bf16_dpp v16, v28, v42 row_newbcast:7 row_mask:0xf bank_mask:0xf
    v_dot2c_f32_bf16_dpp v17, v52, v42 row_newbcast:7 row_mask:0xf bank_mask:0xf
    v_dot2c_f32_bf16_dpp v18, v28, v43 row_newbcast:7 row_mask:0xf bank_mask:0xf
    v_dot2c_f32_bf16_dpp v19, v52, v43 row_newbcast:7 row_mask:0xf bank_mask:0xf
    s_add_u32 m0, s79, 22528
    s_add_u32 s6, s56, 602112
    s_and_b32 s6, s6, 0xfffff
    s_cmp_lt_u32 s3, 4
    s_cbranch_scc0 W_183
    s_waitcnt vmcnt(5)
W_183:
    buffer_load_dwordx4 v1, s[12:15], s6 offen nt lds
    s_waitcnt vmcnt(9)
    ds_read_b128 v[40:43], v53 offset:13312
    s_waitcnt lgkmcnt(2)
    v_dot2c_f32_bf16_dpp v12, v28, v44 row_newbcast:8 row_mask:0xf bank_mask:0xf
    v_dot2c_f32_bf16_dpp v13, v52, v44 row_newbcast:8 row_mask:0xf bank_mask:0xf
    v_dot2c_f32_bf16_dpp v14, v28, v45 row_newbcast:8 row_mask:0xf bank_mask:0xf
    v_dot2c_f32_bf16_dpp v15, v52, v45 row_newbcast:8 row_mask:0xf bank_mask:0xf
    v_dot2c_f32_bf16_dpp v16, v28, v46 row_newbcast:8 row_mask:0xf bank_mask:0xf
    v_dot2c_f32_bf16_dpp v17, v52, v46 row_newbcast:8 row_mask:0xf bank_mask:0xf
    v_dot2c_f32_bf16_dpp v18, v28, v47 row_newbcast:8 row_mask:0xf bank_mask:0xf
    v_dot2c_f32_bf16_dpp v19, v52, v47 row_newbcast:8 row_mask:0xf bank_mask:0xf
    s_add_u32 m0, s79, 23552
    s_add_u32 s6, s56, 606208
    s_and_b32 s6, s6, 0xfffff
    s_cmp_lt_u32 s3, 4
    s_cbranch_scc0 W_184
    s_waitcnt vmcnt(4)
W_184:
    buffer_load_dwordx4 v1, s[12:15], s6 offen nt lds
    s_waitcnt vmcnt(9)
    ds_read_b128 v[44:47], v53 offset:14336
    s_waitcnt lgkmcnt(2)
    v_dot2c_f32_bf16_dpp v12, v28, v36 row_newbcast:9 row_mask:0xf bank_mask:0xf
    v_dot2c_f32_bf16_dpp v13, v52, v36 row_newbcast:9 row_mask:0xf bank_mask:0xf
    v_dot2c_f32_bf16_dpp v14, v28, v37 row_newbcast:9 row_mask:0xf bank_mask:0xf
    v_dot2c_f32_bf16_dpp v15, v52, v37 row_newbcast:9 row_mask:0xf bank_mask:0xf
    v_dot2c_f32_bf16_dpp v16, v28, v38 row_newbcast:9 row_mask:0xf bank_mask:0xf
    v_dot2c_f32_bf16_dpp v17, v52, v38 row_newbcast:9 row_mask:0xf bank_mask:0xf
    v_dot2c_f32_bf16_dpp v18, v28, v39 row_newbcast:9 row_mask:0xf bank_mask:0xf
    v_dot2c_f32_bf16_dpp v19, v52, v39 row_newbcast:9 row_mask:0xf bank_mask:0xf
    s_add_u32 m0, s79, 24576
    s_add_u32 s6, s56, 610304
    s_and_b32 s6, s6, 0xfffff
    s_cmp_lt_u32 s3, 4
    s_cbranch_scc0 W_185
    s_waitcnt vmcnt(5)
W_185:
    buffer_load_dwordx4 v1, s[12:15], s6 offen nt lds
    s_waitcnt vmcnt(9)
    ds_read_b128 v[36:39], v53 offset:15360
    s_waitcnt lgkmcnt(2)
    v_dot2c_f32_bf16_dpp v12, v28, v40 row_newbcast:10 row_mask:0xf bank_mask:0xf
    v_dot2c_f32_bf16_dpp v13, v52, v40 row_newbcast:10 row_mask:0xf bank_mask:0xf
    v_dot2c_f32_bf16_dpp v14, v28, v41 row_newbcast:10 row_mask:0xf bank_mask:0xf
    v_dot2c_f32_bf16_dpp v15, v52, v41 row_newbcast:10 row_mask:0xf bank_mask:0xf
    v_dot2c_f32_bf16_dpp v16, v28, v42 row_newbcast:10 row_mask:0xf bank_mask:0xf
    v_dot2c_f32_bf16_dpp v17, v52, v42 row_newbcast:10 row_mask:0xf bank_mask:0xf
    v_dot2c_f32_bf16_dpp v18, v28, v43 row_newbcast:10 row_mask:0xf bank_mask:0xf
    v_dot2c_f32_bf16_dpp v19, v52, v43 row_newbcast:10 row_mask:0xf bank_mask:0xf
    s_add_u32 m0, s79, 25600
    s_add_u32 s6, s56, 614400
    s_and_b32 s6, s6, 0xfffff
    s_cmp_lt_u32 s3, 4
    s_cbranch_scc0 W_186
    s_waitcnt vmcnt(4)
W_186:
    buffer_load_dwordx4 v1, s[12:15], s6 offen nt lds
    s_waitcnt vmcnt(9)
    ds_read_b128 v[40:43], v53 offset:16384
    s_waitcnt lgkmcnt(2)
    v_dot2c_f32_bf16_dpp v12, v28, v44 row_newbcast:11 row_mask:0xf bank_mask:0xf
    v_dot2c_f32_bf16_dpp v13, v52, v44 row_newbcast:11 row_mask:0xf bank_mask:0xf
    v_dot2c_f32_bf16_dpp v14, v28, v45 row_newbcast:11 row_mask:0xf bank_mask:0xf
    v_dot2c_f32_bf16_dpp v15, v52, v45 row_newbcast:11 row_mask:0xf bank_mask:0xf
    v_dot2c_f32_bf16_dpp v16, v28, v46 row_newbcast:11 row_mask:0xf bank_mask:0xf
    v_dot2c_f32_bf16_dpp v17, v52, v46 row_newbcast:11 row_mask:0xf bank_mask:0xf
    v_dot2c_f32_bf16_dpp v18, v28, v47 row_newbcast:11 row_mask:0xf bank_mask:0xf
    v_dot2c_f32_bf16_dpp v19, v52, v47 row_newbcast:11 row_mask:0xf bank_mask:0xf
    s_add_u32 m0, s79, 26624
    s_add_u32 s6, s56, 618496
    s_and_b32 s6, s6, 0xfffff
    s_cmp_lt_u32 s3, 4
    s_cbranch_scc0 W_187
    s_waitcnt vmcnt(5)
W_187:
    buffer_load_dwordx4 v1, s[12:15], s6 offen nt lds
    s_waitcnt vmcnt(9)
    ds_read_b128 v[44:47], v53 offset:17408
    s_waitcnt lgkmcnt(2)
    v_dot2c_f32_bf16_dpp v12, v28, v36 row_newbcast:12 row_mask:0xf bank_mask:0xf
    v_dot2c_f32_bf16_dpp v13, v52, v36 row_newbcast:12 row_mask:0xf bank_mask:0xf
    v_dot2c_f32_bf16_dpp v14, v28, v37 row_newbcast:12 row_mask:0xf bank_mask:0xf
    v_dot2c_f32_bf16_dpp v15, v52, v37 row_newbcast:12 row_mask:0xf bank_mask:0xf
    v_dot2c_f32_bf16_dpp v16, v28, v38 row_newbcast:12 row_mask:0xf bank_mask:0xf
    v_dot2c_f32_bf16_dpp v17, v52, v38 row_newbcast:12 row_mask:0xf bank_mask:0xf
    v_dot2c_f32_bf16_dpp v18, v28, v39 row_newbcast:12 row_mask:0xf bank_mask:0xf
    v_dot2c_f32_bf16_dpp v19, v52, v39 row_newbcast:12 row_mask:0xf bank_mask:0xf
    s_add_u32 m0, s79, 27648
    s_add_u32 s6, s56, 622592
    s_and_b32 s6, s6, 0xfffff
    s_cmp_lt_u32 s3, 4
    s_cbranch_scc0 W_188
    s_waitcnt vmcnt(4)
W_188:
    buffer_load_dwordx4 v1, s[12:15], s6 offen nt lds
    s_waitcnt vmcnt(9)
    ds_read_b128 v[36:39], v53 offset:18432
    s_waitcnt lgkmcnt(2)
    v_dot2c_f32_bf16_dpp v12, v28, v40 row_newbcast:13 row_mask:0xf bank_mask:0xf
    v_dot2c_f32_bf16_dpp v13, v52, v40 row_newbcast:13 row_mask:0xf bank_mask:0xf
    v_dot2c_f32_bf16_dpp v14, v28, v41 row_newbcast:13 row_mask:0xf bank_mask:0xf
    v_dot2c_f32_bf16_dpp v15, v52, v41 row_newbcast:13 row_mask:0xf bank_mask:0xf
    v_dot2c_f32_bf16_dpp v16, v28, v42 row_newbcast:13 row_mask:0xf bank_mask:0xf
    v_dot2c_f32_bf16_dpp v17, v52, v42 row_newbcast:13 row_mask:0xf bank_mask:0xf
    v_dot2c_f32_bf16_dpp v18, v28, v43 row_newbcast:13 row_mask:0xf bank_mask:0xf
    v_dot2c_f32_bf16_dpp v19, v52, v43 row_newbcast:13 row_mask:0xf bank_mask:0xf
    s_add_u32 m0, s79, 28672
    s_add_u32 s6, s56, 626688
    s_and_b32 s6, s6, 0xfffff
    s_cmp_lt_u32 s3, 4
    s_cbranch_scc0 W_189
    s_waitcnt vmcnt(5)
W_189:
    buffer_load_dwordx4 v1, s[12:15], s6 offen nt lds
    s_waitcnt vmcnt(9)
    ds_read_b128 v[40:43], v53 offset:19456
    s_waitcnt lgkmcnt(2)
    v_dot2c_f32_bf16_dpp v12, v28, v44 row_newbcast:14 row_mask:0xf bank_mask:0xf
    v_dot2c_f32_bf16_dpp v13, v52, v44 row_newbcast:14 row_mask:0xf bank_mask:0xf
    v_dot2c_f32_bf16_dpp v14, v28, v45 row_newbcast:14 row_mask:0xf bank_mask:0xf
    v_dot2c_f32_bf16_dpp v15, v52, v45 row_newbcast:14 row_mask:0xf bank_mask:0xf
    v_dot2c_f32_bf16_dpp v16, v28, v46 row_newbcast:14 row_mask:0xf bank_mask:0xf
    v_dot2c_f32_bf16_dpp v17, v52, v46 row_newbcast:14 row_mask:0xf bank_mask:0xf
    v_dot2c_f32_bf16_dpp v18, v28, v47 row_newbcast:14 row_mask:0xf bank_mask:0xf
    v_dot2c_f32_bf16_dpp v19, v52, v47 row_newbcast:14 row_mask:0xf bank_mask:0xf
    s_add_u32 m0, s79, 29696
    s_add_u32 s6, s56, 630784
    s_and_b32 s6, s6, 0xfffff
    s_cmp_lt_u32 s3, 4
    s_cbranch_scc0 W_190
    s_waitcnt vmcnt(4)
W_190:
    buffer_load_dwordx4 v1, s[12:15], s6 offen nt lds
    s_waitcnt vmcnt(9)
    ds_read_b128 v[44:47], v53 offset:20480
    s_waitcnt lgkmcnt(2)
    v_dot2c_f32_bf16_dpp v12, v28, v36 row_newbcast:15 row_mask:0xf bank_mask:0xf
    v_dot2c_f32_bf16_dpp v13, v52, v36 row_newbcast:15 row_mask:0xf bank_mask:0xf
    v_dot2c_f32_bf16_dpp v14, v28, v37 row_newbcast:15 row_mask:0xf bank_mask:0xf
    v_dot2c_f32_bf16_dpp v15, v52, v37 row_newbcast:15 row_mask:0xf bank_mask:0xf
    v_dot2c_f32_bf16_dpp v16, v28, v38 row_newbcast:15 row_mask:0xf bank_mask:0xf
    v_dot2c_f32_bf16_dpp v17, v52, v38 row_newbcast:15 row_mask:0xf bank_mask:0xf
    v_dot2c_f32_bf16_dpp v18, v28, v39 row_newbcast:15 row_mask:0xf bank_mask:0xf
    v_dot2c_f32_bf16_dpp v19, v52, v39 row_newbcast:15 row_mask:0xf bank_mask:0xf
    s_add_u32 m0, s79, 30720
    s_add_u32 s6, s56, 634880
    s_and_b32 s6, s6, 0xfffff
    s_cmp_lt_u32 s3, 4
    s_cbranch_scc0 W_191
    s_waitcnt vmcnt(5)
W_191:
    buffer_load_dwordx4 v1, s[12:15], s6 offen nt lds
    v_lshlrev_b32 v54, 16, v29
    s_nop 1
    s_waitcnt vmcnt(9)
    ds_read_b128 v[36:39], v53 offset:21504
    s_waitcnt lgkmcnt(2)
    v_dot2c_f32_bf16_dpp v12, v29, v40 row_newbcast:0 row_mask:0xf bank_mask:0xf
    v_dot2c_f32_bf16_dpp v13, v54, v40 row_newbcast:0 row_mask:0xf bank_mask:0xf
    v_dot2c_f32_bf16_dpp v14, v29, v41 row_newbcast:0 row_mask:0xf bank_mask:0xf
    v_dot2c_f32_bf16_dpp v15, v54, v41 row_newbcast:0 row_mask:0xf bank_mask:0xf
    v_dot2c_f32_bf16_dpp v16, v29, v42 row_newbcast:0 row_mask:0xf bank_mask:0xf
    v_dot2c_f32_bf16_dpp v17, v54, v42 row_newbcast:0 row_mask:0xf bank_mask:0xf
    v_dot2c_f32_bf16_dpp v18, v29, v43 row_newbcast:0 row_mask:0xf bank_mask:0xf
    v_dot2c_f32_bf16_dpp v19, v54, v43 row_newbcast:0 row_mask:0xf bank_mask:0xf
    s_add_u32 m0, s79, 31744
    s_add_u32 s6, s56, 638976
    s_and_b32 s6, s6, 0xfffff
    s_cmp_lt_u32 s3, 4
    s_cbranch_scc0 W_192
    s_waitcnt vmcnt(4)
W_192:
    buffer_load_dwordx4 v1, s[12:15], s6 offen nt lds
    s_waitcnt vmcnt(9)
    ds_read_b128 v[40:43], v53 offset:22528
    s_waitcnt lgkmcnt(2)
    v_dot2c_f32_bf16_dpp v12, v29, v44 row_newbcast:1 row_mask:0xf bank_mask:0xf
    v_dot2c_f32_bf16_dpp v13, v54, v44 row_newbcast:1 row_mask:0xf bank_mask:0xf
    v_dot2c_f32_bf16_dpp v14, v29, v45 row_newbcast:1 row_mask:0xf bank_mask:0xf
    v_dot2c_f32_bf16_dpp v15, v54, v45 row_newbcast:1 row_mask:0xf bank_mask:0xf
    v_dot2c_f32_bf16_dpp v16, v29, v46 row_newbcast:1 row_mask:0xf bank_mask:0xf
    v_dot2c_f32_bf16_dpp v17, v54, v46 row_newbcast:1 row_mask:0xf bank_mask:0xf
    v_dot2c_f32_bf16_dpp v18, v29, v47 row_newbcast:1 row_mask:0xf bank_mask:0xf
    v_dot2c_f32_bf16_dpp v19, v54, v47 row_newbcast:1 row_mask:0xf bank_mask:0xf
    s_add_u32 m0, s79, 32768
    s_add_u32 s6, s56, 643072
    s_and_b32 s6, s6, 0xfffff
    s_cmp_lt_u32 s3, 4
    s_cbranch_scc0 W_193
    s_waitcnt vmcnt(5)
W_193:
    buffer_load_dwordx4 v1, s[12:15], s6 offen nt lds
    s_waitcnt vmcnt(9)
    ds_read_b128 v[44:47], v53 offset:23552
    s_waitcnt lgkmcnt(2)
    v_dot2c_f32_bf16_dpp v12, v29, v36 row_newbcast:2 row_mask:0xf bank_mask:0xf
    v_dot2c_f32_bf16_dpp v13, v54, v36 row_newbcast:2 row_mask:0xf bank_mask:0xf
    v_dot2c_f32_bf16_dpp v14, v29, v37 row_newbcast:2 row_mask:0xf bank_mask:0xf
    v_dot2c_f32_bf16_dpp v15, v54, v37 row_newbcast:2 row_mask:0xf bank_mask:0xf
    v_dot2c_f32_bf16_dpp v16, v29, v38 row_newbcast:2 row_mask:0xf bank_mask:0xf
    v_dot2c_f32_bf16_dpp v17, v54, v38 row_newbcast:2 row_mask:0xf bank_mask:0xf
    v_dot2c_f32_bf16_dpp v18, v29, v39 row_newbcast:2 row_mask:0xf bank_mask:0xf
    v_dot2c_f32_bf16_dpp v19, v54, v39 row_newbcast:2 row_mask:0xf bank_mask:0xf
    s_add_u32 m0, s79, 33792
    s_add_u32 s6, s56, 647168
    s_and_b32 s6, s6, 0xfffff
    s_cmp_lt_u32 s3, 4
    s_cbranch_scc0 W_194
    s_waitcnt vmcnt(4)
W_194:
    buffer_load_dwordx4 v1, s[12:15], s6 offen nt lds
    s_waitcnt vmcnt(9)
    ds_read_b128 v[36:39], v53 offset:24576
    s_waitcnt lgkmcnt(2)
    v_dot2c_f32_bf16_dpp v12, v29, v40 row_newbcast:3 row_mask:0xf bank_mask:0xf
    v_dot2c_f32_bf16_dpp v13, v54, v40 row_newbcast:3 row_mask:0xf bank_mask:0xf
    v_dot2c_f32_bf16_dpp v14, v29, v41 row_newbcast:3 row_mask:0xf bank_mask:0xf
    v_dot2c_f32_bf16_dpp v15, v54, v41 row_newbcast:3 row_mask:0xf bank_mask:0xf
    v_dot2c_f32_bf16_dpp v16, v29, v42 row_newbcast:3 row_mask:0xf bank_mask:0xf
    v_dot2c_f32_bf16_dpp v17, v54, v42 row_newbcast:3 row_mask:0xf bank_mask:0xf
    v_dot2c_f32_bf16_dpp v18, v29, v43 row_newbcast:3 row_mask:0xf bank_mask:0xf
    v_dot2c_f32_bf16_dpp v19, v54, v43 row_newbcast:3 row_mask:0xf bank_mask:0xf
    s_add_u32 m0, s79, 34816
    s_add_u32 s6, s56, 651264
    s_and_b32 s6, s6, 0xfffff
    s_cmp_lt_u32 s3, 4
    s_cbranch_scc0 W_195
    s_waitcnt vmcnt(5)
W_195:
    buffer_load_dwordx4 v1, s[12:15], s6 offen nt lds
    s_waitcnt vmcnt(9)
    ds_read_b128 v[40:43], v53 offset:25600
    s_waitcnt lgkmcnt(2)
    v_dot2c_f32_bf16_dpp v12, v29, v44 row_newbcast:4 row_mask:0xf bank_mask:0xf
    v_dot2c_f32_bf16_dpp v13, v54, v44 row_newbcast:4 row_mask:0xf bank_mask:0xf
    v_dot2c_f32_bf16_dpp v14, v29, v45 row_newbcast:4 row_mask:0xf bank_mask:0xf
    v_dot2c_f32_bf16_dpp v15, v54, v45 row_newbcast:4 row_mask:0xf bank_mask:0xf
    v_dot2c_f32_bf16_dpp v16, v29, v46 row_newbcast:4 row_mask:0xf bank_mask:0xf
    v_dot2c_f32_bf16_dpp v17, v54, v46 row_newbcast:4 row_mask:0xf bank_mask:0xf
    v_dot2c_f32_bf16_dpp v18, v29, v47 row_newbcast:4 row_mask:0xf bank_mask:0xf
    v_dot2c_f32_bf16_dpp v19, v54, v47 row_newbcast:4 row_mask:0xf bank_mask:0xf
    s_add_u32 s6, s56, 655360
    s_and_b32 s6, s6, 0xfffff
    s_cmp_lt_u32 s3, 4
    s_cbranch_scc0 W_196
    s_waitcnt vmcnt(4)
W_196:
    buffer_load_dwordx4 a[0:3], v1, s[12:15], s6 offen nt
    s_waitcnt vmcnt(9)
    ds_read_b128 v[44:47], v53 offset:26624
    s_waitcnt lgkmcnt(2)
    v_dot2c_f32_bf16_dpp v12, v29, v36 row_newbcast:5 row_mask:0xf bank_mask:0xf
    v_dot2c_f32_bf16_dpp v13, v54, v36 row_newbcast:5 row_mask:0xf bank_mask:0xf
    v_dot2c_f32_bf16_dpp v14, v29, v37 row_newbcast:5 row_mask:0xf bank_mask:0xf
    v_dot2c_f32_bf16_dpp v15, v54, v37 row_newbcast:5 row_mask:0xf bank_mask:0xf
    v_dot2c_f32_bf16_dpp v16, v29, v38 row_newbcast:5 row_mask:0xf bank_mask:0xf
    v_dot2c_f32_bf16_dpp v17, v54, v38 row_newbcast:5 row_mask:0xf bank_mask:0xf
    v_dot2c_f32_bf16_dpp v18, v29, v39 row_newbcast:5 row_mask:0xf bank_mask:0xf
    v_dot2c_f32_bf16_dpp v19, v54, v39 row_newbcast:5 row_mask:0xf bank_mask:0xf
    s_add_u32 s6, s56, 659456
    s_and_b32 s6, s6, 0xfffff
    s_cmp_lt_u32 s3, 4
    s_cbranch_scc0 W_197
    s_waitcnt vmcnt(5)
W_197:
    buffer_load_dwordx4 a[4:7], v1, s[12:15], s6 offen nt
    s_waitcnt vmcnt(9)
    ds_read_b128 v[36:39], v53 offset:27648
    s_waitcnt lgkmcnt(2)
    v_dot2c_f32_bf16_dpp v12, v29, v40 row_newbcast:6 row_mask:0xf bank_mask:0xf
    v_dot2c_f32_bf16_dpp v13, v54, v40 row_newbcast:6 row_mask:0xf bank_mask:0xf
    v_dot2c_f32_bf16_dpp v14, v29, v41 row_newbcast:6 row_mask:0xf bank_mask:0xf
    v_dot2c_f32_bf16_dpp v15, v54, v41 row_newbcast:6 row_mask:0xf bank_mask:0xf
    v_dot2c_f32_bf16_dpp v16, v29, v42 row_newbcast:6 row_mask:0xf bank_mask:0xf
    v_dot2c_f32_bf16_dpp v17, v54, v42 row_newbcast:6 row_mask:0xf bank_mask:0xf
    v_dot2c_f32_bf16_dpp v18, v29, v43 row_newbcast:6 row_mask:0xf bank_mask:0xf
    v_dot2c_f32_bf16_dpp v19, v54, v43 row_newbcast:6 row_mask:0xf bank_mask:0xf
    s_add_u32 s6, s56, 663552
    s_and_b32 s6, s6, 0xfffff
    s_cmp_lt_u32 s3, 4
    s_cbranch_scc0 W_198
    s_waitcnt vmcnt(4)
W_198:
    buffer_load_dwordx4 a[8:11], v1, s[12:15], s6 offen nt
    s_waitcnt vmcnt(9)
    ds_read_b128 v[40:43], v53 offset:28672
    s_waitcnt lgkmcnt(2)
    v_dot2c_f32_bf16_dpp v12, v29, v44 row_newbcast:7 row_mask:0xf bank_mask:0xf
    v_dot2c_f32_bf16_dpp v13, v54, v44 row_newbcast:7 row_mask:0xf bank_mask:0xf
    v_dot2c_f32_bf16_dpp v14, v29, v45 row_newbcast:7 row_mask:0xf bank_mask:0xf
    v_dot2c_f32_bf16_dpp v15, v54, v45 row_newbcast:7 row_mask:0xf bank_mask:0xf
    v_dot2c_f32_bf16_dpp v16, v29, v46 row_newbcast:7 row_mask:0xf bank_mask:0xf
    v_dot2c_f32_bf16_dpp v17, v54, v46 row_newbcast:7 row_mask:0xf bank_mask:0xf
    v_dot2c_f32_bf16_dpp v18, v29, v47 row_newbcast:7 row_mask:0xf bank_mask:0xf
    v_dot2c_f32_bf16_dpp v19, v54, v47 row_newbcast:7 row_mask:0xf bank_mask:0xf
    s_add_u32 s6, s56, 667648
    s_and_b32 s6, s6, 0xfffff
    s_cmp_lt_u32 s3, 4
    s_cbranch_scc0 W_199
    s_waitcnt vmcnt(5)
W_199:
    buffer_load_dwordx4 a[12:15], v1, s[12:15], s6 offen nt
    s_waitcnt vmcnt(9)
    ds_read_b128 v[44:47], v53 offset:29696
    s_waitcnt lgkmcnt(2)
    v_dot2c_f32_bf16_dpp v12, v29, v36 row_newbcast:8 row_mask:0xf bank_mask:0xf
    v_dot2c_f32_bf16_dpp v13, v54, v36 row_newbcast:8 row_mask:0xf bank_mask:0xf
    v_dot2c_f32_bf16_dpp v14, v29, v37 row_newbcast:8 row_mask:0xf bank_mask:0xf
    v_dot2c_f32_bf16_dpp v15, v54, v37 row_newbcast:8 row_mask:0xf bank_mask:0xf
    v_dot2c_f32_bf16_dpp v16, v29, v38 row_newbcast:8 row_mask:0xf bank_mask:0xf
    v_dot2c_f32_bf16_dpp v17, v54, v38 row_newbcast:8 row_mask:0xf bank_mask:0xf
    v_dot2c_f32_bf16_dpp v18, v29, v39 row_newbcast:8 row_mask:0xf bank_mask:0xf
    v_dot2c_f32_bf16_dpp v19, v54, v39 row_newbcast:8 row_mask:0xf bank_mask:0xf
    s_add_u32 s6, s56, 671744
    s_and_b32 s6, s6, 0xfffff
    s_cmp_lt_u32 s3, 4
    s_cbranch_scc0 W_200
    s_waitcnt vmcnt(4)
W_200:
    buffer_load_dwordx4 a[16:19], v1, s[12:15], s6 offen nt
    s_waitcnt vmcnt(9)
    ds_read_b128 v[36:39], v53 offset:30720
    s_waitcnt lgkmcnt(2)
    v_dot2c_f32_bf16_dpp v12, v29, v40 row_newbcast:9 row_mask:0xf bank_mask:0xf
    v_dot2c_f32_bf16_dpp v13, v54, v40 row_newbcast:9 row_mask:0xf bank_mask:0xf
    v_dot2c_f32_bf16_dpp v14, v29, v41 row_newbcast:9 row_mask:0xf bank_mask:0xf
    v_dot2c_f32_bf16_dpp v15, v54, v41 row_newbcast:9 row_mask:0xf bank_mask:0xf
    v_dot2c_f32_bf16_dpp v16, v29, v42 row_newbcast:9 row_mask:0xf bank_mask:0xf
    v_dot2c_f32_bf16_dpp v17, v54, v42 row_newbcast:9 row_mask:0xf bank_mask:0xf
    v_dot2c_f32_bf16_dpp v18, v29, v43 row_newbcast:9 row_mask:0xf bank_mask:0xf
    v_dot2c_f32_bf16_dpp v19, v54, v43 row_newbcast:9 row_mask:0xf bank_mask:0xf
    s_add_u32 s6, s56, 675840
    s_and_b32 s6, s6, 0xfffff
    s_cmp_lt_u32 s3, 4
    s_cbranch_scc0 W_201
    s_waitcnt vmcnt(5)
W_201:
    buffer_load_dwordx4 a[20:23], v1, s[12:15], s6 offen nt
    s_waitcnt vmcnt(9)
    ds_read_b128 v[40:43], v53 offset:31744
    s_waitcnt lgkmcnt(2)
    v_dot2c_f32_bf16_dpp v12, v29, v44 row_newbcast:10 row_mask:0xf bank_mask:0xf
    v_dot2c_f32_bf16_dpp v13, v54, v44 row_newbcast:10 row_mask:0xf bank_mask:0xf
    v_dot2c_f32_bf16_dpp v14, v29, v45 row_newbcast:10 row_mask:0xf bank_mask:0xf
    v_dot2c_f32_bf16_dpp v15, v54, v45 row_newbcast:10 row_mask:0xf bank_mask:0xf
    v_dot2c_f32_bf16_dpp v16, v29, v46 row_newbcast:10 row_mask:0xf bank_mask:0xf
    v_dot2c_f32_bf16_dpp v17, v54, v46 row_newbcast:10 row_mask:0xf bank_mask:0xf
    v_dot2c_f32_bf16_dpp v18, v29, v47 row_newbcast:10 row_mask:0xf bank_mask:0xf
    v_dot2c_f32_bf16_dpp v19, v54, v47 row_newbcast:10 row_mask:0xf bank_mask:0xf
    s_add_u32 s6, s56, 679936
    s_and_b32 s6, s6, 0xfffff
    s_cmp_lt_u32 s3, 4
    s_cbranch_scc0 W_202
    s_waitcnt vmcnt(4)
W_202:
    buffer_load_dwordx4 a[24:27], v1, s[12:15], s6 offen nt
    s_waitcnt vmcnt(9)
    ds_read_b128 v[44:47], v53 offset:32768
    s_waitcnt lgkmcnt(2)
    v_dot2c_f32_bf16_dpp v12, v29, v36 row_newbcast:11 row_mask:0xf bank_mask:0xf
    v_dot2c_f32_bf16_dpp v13, v54, v36 row_newbcast:11 row_mask:0xf bank_mask:0xf
    v_dot2c_f32_bf16_dpp v14, v29, v37 row_newbcast:11 row_mask:0xf bank_mask:0xf
    v_dot2c_f32_bf16_dpp v15, v54, v37 row_newbcast:11 row_mask:0xf bank_mask:0xf
    v_dot2c_f32_bf16_dpp v16, v29, v38 row_newbcast:11 row_mask:0xf bank_mask:0xf
    v_dot2c_f32_bf16_dpp v17, v54, v38 row_newbcast:11 row_mask:0xf bank_mask:0xf
    v_dot2c_f32_bf16_dpp v18, v29, v39 row_newbcast:11 row_mask:0xf bank_mask:0xf
    v_dot2c_f32_bf16_dpp v19, v54, v39 row_newbcast:11 row_mask:0xf bank_mask:0xf
    s_add_u32 s6, s56, 684032
    s_and_b32 s6, s6, 0xfffff
    s_cmp_lt_u32 s3, 4
    s_cbranch_scc0 W_203
    s_waitcnt vmcnt(5)
W_203:
    buffer_load_dwordx4 a[28:31], v1, s[12:15], s6 offen nt
    s_waitcnt vmcnt(9)
    ds_read_b128 v[36:39], v53 offset:33792
    s_waitcnt lgkmcnt(2)
    v_dot2c_f32_bf16_dpp v12, v29, v40 row_newbcast:12 row_mask:0xf bank_mask:0xf
    v_dot2c_f32_bf16_dpp v13, v54, v40 row_newbcast:12 row_mask:0xf bank_mask:0xf
    v_dot2c_f32_bf16_dpp v14, v29, v41 row_newbcast:12 row_mask:0xf bank_mask:0xf
    v_dot2c_f32_bf16_dpp v15, v54, v41 row_newbcast:12 row_mask:0xf bank_mask:0xf
    v_dot2c_f32_bf16_dpp v16, v29, v42 row_newbcast:12 row_mask:0xf bank_mask:0xf
    v_dot2c_f32_bf16_dpp v17, v54, v42 row_newbcast:12 row_mask:0xf bank_mask:0xf
    v_dot2c_f32_bf16_dpp v18, v29, v43 row_newbcast:12 row_mask:0xf bank_mask:0xf
    v_dot2c_f32_bf16_dpp v19, v54, v43 row_newbcast:12 row_mask:0xf bank_mask:0xf
    s_add_u32 s6, s56, 688128
    s_and_b32 s6, s6, 0xfffff
    s_cmp_lt_u32 s3, 4
    s_cbranch_scc0 W_204
    s_waitcnt vmcnt(4)
W_204:
    buffer_load_dwordx4 a[32:35], v1, s[12:15], s6 offen nt
    s_waitcnt vmcnt(9)
    ds_read_b128 v[40:43], v53 offset:34816
    s_waitcnt lgkmcnt(2)
    v_dot2c_f32_bf16_dpp v12, v29, v44 row_newbcast:13 row_mask:0xf bank_mask:0xf
    v_dot2c_f32_bf16_dpp v13, v54, v44 row_newbcast:13 row_mask:0xf bank_mask:0xf
    v_dot2c_f32_bf16_dpp v14, v29, v45 row_newbcast:13 row_mask:0xf bank_mask:0xf
    v_dot2c_f32_bf16_dpp v15, v54, v45 row_newbcast:13 row_mask:0xf bank_mask:0xf
    v_dot2c_f32_bf16_dpp v16, v29, v46 row_newbcast:13 row_mask:0xf bank_mask:0xf
    v_dot2c_f32_bf16_dpp v17, v54, v46 row_newbcast:13 row_mask:0xf bank_mask:0xf
    v_dot2c_f32_bf16_dpp v18, v29, v47 row_newbcast:13 row_mask:0xf bank_mask:0xf
    v_dot2c_f32_bf16_dpp v19, v54, v47 row_newbcast:13 row_mask:0xf bank_mask:0xf
    s_add_u32 s6, s56, 692224
    s_and_b32 s6, s6, 0xfffff
    s_cmp_lt_u32 s3, 4
    s_cbranch_scc0 W_205
    s_waitcnt vmcnt(5)
W_205:
    buffer_load_dwordx4 a[36:39], v1, s[12:15], s6 offen nt
    s_waitcnt lgkmcnt(1)
    v_dot2c_f32_bf16_dpp v12, v29, v36 row_newbcast:14 row_mask:0xf bank_mask:0xf
    v_dot2c_f32_bf16_dpp v13, v54, v36 row_newbcast:14 row_mask:0xf bank_mask:0xf
    v_dot2c_f32_bf16_dpp v14, v29, v37 row_newbcast:14 row_mask:0xf bank_mask:0xf
    v_dot2c_f32_bf16_dpp v15, v54, v37 row_newbcast:14 row_mask:0xf bank_mask:0xf
    v_dot2c_f32_bf16_dpp v16, v29, v38 row_newbcast:14 row_mask:0xf bank_mask:0xf
    v_dot2c_f32_bf16_dpp v17, v54, v38 row_newbcast:14 row_mask:0xf bank_mask:0xf
    v_dot2c_f32_bf16_dpp v18, v29, v39 row_newbcast:14 row_mask:0xf bank_mask:0xf
    v_dot2c_f32_bf16_dpp v19, v54, v39 row_newbcast:14 row_mask:0xf bank_mask:0xf
    s_add_u32 s6, s56, 696320
    s_and_b32 s6, s6, 0xfffff
    s_cmp_lt_u32 s3, 4
    s_cbranch_scc0 W_206
    s_waitcnt vmcnt(4)
W_206:
    buffer_load_dwordx4 a[40:43], v1, s[12:15], s6 offen nt
    s_waitcnt lgkmcnt(0)
    v_dot2c_f32_bf16_dpp v12, v29, v40 row_newbcast:15 row_mask:0xf bank_mask:0xf
    v_dot2c_f32_bf16_dpp v13, v54, v40 row_newbcast:15 row_mask:0xf bank_mask:0xf
    v_dot2c_f32_bf16_dpp v14, v29, v41 row_newbcast:15 row_mask:0xf bank_mask:0xf
    v_dot2c_f32_bf16_dpp v15, v54, v41 row_newbcast:15 row_mask:0xf bank_mask:0xf
    v_dot2c_f32_bf16_dpp v16, v29, v42 row_newbcast:15 row_mask:0xf bank_mask:0xf
    v_dot2c_f32_bf16_dpp v17, v54, v42 row_newbcast:15 row_mask:0xf bank_mask:0xf
    v_dot2c_f32_bf16_dpp v18, v29, v43 row_newbcast:15 row_mask:0xf bank_mask:0xf
    v_dot2c_f32_bf16_dpp v19, v54, v43 row_newbcast:15 row_mask:0xf bank_mask:0xf
    s_add_u32 s6, s56, 700416
    s_and_b32 s6, s6, 0xfffff
    s_cmp_lt_u32 s3, 4
    s_cbranch_scc0 W_207
    s_waitcnt vmcnt(5)
W_207:
    buffer_load_dwordx4 a[44:47], v1, s[12:15], s6 offen nt
    v_lshlrev_b32 v52, 16, v30
    s_nop 1
    s_waitcnt vmcnt(11)
    v_accvgpr_read_b32 v48, a0
    v_accvgpr_read_b32 v49, a1
    v_accvgpr_read_b32 v50, a2
    v_accvgpr_read_b32 v51, a3
    v_dot2c_f32_bf16_dpp v12, v30, v48 row_newbcast:0 row_mask:0xf bank_mask:0xf
    v_dot2c_f32_bf16_dpp v13, v52, v48 row_newbcast:0 row_mask:0xf bank_mask:0xf
    v_dot2c_f32_bf16_dpp v14, v30, v49 row_newbcast:0 row_mask:0xf bank_mask:0xf
    v_dot2c_f32_bf16_dpp v15, v52, v49 row_newbcast:0 row_mask:0xf bank_mask:0xf
    v_dot2c_f32_bf16_dpp v16, v30, v50 row_newbcast:0 row_mask:0xf bank_mask:0xf
    v_dot2c_f32_bf16_dpp v17, v52, v50 row_newbcast:0 row_mask:0xf bank_mask:0xf
    v_dot2c_f32_bf16_dpp v18, v30, v51 row_newbcast:0 row_mask:0xf bank_mask:0xf
    v_dot2c_f32_bf16_dpp v19, v52, v51 row_newbcast:0 row_mask:0xf bank_mask:0xf
    s_add_u32 s6, s56, 704512
    s_and_b32 s6, s6, 0xfffff
    s_cmp_lt_u32 s3, 4
    s_cbranch_scc0 W_208
    s_waitcnt vmcnt(4)
W_208:
    buffer_load_dwordx4 a[48:51], v1, s[12:15], s6 offen nt
    s_waitcnt vmcnt(11)
    v_accvgpr_read_b32 v48, a4
    v_accvgpr_read_b32 v49, a5
    v_accvgpr_read_b32 v50, a6
    v_accvgpr_read_b32 v51, a7
    v_dot2c_f32_bf16_dpp v12, v30, v48 row_newbcast:1 row_mask:0xf bank_mask:0xf
    v_dot2c_f32_bf16_dpp v13, v52, v48 row_newbcast:1 row_mask:0xf bank_mask:0xf
    v_dot2c_f32_bf16_dpp v14, v30, v49 row_newbcast:1 row_mask:0xf bank_mask:0xf
    v_dot2c_f32_bf16_dpp v15, v52, v49 row_newbcast:1 row_mask:0xf bank_mask:0xf
    v_dot2c_f32_bf16_dpp v16, v30, v50 row_newbcast:1 row_mask:0xf bank_mask:0xf
    v_dot2c_f32_bf16_dpp v17, v52, v50 row_newbcast:1 row_mask:0xf bank_mask:0xf
    v_dot2c_f32_bf16_dpp v18, v30, v51 row_newbcast:1 row_mask:0xf bank_mask:0xf
    v_dot2c_f32_bf16_dpp v19, v52, v51 row_newbcast:1 row_mask:0xf bank_mask:0xf
    s_add_u32 s6, s56, 708608
    s_and_b32 s6, s6, 0xfffff
    s_cmp_lt_u32 s3, 4
    s_cbranch_scc0 W_209
    s_waitcnt vmcnt(5)
W_209:
    buffer_load_dwordx4 a[52:55], v1, s[12:15], s6 offen nt
    s_waitcnt vmcnt(11)
    v_accvgpr_read_b32 v48, a8
    v_accvgpr_read_b32 v49, a9
    v_accvgpr_read_b32 v50, a10
    v_accvgpr_read_b32 v51, a11
    v_dot2c_f32_bf16_dpp v12, v30, v48 row_newbcast:2 row_mask:0xf bank_mask:0xf
    v_dot2c_f32_bf16_dpp v13, v52, v48 row_newbcast:2 row_mask:0xf bank_mask:0xf
    v_dot2c_f32_bf16_dpp v14, v30, v49 row_newbcast:2 row_mask:0xf bank_mask:0xf
    v_dot2c_f32_bf16_dpp v15, v52, v49 row_newbcast:2 row_mask:0xf bank_mask:0xf
    v_dot2c_f32_bf16_dpp v16, v30, v50 row_newbcast:2 row_mask:0xf bank_mask:0xf
    v_dot2c_f32_bf16_dpp v17, v52, v50 row_newbcast:2 row_mask:0xf bank_mask:0xf
    v_dot2c_f32_bf16_dpp v18, v30, v51 row_newbcast:2 row_mask:0xf bank_mask:0xf
    v_dot2c_f32_bf16_dpp v19, v52, v51 row_newbcast:2 row_mask:0xf bank_mask:0xf
    s_add_u32 s6, s56, 712704
    s_and_b32 s6, s6, 0xfffff
    s_cmp_lt_u32 s3, 4
    s_cbranch_scc0 W_210
    s_waitcnt vmcnt(4)
W_210:
    buffer_load_dwordx4 a[56:59], v1, s[12:15], s6 offen nt
    s_waitcnt vmcnt(11)
    v_accvgpr_read_b32 v48, a12
    v_accvgpr_read_b32 v49, a13
    v_accvgpr_read_b32 v50, a14
    v_accvgpr_read_b32 v51, a15
    v_dot2c_f32_bf16_dpp v12, v30, v48 row_newbcast:3 row_mask:0xf bank_mask:0xf
    v_dot2c_f32_bf16_dpp v13, v52, v48 row_newbcast:3 row_mask:0xf bank_mask:0xf
    v_dot2c_f32_bf16_dpp v14, v30, v49 row_newbcast:3 row_mask:0xf bank_mask:0xf
    v_dot2c_f32_bf16_dpp v15, v52, v49 row_newbcast:3 row_mask:0xf bank_mask:0xf
    v_dot2c_f32_bf16_dpp v16, v30, v50 row_newbcast:3 row_mask:0xf bank_mask:0xf
    v_dot2c_f32_bf16_dpp v17, v52, v50 row_newbcast:3 row_mask:0xf bank_mask:0xf
    v_dot2c_f32_bf16_dpp v18, v30, v51 row_newbcast:3 row_mask:0xf bank_mask:0xf
    v_dot2c_f32_bf16_dpp v19, v52, v51 row_newbcast:3 row_mask:0xf bank_mask:0xf
    s_add_u32 s6, s56, 716800
    s_and_b32 s6, s6, 0xfffff
    s_cmp_lt_u32 s3, 4
    s_cbranch_scc0 W_211
    s_waitcnt vmcnt(5)
W_211:
    buffer_load_dwordx4 a[60:63], v1, s[12:15], s6 offen nt
    s_waitcnt vmcnt(11)
    v_accvgpr_read_b32 v48, a16
    v_accvgpr_read_b32 v49, a17
    v_accvgpr_read_b32 v50, a18
    v_accvgpr_read_b32 v51, a19
    v_dot2c_f32_bf16_dpp v12, v30, v48 row_newbcast:4 row_mask:0xf bank_mask:0xf
    v_dot2c_f32_bf16_dpp v13, v52, v48 row_newbcast:4 row_mask:0xf bank_mask:0xf
    v_dot2c_f32_bf16_dpp v14, v30, v49 row_newbcast:4 row_mask:0xf bank_mask:0xf
    v_dot2c_f32_bf16_dpp v15, v52, v49 row_newbcast:4 row_mask:0xf bank_mask:0xf
    v_dot2c_f32_bf16_dpp v16, v30, v50 row_newbcast:4 row_mask:0xf bank_mask:0xf
    v_dot2c_f32_bf16_dpp v17, v52, v50 row_newbcast:4 row_mask:0xf bank_mask:0xf
    v_dot2c_f32_bf16_dpp v18, v30, v51 row_newbcast:4 row_mask:0xf bank_mask:0xf
    v_dot2c_f32_bf16_dpp v19, v52, v51 row_newbcast:4 row_mask:0xf bank_mask:0xf
    s_add_u32 s6, s56, 720896
    s_and_b32 s6, s6, 0xfffff
    s_cmp_lt_u32 s3, 4
    s_cbranch_scc0 W_212
    s_waitcnt vmcnt(4)
W_212:
    buffer_load_dwordx4 a[64:67], v1, s[12:15], s6 offen nt
    s_waitcnt vmcnt(11)
    v_accvgpr_read_b32 v48, a20
    v_accvgpr_read_b32 v49, a21
    v_accvgpr_read_b32 v50, a22
    v_accvgpr_read_b32 v51, a23
    v_dot2c_f32_bf16_dpp v12, v30, v48 row_newbcast:5 row_mask:0xf bank_mask:0xf
    v_dot2c_f32_bf16_dpp v13, v52, v48 row_newbcast:5 row_mask:0xf bank_mask:0xf
    v_dot2c_f32_bf16_dpp v14, v30, v49 row_newbcast:5 row_mask:0xf bank_mask:0xf
    v_dot2c_f32_bf16_dpp v15, v52, v49 row_newbcast:5 row_mask:0xf bank_mask:0xf
    v_dot2c_f32_bf16_dpp v16, v30, v50 row_newbcast:5 row_mask:0xf bank_mask:0xf
    v_dot2c_f32_bf16_dpp v17, v52, v50 row_newbcast:5 row_mask:0xf bank_mask:0xf
    v_dot2c_f32_bf16_dpp v18, v30, v51 row_newbcast:5 row_mask:0xf bank_mask:0xf
    v_dot2c_f32_bf16_dpp v19, v52, v51 row_newbcast:5 row_mask:0xf bank_mask:0xf
    s_add_u32 s6, s56, 724992
    s_and_b32 s6, s6, 0xfffff
    s_cmp_lt_u32 s3, 4
    s_cbranch_scc0 W_213
    s_waitcnt vmcnt(5)
W_213:
    buffer_load_dwordx4 a[68:71], v1, s[12:15], s6 offen nt
    s_waitcnt vmcnt(11)
    v_accvgpr_read_b32 v48, a24
    v_accvgpr_read_b32 v49, a25
    v_accvgpr_read_b32 v50, a26
    v_accvgpr_read_b32 v51, a27
    v_dot2c_f32_bf16_dpp v12, v30, v48 row_newbcast:6 row_mask:0xf bank_mask:0xf
    v_dot2c_f32_bf16_dpp v13, v52, v48 row_newbcast:6 row_mask:0xf bank_mask:0xf
    v_dot2c_f32_bf16_dpp v14, v30, v49 row_newbcast:6 row_mask:0xf bank_mask:0xf
    v_dot2c_f32_bf16_dpp v15, v52, v49 row_newbcast:6 row_mask:0xf bank_mask:0xf
    v_dot2c_f32_bf16_dpp v16, v30, v50 row_newbcast:6 row_mask:0xf bank_mask:0xf
    v_dot2c_f32_bf16_dpp v17, v52, v50 row_newbcast:6 row_mask:0xf bank_mask:0xf
    v_dot2c_f32_bf16_dpp v18, v30, v51 row_newbcast:6 row_mask:0xf bank_mask:0xf
    v_dot2c_f32_bf16_dpp v19, v52, v51 row_newbcast:6 row_mask:0xf bank_mask:0xf
    s_add_u32 s6, s56, 729088
    s_and_b32 s6, s6, 0xfffff
    s_cmp_lt_u32 s3, 4
    s_cbranch_scc0 W_214
    s_waitcnt vmcnt(4)
W_214:
    buffer_load_dwordx4 a[72:75], v1, s[12:15], s6 offen nt
    s_waitcnt vmcnt(11)
    v_accvgpr_read_b32 v48, a28
    v_accvgpr_read_b32 v49, a29
    v_accvgpr_read_b32 v50, a30
    v_accvgpr_read_b32 v51, a31
    v_dot2c_f32_bf16_dpp v12, v30, v48 row_newbcast:7 row_mask:0xf bank_mask:0xf
    v_dot2c_f32_bf16_dpp v13, v52, v48 row_newbcast:7 row_mask:0xf bank_mask:0xf
    v_dot2c_f32_bf16_dpp v14, v30, v49 row_newbcast:7 row_mask:0xf bank_mask:0xf
    v_dot2c_f32_bf16_dpp v15, v52, v49 row_newbcast:7 row_mask:0xf bank_mask:0xf
    v_dot2c_f32_bf16_dpp v16, v30, v50 row_newbcast:7 row_mask:0xf bank_mask:0xf
    v_dot2c_f32_bf16_dpp v17, v52, v50 row_newbcast:7 row_mask:0xf bank_mask:0xf
    v_dot2c_f32_bf16_dpp v18, v30, v51 row_newbcast:7 row_mask:0xf bank_mask:0xf
    v_dot2c_f32_bf16_dpp v19, v52, v51 row_newbcast:7 row_mask:0xf bank_mask:0xf
    s_add_u32 s6, s56, 733184
    s_and_b32 s6, s6, 0xfffff
    s_cmp_lt_u32 s3, 4
    s_cbranch_scc0 W_215
    s_waitcnt vmcnt(5)
W_215:
    buffer_load_dwordx4 a[76:79], v1, s[12:15], s6 offen nt
    s_waitcnt vmcnt(11)
    v_accvgpr_read_b32 v48, a32
    v_accvgpr_read_b32 v49, a33
    v_accvgpr_read_b32 v50, a34
    v_accvgpr_read_b32 v51, a35
    v_dot2c_f32_bf16_dpp v12, v30, v48 row_newbcast:8 row_mask:0xf bank_mask:0xf
    v_dot2c_f32_bf16_dpp v13, v52, v48 row_newbcast:8 row_mask:0xf bank_mask:0xf
    v_dot2c_f32_bf16_dpp v14, v30, v49 row_newbcast:8 row_mask:0xf bank_mask:0xf
    v_dot2c_f32_bf16_dpp v15, v52, v49 row_newbcast:8 row_mask:0xf bank_mask:0xf
    v_dot2c_f32_bf16_dpp v16, v30, v50 row_newbcast:8 row_mask:0xf bank_mask:0xf
    v_dot2c_f32_bf16_dpp v17, v52, v50 row_newbcast:8 row_mask:0xf bank_mask:0xf
    v_dot2c_f32_bf16_dpp v18, v30, v51 row_newbcast:8 row_mask:0xf bank_mask:0xf
    v_dot2c_f32_bf16_dpp v19, v52, v51 row_newbcast:8 row_mask:0xf bank_mask:0xf
    s_add_u32 s6, s56, 737280
    s_and_b32 s6, s6, 0xfffff
    s_cmp_lt_u32 s3, 4
    s_cbranch_scc0 W_216
    s_waitcnt vmcnt(4)
W_216:
    buffer_load_dwordx4 a[80:83], v1, s[12:15], s6 offen nt
    s_waitcnt vmcnt(11)
    v_accvgpr_read_b32 v48, a36
    v_accvgpr_read_b32 v49, a37
    v_accvgpr_read_b32 v50, a38
    v_accvgpr_read_b32 v51, a39
    v_dot2c_f32_bf16_dpp v12, v30, v48 row_newbcast:9 row_mask:0xf bank_mask:0xf
    v_dot2c_f32_bf16_dpp v13, v52, v48 row_newbcast:9 row_mask:0xf bank_mask:0xf
    v_dot2c_f32_bf16_dpp v14, v30, v49 row_newbcast:9 row_mask:0xf bank_mask:0xf
    v_dot2c_f32_bf16_dpp v15, v52, v49 row_newbcast:9 row_mask:0xf bank_mask:0xf
    v_dot2c_f32_bf16_dpp v16, v30, v50 row_newbcast:9 row_mask:0xf bank_mask:0xf
    v_dot2c_f32_bf16_dpp v17, v52, v50 row_newbcast:9 row_mask:0xf bank_mask:0xf
    v_dot2c_f32_bf16_dpp v18, v30, v51 row_newbcast:9 row_mask:0xf bank_mask:0xf
    v_dot2c_f32_bf16_dpp v19, v52, v51 row_newbcast:9 row_mask:0xf bank_mask:0xf
    s_add_u32 s6, s56, 741376
    s_and_b32 s6, s6, 0xfffff
    s_cmp_lt_u32 s3, 4
    s_cbranch_scc0 W_217
    s_waitcnt vmcnt(5)
W_217:
    buffer_load_dwordx4 a[84:87], v1, s[12:15], s6 offen nt
    s_waitcnt vmcnt(11)
    v_accvgpr_read_b32 v48, a40
    v_accvgpr_read_b32 v49, a41
    v_accvgpr_read_b32 v50, a42
    v_accvgpr_read_b32 v51, a43
    v_dot2c_f32_bf16_dpp v12, v30, v48 row_newbcast:10 row_mask:0xf bank_mask:0xf
    v_dot2c_f32_bf16_dpp v13, v52, v48 row_newbcast:10 row_mask:0xf bank_mask:0xf
    v_dot2c_f32_bf16_dpp v14, v30, v49 row_newbcast:10 row_mask:0xf bank_mask:0xf
    v_dot2c_f32_bf16_dpp v15, v52, v49 row_newbcast:10 row_mask:0xf bank_mask:0xf
    v_dot2c_f32_bf16_dpp v16, v30, v50 row_newbcast:10 row_mask:0xf bank_mask:0xf
    v_dot2c_f32_bf16_dpp v17, v52, v50 row_newbcast:10 row_mask:0xf bank_mask:0xf
    v_dot2c_f32_bf16_dpp v18, v30, v51 row_newbcast:10 row_mask:0xf bank_mask:0xf
    v_dot2c_f32_bf16_dpp v19, v52, v51 row_newbcast:10 row_mask:0xf bank_mask:0xf
    s_add_u32 s6, s56, 745472
    s_and_b32 s6, s6, 0xfffff
    s_cmp_lt_u32 s3, 4
    s_cbranch_scc0 W_218
    s_waitcnt vmcnt(4)
W_218:
    buffer_load_dwordx4 a[88:91], v1, s[12:15], s6 offen nt
    s_waitcnt vmcnt(11)
    v_accvgpr_read_b32 v48, a44
    v_accvgpr_read_b32 v49, a45
    v_accvgpr_read_b32 v50, a46
    v_accvgpr_read_b32 v51, a47
    v_dot2c_f32_bf16_dpp v12, v30, v48 row_newbcast:11 row_mask:0xf bank_mask:0xf
    v_dot2c_f32_bf16_dpp v13, v52, v48 row_newbcast:11 row_mask:0xf bank_mask:0xf
    v_dot2c_f32_bf16_dpp v14, v30, v49 row_newbcast:11 row_mask:0xf bank_mask:0xf
    v_dot2c_f32_bf16_dpp v15, v52, v49 row_newbcast:11 row_mask:0xf bank_mask:0xf
    v_dot2c_f32_bf16_dpp v16, v30, v50 row_newbcast:11 row_mask:0xf bank_mask:0xf
    v_dot2c_f32_bf16_dpp v17, v52, v50 row_newbcast:11 row_mask:0xf bank_mask:0xf
    v_dot2c_f32_bf16_dpp v18, v30, v51 row_newbcast:11 row_mask:0xf bank_mask:0xf
    v_dot2c_f32_bf16_dpp v19, v52, v51 row_newbcast:11 row_mask:0xf bank_mask:0xf
    s_add_u32 s6, s56, 749568
    s_and_b32 s6, s6, 0xfffff
    s_cmp_lt_u32 s3, 4
    s_cbranch_scc0 W_219
    s_waitcnt vmcnt(5)
W_219:
    buffer_load_dwordx4 a[92:95], v1, s[12:15], s6 offen nt
    s_waitcnt vmcnt(11)
    v_accvgpr_read_b32 v48, a48
    v_accvgpr_read_b32 v49, a49
    v_accvgpr_read_b32 v50, a50
    v_accvgpr_read_b32 v51, a51
    v_dot2c_f32_bf16_dpp v12, v30, v48 row_newbcast:12 row_mask:0xf bank_mask:0xf
    v_dot2c_f32_bf16_dpp v13, v52, v48 row_newbcast:12 row_mask:0xf bank_mask:0xf
    v_dot2c_f32_bf16_dpp v14, v30, v49 row_newbcast:12 row_mask:0xf bank_mask:0xf
    v_dot2c_f32_bf16_dpp v15, v52, v49 row_newbcast:12 row_mask:0xf bank_mask:0xf
    v_dot2c_f32_bf16_dpp v16, v30, v50 row_newbcast:12 row_mask:0xf bank_mask:0xf
    v_dot2c_f32_bf16_dpp v17, v52, v50 row_newbcast:12 row_mask:0xf bank_mask:0xf
    v_dot2c_f32_bf16_dpp v18, v30, v51 row_newbcast:12 row_mask:0xf bank_mask:0xf
    v_dot2c_f32_bf16_dpp v19, v52, v51 row_newbcast:12 row_mask:0xf bank_mask:0xf
    s_add_u32 s6, s56, 753664
    s_and_b32 s6, s6, 0xfffff
    s_cmp_lt_u32 s3, 4
    s_cbranch_scc0 W_220
    s_waitcnt vmcnt(4)
W_220:
    buffer_load_dwordx4 a[96:99], v1, s[12:15], s6 offen nt
    s_waitcnt vmcnt(11)
    v_accvgpr_read_b32 v48, a52
    v_accvgpr_read_b32 v49, a53
    v_accvgpr_read_b32 v50, a54
    v_accvgpr_read_b32 v51, a55
    v_dot2c_f32_bf16_dpp v12, v30, v48 row_newbcast:13 row_mask:0xf bank_mask:0xf
    v_dot2c_f32_bf16_dpp v13, v52, v48 row_newbcast:13 row_mask:0xf bank_mask:0xf
    v_dot2c_f32_bf16_dpp v14, v30, v49 row_newbcast:13 row_mask:0xf bank_mask:0xf
    v_dot2c_f32_bf16_dpp v15, v52, v49 row_newbcast:13 row_mask:0xf bank_mask:0xf
    v_dot2c_f32_bf16_dpp v16, v30, v50 row_newbcast:13 row_mask:0xf bank_mask:0xf
    v_dot2c_f32_bf16_dpp v17, v52, v50 row_newbcast:13 row_mask:0xf bank_mask:0xf
    v_dot2c_f32_bf16_dpp v18, v30, v51 row_newbcast:13 row_mask:0xf bank_mask:0xf
    v_dot2c_f32_bf16_dpp v19, v52, v51 row_newbcast:13 row_mask:0xf bank_mask:0xf
    s_add_u32 s6, s56, 757760
    s_and_b32 s6, s6, 0xfffff
    s_cmp_lt_u32 s3, 4
    s_cbranch_scc0 W_221
    s_waitcnt vmcnt(5)
W_221:
    buffer_load_dwordx4 a[100:103], v1, s[12:15], s6 offen nt
    s_waitcnt vmcnt(11)
    v_accvgpr_read_b32 v48, a56
    v_accvgpr_read_b32 v49, a57
    v_accvgpr_read_b32 v50, a58
    v_accvgpr_read_b32 v51, a59
    v_dot2c_f32_bf16_dpp v12, v30, v48 row_newbcast:14 row_mask:0xf bank_mask:0xf
    v_dot2c_f32_bf16_dpp v13, v52, v48 row_newbcast:14 row_mask:0xf bank_mask:0xf
    v_dot2c_f32_bf16_dpp v14, v30, v49 row_newbcast:14 row_mask:0xf bank_mask:0xf
    v_dot2c_f32_bf16_dpp v15, v52, v49 row_newbcast:14 row_mask:0xf bank_mask:0xf
    v_dot2c_f32_bf16_dpp v16, v30, v50 row_newbcast:14 row_mask:0xf bank_mask:0xf
    v_dot2c_f32_bf16_dpp v17, v52, v50 row_newbcast:14 row_mask:0xf bank_mask:0xf
    v_dot2c_f32_bf16_dpp v18, v30, v51 row_newbcast:14 row_mask:0xf bank_mask:0xf
    v_dot2c_f32_bf16_dpp v19, v52, v51 row_newbcast:14 row_mask:0xf bank_mask:0xf
    s_add_u32 s6, s56, 761856
    s_and_b32 s6, s6, 0xfffff
    s_cmp_lt_u32 s3, 4
    s_cbranch_scc0 W_222
    s_waitcnt vmcnt(4)
W_222:
    buffer_load_dwordx4 a[104:107], v1, s[12:15], s6 offen nt
    s_waitcnt vmcnt(11)
    v_accvgpr_read_b32 v48, a60
    v_accvgpr_read_b32 v49, a61
    v_accvgpr_read_b32 v50, a62
    v_accvgpr_read_b32 v51, a63
    v_dot2c_f32_bf16_dpp v12, v30, v48 row_newbcast:15 row_mask:0xf bank_mask:0xf
    v_dot2c_f32_bf16_dpp v13, v52, v48 row_newbcast:15 row_mask:0xf bank_mask:0xf
    v_dot2c_f32_bf16_dpp v14, v30, v49 row_newbcast:15 row_mask:0xf bank_mask:0xf
    v_dot2c_f32_bf16_dpp v15, v52, v49 row_newbcast:15 row_mask:0xf bank_mask:0xf
    v_dot2c_f32_bf16_dpp v16, v30, v50 row_newbcast:15 row_mask:0xf bank_mask:0xf
    v_dot2c_f32_bf16_dpp v17, v52, v50 row_newbcast:15 row_mask:0xf bank_mask:0xf
    v_dot2c_f32_bf16_dpp v18, v30, v51 row_newbcast:15 row_mask:0xf bank_mask:0xf
    v_dot2c_f32_bf16_dpp v19, v52, v51 row_newbcast:15 row_mask:0xf bank_mask:0xf
    s_add_u32 s6, s56, 765952
    s_and_b32 s6, s6, 0xfffff
    s_cmp_lt_u32 s3, 4
    s_cbranch_scc0 W_223
    s_waitcnt vmcnt(5)
W_223:
    buffer_load_dwordx4 a[108:111], v1, s[12:15], s6 offen nt
    v_lshlrev_b32 v54, 16, v31
    s_nop 1
    s_waitcnt vmcnt(11)
    v_accvgpr_read_b32 v48, a64
    v_accvgpr_read_b32 v49, a65
    v_accvgpr_read_b32 v50, a66
    v_accvgpr_read_b32 v51, a67
    v_dot2c_f32_bf16_dpp v12, v31, v48 row_newbcast:0 row_mask:0xf bank_mask:0xf
    v_dot2c_f32_bf16_dpp v13, v54, v48 row_newbcast:0 row_mask:0xf bank_mask:0xf
    v_dot2c_f32_bf16_dpp v14, v31, v49 row_newbcast:0 row_mask:0xf bank_mask:0xf
    v_dot2c_f32_bf16_dpp v15, v54, v49 row_newbcast:0 row_mask:0xf bank_mask:0xf
    v_dot2c_f32_bf16_dpp v16, v31, v50 row_newbcast:0 row_mask:0xf bank_mask:0xf
    v_dot2c_f32_bf16_dpp v17, v54, v50 row_newbcast:0 row_mask:0xf bank_mask:0xf
    v_dot2c_f32_bf16_dpp v18, v31, v51 row_newbcast:0 row_mask:0xf bank_mask:0xf
    v_dot2c_f32_bf16_dpp v19, v54, v51 row_newbcast:0 row_mask:0xf bank_mask:0xf
    s_add_u32 s6, s56, 770048
    s_and_b32 s6, s6, 0xfffff
    s_cmp_lt_u32 s3, 4
    s_cbranch_scc0 W_224
    s_waitcnt vmcnt(4)
W_224:
    buffer_load_dwordx4 a[112:115], v1, s[12:15], s6 offen nt
    s_waitcnt vmcnt(11)
    v_accvgpr_read_b32 v48, a68
    v_accvgpr_read_b32 v49, a69
    v_accvgpr_read_b32 v50, a70
    v_accvgpr_read_b32 v51, a71
    v_dot2c_f32_bf16_dpp v12, v31, v48 row_newbcast:1 row_mask:0xf bank_mask:0xf
    v_dot2c_f32_bf16_dpp v13, v54, v48 row_newbcast:1 row_mask:0xf bank_mask:0xf
    v_dot2c_f32_bf16_dpp v14, v31, v49 row_newbcast:1 row_mask:0xf bank_mask:0xf
    v_dot2c_f32_bf16_dpp v15, v54, v49 row_newbcast:1 row_mask:0xf bank_mask:0xf
    v_dot2c_f32_bf16_dpp v16, v31, v50 row_newbcast:1 row_mask:0xf bank_mask:0xf
    v_dot2c_f32_bf16_dpp v17, v54, v50 row_newbcast:1 row_mask:0xf bank_mask:0xf
    v_dot2c_f32_bf16_dpp v18, v31, v51 row_newbcast:1 row_mask:0xf bank_mask:0xf
    v_dot2c_f32_bf16_dpp v19, v54, v51 row_newbcast:1 row_mask:0xf bank_mask:0xf
    s_add_u32 s6, s56, 774144
    s_and_b32 s6, s6, 0xfffff
    s_cmp_lt_u32 s3, 4
    s_cbranch_scc0 W_225
    s_waitcnt vmcnt(5)
W_225:
    buffer_load_dwordx4 a[116:119], v1, s[12:15], s6 offen nt
    s_waitcnt vmcnt(11)
    v_accvgpr_read_b32 v48, a72
    v_accvgpr_read_b32 v49, a73
    v_accvgpr_read_b32 v50, a74
    v_accvgpr_read_b32 v51, a75
    v_dot2c_f32_bf16_dpp v12, v31, v48 row_newbcast:2 row_mask:0xf bank_mask:0xf
    v_dot2c_f32_bf16_dpp v13, v54, v48 row_newbcast:2 row_mask:0xf bank_mask:0xf
    v_dot2c_f32_bf16_dpp v14, v31, v49 row_newbcast:2 row_mask:0xf bank_mask:0xf
    v_dot2c_f32_bf16_dpp v15, v54, v49 row_newbcast:2 row_mask:0xf bank_mask:0xf
    v_dot2c_f32_bf16_dpp v16, v31, v50 row_newbcast:2 row_mask:0xf bank_mask:0xf
    v_dot2c_f32_bf16_dpp v17, v54, v50 row_newbcast:2 row_mask:0xf bank_mask:0xf
    v_dot2c_f32_bf16_dpp v18, v31, v51 row_newbcast:2 row_mask:0xf bank_mask:0xf
    v_dot2c_f32_bf16_dpp v19, v54, v51 row_newbcast:2 row_mask:0xf bank_mask:0xf
    s_add_u32 s6, s56, 778240
    s_and_b32 s6, s6, 0xfffff
    s_cmp_lt_u32 s3, 4
    s_cbranch_scc0 W_226
    s_waitcnt vmcnt(4)
W_226:
    buffer_load_dwordx4 a[120:123], v1, s[12:15], s6 offen nt
    s_waitcnt vmcnt(11)
    v_accvgpr_read_b32 v48, a76
    v_accvgpr_read_b32 v49, a77
    v_accvgpr_read_b32 v50, a78
    v_accvgpr_read_b32 v51, a79
    v_dot2c_f32_bf16_dpp v12, v31, v48 row_newbcast:3 row_mask:0xf bank_mask:0xf
    v_dot2c_f32_bf16_dpp v13, v54, v48 row_newbcast:3 row_mask:0xf bank_mask:0xf
    v_dot2c_f32_bf16_dpp v14, v31, v49 row_newbcast:3 row_mask:0xf bank_mask:0xf
    v_dot2c_f32_bf16_dpp v15, v54, v49 row_newbcast:3 row_mask:0xf bank_mask:0xf
    v_dot2c_f32_bf16_dpp v16, v31, v50 row_newbcast:3 row_mask:0xf bank_mask:0xf
    v_dot2c_f32_bf16_dpp v17, v54, v50 row_newbcast:3 row_mask:0xf bank_mask:0xf
    v_dot2c_f32_bf16_dpp v18, v31, v51 row_newbcast:3 row_mask:0xf bank_mask:0xf
    v_dot2c_f32_bf16_dpp v19, v54, v51 row_newbcast:3 row_mask:0xf bank_mask:0xf
    s_add_u32 s6, s56, 782336
    s_and_b32 s6, s6, 0xfffff
    s_cmp_lt_u32 s3, 4
    s_cbranch_scc0 W_227
    s_waitcnt vmcnt(5)
W_227:
    buffer_load_dwordx4 a[124:127], v1, s[12:15], s6 offen nt
    s_waitcnt vmcnt(11)
    v_accvgpr_read_b32 v48, a80
    v_accvgpr_read_b32 v49, a81
    v_accvgpr_read_b32 v50, a82
    v_accvgpr_read_b32 v51, a83
    v_dot2c_f32_bf16_dpp v12, v31, v48 row_newbcast:4 row_mask:0xf bank_mask:0xf
    v_dot2c_f32_bf16_dpp v13, v54, v48 row_newbcast:4 row_mask:0xf bank_mask:0xf
    v_dot2c_f32_bf16_dpp v14, v31, v49 row_newbcast:4 row_mask:0xf bank_mask:0xf
    v_dot2c_f32_bf16_dpp v15, v54, v49 row_newbcast:4 row_mask:0xf bank_mask:0xf
    v_dot2c_f32_bf16_dpp v16, v31, v50 row_newbcast:4 row_mask:0xf bank_mask:0xf
    v_dot2c_f32_bf16_dpp v17, v54, v50 row_newbcast:4 row_mask:0xf bank_mask:0xf
    v_dot2c_f32_bf16_dpp v18, v31, v51 row_newbcast:4 row_mask:0xf bank_mask:0xf
    v_dot2c_f32_bf16_dpp v19, v54, v51 row_newbcast:4 row_mask:0xf bank_mask:0xf
    s_add_u32 s6, s56, 786432
    s_and_b32 s6, s6, 0xfffff
    s_cmp_lt_u32 s3, 4
    s_cbranch_scc0 W_228
    s_waitcnt vmcnt(4)
W_228:
    buffer_load_dwordx4 a[128:131], v1, s[12:15], s6 offen nt
    s_waitcnt vmcnt(11)
    v_accvgpr_read_b32 v48, a84
    v_accvgpr_read_b32 v49, a85
    v_accvgpr_read_b32 v50, a86
    v_accvgpr_read_b32 v51, a87
    v_dot2c_f32_bf16_dpp v12, v31, v48 row_newbcast:5 row_mask:0xf bank_mask:0xf
    v_dot2c_f32_bf16_dpp v13, v54, v48 row_newbcast:5 row_mask:0xf bank_mask:0xf
    v_dot2c_f32_bf16_dpp v14, v31, v49 row_newbcast:5 row_mask:0xf bank_mask:0xf
    v_dot2c_f32_bf16_dpp v15, v54, v49 row_newbcast:5 row_mask:0xf bank_mask:0xf
    v_dot2c_f32_bf16_dpp v16, v31, v50 row_newbcast:5 row_mask:0xf bank_mask:0xf
    v_dot2c_f32_bf16_dpp v17, v54, v50 row_newbcast:5 row_mask:0xf bank_mask:0xf
    v_dot2c_f32_bf16_dpp v18, v31, v51 row_newbcast:5 row_mask:0xf bank_mask:0xf
    v_dot2c_f32_bf16_dpp v19, v54, v51 row_newbcast:5 row_mask:0xf bank_mask:0xf
    s_add_u32 s6, s56, 790528
    s_and_b32 s6, s6, 0xfffff
    s_cmp_lt_u32 s3, 4
    s_cbranch_scc0 W_229
    s_waitcnt vmcnt(5)
W_229:
    buffer_load_dwordx4 a[132:135], v1, s[12:15], s6 offen nt
    s_waitcnt vmcnt(11)
    v_accvgpr_read_b32 v48, a88
    v_accvgpr_read_b32 v49, a89
    v_accvgpr_read_b32 v50, a90
    v_accvgpr_read_b32 v51, a91
    v_dot2c_f32_bf16_dpp v12, v31, v48 row_newbcast:6 row_mask:0xf bank_mask:0xf
    v_dot2c_f32_bf16_dpp v13, v54, v48 row_newbcast:6 row_mask:0xf bank_mask:0xf
    v_dot2c_f32_bf16_dpp v14, v31, v49 row_newbcast:6 row_mask:0xf bank_mask:0xf
    v_dot2c_f32_bf16_dpp v15, v54, v49 row_newbcast:6 row_mask:0xf bank_mask:0xf
    v_dot2c_f32_bf16_dpp v16, v31, v50 row_newbcast:6 row_mask:0xf bank_mask:0xf
    v_dot2c_f32_bf16_dpp v17, v54, v50 row_newbcast:6 row_mask:0xf bank_mask:0xf
    v_dot2c_f32_bf16_dpp v18, v31, v51 row_newbcast:6 row_mask:0xf bank_mask:0xf
    v_dot2c_f32_bf16_dpp v19, v54, v51 row_newbcast:6 row_mask:0xf bank_mask:0xf
    s_add_u32 s6, s56, 794624
    s_and_b32 s6, s6, 0xfffff
    s_cmp_lt_u32 s3, 4
    s_cbranch_scc0 W_230
    s_waitcnt vmcnt(4)
W_230:
    buffer_load_dwordx4 a[136:139], v1, s[12:15], s6 offen nt
    s_waitcnt vmcnt(11)
    v_accvgpr_read_b32 v48, a92
    v_accvgpr_read_b32 v49, a93
    v_accvgpr_read_b32 v50, a94
    v_accvgpr_read_b32 v51, a95
    v_dot2c_f32_bf16_dpp v12, v31, v48 row_newbcast:7 row_mask:0xf bank_mask:0xf
    v_dot2c_f32_bf16_dpp v13, v54, v48 row_newbcast:7 row_mask:0xf bank_mask:0xf
    v_dot2c_f32_bf16_dpp v14, v31, v49 row_newbcast:7 row_mask:0xf bank_mask:0xf
    v_dot2c_f32_bf16_dpp v15, v54, v49 row_newbcast:7 row_mask:0xf bank_mask:0xf
    v_dot2c_f32_bf16_dpp v16, v31, v50 row_newbcast:7 row_mask:0xf bank_mask:0xf
    v_dot2c_f32_bf16_dpp v17, v54, v50 row_newbcast:7 row_mask:0xf bank_mask:0xf
    v_dot2c_f32_bf16_dpp v18, v31, v51 row_newbcast:7 row_mask:0xf bank_mask:0xf
    v_dot2c_f32_bf16_dpp v19, v54, v51 row_newbcast:7 row_mask:0xf bank_mask:0xf
    s_add_u32 s6, s56, 798720
    s_and_b32 s6, s6, 0xfffff
    s_cmp_lt_u32 s3, 4
    s_cbranch_scc0 W_231
    s_waitcnt vmcnt(5)
W_231:
    buffer_load_dwordx4 a[140:143], v1, s[12:15], s6 offen nt
    s_waitcnt vmcnt(11)
    v_accvgpr_read_b32 v48, a96
    v_accvgpr_read_b32 v49, a97
    v_accvgpr_read_b32 v50, a98
    v_accvgpr_read_b32 v51, a99
    v_dot2c_f32_bf16_dpp v12, v31, v48 row_newbcast:8 row_mask:0xf bank_mask:0xf
    v_dot2c_f32_bf16_dpp v13, v54, v48 row_newbcast:8 row_mask:0xf bank_mask:0xf
    v_dot2c_f32_bf16_dpp v14, v31, v49 row_newbcast:8 row_mask:0xf bank_mask:0xf
    v_dot2c_f32_bf16_dpp v15, v54, v49 row_newbcast:8 row_mask:0xf bank_mask:0xf
    v_dot2c_f32_bf16_dpp v16, v31, v50 row_newbcast:8 row_mask:0xf bank_mask:0xf
    v_dot2c_f32_bf16_dpp v17, v54, v50 row_newbcast:8 row_mask:0xf bank_mask:0xf
    v_dot2c_f32_bf16_dpp v18, v31, v51 row_newbcast:8 row_mask:0xf bank_mask:0xf
    v_dot2c_f32_bf16_dpp v19, v54, v51 row_newbcast:8 row_mask:0xf bank_mask:0xf
    s_add_u32 s6, s56, 802816
    s_and_b32 s6, s6, 0xfffff
    s_cmp_lt_u32 s3, 4
    s_cbranch_scc0 W_232
    s_waitcnt vmcnt(4)
W_232:
    buffer_load_dwordx4 a[144:147], v1, s[12:15], s6 offen nt
    s_waitcnt vmcnt(11)
    v_accvgpr_read_b32 v48, a100
    v_accvgpr_read_b32 v49, a101
    v_accvgpr_read_b32 v50, a102
    v_accvgpr_read_b32 v51, a103
    v_dot2c_f32_bf16_dpp v12, v31, v48 row_newbcast:9 row_mask:0xf bank_mask:0xf
    v_dot2c_f32_bf16_dpp v13, v54, v48 row_newbcast:9 row_mask:0xf bank_mask:0xf
    v_dot2c_f32_bf16_dpp v14, v31, v49 row_newbcast:9 row_mask:0xf bank_mask:0xf
    v_dot2c_f32_bf16_dpp v15, v54, v49 row_newbcast:9 row_mask:0xf bank_mask:0xf
    v_dot2c_f32_bf16_dpp v16, v31, v50 row_newbcast:9 row_mask:0xf bank_mask:0xf
    v_dot2c_f32_bf16_dpp v17, v54, v50 row_newbcast:9 row_mask:0xf bank_mask:0xf
    v_dot2c_f32_bf16_dpp v18, v31, v51 row_newbcast:9 row_mask:0xf bank_mask:0xf
    v_dot2c_f32_bf16_dpp v19, v54, v51 row_newbcast:9 row_mask:0xf bank_mask:0xf
    s_add_u32 s6, s56, 806912
    s_and_b32 s6, s6, 0xfffff
    s_cmp_lt_u32 s3, 4
    s_cbranch_scc0 W_233
    s_waitcnt vmcnt(5)
W_233:
    buffer_load_dwordx4 a[148:151], v1, s[12:15], s6 offen nt
    s_waitcnt vmcnt(11)
    v_accvgpr_read_b32 v48, a104
    v_accvgpr_read_b32 v49, a105
    v_accvgpr_read_b32 v50, a106
    v_accvgpr_read_b32 v51, a107
    v_dot2c_f32_bf16_dpp v12, v31, v48 row_newbcast:10 row_mask:0xf bank_mask:0xf
    v_dot2c_f32_bf16_dpp v13, v54, v48 row_newbcast:10 row_mask:0xf bank_mask:0xf
    v_dot2c_f32_bf16_dpp v14, v31, v49 row_newbcast:10 row_mask:0xf bank_mask:0xf
    v_dot2c_f32_bf16_dpp v15, v54, v49 row_newbcast:10 row_mask:0xf bank_mask:0xf
    v_dot2c_f32_bf16_dpp v16, v31, v50 row_newbcast:10 row_mask:0xf bank_mask:0xf
    v_dot2c_f32_bf16_dpp v17, v54, v50 row_newbcast:10 row_mask:0xf bank_mask:0xf
    v_dot2c_f32_bf16_dpp v18, v31, v51 row_newbcast:10 row_mask:0xf bank_mask:0xf
    v_dot2c_f32_bf16_dpp v19, v54, v51 row_newbcast:10 row_mask:0xf bank_mask:0xf
    s_add_u32 s6, s56, 811008
    s_and_b32 s6, s6, 0xfffff
    s_cmp_lt_u32 s3, 4
    s_cbranch_scc0 W_234
    s_waitcnt vmcnt(4)
W_234:
    buffer_load_dwordx4 a[152:155], v1, s[12:15], s6 offen nt
    s_waitcnt vmcnt(11)
    v_accvgpr_read_b32 v48, a108
    v_accvgpr_read_b32 v49, a109
    v_accvgpr_read_b32 v50, a110
    v_accvgpr_read_b32 v51, a111
    v_dot2c_f32_bf16_dpp v12, v31, v48 row_newbcast:11 row_mask:0xf bank_mask:0xf
    v_dot2c_f32_bf16_dpp v13, v54, v48 row_newbcast:11 row_mask:0xf bank_mask:0xf
    v_dot2c_f32_bf16_dpp v14, v31, v49 row_newbcast:11 row_mask:0xf bank_mask:0xf
    v_dot2c_f32_bf16_dpp v15, v54, v49 row_newbcast:11 row_mask:0xf bank_mask:0xf
    v_dot2c_f32_bf16_dpp v16, v31, v50 row_newbcast:11 row_mask:0xf bank_mask:0xf
    v_dot2c_f32_bf16_dpp v17, v54, v50 row_newbcast:11 row_mask:0xf bank_mask:0xf
    v_dot2c_f32_bf16_dpp v18, v31, v51 row_newbcast:11 row_mask:0xf bank_mask:0xf
    v_dot2c_f32_bf16_dpp v19, v54, v51 row_newbcast:11 row_mask:0xf bank_mask:0xf
    s_add_u32 s6, s56, 815104
    s_and_b32 s6, s6, 0xfffff
    s_cmp_lt_u32 s3, 4
    s_cbranch_scc0 W_235
    s_waitcnt vmcnt(5)
W_235:
    buffer_load_dwordx4 a[156:159], v1, s[12:15], s6 offen nt
    s_waitcnt vmcnt(11)
    v_accvgpr_read_b32 v48, a112
    v_accvgpr_read_b32 v49, a113
    v_accvgpr_read_b32 v50, a114
    v_accvgpr_read_b32 v51, a115
    v_dot2c_f32_bf16_dpp v12, v31, v48 row_newbcast:12 row_mask:0xf bank_mask:0xf
    v_dot2c_f32_bf16_dpp v13, v54, v48 row_newbcast:12 row_mask:0xf bank_mask:0xf
    v_dot2c_f32_bf16_dpp v14, v31, v49 row_newbcast:12 row_mask:0xf bank_mask:0xf
    v_dot2c_f32_bf16_dpp v15, v54, v49 row_newbcast:12 row_mask:0xf bank_mask:0xf
    v_dot2c_f32_bf16_dpp v16, v31, v50 row_newbcast:12 row_mask:0xf bank_mask:0xf
    v_dot2c_f32_bf16_dpp v17, v54, v50 row_newbcast:12 row_mask:0xf bank_mask:0xf
    v_dot2c_f32_bf16_dpp v18, v31, v51 row_newbcast:12 row_mask:0xf bank_mask:0xf
    v_dot2c_f32_bf16_dpp v19, v54, v51 row_newbcast:12 row_mask:0xf bank_mask:0xf
    s_add_u32 s6, s56, 819200
    s_and_b32 s6, s6, 0xfffff
    s_cmp_lt_u32 s3, 4
    s_cbranch_scc0 W_236
    s_waitcnt vmcnt(4)
W_236:
    buffer_load_dwordx4 a[160:163], v1, s[12:15], s6 offen nt
    s_waitcnt vmcnt(11)
    v_accvgpr_read_b32 v48, a116
    v_accvgpr_read_b32 v49, a117
    v_accvgpr_read_b32 v50, a118
    v_accvgpr_read_b32 v51, a119
    v_dot2c_f32_bf16_dpp v12, v31, v48 row_newbcast:13 row_mask:0xf bank_mask:0xf
    v_dot2c_f32_bf16_dpp v13, v54, v48 row_newbcast:13 row_mask:0xf bank_mask:0xf
    v_dot2c_f32_bf16_dpp v14, v31, v49 row_newbcast:13 row_mask:0xf bank_mask:0xf
    v_dot2c_f32_bf16_dpp v15, v54, v49 row_newbcast:13 row_mask:0xf bank_mask:0xf
    v_dot2c_f32_bf16_dpp v16, v31, v50 row_newbcast:13 row_mask:0xf bank_mask:0xf
    v_dot2c_f32_bf16_dpp v17, v54, v50 row_newbcast:13 row_mask:0xf bank_mask:0xf
    v_dot2c_f32_bf16_dpp v18, v31, v51 row_newbcast:13 row_mask:0xf bank_mask:0xf
    v_dot2c_f32_bf16_dpp v19, v54, v51 row_newbcast:13 row_mask:0xf bank_mask:0xf
    s_add_u32 s6, s56, 823296
    s_and_b32 s6, s6, 0xfffff
    s_cmp_lt_u32 s3, 4
    s_cbranch_scc0 W_237
    s_waitcnt vmcnt(5)
W_237:
    buffer_load_dwordx4 a[164:167], v1, s[12:15], s6 offen nt
    s_waitcnt vmcnt(11)
    v_accvgpr_read_b32 v48, a120
    v_accvgpr_read_b32 v49, a121
    v_accvgpr_read_b32 v50, a122
    v_accvgpr_read_b32 v51, a123
    v_dot2c_f32_bf16_dpp v12, v31, v48 row_newbcast:14 row_mask:0xf bank_mask:0xf
    v_dot2c_f32_bf16_dpp v13, v54, v48 row_newbcast:14 row_mask:0xf bank_mask:0xf
    v_dot2c_f32_bf16_dpp v14, v31, v49 row_newbcast:14 row_mask:0xf bank_mask:0xf
    v_dot2c_f32_bf16_dpp v15, v54, v49 row_newbcast:14 row_mask:0xf bank_mask:0xf
    v_dot2c_f32_bf16_dpp v16, v31, v50 row_newbcast:14 row_mask:0xf bank_mask:0xf
    v_dot2c_f32_bf16_dpp v17, v54, v50 row_newbcast:14 row_mask:0xf bank_mask:0xf
    v_dot2c_f32_bf16_dpp v18, v31, v51 row_newbcast:14 row_mask:0xf bank_mask:0xf
    v_dot2c_f32_bf16_dpp v19, v54, v51 row_newbcast:14 row_mask:0xf bank_mask:0xf
    s_add_u32 s6, s56, 827392
    s_and_b32 s6, s6, 0xfffff
    s_cmp_lt_u32 s3, 4
    s_cbranch_scc0 W_238
    s_waitcnt vmcnt(4)
W_238:
    buffer_load_dwordx4 a[168:171], v1, s[12:15], s6 offen nt
    s_waitcnt vmcnt(11)
    v_accvgpr_read_b32 v48, a124
    v_accvgpr_read_b32 v49, a125
    v_accvgpr_read_b32 v50, a126
    v_accvgpr_read_b32 v51, a127
    v_dot2c_f32_bf16_dpp v12, v31, v48 row_newbcast:15 row_mask:0xf bank_mask:0xf
    v_dot2c_f32_bf16_dpp v13, v54, v48 row_newbcast:15 row_mask:0xf bank_mask:0xf
    v_dot2c_f32_bf16_dpp v14, v31, v49 row_newbcast:15 row_mask:0xf bank_mask:0xf
    v_dot2c_f32_bf16_dpp v15, v54, v49 row_newbcast:15 row_mask:0xf bank_mask:0xf
    v_dot2c_f32_bf16_dpp v16, v31, v50 row_newbcast:15 row_mask:0xf bank_mask:0xf
    v_dot2c_f32_bf16_dpp v17, v54, v50 row_newbcast:15 row_mask:0xf bank_mask:0xf
    v_dot2c_f32_bf16_dpp v18, v31, v51 row_newbcast:15 row_mask:0xf bank_mask:0xf
    v_dot2c_f32_bf16_dpp v19, v54, v51 row_newbcast:15 row_mask:0xf bank_mask:0xf
    s_add_u32 s6, s56, 831488
    s_and_b32 s6, s6, 0xfffff
    s_cmp_lt_u32 s3, 4
    s_cbranch_scc0 W_239
    s_waitcnt vmcnt(5)
W_239:
    buffer_load_dwordx4 a[172:175], v1, s[12:15], s6 offen nt
    v_lshlrev_b32 v52, 16, v32
    s_nop 1
    s_waitcnt vmcnt(11)
    v_accvgpr_read_b32 v48, a128
    v_accvgpr_read_b32 v49, a129
    v_accvgpr_read_b32 v50, a130
    v_accvgpr_read_b32 v51, a131
    v_dot2c_f32_bf16_dpp v12, v32, v48 row_newbcast:0 row_mask:0xf bank_mask:0xf
    v_dot2c_f32_bf16_dpp v13, v52, v48 row_newbcast:0 row_mask:0xf bank_mask:0xf
    v_dot2c_f32_bf16_dpp v14, v32, v49 row_newbcast:0 row_mask:0xf bank_mask:0xf
    v_dot2c_f32_bf16_dpp v15, v52, v49 row_newbcast:0 row_mask:0xf bank_mask:0xf
    v_dot2c_f32_bf16_dpp v16, v32, v50 row_newbcast:0 row_mask:0xf bank_mask:0xf
    v_dot2c_f32_bf16_dpp v17, v52, v50 row_newbcast:0 row_mask:0xf bank_mask:0xf
    v_dot2c_f32_bf16_dpp v18, v32, v51 row_newbcast:0 row_mask:0xf bank_mask:0xf
    v_dot2c_f32_bf16_dpp v19, v52, v51 row_newbcast:0 row_mask:0xf bank_mask:0xf
    s_add_u32 s6, s56, 835584
    s_and_b32 s6, s6, 0xfffff
    s_cmp_lt_u32 s3, 4
    s_cbranch_scc0 W_240
    s_waitcnt vmcnt(4)
W_240:
    buffer_load_dwordx4 a[176:179], v1, s[12:15], s6 offen nt
    s_waitcnt vmcnt(11)
    v_accvgpr_read_b32 v48, a132
    v_accvgpr_read_b32 v49, a133
    v_accvgpr_read_b32 v50, a134
    v_accvgpr_read_b32 v51, a135
    v_dot2c_f32_bf16_dpp v12, v32, v48 row_newbcast:1 row_mask:0xf bank_mask:0xf
    v_dot2c_f32_bf16_dpp v13, v52, v48 row_newbcast:1 row_mask:0xf bank_mask:0xf
    v_dot2c_f32_bf16_dpp v14, v32, v49 row_newbcast:1 row_mask:0xf bank_mask:0xf
    v_dot2c_f32_bf16_dpp v15, v52, v49 row_newbcast:1 row_mask:0xf bank_mask:0xf
    v_dot2c_f32_bf16_dpp v16, v32, v50 row_newbcast:1 row_mask:0xf bank_mask:0xf
    v_dot2c_f32_bf16_dpp v17, v52, v50 row_newbcast:1 row_mask:0xf bank_mask:0xf
    v_dot2c_f32_bf16_dpp v18, v32, v51 row_newbcast:1 row_mask:0xf bank_mask:0xf
    v_dot2c_f32_bf16_dpp v19, v52, v51 row_newbcast:1 row_mask:0xf bank_mask:0xf
    s_add_u32 s6, s56, 839680
    s_and_b32 s6, s6, 0xfffff
    s_cmp_lt_u32 s3, 4
    s_cbranch_scc0 W_241
    s_waitcnt vmcnt(5)
W_241:
    buffer_load_dwordx4 a[180:183], v1, s[12:15], s6 offen nt
    s_waitcnt vmcnt(11)
    v_accvgpr_read_b32 v48, a136
    v_accvgpr_read_b32 v49, a137
    v_accvgpr_read_b32 v50, a138
    v_accvgpr_read_b32 v51, a139
    v_dot2c_f32_bf16_dpp v12, v32, v48 row_newbcast:2 row_mask:0xf bank_mask:0xf
    v_dot2c_f32_bf16_dpp v13, v52, v48 row_newbcast:2 row_mask:0xf bank_mask:0xf
    v_dot2c_f32_bf16_dpp v14, v32, v49 row_newbcast:2 row_mask:0xf bank_mask:0xf
    v_dot2c_f32_bf16_dpp v15, v52, v49 row_newbcast:2 row_mask:0xf bank_mask:0xf
    v_dot2c_f32_bf16_dpp v16, v32, v50 row_newbcast:2 row_mask:0xf bank_mask:0xf
    v_dot2c_f32_bf16_dpp v17, v52, v50 row_newbcast:2 row_mask:0xf bank_mask:0xf
    v_dot2c_f32_bf16_dpp v18, v32, v51 row_newbcast:2 row_mask:0xf bank_mask:0xf
    v_dot2c_f32_bf16_dpp v19, v52, v51 row_newbcast:2 row_mask:0xf bank_mask:0xf
    s_add_u32 s6, s56, 843776
    s_and_b32 s6, s6, 0xfffff
    s_cmp_lt_u32 s3, 4
    s_cbranch_scc0 W_242
    s_waitcnt vmcnt(4)
W_242:
    buffer_load_dwordx4 a[184:187], v1, s[12:15], s6 offen nt
    s_waitcnt vmcnt(11)
    v_accvgpr_read_b32 v48, a140
    v_accvgpr_read_b32 v49, a141
    v_accvgpr_read_b32 v50, a142
    v_accvgpr_read_b32 v51, a143
    v_dot2c_f32_bf16_dpp v12, v32, v48 row_newbcast:3 row_mask:0xf bank_mask:0xf
    v_dot2c_f32_bf16_dpp v13, v52, v48 row_newbcast:3 row_mask:0xf bank_mask:0xf
    v_dot2c_f32_bf16_dpp v14, v32, v49 row_newbcast:3 row_mask:0xf bank_mask:0xf
    v_dot2c_f32_bf16_dpp v15, v52, v49 row_newbcast:3 row_mask:0xf bank_mask:0xf
    v_dot2c_f32_bf16_dpp v16, v32, v50 row_newbcast:3 row_mask:0xf bank_mask:0xf
    v_dot2c_f32_bf16_dpp v17, v52, v50 row_newbcast:3 row_mask:0xf bank_mask:0xf
    v_dot2c_f32_bf16_dpp v18, v32, v51 row_newbcast:3 row_mask:0xf bank_mask:0xf
    v_dot2c_f32_bf16_dpp v19, v52, v51 row_newbcast:3 row_mask:0xf bank_mask:0xf
    s_add_u32 s6, s56, 847872
    s_and_b32 s6, s6, 0xfffff
    s_cmp_lt_u32 s3, 4
    s_cbranch_scc0 W_243
    s_waitcnt vmcnt(5)
W_243:
    buffer_load_dwordx4 a[188:191], v1, s[12:15], s6 offen nt
    s_waitcnt vmcnt(11)
    v_accvgpr_read_b32 v48, a144
    v_accvgpr_read_b32 v49, a145
    v_accvgpr_read_b32 v50, a146
    v_accvgpr_read_b32 v51, a147
    v_dot2c_f32_bf16_dpp v12, v32, v48 row_newbcast:4 row_mask:0xf bank_mask:0xf
    v_dot2c_f32_bf16_dpp v13, v52, v48 row_newbcast:4 row_mask:0xf bank_mask:0xf
    v_dot2c_f32_bf16_dpp v14, v32, v49 row_newbcast:4 row_mask:0xf bank_mask:0xf
    v_dot2c_f32_bf16_dpp v15, v52, v49 row_newbcast:4 row_mask:0xf bank_mask:0xf
    v_dot2c_f32_bf16_dpp v16, v32, v50 row_newbcast:4 row_mask:0xf bank_mask:0xf
    v_dot2c_f32_bf16_dpp v17, v52, v50 row_newbcast:4 row_mask:0xf bank_mask:0xf
    v_dot2c_f32_bf16_dpp v18, v32, v51 row_newbcast:4 row_mask:0xf bank_mask:0xf
    v_dot2c_f32_bf16_dpp v19, v52, v51 row_newbcast:4 row_mask:0xf bank_mask:0xf
    s_add_u32 s6, s56, 851968
    s_and_b32 s6, s6, 0xfffff
    s_cmp_lt_u32 s3, 4
    s_cbranch_scc0 W_244
    s_waitcnt vmcnt(4)
W_244:
    buffer_load_dwordx4 a[192:195], v1, s[12:15], s6 offen nt
    s_waitcnt vmcnt(11)
    v_accvgpr_read_b32 v48, a148
    v_accvgpr_read_b32 v49, a149
    v_accvgpr_read_b32 v50, a150
    v_accvgpr_read_b32 v51, a151
    v_dot2c_f32_bf16_dpp v12, v32, v48 row_newbcast:5 row_mask:0xf bank_mask:0xf
    v_dot2c_f32_bf16_dpp v13, v52, v48 row_newbcast:5 row_mask:0xf bank_mask:0xf
    v_dot2c_f32_bf16_dpp v14, v32, v49 row_newbcast:5 row_mask:0xf bank_mask:0xf
    v_dot2c_f32_bf16_dpp v15, v52, v49 row_newbcast:5 row_mask:0xf bank_mask:0xf
    v_dot2c_f32_bf16_dpp v16, v32, v50 row_newbcast:5 row_mask:0xf bank_mask:0xf
    v_dot2c_f32_bf16_dpp v17, v52, v50 row_newbcast:5 row_mask:0xf bank_mask:0xf
    v_dot2c_f32_bf16_dpp v18, v32, v51 row_newbcast:5 row_mask:0xf bank_mask:0xf
    v_dot2c_f32_bf16_dpp v19, v52, v51 row_newbcast:5 row_mask:0xf bank_mask:0xf
    s_add_u32 s6, s56, 856064
    s_and_b32 s6, s6, 0xfffff
    s_cmp_lt_u32 s3, 4
    s_cbranch_scc0 W_245
    s_waitcnt vmcnt(5)
W_245:
    buffer_load_dwordx4 a[196:199], v1, s[12:15], s6 offen nt
    s_waitcnt vmcnt(11)
    v_accvgpr_read_b32 v48, a152
    v_accvgpr_read_b32 v49, a153
    v_accvgpr_read_b32 v50, a154
    v_accvgpr_read_b32 v51, a155
    v_dot2c_f32_bf16_dpp v12, v32, v48 row_newbcast:6 row_mask:0xf bank_mask:0xf
    v_dot2c_f32_bf16_dpp v13, v52, v48 row_newbcast:6 row_mask:0xf bank_mask:0xf
    v_dot2c_f32_bf16_dpp v14, v32, v49 row_newbcast:6 row_mask:0xf bank_mask:0xf
    v_dot2c_f32_bf16_dpp v15, v52, v49 row_newbcast:6 row_mask:0xf bank_mask:0xf
    v_dot2c_f32_bf16_dpp v16, v32, v50 row_newbcast:6 row_mask:0xf bank_mask:0xf
    v_dot2c_f32_bf16_dpp v17, v52, v50 row_newbcast:6 row_mask:0xf bank_mask:0xf
    v_dot2c_f32_bf16_dpp v18, v32, v51 row_newbcast:6 row_mask:0xf bank_mask:0xf
    v_dot2c_f32_bf16_dpp v19, v52, v51 row_newbcast:6 row_mask:0xf bank_mask:0xf
    s_add_u32 s6, s56, 860160
    s_and_b32 s6, s6, 0xfffff
    s_cmp_lt_u32 s3, 4
    s_cbranch_scc0 W_246
    s_waitcnt vmcnt(4)
W_246:
    buffer_load_dwordx4 a[200:203], v1, s[12:15], s6 offen nt
    s_waitcnt vmcnt(11)
    v_accvgpr_read_b32 v48, a156
    v_accvgpr_read_b32 v49, a157
    v_accvgpr_read_b32 v50, a158
    v_accvgpr_read_b32 v51, a159
    v_dot2c_f32_bf16_dpp v12, v32, v48 row_newbcast:7 row_mask:0xf bank_mask:0xf
    v_dot2c_f32_bf16_dpp v13, v52, v48 row_newbcast:7 row_mask:0xf bank_mask:0xf
    v_dot2c_f32_bf16_dpp v14, v32, v49 row_newbcast:7 row_mask:0xf bank_mask:0xf
    v_dot2c_f32_bf16_dpp v15, v52, v49 row_newbcast:7 row_mask:0xf bank_mask:0xf
    v_dot2c_f32_bf16_dpp v16, v32, v50 row_newbcast:7 row_mask:0xf bank_mask:0xf
    v_dot2c_f32_bf16_dpp v17, v52, v50 row_newbcast:7 row_mask:0xf bank_mask:0xf
    v_dot2c_f32_bf16_dpp v18, v32, v51 row_newbcast:7 row_mask:0xf bank_mask:0xf
    v_dot2c_f32_bf16_dpp v19, v52, v51 row_newbcast:7 row_mask:0xf bank_mask:0xf
    s_add_u32 s6, s56, 864256
    s_and_b32 s6, s6, 0xfffff
    s_cmp_lt_u32 s3, 4
    s_cbranch_scc0 W_247
    s_waitcnt vmcnt(5)
W_247:
    buffer_load_dwordx4 a[204:207], v1, s[12:15], s6 offen nt
    s_lshl_b32 s6, s3, 5
    buffer_load_dword v9, off, s[44:47], s6 sc0 sc1
    s_waitcnt vmcnt(12)
    v_accvgpr_read_b32 v48, a160
    v_accvgpr_read_b32 v49, a161
    v_accvgpr_read_b32 v50, a162
    v_accvgpr_read_b32 v51, a163
    v_dot2c_f32_bf16_dpp v12, v32, v48 row_newbcast:8 row_mask:0xf bank_mask:0xf
    v_dot2c_f32_bf16_dpp v13, v52, v48 row_newbcast:8 row_mask:0xf bank_mask:0xf
    v_dot2c_f32_bf16_dpp v14, v32, v49 row_newbcast:8 row_mask:0xf bank_mask:0xf
    v_dot2c_f32_bf16_dpp v15, v52, v49 row_newbcast:8 row_mask:0xf bank_mask:0xf
    v_dot2c_f32_bf16_dpp v16, v32, v50 row_newbcast:8 row_mask:0xf bank_mask:0xf
    v_dot2c_f32_bf16_dpp v17, v52, v50 row_newbcast:8 row_mask:0xf bank_mask:0xf
    v_dot2c_f32_bf16_dpp v18, v32, v51 row_newbcast:8 row_mask:0xf bank_mask:0xf
    v_dot2c_f32_bf16_dpp v19, v52, v51 row_newbcast:8 row_mask:0xf bank_mask:0xf
    s_add_u32 s6, s56, 868352
    s_and_b32 s6, s6, 0xfffff
    s_cmp_lt_u32 s3, 4
    s_cbranch_scc0 W_248
    s_waitcnt vmcnt(4)
W_248:
    buffer_load_dwordx4 a[208:211], v1, s[12:15], s6 offen nt
    s_waitcnt vmcnt(12)
    v_accvgpr_read_b32 v48, a164
    v_accvgpr_read_b32 v49, a165
    v_accvgpr_read_b32 v50, a166
    v_accvgpr_read_b32 v51, a167
    v_dot2c_f32_bf16_dpp v12, v32, v48 row_newbcast:9 row_mask:0xf bank_mask:0xf
    v_dot2c_f32_bf16_dpp v13, v52, v48 row_newbcast:9 row_mask:0xf bank_mask:0xf
    v_dot2c_f32_bf16_dpp v14, v32, v49 row_newbcast:9 row_mask:0xf bank_mask:0xf
    v_dot2c_f32_bf16_dpp v15, v52, v49 row_newbcast:9 row_mask:0xf bank_mask:0xf
    v_dot2c_f32_bf16_dpp v16, v32, v50 row_newbcast:9 row_mask:0xf bank_mask:0xf
    v_dot2c_f32_bf16_dpp v17, v52, v50 row_newbcast:9 row_mask:0xf bank_mask:0xf
    v_dot2c_f32_bf16_dpp v18, v32, v51 row_newbcast:9 row_mask:0xf bank_mask:0xf
    v_dot2c_f32_bf16_dpp v19, v52, v51 row_newbcast:9 row_mask:0xf bank_mask:0xf
    s_add_u32 s6, s56, 872448
    s_and_b32 s6, s6, 0xfffff
    s_cmp_lt_u32 s3, 4
    s_cbranch_scc0 W_249
    s_waitcnt vmcnt(5)
W_249:
    buffer_load_dwordx4 a[212:215], v1, s[12:15], s6 offen nt
    s_waitcnt vmcnt(12)
    v_accvgpr_read_b32 v48, a168
    v_accvgpr_read_b32 v49, a169
    v_accvgpr_read_b32 v50, a170
    v_accvgpr_read_b32 v51, a171
    v_dot2c_f32_bf16_dpp v12, v32, v48 row_newbcast:10 row_mask:0xf bank_mask:0xf
    v_dot2c_f32_bf16_dpp v13, v52, v48 row_newbcast:10 row_mask:0xf bank_mask:0xf
    v_dot2c_f32_bf16_dpp v14, v32, v49 row_newbcast:10 row_mask:0xf bank_mask:0xf
    v_dot2c_f32_bf16_dpp v15, v52, v49 row_newbcast:10 row_mask:0xf bank_mask:0xf
    v_dot2c_f32_bf16_dpp v16, v32, v50 row_newbcast:10 row_mask:0xf bank_mask:0xf
    v_dot2c_f32_bf16_dpp v17, v52, v50 row_newbcast:10 row_mask:0xf bank_mask:0xf
    v_dot2c_f32_bf16_dpp v18, v32, v51 row_newbcast:10 row_mask:0xf bank_mask:0xf
    v_dot2c_f32_bf16_dpp v19, v52, v51 row_newbcast:10 row_mask:0xf bank_mask:0xf
    s_add_u32 s6, s56, 876544
    s_and_b32 s6, s6, 0xfffff
    s_cmp_lt_u32 s3, 4
    s_cbranch_scc0 W_250
    s_waitcnt vmcnt(4)
W_250:
    buffer_load_dwordx4 a[216:219], v1, s[12:15], s6 offen nt
    s_waitcnt vmcnt(12)
    v_accvgpr_read_b32 v48, a172
    v_accvgpr_read_b32 v49, a173
    v_accvgpr_read_b32 v50, a174
    v_accvgpr_read_b32 v51, a175
    v_dot2c_f32_bf16_dpp v12, v32, v48 row_newbcast:11 row_mask:0xf bank_mask:0xf
    v_dot2c_f32_bf16_dpp v13, v52, v48 row_newbcast:11 row_mask:0xf bank_mask:0xf
    v_dot2c_f32_bf16_dpp v14, v32, v49 row_newbcast:11 row_mask:0xf bank_mask:0xf
    v_dot2c_f32_bf16_dpp v15, v52, v49 row_newbcast:11 row_mask:0xf bank_mask:0xf
    v_dot2c_f32_bf16_dpp v16, v32, v50 row_newbcast:11 row_mask:0xf bank_mask:0xf
    v_dot2c_f32_bf16_dpp v17, v52, v50 row_newbcast:11 row_mask:0xf bank_mask:0xf
    v_dot2c_f32_bf16_dpp v18, v32, v51 row_newbcast:11 row_mask:0xf bank_mask:0xf
    v_dot2c_f32_bf16_dpp v19, v52, v51 row_newbcast:11 row_mask:0xf bank_mask:0xf
    s_add_u32 s6, s56, 880640
    s_and_b32 s6, s6, 0xfffff
    s_cmp_lt_u32 s3, 4
    s_cbranch_scc0 W_251
    s_waitcnt vmcnt(5)
W_251:
    buffer_load_dwordx4 a[220:223], v1, s[12:15], s6 offen nt
    s_waitcnt vmcnt(12)
    v_accvgpr_read_b32 v48, a176
    v_accvgpr_read_b32 v49, a177
    v_accvgpr_read_b32 v50, a178
    v_accvgpr_read_b32 v51, a179
    v_dot2c_f32_bf16_dpp v12, v32, v48 row_newbcast:12 row_mask:0xf bank_mask:0xf
    v_dot2c_f32_bf16_dpp v13, v52, v48 row_newbcast:12 row_mask:0xf bank_mask:0xf
    v_dot2c_f32_bf16_dpp v14, v32, v49 row_newbcast:12 row_mask:0xf bank_mask:0xf
    v_dot2c_f32_bf16_dpp v15, v52, v49 row_newbcast:12 row_mask:0xf bank_mask:0xf
    v_dot2c_f32_bf16_dpp v16, v32, v50 row_newbcast:12 row_mask:0xf bank_mask:0xf
    v_dot2c_f32_bf16_dpp v17, v52, v50 row_newbcast:12 row_mask:0xf bank_mask:0xf
    v_dot2c_f32_bf16_dpp v18, v32, v51 row_newbcast:12 row_mask:0xf bank_mask:0xf
    v_dot2c_f32_bf16_dpp v19, v52, v51 row_newbcast:12 row_mask:0xf bank_mask:0xf
    s_add_u32 s6, s56, 884736
    s_and_b32 s6, s6, 0xfffff
    s_cmp_lt_u32 s3, 4
    s_cbranch_scc0 W_252
    s_waitcnt vmcnt(4)
W_252:
    buffer_load_dwordx4 a[224:227], v1, s[12:15], s6 offen nt
    s_waitcnt vmcnt(12)
    v_accvgpr_read_b32 v48, a180
    v_accvgpr_read_b32 v49, a181
    v_accvgpr_read_b32 v50, a182
    v_accvgpr_read_b32 v51, a183
    v_dot2c_f32_bf16_dpp v12, v32, v48 row_newbcast:13 row_mask:0xf bank_mask:0xf
    v_dot2c_f32_bf16_dpp v13, v52, v48 row_newbcast:13 row_mask:0xf bank_mask:0xf
    v_dot2c_f32_bf16_dpp v14, v32, v49 row_newbcast:13 row_mask:0xf bank_mask:0xf
    v_dot2c_f32_bf16_dpp v15, v52, v49 row_newbcast:13 row_mask:0xf bank_mask:0xf
    v_dot2c_f32_bf16_dpp v16, v32, v50 row_newbcast:13 row_mask:0xf bank_mask:0xf
    v_dot2c_f32_bf16_dpp v17, v52, v50 row_newbcast:13 row_mask:0xf bank_mask:0xf
    v_dot2c_f32_bf16_dpp v18, v32, v51 row_newbcast:13 row_mask:0xf bank_mask:0xf
    v_dot2c_f32_bf16_dpp v19, v52, v51 row_newbcast:13 row_mask:0xf bank_mask:0xf
    s_add_u32 s6, s56, 888832
    s_and_b32 s6, s6, 0xfffff
    s_cmp_lt_u32 s3, 4
    s_cbranch_scc0 W_253
    s_waitcnt vmcnt(5)
W_253:
    buffer_load_dwordx4 a[228:231], v1, s[12:15], s6 offen nt
    s_waitcnt vmcnt(12)
    v_accvgpr_read_b32 v48, a184
    v_accvgpr_read_b32 v49, a185
    v_accvgpr_read_b32 v50, a186
    v_accvgpr_read_b32 v51, a187
    v_dot2c_f32_bf16_dpp v12, v32, v48 row_newbcast:14 row_mask:0xf bank_mask:0xf
    v_dot2c_f32_bf16_dpp v13, v52, v48 row_newbcast:14 row_mask:0xf bank_mask:0xf
    v_dot2c_f32_bf16_dpp v14, v32, v49 row_newbcast:14 row_mask:0xf bank_mask:0xf
    v_dot2c_f32_bf16_dpp v15, v52, v49 row_newbcast:14 row_mask:0xf bank_mask:0xf
    v_dot2c_f32_bf16_dpp v16, v32, v50 row_newbcast:14 row_mask:0xf bank_mask:0xf
    v_dot2c_f32_bf16_dpp v17, v52, v50 row_newbcast:14 row_mask:0xf bank_mask:0xf
    v_dot2c_f32_bf16_dpp v18, v32, v51 row_newbcast:14 row_mask:0xf bank_mask:0xf
    v_dot2c_f32_bf16_dpp v19, v52, v51 row_newbcast:14 row_mask:0xf bank_mask:0xf
    s_add_u32 s6, s56, 892928
    s_and_b32 s6, s6, 0xfffff
    s_cmp_lt_u32 s3, 4
    s_cbranch_scc0 W_254
    s_waitcnt vmcnt(4)
W_254:
    buffer_load_dwordx4 a[232:235], v1, s[12:15], s6 offen nt
    s_waitcnt vmcnt(12)
    v_accvgpr_read_b32 v48, a188
    v_accvgpr_read_b32 v49, a189
    v_accvgpr_read_b32 v50, a190
    v_accvgpr_read_b32 v51, a191
    v_dot2c_f32_bf16_dpp v12, v32, v48 row_newbcast:15 row_mask:0xf bank_mask:0xf
    v_dot2c_f32_bf16_dpp v13, v52, v48 row_newbcast:15 row_mask:0xf bank_mask:0xf
    v_dot2c_f32_bf16_dpp v14, v32, v49 row_newbcast:15 row_mask:0xf bank_mask:0xf
    v_dot2c_f32_bf16_dpp v15, v52, v49 row_newbcast:15 row_mask:0xf bank_mask:0xf
    v_dot2c_f32_bf16_dpp v16, v32, v50 row_newbcast:15 row_mask:0xf bank_mask:0xf
    v_dot2c_f32_bf16_dpp v17, v52, v50 row_newbcast:15 row_mask:0xf bank_mask:0xf
    v_dot2c_f32_bf16_dpp v18, v32, v51 row_newbcast:15 row_mask:0xf bank_mask:0xf
    v_dot2c_f32_bf16_dpp v19, v52, v51 row_newbcast:15 row_mask:0xf bank_mask:0xf
    s_add_u32 s6, s56, 897024
    s_and_b32 s6, s6, 0xfffff
    s_cmp_lt_u32 s3, 4
    s_cbranch_scc0 W_255
    s_waitcnt vmcnt(5)
W_255:
    buffer_load_dwordx4 a[236:239], v1, s[12:15], s6 offen nt
    v_lshlrev_b32 v54, 16, v33
    s_nop 1
    s_waitcnt vmcnt(12)
    v_accvgpr_read_b32 v48, a192
    v_accvgpr_read_b32 v49, a193
    v_accvgpr_read_b32 v50, a194
    v_accvgpr_read_b32 v51, a195
    v_dot2c_f32_bf16_dpp v12, v33, v48 row_newbcast:0 row_mask:0xf bank_mask:0xf
    v_dot2c_f32_bf16_dpp v13, v54, v48 row_newbcast:0 row_mask:0xf bank_mask:0xf
    v_dot2c_f32_bf16_dpp v14, v33, v49 row_newbcast:0 row_mask:0xf bank_mask:0xf
    v_dot2c_f32_bf16_dpp v15, v54, v49 row_newbcast:0 row_mask:0xf bank_mask:0xf
    v_dot2c_f32_bf16_dpp v16, v33, v50 row_newbcast:0 row_mask:0xf bank_mask:0xf
    v_dot2c_f32_bf16_dpp v17, v54, v50 row_newbcast:0 row_mask:0xf bank_mask:0xf
    v_dot2c_f32_bf16_dpp v18, v33, v51 row_newbcast:0 row_mask:0xf bank_mask:0xf
    v_dot2c_f32_bf16_dpp v19, v54, v51 row_newbcast:0 row_mask:0xf bank_mask:0xf
    s_add_u32 s6, s56, 901120
    s_and_b32 s6, s6, 0xfffff
    s_cmp_lt_u32 s3, 4
    s_cbranch_scc0 W_256
    s_waitcnt vmcnt(4)
W_256:
    buffer_load_dwordx4 a[240:243], v1, s[12:15], s6 offen nt
    s_waitcnt vmcnt(12)
    v_accvgpr_read_b32 v48, a196
    v_accvgpr_read_b32 v49, a197
    v_accvgpr_read_b32 v50, a198
    v_accvgpr_read_b32 v51, a199
    v_dot2c_f32_bf16_dpp v12, v33, v48 row_newbcast:1 row_mask:0xf bank_mask:0xf
    v_dot2c_f32_bf16_dpp v13, v54, v48 row_newbcast:1 row_mask:0xf bank_mask:0xf
    v_dot2c_f32_bf16_dpp v14, v33, v49 row_newbcast:1 row_mask:0xf bank_mask:0xf
    v_dot2c_f32_bf16_dpp v15, v54, v49 row_newbcast:1 row_mask:0xf bank_mask:0xf
    v_dot2c_f32_bf16_dpp v16, v33, v50 row_newbcast:1 row_mask:0xf bank_mask:0xf
    v_dot2c_f32_bf16_dpp v17, v54, v50 row_newbcast:1 row_mask:0xf bank_mask:0xf
    v_dot2c_f32_bf16_dpp v18, v33, v51 row_newbcast:1 row_mask:0xf bank_mask:0xf
    v_dot2c_f32_bf16_dpp v19, v54, v51 row_newbcast:1 row_mask:0xf bank_mask:0xf
    s_add_u32 s6, s56, 905216
    s_and_b32 s6, s6, 0xfffff
    s_cmp_lt_u32 s3, 4
    s_cbranch_scc0 W_257
    s_waitcnt vmcnt(5)
W_257:
    buffer_load_dwordx4 a[244:247], v1, s[12:15], s6 offen nt
    s_waitcnt vmcnt(12)
    v_accvgpr_read_b32 v48, a200
    v_accvgpr_read_b32 v49, a201
    v_accvgpr_read_b32 v50, a202
    v_accvgpr_read_b32 v51, a203
    v_dot2c_f32_bf16_dpp v12, v33, v48 row_newbcast:2 row_mask:0xf bank_mask:0xf
    v_dot2c_f32_bf16_dpp v13, v54, v48 row_newbcast:2 row_mask:0xf bank_mask:0xf
    v_dot2c_f32_bf16_dpp v14, v33, v49 row_newbcast:2 row_mask:0xf bank_mask:0xf
    v_dot2c_f32_bf16_dpp v15, v54, v49 row_newbcast:2 row_mask:0xf bank_mask:0xf
    v_dot2c_f32_bf16_dpp v16, v33, v50 row_newbcast:2 row_mask:0xf bank_mask:0xf
    v_dot2c_f32_bf16_dpp v17, v54, v50 row_newbcast:2 row_mask:0xf bank_mask:0xf
    v_dot2c_f32_bf16_dpp v18, v33, v51 row_newbcast:2 row_mask:0xf bank_mask:0xf
    v_dot2c_f32_bf16_dpp v19, v54, v51 row_newbcast:2 row_mask:0xf bank_mask:0xf
    s_add_u32 s6, s56, 909312
    s_and_b32 s6, s6, 0xfffff
    s_cmp_lt_u32 s3, 4
    s_cbranch_scc0 W_258
    s_waitcnt vmcnt(4)
W_258:
    buffer_load_dwordx4 a[248:251], v1, s[12:15], s6 offen nt
    s_waitcnt vmcnt(12)
    v_accvgpr_read_b32 v48, a204
    v_accvgpr_read_b32 v49, a205
    v_accvgpr_read_b32 v50, a206
    v_accvgpr_read_b32 v51, a207
    v_dot2c_f32_bf16_dpp v12, v33, v48 row_newbcast:3 row_mask:0xf bank_mask:0xf
    v_dot2c_f32_bf16_dpp v13, v54, v48 row_newbcast:3 row_mask:0xf bank_mask:0xf
    v_dot2c_f32_bf16_dpp v14, v33, v49 row_newbcast:3 row_mask:0xf bank_mask:0xf
    v_dot2c_f32_bf16_dpp v15, v54, v49 row_newbcast:3 row_mask:0xf bank_mask:0xf
    v_dot2c_f32_bf16_dpp v16, v33, v50 row_newbcast:3 row_mask:0xf bank_mask:0xf
    v_dot2c_f32_bf16_dpp v17, v54, v50 row_newbcast:3 row_mask:0xf bank_mask:0xf
    v_dot2c_f32_bf16_dpp v18, v33, v51 row_newbcast:3 row_mask:0xf bank_mask:0xf
    v_dot2c_f32_bf16_dpp v19, v54, v51 row_newbcast:3 row_mask:0xf bank_mask:0xf
    s_add_u32 s6, s56, 913408
    s_and_b32 s6, s6, 0xfffff
    s_cmp_lt_u32 s3, 4
    s_cbranch_scc0 W_259
    s_waitcnt vmcnt(5)
W_259:
    buffer_load_dwordx4 a[252:255], v1, s[12:15], s6 offen nt
    s_waitcnt vmcnt(11)
    v_accvgpr_read_b32 v48, a208
    v_accvgpr_read_b32 v49, a209
    v_accvgpr_read_b32 v50, a210
    v_accvgpr_read_b32 v51, a211
    v_dot2c_f32_bf16_dpp v12, v33, v48 row_newbcast:4 row_mask:0xf bank_mask:0xf
    v_dot2c_f32_bf16_dpp v13, v54, v48 row_newbcast:4 row_mask:0xf bank_mask:0xf
    v_dot2c_f32_bf16_dpp v14, v33, v49 row_newbcast:4 row_mask:0xf bank_mask:0xf
    v_dot2c_f32_bf16_dpp v15, v54, v49 row_newbcast:4 row_mask:0xf bank_mask:0xf
    v_dot2c_f32_bf16_dpp v16, v33, v50 row_newbcast:4 row_mask:0xf bank_mask:0xf
    v_dot2c_f32_bf16_dpp v17, v54, v50 row_newbcast:4 row_mask:0xf bank_mask:0xf
    v_dot2c_f32_bf16_dpp v18, v33, v51 row_newbcast:4 row_mask:0xf bank_mask:0xf
    v_dot2c_f32_bf16_dpp v19, v54, v51 row_newbcast:4 row_mask:0xf bank_mask:0xf
    s_add_u32 s6, s56, 917504
    s_and_b32 s6, s6, 0xfffff
    buffer_load_dwordx4 v[128:131], v1, s[12:15], s6 offen nt
    s_waitcnt vmcnt(11)
    v_accvgpr_read_b32 v48, a212
    v_accvgpr_read_b32 v49, a213
    v_accvgpr_read_b32 v50, a214
    v_accvgpr_read_b32 v51, a215
    v_dot2c_f32_bf16_dpp v12, v33, v48 row_newbcast:5 row_mask:0xf bank_mask:0xf
    v_dot2c_f32_bf16_dpp v13, v54, v48 row_newbcast:5 row_mask:0xf bank_mask:0xf
    v_dot2c_f32_bf16_dpp v14, v33, v49 row_newbcast:5 row_mask:0xf bank_mask:0xf
    v_dot2c_f32_bf16_dpp v15, v54, v49 row_newbcast:5 row_mask:0xf bank_mask:0xf
    v_dot2c_f32_bf16_dpp v16, v33, v50 row_newbcast:5 row_mask:0xf bank_mask:0xf
    v_dot2c_f32_bf16_dpp v17, v54, v50 row_newbcast:5 row_mask:0xf bank_mask:0xf
    v_dot2c_f32_bf16_dpp v18, v33, v51 row_newbcast:5 row_mask:0xf bank_mask:0xf
    v_dot2c_f32_bf16_dpp v19, v54, v51 row_newbcast:5 row_mask:0xf bank_mask:0xf
    s_add_u32 s6, s56, 921600
    s_and_b32 s6, s6, 0xfffff
    buffer_load_dwordx4 v[132:135], v1, s[12:15], s6 offen nt
    s_waitcnt vmcnt(11)
    v_accvgpr_read_b32 v48, a216
    v_accvgpr_read_b32 v49, a217
    v_accvgpr_read_b32 v50, a218
    v_accvgpr_read_b32 v51, a219
    v_dot2c_f32_bf16_dpp v12, v33, v48 row_newbcast:6 row_mask:0xf bank_mask:0xf
    v_dot2c_f32_bf16_dpp v13, v54, v48 row_newbcast:6 row_mask:0xf bank_mask:0xf
    v_dot2c_f32_bf16_dpp v14, v33, v49 row_newbcast:6 row_mask:0xf bank_mask:0xf
    v_dot2c_f32_bf16_dpp v15, v54, v49 row_newbcast:6 row_mask:0xf bank_mask:0xf
    v_dot2c_f32_bf16_dpp v16, v33, v50 row_newbcast:6 row_mask:0xf bank_mask:0xf
    v_dot2c_f32_bf16_dpp v17, v54, v50 row_newbcast:6 row_mask:0xf bank_mask:0xf
    v_dot2c_f32_bf16_dpp v18, v33, v51 row_newbcast:6 row_mask:0xf bank_mask:0xf
    v_dot2c_f32_bf16_dpp v19, v54, v51 row_newbcast:6 row_mask:0xf bank_mask:0xf
    s_add_u32 s6, s56, 925696
    s_and_b32 s6, s6, 0xfffff
    buffer_load_dwordx4 v[136:139], v1, s[12:15], s6 offen nt
    s_waitcnt vmcnt(11)
    v_accvgpr_read_b32 v48, a220
    v_accvgpr_read_b32 v49, a221
    v_accvgpr_read_b32 v50, a222
    v_accvgpr_read_b32 v51, a223
    v_dot2c_f32_bf16_dpp v12, v33, v48 row_newbcast:7 row_mask:0xf bank_mask:0xf
    v_dot2c_f32_bf16_dpp v13, v54, v48 row_newbcast:7 row_mask:0xf bank_mask:0xf
    v_dot2c_f32_bf16_dpp v14, v33, v49 row_newbcast:7 row_mask:0xf bank_mask:0xf
    v_dot2c_f32_bf16_dpp v15, v54, v49 row_newbcast:7 row_mask:0xf bank_mask:0xf
    v_dot2c_f32_bf16_dpp v16, v33, v50 row_newbcast:7 row_mask:0xf bank_mask:0xf
    v_dot2c_f32_bf16_dpp v17, v54, v50 row_newbcast:7 row_mask:0xf bank_mask:0xf
    v_dot2c_f32_bf16_dpp v18, v33, v51 row_newbcast:7 row_mask:0xf bank_mask:0xf
    v_dot2c_f32_bf16_dpp v19, v54, v51 row_newbcast:7 row_mask:0xf bank_mask:0xf
    s_add_u32 s6, s56, 929792
    s_and_b32 s6, s6, 0xfffff
    buffer_load_dwordx4 v[140:143], v1, s[12:15], s6 offen nt
    s_waitcnt vmcnt(11)
    v_accvgpr_read_b32 v48, a224
    v_accvgpr_read_b32 v49, a225
    v_accvgpr_read_b32 v50, a226
    v_accvgpr_read_b32 v51, a227
    v_dot2c_f32_bf16_dpp v12, v33, v48 row_newbcast:8 row_mask:0xf bank_mask:0xf
    v_dot2c_f32_bf16_dpp v13, v54, v48 row_newbcast:8 row_mask:0xf bank_mask:0xf
    v_dot2c_f32_bf16_dpp v14, v33, v49 row_newbcast:8 row_mask:0xf bank_mask:0xf
    v_dot2c_f32_bf16_dpp v15, v54, v49 row_newbcast:8 row_mask:0xf bank_mask:0xf
    v_dot2c_f32_bf16_dpp v16, v33, v50 row_newbcast:8 row_mask:0xf bank_mask:0xf
    v_dot2c_f32_bf16_dpp v17, v54, v50 row_newbcast:8 row_mask:0xf bank_mask:0xf
    v_dot2c_f32_bf16_dpp v18, v33, v51 row_newbcast:8 row_mask:0xf bank_mask:0xf
    v_dot2c_f32_bf16_dpp v19, v54, v51 row_newbcast:8 row_mask:0xf bank_mask:0xf
    s_add_u32 s6, s56, 933888
    s_and_b32 s6, s6, 0xfffff
    buffer_load_dwordx4 v[144:147], v1, s[12:15], s6 offen nt
    s_waitcnt vmcnt(11)
    v_accvgpr_read_b32 v48, a228
    v_accvgpr_read_b32 v49, a229
    v_accvgpr_read_b32 v50, a230
    v_accvgpr_read_b32 v51, a231
    v_dot2c_f32_bf16_dpp v12, v33, v48 row_newbcast:9 row_mask:0xf bank_mask:0xf
    v_dot2c_f32_bf16_dpp v13, v54, v48 row_newbcast:9 row_mask:0xf bank_mask:0xf
    v_dot2c_f32_bf16_dpp v14, v33, v49 row_newbcast:9 row_mask:0xf bank_mask:0xf
    v_dot2c_f32_bf16_dpp v15, v54, v49 row_newbcast:9 row_mask:0xf bank_mask:0xf
    v_dot2c_f32_bf16_dpp v16, v33, v50 row_newbcast:9 row_mask:0xf bank_mask:0xf
    v_dot2c_f32_bf16_dpp v17, v54, v50 row_newbcast:9 row_mask:0xf bank_mask:0xf
    v_dot2c_f32_bf16_dpp v18, v33, v51 row_newbcast:9 row_mask:0xf bank_mask:0xf
    v_dot2c_f32_bf16_dpp v19, v54, v51 row_newbcast:9 row_mask:0xf bank_mask:0xf
    s_add_u32 s6, s56, 937984
    s_and_b32 s6, s6, 0xfffff
    buffer_load_dwordx4 v[148:151], v1, s[12:15], s6 offen nt
    s_waitcnt vmcnt(11)
    v_accvgpr_read_b32 v48, a232
    v_accvgpr_read_b32 v49, a233
    v_accvgpr_read_b32 v50, a234
    v_accvgpr_read_b32 v51, a235
    v_dot2c_f32_bf16_dpp v12, v33, v48 row_newbcast:10 row_mask:0xf bank_mask:0xf
    v_dot2c_f32_bf16_dpp v13, v54, v48 row_newbcast:10 row_mask:0xf bank_mask:0xf
    v_dot2c_f32_bf16_dpp v14, v33, v49 row_newbcast:10 row_mask:0xf bank_mask:0xf
    v_dot2c_f32_bf16_dpp v15, v54, v49 row_newbcast:10 row_mask:0xf bank_mask:0xf
    v_dot2c_f32_bf16_dpp v16, v33, v50 row_newbcast:10 row_mask:0xf bank_mask:0xf
    v_dot2c_f32_bf16_dpp v17, v54, v50 row_newbcast:10 row_mask:0xf bank_mask:0xf
    v_dot2c_f32_bf16_dpp v18, v33, v51 row_newbcast:10 row_mask:0xf bank_mask:0xf
    v_dot2c_f32_bf16_dpp v19, v54, v51 row_newbcast:10 row_mask:0xf bank_mask:0xf
    s_add_u32 s6, s56, 942080
    s_and_b32 s6, s6, 0xfffff
    buffer_load_dwordx4 v[152:155], v1, s[12:15], s6 offen nt
    s_waitcnt vmcnt(11)
    v_accvgpr_read_b32 v48, a236
    v_accvgpr_read_b32 v49, a237
    v_accvgpr_read_b32 v50, a238
    v_accvgpr_read_b32 v51, a239
    v_dot2c_f32_bf16_dpp v12, v33, v48 row_newbcast:11 row_mask:0xf bank_mask:0xf
    v_dot2c_f32_bf16_dpp v13, v54, v48 row_newbcast:11 row_mask:0xf bank_mask:0xf
    v_dot2c_f32_bf16_dpp v14, v33, v49 row_newbcast:11 row_mask:0xf bank_mask:0xf
    v_dot2c_f32_bf16_dpp v15, v54, v49 row_newbcast:11 row_mask:0xf bank_mask:0xf
    v_dot2c_f32_bf16_dpp v16, v33, v50 row_newbcast:11 row_mask:0xf bank_mask:0xf
    v_dot2c_f32_bf16_dpp v17, v54, v50 row_newbcast:11 row_mask:0xf bank_mask:0xf
    v_dot2c_f32_bf16_dpp v18, v33, v51 row_newbcast:11 row_mask:0xf bank_mask:0xf
    v_dot2c_f32_bf16_dpp v19, v54, v51 row_newbcast:11 row_mask:0xf bank_mask:0xf
    s_add_u32 s6, s56, 946176
    s_and_b32 s6, s6, 0xfffff
    buffer_load_dwordx4 v[156:159], v1, s[12:15], s6 offen nt
    s_waitcnt vmcnt(11)
    v_accvgpr_read_b32 v48, a240
    v_accvgpr_read_b32 v49, a241
    v_accvgpr_read_b32 v50, a242
    v_accvgpr_read_b32 v51, a243
    v_dot2c_f32_bf16_dpp v12, v33, v48 row_newbcast:12 row_mask:0xf bank_mask:0xf
    v_dot2c_f32_bf16_dpp v13, v54, v48 row_newbcast:12 row_mask:0xf bank_mask:0xf
    v_dot2c_f32_bf16_dpp v14, v33, v49 row_newbcast:12 row_mask:0xf bank_mask:0xf
    v_dot2c_f32_bf16_dpp v15, v54, v49 row_newbcast:12 row_mask:0xf bank_mask:0xf
    v_dot2c_f32_bf16_dpp v16, v33, v50 row_newbcast:12 row_mask:0xf bank_mask:0xf
    v_dot2c_f32_bf16_dpp v17, v54, v50 row_newbcast:12 row_mask:0xf bank_mask:0xf
    v_dot2c_f32_bf16_dpp v18, v33, v51 row_newbcast:12 row_mask:0xf bank_mask:0xf
    v_dot2c_f32_bf16_dpp v19, v54, v51 row_newbcast:12 row_mask:0xf bank_mask:0xf
    s_add_u32 s6, s56, 950272
    s_and_b32 s6, s6, 0xfffff
    buffer_load_dwordx4 v[160:163], v1, s[12:15], s6 offen nt
    s_waitcnt vmcnt(11)
    v_accvgpr_read_b32 v48, a244
    v_accvgpr_read_b32 v49, a245
    v_accvgpr_read_b32 v50, a246
    v_accvgpr_read_b32 v51, a247
    v_dot2c_f32_bf16_dpp v12, v33, v48 row_newbcast:13 row_mask:0xf bank_mask:0xf
    v_dot2c_f32_bf16_dpp v13, v54, v48 row_newbcast:13 row_mask:0xf bank_mask:0xf
    v_dot2c_f32_bf16_dpp v14, v33, v49 row_newbcast:13 row_mask:0xf bank_mask:0xf
    v_dot2c_f32_bf16_dpp v15, v54, v49 row_newbcast:13 row_mask:0xf bank_mask:0xf
    v_dot2c_f32_bf16_dpp v16, v33, v50 row_newbcast:13 row_mask:0xf bank_mask:0xf
    v_dot2c_f32_bf16_dpp v17, v54, v50 row_newbcast:13 row_mask:0xf bank_mask:0xf
    v_dot2c_f32_bf16_dpp v18, v33, v51 row_newbcast:13 row_mask:0xf bank_mask:0xf
    v_dot2c_f32_bf16_dpp v19, v54, v51 row_newbcast:13 row_mask:0xf bank_mask:0xf
    s_add_u32 s6, s56, 954368
    s_and_b32 s6, s6, 0xfffff
    buffer_load_dwordx4 v[164:167], v1, s[12:15], s6 offen nt
    s_waitcnt vmcnt(11)
    v_accvgpr_read_b32 v48, a248
    v_accvgpr_read_b32 v49, a249
    v_accvgpr_read_b32 v50, a250
    v_accvgpr_read_b32 v51, a251
    v_dot2c_f32_bf16_dpp v12, v33, v48 row_newbcast:14 row_mask:0xf bank_mask:0xf
    v_dot2c_f32_bf16_dpp v13, v54, v48 row_newbcast:14 row_mask:0xf bank_mask:0xf
    v_dot2c_f32_bf16_dpp v14, v33, v49 row_newbcast:14 row_mask:0xf bank_mask:0xf
    v_dot2c_f32_bf16_dpp v15, v54, v49 row_newbcast:14 row_mask:0xf bank_mask:0xf
    v_dot2c_f32_bf16_dpp v16, v33, v50 row_newbcast:14 row_mask:0xf bank_mask:0xf
    v_dot2c_f32_bf16_dpp v17, v54, v50 row_newbcast:14 row_mask:0xf bank_mask:0xf
    v_dot2c_f32_bf16_dpp v18, v33, v51 row_newbcast:14 row_mask:0xf bank_mask:0xf
    v_dot2c_f32_bf16_dpp v19, v54, v51 row_newbcast:14 row_mask:0xf bank_mask:0xf
    s_add_u32 s6, s56, 958464
    s_and_b32 s6, s6, 0xfffff
    buffer_load_dwordx4 v[168:171], v1, s[12:15], s6 offen nt
    s_waitcnt vmcnt(11)
    v_accvgpr_read_b32 v48, a252
    v_accvgpr_read_b32 v49, a253
    v_accvgpr_read_b32 v50, a254
    v_accvgpr_read_b32 v51, a255
    v_dot2c_f32_bf16_dpp v12, v33, v48 row_newbcast:15 row_mask:0xf bank_mask:0xf
    v_dot2c_f32_bf16_dpp v13, v54, v48 row_newbcast:15 row_mask:0xf bank_mask:0xf
    v_dot2c_f32_bf16_dpp v14, v33, v49 row_newbcast:15 row_mask:0xf bank_mask:0xf
    v_dot2c_f32_bf16_dpp v15, v54, v49 row_newbcast:15 row_mask:0xf bank_mask:0xf
    v_dot2c_f32_bf16_dpp v16, v33, v50 row_newbcast:15 row_mask:0xf bank_mask:0xf
    v_dot2c_f32_bf16_dpp v17, v54, v50 row_newbcast:15 row_mask:0xf bank_mask:0xf
    v_dot2c_f32_bf16_dpp v18, v33, v51 row_newbcast:15 row_mask:0xf bank_mask:0xf
    v_dot2c_f32_bf16_dpp v19, v54, v51 row_newbcast:15 row_mask:0xf bank_mask:0xf
    s_add_u32 s6, s56, 962560
    s_and_b32 s6, s6, 0xfffff
    buffer_load_dwordx4 v[172:175], v1, s[12:15], s6 offen nt
    v_lshlrev_b32 v52, 16, v34
    s_nop 1
    s_waitcnt vmcnt(11)
    v_dot2c_f32_bf16_dpp v12, v34, v128 row_newbcast:0 row_mask:0xf bank_mask:0xf
    v_dot2c_f32_bf16_dpp v13, v52, v128 row_newbcast:0 row_mask:0xf bank_mask:0xf
    v_dot2c_f32_bf16_dpp v14, v34, v129 row_newbcast:0 row_mask:0xf bank_mask:0xf
    v_dot2c_f32_bf16_dpp v15, v52, v129 row_newbcast:0 row_mask:0xf bank_mask:0xf
    v_dot2c_f32_bf16_dpp v16, v34, v130 row_newbcast:0 row_mask:0xf bank_mask:0xf
    v_dot2c_f32_bf16_dpp v17, v52, v130 row_newbcast:0 row_mask:0xf bank_mask:0xf
    v_dot2c_f32_bf16_dpp v18, v34, v131 row_newbcast:0 row_mask:0xf bank_mask:0xf
    v_dot2c_f32_bf16_dpp v19, v52, v131 row_newbcast:0 row_mask:0xf bank_mask:0xf
    s_add_u32 s6, s56, 966656
    s_and_b32 s6, s6, 0xfffff
    buffer_load_dwordx4 v[176:179], v1, s[12:15], s6 offen nt
    s_waitcnt vmcnt(11)
    v_dot2c_f32_bf16_dpp v12, v34, v132 row_newbcast:1 row_mask:0xf bank_mask:0xf
    v_dot2c_f32_bf16_dpp v13, v52, v132 row_newbcast:1 row_mask:0xf bank_mask:0xf
    v_dot2c_f32_bf16_dpp v14, v34, v133 row_newbcast:1 row_mask:0xf bank_mask:0xf
    v_dot2c_f32_bf16_dpp v15, v52, v133 row_newbcast:1 row_mask:0xf bank_mask:0xf
    v_dot2c_f32_bf16_dpp v16, v34, v134 row_newbcast:1 row_mask:0xf bank_mask:0xf
    v_dot2c_f32_bf16_dpp v17, v52, v134 row_newbcast:1 row_mask:0xf bank_mask:0xf
    v_dot2c_f32_bf16_dpp v18, v34, v135 row_newbcast:1 row_mask:0xf bank_mask:0xf
    v_dot2c_f32_bf16_dpp v19, v52, v135 row_newbcast:1 row_mask:0xf bank_mask:0xf
    s_add_u32 s6, s56, 970752
    s_and_b32 s6, s6, 0xfffff
    buffer_load_dwordx4 v[180:183], v1, s[12:15], s6 offen nt
    s_waitcnt vmcnt(11)
    v_dot2c_f32_bf16_dpp v12, v34, v136 row_newbcast:2 row_mask:0xf bank_mask:0xf
    v_dot2c_f32_bf16_dpp v13, v52, v136 row_newbcast:2 row_mask:0xf bank_mask:0xf
    v_dot2c_f32_bf16_dpp v14, v34, v137 row_newbcast:2 row_mask:0xf bank_mask:0xf
    v_dot2c_f32_bf16_dpp v15, v52, v137 row_newbcast:2 row_mask:0xf bank_mask:0xf
    v_dot2c_f32_bf16_dpp v16, v34, v138 row_newbcast:2 row_mask:0xf bank_mask:0xf
    v_dot2c_f32_bf16_dpp v17, v52, v138 row_newbcast:2 row_mask:0xf bank_mask:0xf
    v_dot2c_f32_bf16_dpp v18, v34, v139 row_newbcast:2 row_mask:0xf bank_mask:0xf
    v_dot2c_f32_bf16_dpp v19, v52, v139 row_newbcast:2 row_mask:0xf bank_mask:0xf
    s_add_u32 s6, s56, 974848
    s_and_b32 s6, s6, 0xfffff
    buffer_load_dwordx4 v[184:187], v1, s[12:15], s6 offen nt
    s_waitcnt vmcnt(11)
    v_dot2c_f32_bf16_dpp v12, v34, v140 row_newbcast:3 row_mask:0xf bank_mask:0xf
    v_dot2c_f32_bf16_dpp v13, v52, v140 row_newbcast:3 row_mask:0xf bank_mask:0xf
    v_dot2c_f32_bf16_dpp v14, v34, v141 row_newbcast:3 row_mask:0xf bank_mask:0xf
    v_dot2c_f32_bf16_dpp v15, v52, v141 row_newbcast:3 row_mask:0xf bank_mask:0xf
    v_dot2c_f32_bf16_dpp v16, v34, v142 row_newbcast:3 row_mask:0xf bank_mask:0xf
    v_dot2c_f32_bf16_dpp v17, v52, v142 row_newbcast:3 row_mask:0xf bank_mask:0xf
    v_dot2c_f32_bf16_dpp v18, v34, v143 row_newbcast:3 row_mask:0xf bank_mask:0xf
    v_dot2c_f32_bf16_dpp v19, v52, v143 row_newbcast:3 row_mask:0xf bank_mask:0xf
    s_add_u32 s6, s56, 978944
    s_and_b32 s6, s6, 0xfffff
    buffer_load_dwordx4 v[188:191], v1, s[12:15], s6 offen nt
    s_waitcnt vmcnt(11)
    v_dot2c_f32_bf16_dpp v12, v34, v144 row_newbcast:4 row_mask:0xf bank_mask:0xf
    v_dot2c_f32_bf16_dpp v13, v52, v144 row_newbcast:4 row_mask:0xf bank_mask:0xf
    v_dot2c_f32_bf16_dpp v14, v34, v145 row_newbcast:4 row_mask:0xf bank_mask:0xf
    v_dot2c_f32_bf16_dpp v15, v52, v145 row_newbcast:4 row_mask:0xf bank_mask:0xf
    v_dot2c_f32_bf16_dpp v16, v34, v146 row_newbcast:4 row_mask:0xf bank_mask:0xf
    v_dot2c_f32_bf16_dpp v17, v52, v146 row_newbcast:4 row_mask:0xf bank_mask:0xf
    v_dot2c_f32_bf16_dpp v18, v34, v147 row_newbcast:4 row_mask:0xf bank_mask:0xf
    v_dot2c_f32_bf16_dpp v19, v52, v147 row_newbcast:4 row_mask:0xf bank_mask:0xf
    s_add_u32 s6, s56, 983040
    s_and_b32 s6, s6, 0xfffff
    buffer_load_dwordx4 v[192:195], v1, s[12:15], s6 offen nt
    s_waitcnt vmcnt(11)
    v_dot2c_f32_bf16_dpp v12, v34, v148 row_newbcast:5 row_mask:0xf bank_mask:0xf
    v_dot2c_f32_bf16_dpp v13, v52, v148 row_newbcast:5 row_mask:0xf bank_mask:0xf
    v_dot2c_f32_bf16_dpp v14, v34, v149 row_newbcast:5 row_mask:0xf bank_mask:0xf
    v_dot2c_f32_bf16_dpp v15, v52, v149 row_newbcast:5 row_mask:0xf bank_mask:0xf
    v_dot2c_f32_bf16_dpp v16, v34, v150 row_newbcast:5 row_mask:0xf bank_mask:0xf
    v_dot2c_f32_bf16_dpp v17, v52, v150 row_newbcast:5 row_mask:0xf bank_mask:0xf
    v_dot2c_f32_bf16_dpp v18, v34, v151 row_newbcast:5 row_mask:0xf bank_mask:0xf
    v_dot2c_f32_bf16_dpp v19, v52, v151 row_newbcast:5 row_mask:0xf bank_mask:0xf
    s_add_u32 s6, s56, 987136
    s_and_b32 s6, s6, 0xfffff
    buffer_load_dwordx4 v[196:199], v1, s[12:15], s6 offen nt
    s_waitcnt vmcnt(11)
    v_dot2c_f32_bf16_dpp v12, v34, v152 row_newbcast:6 row_mask:0xf bank_mask:0xf
    v_dot2c_f32_bf16_dpp v13, v52, v152 row_newbcast:6 row_mask:0xf bank_mask:0xf
    v_dot2c_f32_bf16_dpp v14, v34, v153 row_newbcast:6 row_mask:0xf bank_mask:0xf
    v_dot2c_f32_bf16_dpp v15, v52, v153 row_newbcast:6 row_mask:0xf bank_mask:0xf
    v_dot2c_f32_bf16_dpp v16, v34, v154 row_newbcast:6 row_mask:0xf bank_mask:0xf
    v_dot2c_f32_bf16_dpp v17, v52, v154 row_newbcast:6 row_mask:0xf bank_mask:0xf
    v_dot2c_f32_bf16_dpp v18, v34, v155 row_newbcast:6 row_mask:0xf bank_mask:0xf
    v_dot2c_f32_bf16_dpp v19, v52, v155 row_newbcast:6 row_mask:0xf bank_mask:0xf
    s_add_u32 s6, s56, 991232
    s_and_b32 s6, s6, 0xfffff
    buffer_load_dwordx4 v[200:203], v1, s[12:15], s6 offen nt
    s_waitcnt vmcnt(11)
    v_dot2c_f32_bf16_dpp v12, v34, v156 row_newbcast:7 row_mask:0xf bank_mask:0xf
    v_dot2c_f32_bf16_dpp v13, v52, v156 row_newbcast:7 row_mask:0xf bank_mask:0xf
    v_dot2c_f32_bf16_dpp v14, v34, v157 row_newbcast:7 row_mask:0xf bank_mask:0xf
    v_dot2c_f32_bf16_dpp v15, v52, v157 row_newbcast:7 row_mask:0xf bank_mask:0xf
    v_dot2c_f32_bf16_dpp v16, v34, v158 row_newbcast:7 row_mask:0xf bank_mask:0xf
    v_dot2c_f32_bf16_dpp v17, v52, v158 row_newbcast:7 row_mask:0xf bank_mask:0xf
    v_dot2c_f32_bf16_dpp v18, v34, v159 row_newbcast:7 row_mask:0xf bank_mask:0xf
    v_dot2c_f32_bf16_dpp v19, v52, v159 row_newbcast:7 row_mask:0xf bank_mask:0xf
    s_add_u32 s6, s56, 995328
    s_and_b32 s6, s6, 0xfffff
    buffer_load_dwordx4 v[204:207], v1, s[12:15], s6 offen nt
    s_waitcnt vmcnt(11)
    v_dot2c_f32_bf16_dpp v12, v34, v160 row_newbcast:8 row_mask:0xf bank_mask:0xf
    v_dot2c_f32_bf16_dpp v13, v52, v160 row_newbcast:8 row_mask:0xf bank_mask:0xf
    v_dot2c_f32_bf16_dpp v14, v34, v161 row_newbcast:8 row_mask:0xf bank_mask:0xf
    v_dot2c_f32_bf16_dpp v15, v52, v161 row_newbcast:8 row_mask:0xf bank_mask:0xf
    v_dot2c_f32_bf16_dpp v16, v34, v162 row_newbcast:8 row_mask:0xf bank_mask:0xf
    v_dot2c_f32_bf16_dpp v17, v52, v162 row_newbcast:8 row_mask:0xf bank_mask:0xf
    v_dot2c_f32_bf16_dpp v18, v34, v163 row_newbcast:8 row_mask:0xf bank_mask:0xf
    v_dot2c_f32_bf16_dpp v19, v52, v163 row_newbcast:8 row_mask:0xf bank_mask:0xf
    s_add_u32 s6, s56, 999424
    s_and_b32 s6, s6, 0xfffff
    buffer_load_dwordx4 v[208:211], v1, s[12:15], s6 offen nt
    s_waitcnt vmcnt(11)
    v_dot2c_f32_bf16_dpp v12, v34, v164 row_newbcast:9 row_mask:0xf bank_mask:0xf
    v_dot2c_f32_bf16_dpp v13, v52, v164 row_newbcast:9 row_mask:0xf bank_mask:0xf
    v_dot2c_f32_bf16_dpp v14, v34, v165 row_newbcast:9 row_mask:0xf bank_mask:0xf
    v_dot2c_f32_bf16_dpp v15, v52, v165 row_newbcast:9 row_mask:0xf bank_mask:0xf
    v_dot2c_f32_bf16_dpp v16, v34, v166 row_newbcast:9 row_mask:0xf bank_mask:0xf
    v_dot2c_f32_bf16_dpp v17, v52, v166 row_newbcast:9 row_mask:0xf bank_mask:0xf
    v_dot2c_f32_bf16_dpp v18, v34, v167 row_newbcast:9 row_mask:0xf bank_mask:0xf
    v_dot2c_f32_bf16_dpp v19, v52, v167 row_newbcast:9 row_mask:0xf bank_mask:0xf
    s_add_u32 s6, s56, 1003520
    s_and_b32 s6, s6, 0xfffff
    buffer_load_dwordx4 v[212:215], v1, s[12:15], s6 offen nt
    s_waitcnt vmcnt(11)
    v_dot2c_f32_bf16_dpp v12, v34, v168 row_newbcast:10 row_mask:0xf bank_mask:0xf
    v_dot2c_f32_bf16_dpp v13, v52, v168 row_newbcast:10 row_mask:0xf bank_mask:0xf
    v_dot2c_f32_bf16_dpp v14, v34, v169 row_newbcast:10 row_mask:0xf bank_mask:0xf
    v_dot2c_f32_bf16_dpp v15, v52, v169 row_newbcast:10 row_mask:0xf bank_mask:0xf
    v_dot2c_f32_bf16_dpp v16, v34, v170 row_newbcast:10 row_mask:0xf bank_mask:0xf
    v_dot2c_f32_bf16_dpp v17, v52, v170 row_newbcast:10 row_mask:0xf bank_mask:0xf
    v_dot2c_f32_bf16_dpp v18, v34, v171 row_newbcast:10 row_mask:0xf bank_mask:0xf
    v_dot2c_f32_bf16_dpp v19, v52, v171 row_newbcast:10 row_mask:0xf bank_mask:0xf
    s_add_u32 s6, s56, 1007616
    s_and_b32 s6, s6, 0xfffff
    buffer_load_dwordx4 v[216:219], v1, s[12:15], s6 offen nt
    s_waitcnt vmcnt(11)
    v_dot2c_f32_bf16_dpp v12, v34, v172 row_newbcast:11 row_mask:0xf bank_mask:0xf
    v_dot2c_f32_bf16_dpp v13, v52, v172 row_newbcast:11 row_mask:0xf bank_mask:0xf
    v_dot2c_f32_bf16_dpp v14, v34, v173 row_newbcast:11 row_mask:0xf bank_mask:0xf
    v_dot2c_f32_bf16_dpp v15, v52, v173 row_newbcast:11 row_mask:0xf bank_mask:0xf
    v_dot2c_f32_bf16_dpp v16, v34, v174 row_newbcast:11 row_mask:0xf bank_mask:0xf
    v_dot2c_f32_bf16_dpp v17, v52, v174 row_newbcast:11 row_mask:0xf bank_mask:0xf
    v_dot2c_f32_bf16_dpp v18, v34, v175 row_newbcast:11 row_mask:0xf bank_mask:0xf
    v_dot2c_f32_bf16_dpp v19, v52, v175 row_newbcast:11 row_mask:0xf bank_mask:0xf
    s_add_u32 s6, s56, 1011712
    s_and_b32 s6, s6, 0xfffff
    buffer_load_dwordx4 v[220:223], v1, s[12:15], s6 offen nt
    s_waitcnt vmcnt(11)
    v_dot2c_f32_bf16_dpp v12, v34, v176 row_newbcast:12 row_mask:0xf bank_mask:0xf
    v_dot2c_f32_bf16_dpp v13, v52, v176 row_newbcast:12 row_mask:0xf bank_mask:0xf
    v_dot2c_f32_bf16_dpp v14, v34, v177 row_newbcast:12 row_mask:0xf bank_mask:0xf
    v_dot2c_f32_bf16_dpp v15, v52, v177 row_newbcast:12 row_mask:0xf bank_mask:0xf
    v_dot2c_f32_bf16_dpp v16, v34, v178 row_newbcast:12 row_mask:0xf bank_mask:0xf
    v_dot2c_f32_bf16_dpp v17, v52, v178 row_newbcast:12 row_mask:0xf bank_mask:0xf
    v_dot2c_f32_bf16_dpp v18, v34, v179 row_newbcast:12 row_mask:0xf bank_mask:0xf
    v_dot2c_f32_bf16_dpp v19, v52, v179 row_newbcast:12 row_mask:0xf bank_mask:0xf
    s_add_u32 s6, s56, 1015808
    s_and_b32 s6, s6, 0xfffff
    buffer_load_dwordx4 v[224:227], v1, s[12:15], s6 offen nt
    s_waitcnt vmcnt(11)
    v_dot2c_f32_bf16_dpp v12, v34, v180 row_newbcast:13 row_mask:0xf bank_mask:0xf
    v_dot2c_f32_bf16_dpp v13, v52, v180 row_newbcast:13 row_mask:0xf bank_mask:0xf
    v_dot2c_f32_bf16_dpp v14, v34, v181 row_newbcast:13 row_mask:0xf bank_mask:0xf
    v_dot2c_f32_bf16_dpp v15, v52, v181 row_newbcast:13 row_mask:0xf bank_mask:0xf
    v_dot2c_f32_bf16_dpp v16, v34, v182 row_newbcast:13 row_mask:0xf bank_mask:0xf
    v_dot2c_f32_bf16_dpp v17, v52, v182 row_newbcast:13 row_mask:0xf bank_mask:0xf
    v_dot2c_f32_bf16_dpp v18, v34, v183 row_newbcast:13 row_mask:0xf bank_mask:0xf
    v_dot2c_f32_bf16_dpp v19, v52, v183 row_newbcast:13 row_mask:0xf bank_mask:0xf
    s_add_u32 s6, s56, 1019904
    s_and_b32 s6, s6, 0xfffff
    buffer_load_dwordx4 v[228:231], v1, s[12:15], s6 offen nt
    s_waitcnt vmcnt(11)
    v_dot2c_f32_bf16_dpp v12, v34, v184 row_newbcast:14 row_mask:0xf bank_mask:0xf
    v_dot2c_f32_bf16_dpp v13, v52, v184 row_newbcast:14 row_mask:0xf bank_mask:0xf
    v_dot2c_f32_bf16_dpp v14, v34, v185 row_newbcast:14 row_mask:0xf bank_mask:0xf
    v_dot2c_f32_bf16_dpp v15, v52, v185 row_newbcast:14 row_mask:0xf bank_mask:0xf
    v_dot2c_f32_bf16_dpp v16, v34, v186 row_newbcast:14 row_mask:0xf bank_mask:0xf
    v_dot2c_f32_bf16_dpp v17, v52, v186 row_newbcast:14 row_mask:0xf bank_mask:0xf
    v_dot2c_f32_bf16_dpp v18, v34, v187 row_newbcast:14 row_mask:0xf bank_mask:0xf
    v_dot2c_f32_bf16_dpp v19, v52, v187 row_newbcast:14 row_mask:0xf bank_mask:0xf
    s_add_u32 s6, s56, 1024000
    s_and_b32 s6, s6, 0xfffff
    buffer_load_dwordx4 v[232:235], v1, s[12:15], s6 offen nt
    s_waitcnt vmcnt(11)
    v_dot2c_f32_bf16_dpp v12, v34, v188 row_newbcast:15 row_mask:0xf bank_mask:0xf
    v_dot2c_f32_bf16_dpp v13, v52, v188 row_newbcast:15 row_mask:0xf bank_mask:0xf
    v_dot2c_f32_bf16_dpp v14, v34, v189 row_newbcast:15 row_mask:0xf bank_mask:0xf
    v_dot2c_f32_bf16_dpp v15, v52, v189 row_newbcast:15 row_mask:0xf bank_mask:0xf
    v_dot2c_f32_bf16_dpp v16, v34, v190 row_newbcast:15 row_mask:0xf bank_mask:0xf
    v_dot2c_f32_bf16_dpp v17, v52, v190 row_newbcast:15 row_mask:0xf bank_mask:0xf
    v_dot2c_f32_bf16_dpp v18, v34, v191 row_newbcast:15 row_mask:0xf bank_mask:0xf
    v_dot2c_f32_bf16_dpp v19, v52, v191 row_newbcast:15 row_mask:0xf bank_mask:0xf
    s_add_u32 s6, s56, 1028096
    s_and_b32 s6, s6, 0xfffff
    buffer_load_dwordx4 v[236:239], v1, s[12:15], s6 offen nt
    v_lshlrev_b32 v54, 16, v35
    s_nop 1
    s_waitcnt vmcnt(11)
    v_dot2c_f32_bf16_dpp v12, v35, v192 row_newbcast:0 row_mask:0xf bank_mask:0xf
    v_dot2c_f32_bf16_dpp v13, v54, v192 row_newbcast:0 row_mask:0xf bank_mask:0xf
    v_dot2c_f32_bf16_dpp v14, v35, v193 row_newbcast:0 row_mask:0xf bank_mask:0xf
    v_dot2c_f32_bf16_dpp v15, v54, v193 row_newbcast:0 row_mask:0xf bank_mask:0xf
    v_dot2c_f32_bf16_dpp v16, v35, v194 row_newbcast:0 row_mask:0xf bank_mask:0xf
    v_dot2c_f32_bf16_dpp v17, v54, v194 row_newbcast:0 row_mask:0xf bank_mask:0xf
    v_dot2c_f32_bf16_dpp v18, v35, v195 row_newbcast:0 row_mask:0xf bank_mask:0xf
    v_dot2c_f32_bf16_dpp v19, v54, v195 row_newbcast:0 row_mask:0xf bank_mask:0xf
    s_add_u32 s6, s56, 1032192
    s_and_b32 s6, s6, 0xfffff
    buffer_load_dwordx4 v[240:243], v1, s[12:15], s6 offen nt
    s_waitcnt vmcnt(11)
    v_dot2c_f32_bf16_dpp v12, v35, v196 row_newbcast:1 row_mask:0xf bank_mask:0xf
    v_dot2c_f32_bf16_dpp v13, v54, v196 row_newbcast:1 row_mask:0xf bank_mask:0xf
    v_dot2c_f32_bf16_dpp v14, v35, v197 row_newbcast:1 row_mask:0xf bank_mask:0xf
    v_dot2c_f32_bf16_dpp v15, v54, v197 row_newbcast:1 row_mask:0xf bank_mask:0xf
    v_dot2c_f32_bf16_dpp v16, v35, v198 row_newbcast:1 row_mask:0xf bank_mask:0xf
    v_dot2c_f32_bf16_dpp v17, v54, v198 row_newbcast:1 row_mask:0xf bank_mask:0xf
    v_dot2c_f32_bf16_dpp v18, v35, v199 row_newbcast:1 row_mask:0xf bank_mask:0xf
    v_dot2c_f32_bf16_dpp v19, v54, v199 row_newbcast:1 row_mask:0xf bank_mask:0xf
    s_add_u32 s6, s56, 1036288
    s_and_b32 s6, s6, 0xfffff
    buffer_load_dwordx4 v[244:247], v1, s[12:15], s6 offen nt
    s_waitcnt vmcnt(11)
    v_dot2c_f32_bf16_dpp v12, v35, v200 row_newbcast:2 row_mask:0xf bank_mask:0xf
    v_dot2c_f32_bf16_dpp v13, v54, v200 row_newbcast:2 row_mask:0xf bank_mask:0xf
    v_dot2c_f32_bf16_dpp v14, v35, v201 row_newbcast:2 row_mask:0xf bank_mask:0xf
    v_dot2c_f32_bf16_dpp v15, v54, v201 row_newbcast:2 row_mask:0xf bank_mask:0xf
    v_dot2c_f32_bf16_dpp v16, v35, v202 row_newbcast:2 row_mask:0xf bank_mask:0xf
    v_dot2c_f32_bf16_dpp v17, v54, v202 row_newbcast:2 row_mask:0xf bank_mask:0xf
    v_dot2c_f32_bf16_dpp v18, v35, v203 row_newbcast:2 row_mask:0xf bank_mask:0xf
    v_dot2c_f32_bf16_dpp v19, v54, v203 row_newbcast:2 row_mask:0xf bank_mask:0xf
    s_add_u32 s6, s56, 1040384
    s_and_b32 s6, s6, 0xfffff
    buffer_load_dwordx4 v[248:251], v1, s[12:15], s6 offen nt
    s_waitcnt vmcnt(11)
    v_dot2c_f32_bf16_dpp v12, v35, v204 row_newbcast:3 row_mask:0xf bank_mask:0xf
    v_dot2c_f32_bf16_dpp v13, v54, v204 row_newbcast:3 row_mask:0xf bank_mask:0xf
    v_dot2c_f32_bf16_dpp v14, v35, v205 row_newbcast:3 row_mask:0xf bank_mask:0xf
    v_dot2c_f32_bf16_dpp v15, v54, v205 row_newbcast:3 row_mask:0xf bank_mask:0xf
    v_dot2c_f32_bf16_dpp v16, v35, v206 row_newbcast:3 row_mask:0xf bank_mask:0xf
    v_dot2c_f32_bf16_dpp v17, v54, v206 row_newbcast:3 row_mask:0xf bank_mask:0xf
    v_dot2c_f32_bf16_dpp v18, v35, v207 row_newbcast:3 row_mask:0xf bank_mask:0xf
    v_dot2c_f32_bf16_dpp v19, v54, v207 row_newbcast:3 row_mask:0xf bank_mask:0xf
    s_add_u32 s6, s56, 1044480
    s_and_b32 s6, s6, 0xfffff
    buffer_load_dwordx4 v[252:255], v1, s[12:15], s6 offen nt
    buffer_load_dwordx4 v[116:119], v3, s[20:23], 0 offen
    buffer_load_dwordx4 v[120:123], v3, s[20:23], 0 offen offset:1024
    buffer_load_dwordx4 v[124:127], v3, s[20:23], 0 offen offset:2048
    buffer_load_dwordx4 v[64:67], v3, s[20:23], 0 offen offset:3072
    s_mov_b32 s6, 4096
    buffer_load_dwordx4 v[68:71], v3, s[20:23], s6 offen
    buffer_load_dwordx4 v[72:75], v3, s[20:23], s6 offen offset:1024
    buffer_load_dwordx4 v[76:79], v3, s[20:23], s6 offen offset:2048
    buffer_load_dwordx4 v[80:83], v3, s[20:23], s6 offen offset:3072
    s_mov_b32 s6, 8192
    buffer_load_dwordx4 v[84:87], v3, s[20:23], s6 offen
    buffer_load_dwordx4 v[88:91], v3, s[20:23], s6 offen offset:1024
    buffer_load_dwordx4 v[92:95], v3, s[20:23], s6 offen offset:2048
    buffer_load_dwordx4 v[96:99], v3, s[20:23], s6 offen offset:3072
    s_mov_b32 s6, 12288
    buffer_load_dwordx4 v[100:103], v3, s[20:23], s6 offen
    buffer_load_dwordx4 v[104:107], v3, s[20:23], s6 offen offset:1024
    buffer_load_dwordx4 v[108:111], v3, s[20:23], s6 offen offset:2048
    buffer_load_dwordx4 v[112:115], v3, s[20:23], s6 offen offset:3072
    s_waitcnt vmcnt(27)
    v_dot2c_f32_bf16_dpp v12, v35, v208 row_newbcast:4 row_mask:0xf bank_mask:0xf
    v_dot2c_f32_bf16_dpp v13, v54, v208 row_newbcast:4 row_mask:0xf bank_mask:0xf
    v_dot2c_f32_bf16_dpp v14, v35, v209 row_newbcast:4 row_mask:0xf bank_mask:0xf
    v_dot2c_f32_bf16_dpp v15, v54, v209 row_newbcast:4 row_mask:0xf bank_mask:0xf
    v_dot2c_f32_bf16_dpp v16, v35, v210 row_newbcast:4 row_mask:0xf bank_mask:0xf
    v_dot2c_f32_bf16_dpp v17, v54, v210 row_newbcast:4 row_mask:0xf bank_mask:0xf
    v_dot2c_f32_bf16_dpp v18, v35, v211 row_newbcast:4 row_mask:0xf bank_mask:0xf
    v_dot2c_f32_bf16_dpp v19, v54, v211 row_newbcast:4 row_mask:0xf bank_mask:0xf
    s_waitcnt vmcnt(26)
    v_dot2c_f32_bf16_dpp v12, v35, v212 row_newbcast:5 row_mask:0xf bank_mask:0xf
    v_dot2c_f32_bf16_dpp v13, v54, v212 row_newbcast:5 row_mask:0xf bank_mask:0xf
    v_dot2c_f32_bf16_dpp v14, v35, v213 row_newbcast:5 row_mask:0xf bank_mask:0xf
    v_dot2c_f32_bf16_dpp v15, v54, v213 row_newbcast:5 row_mask:0xf bank_mask:0xf
    v_dot2c_f32_bf16_dpp v16, v35, v214 row_newbcast:5 row_mask:0xf bank_mask:0xf
    v_dot2c_f32_bf16_dpp v17, v54, v214 row_newbcast:5 row_mask:0xf bank_mask:0xf
    v_dot2c_f32_bf16_dpp v18, v35, v215 row_newbcast:5 row_mask:0xf bank_mask:0xf
    v_dot2c_f32_bf16_dpp v19, v54, v215 row_newbcast:5 row_mask:0xf bank_mask:0xf
    s_waitcnt vmcnt(25)
    v_dot2c_f32_bf16_dpp v12, v35, v216 row_newbcast:6 row_mask:0xf bank_mask:0xf
    v_dot2c_f32_bf16_dpp v13, v54, v216 row_newbcast:6 row_mask:0xf bank_mask:0xf
    v_dot2c_f32_bf16_dpp v14, v35, v217 row_newbcast:6 row_mask:0xf bank_mask:0xf
    v_dot2c_f32_bf16_dpp v15, v54, v217 row_newbcast:6 row_mask:0xf bank_mask:0xf
    v_dot2c_f32_bf16_dpp v16, v35, v218 row_newbcast:6 row_mask:0xf bank_mask:0xf
    v_dot2c_f32_bf16_dpp v17, v54, v218 row_newbcast:6 row_mask:0xf bank_mask:0xf
    v_dot2c_f32_bf16_dpp v18, v35, v219 row_newbcast:6 row_mask:0xf bank_mask:0xf
    v_dot2c_f32_bf16_dpp v19, v54, v219 row_newbcast:6 row_mask:0xf bank_mask:0xf
    s_waitcnt vmcnt(24)
    v_dot2c_f32_bf16_dpp v12, v35, v220 row_newbcast:7 row_mask:0xf bank_mask:0xf
    v_dot2c_f32_bf16_dpp v13, v54, v220 row_newbcast:7 row_mask:0xf bank_mask:0xf
    v_dot2c_f32_bf16_dpp v14, v35, v221 row_newbcast:7 row_mask:0xf bank_mask:0xf
    v_dot2c_f32_bf16_dpp v15, v54, v221 row_newbcast:7 row_mask:0xf bank_mask:0xf
    v_dot2c_f32_bf16_dpp v16, v35, v222 row_newbcast:7 row_mask:0xf bank_mask:0xf
    v_dot2c_f32_bf16_dpp v17, v54, v222 row_newbcast:7 row_mask:0xf bank_mask:0xf
    v_dot2c_f32_bf16_dpp v18, v35, v223 row_newbcast:7 row_mask:0xf bank_mask:0xf
    v_dot2c_f32_bf16_dpp v19, v54, v223 row_newbcast:7 row_mask:0xf bank_mask:0xf
    s_waitcnt vmcnt(23)
    v_dot2c_f32_bf16_dpp v12, v35, v224 row_newbcast:8 row_mask:0xf bank_mask:0xf
    v_dot2c_f32_bf16_dpp v13, v54, v224 row_newbcast:8 row_mask:0xf bank_mask:0xf
    v_dot2c_f32_bf16_dpp v14, v35, v225 row_newbcast:8 row_mask:0xf bank_mask:0xf
    v_dot2c_f32_bf16_dpp v15, v54, v225 row_newbcast:8 row_mask:0xf bank_mask:0xf
    v_dot2c_f32_bf16_dpp v16, v35, v226 row_newbcast:8 row_mask:0xf bank_mask:0xf
    v_dot2c_f32_bf16_dpp v17, v54, v226 row_newbcast:8 row_mask:0xf bank_mask:0xf
    v_dot2c_f32_bf16_dpp v18, v35, v227 row_newbcast:8 row_mask:0xf bank_mask:0xf
    v_dot2c_f32_bf16_dpp v19, v54, v227 row_newbcast:8 row_mask:0xf bank_mask:0xf
    s_waitcnt vmcnt(22)
    v_dot2c_f32_bf16_dpp v12, v35, v228 row_newbcast:9 row_mask:0xf bank_mask:0xf
    v_dot2c_f32_bf16_dpp v13, v54, v228 row_newbcast:9 row_mask:0xf bank_mask:0xf
    v_dot2c_f32_bf16_dpp v14, v35, v229 row_newbcast:9 row_mask:0xf bank_mask:0xf
    v_dot2c_f32_bf16_dpp v15, v54, v229 row_newbcast:9 row_mask:0xf bank_mask:0xf
    v_dot2c_f32_bf16_dpp v16, v35, v230 row_newbcast:9 row_mask:0xf bank_mask:0xf
    v_dot2c_f32_bf16_dpp v17, v54, v230 row_newbcast:9 row_mask:0xf bank_mask:0xf
    v_dot2c_f32_bf16_dpp v18, v35, v231 row_newbcast:9 row_mask:0xf bank_mask:0xf
    v_dot2c_f32_bf16_dpp v19, v54, v231 row_newbcast:9 row_mask:0xf bank_mask:0xf
    s_waitcnt vmcnt(21)
    v_dot2c_f32_bf16_dpp v12, v35, v232 row_newbcast:10 row_mask:0xf bank_mask:0xf
    v_dot2c_f32_bf16_dpp v13, v54, v232 row_newbcast:10 row_mask:0xf bank_mask:0xf
    v_dot2c_f32_bf16_dpp v14, v35, v233 row_newbcast:10 row_mask:0xf bank_mask:0xf
    v_dot2c_f32_bf16_dpp v15, v54, v233 row_newbcast:10 row_mask:0xf bank_mask:0xf
    v_dot2c_f32_bf16_dpp v16, v35, v234 row_newbcast:10 row_mask:0xf bank_mask:0xf
    v_dot2c_f32_bf16_dpp v17, v54, v234 row_newbcast:10 row_mask:0xf bank_mask:0xf
    v_dot2c_f32_bf16_dpp v18, v35, v235 row_newbcast:10 row_mask:0xf bank_mask:0xf
    v_dot2c_f32_bf16_dpp v19, v54, v235 row_newbcast:10 row_mask:0xf bank_mask:0xf
    s_waitcnt vmcnt(20)
    v_dot2c_f32_bf16_dpp v12, v35, v236 row_newbcast:11 row_mask:0xf bank_mask:0xf
    v_dot2c_f32_bf16_dpp v13, v54, v236 row_newbcast:11 row_mask:0xf bank_mask:0xf
    v_dot2c_f32_bf16_dpp v14, v35, v237 row_newbcast:11 row_mask:0xf bank_mask:0xf
    v_dot2c_f32_bf16_dpp v15, v54, v237 row_newbcast:11 row_mask:0xf bank_mask:0xf
    v_dot2c_f32_bf16_dpp v16, v35, v238 row_newbcast:11 row_mask:0xf bank_mask:0xf
    v_dot2c_f32_bf16_dpp v17, v54, v238 row_newbcast:11 row_mask:0xf bank_mask:0xf
    v_dot2c_f32_bf16_dpp v18, v35, v239 row_newbcast:11 row_mask:0xf bank_mask:0xf
    v_dot2c_f32_bf16_dpp v19, v54, v239 row_newbcast:11 row_mask:0xf bank_mask:0xf
    s_waitcnt vmcnt(19)
    v_dot2c_f32_bf16_dpp v12, v35, v240 row_newbcast:12 row_mask:0xf bank_mask:0xf
    v_dot2c_f32_bf16_dpp v13, v54, v240 row_newbcast:12 row_mask:0xf bank_mask:0xf
    v_dot2c_f32_bf16_dpp v14, v35, v241 row_newbcast:12 row_mask:0xf bank_mask:0xf
    v_dot2c_f32_bf16_dpp v15, v54, v241 row_newbcast:12 row_mask:0xf bank_mask:0xf
    v_dot2c_f32_bf16_dpp v16, v35, v242 row_newbcast:12 row_mask:0xf bank_mask:0xf
    v_dot2c_f32_bf16_dpp v17, v54, v242 row_newbcast:12 row_mask:0xf bank_mask:0xf
    v_dot2c_f32_bf16_dpp v18, v35, v243 row_newbcast:12 row_mask:0xf bank_mask:0xf
    v_dot2c_f32_bf16_dpp v19, v54, v243 row_newbcast:12 row_mask:0xf bank_mask:0xf
    s_waitcnt vmcnt(18)
    v_dot2c_f32_bf16_dpp v12, v35, v244 row_newbcast:13 row_mask:0xf bank_mask:0xf
    v_dot2c_f32_bf16_dpp v13, v54, v244 row_newbcast:13 row_mask:0xf bank_mask:0xf
    v_dot2c_f32_bf16_dpp v14, v35, v245 row_newbcast:13 row_mask:0xf bank_mask:0xf
    v_dot2c_f32_bf16_dpp v15, v54, v245 row_newbcast:13 row_mask:0xf bank_mask:0xf
    v_dot2c_f32_bf16_dpp v16, v35, v246 row_newbcast:13 row_mask:0xf bank_mask:0xf
    v_dot2c_f32_bf16_dpp v17, v54, v246 row_newbcast:13 row_mask:0xf bank_mask:0xf
    v_dot2c_f32_bf16_dpp v18, v35, v247 row_newbcast:13 row_mask:0xf bank_mask:0xf
    v_dot2c_f32_bf16_dpp v19, v54, v247 row_newbcast:13 row_mask:0xf bank_mask:0xf
    s_waitcnt vmcnt(17)
    v_dot2c_f32_bf16_dpp v12, v35, v248 row_newbcast:14 row_mask:0xf bank_mask:0xf
    v_dot2c_f32_bf16_dpp v13, v54, v248 row_newbcast:14 row_mask:0xf bank_mask:0xf
    v_dot2c_f32_bf16_dpp v14, v35, v249 row_newbcast:14 row_mask:0xf bank_mask:0xf
    v_dot2c_f32_bf16_dpp v15, v54, v249 row_newbcast:14 row_mask:0xf bank_mask:0xf
    v_dot2c_f32_bf16_dpp v16, v35, v250 row_newbcast:14 row_mask:0xf bank_mask:0xf
    v_dot2c_f32_bf16_dpp v17, v54, v250 row_newbcast:14 row_mask:0xf bank_mask:0xf
    v_dot2c_f32_bf16_dpp v18, v35, v251 row_newbcast:14 row_mask:0xf bank_mask:0xf
    v_dot2c_f32_bf16_dpp v19, v54, v251 row_newbcast:14 row_mask:0xf bank_mask:0xf
    s_waitcnt vmcnt(16)
    v_dot2c_f32_bf16_dpp v12, v35, v252 row_newbcast:15 row_mask:0xf bank_mask:0xf
    v_dot2c_f32_bf16_dpp v13, v54, v252 row_newbcast:15 row_mask:0xf bank_mask:0xf
    v_dot2c_f32_bf16_dpp v14, v35, v253 row_newbcast:15 row_mask:0xf bank_mask:0xf
    v_dot2c_f32_bf16_dpp v15, v54, v253 row_newbcast:15 row_mask:0xf bank_mask:0xf
    v_dot2c_f32_bf16_dpp v16, v35, v254 row_newbcast:15 row_mask:0xf bank_mask:0xf
    v_dot2c_f32_bf16_dpp v17, v54, v254 row_newbcast:15 row_mask:0xf bank_mask:0xf
    v_dot2c_f32_bf16_dpp v18, v35, v255 row_newbcast:15 row_mask:0xf bank_mask:0xf
    v_dot2c_f32_bf16_dpp v19, v54, v255 row_newbcast:15 row_mask:0xf bank_mask:0xf
    s_nop 2
    ds_write_b128 v6, v[12:15] offset:8192
    ds_write_b128 v6, v[16:19] offset:8208
    s_lshl_b32 s7, s5, 3
    v_mov_b32 v7, s7
    s_mov_b64 exec, 1
    ds_write_b64 v7, v[60:61] offset:18432
    s_mov_b64 exec, -1
    s_waitcnt lgkmcnt(0)
    s_barrier
    v_lshrrev_b32 v55, 4, v0
    v_lshlrev_b32 v7, 3, v55
    ds_read_b64 v[60:61], v7 offset:18432
    v_lshlrev_b32 v7, 11, v55
    v_and_b32 v55, 15, v0
    v_lshl_add_u32 v7, v55, 2, v7
    s_lshl_b32 s7, s5, 7
    v_add_u32 v7, s7, v7
    ds_read_b32 v36, v7 offset:8192
    ds_read_b32 v37, v7 offset:8704
    ds_read_b32 v38, v7 offset:9216
    ds_read_b32 v39, v7 offset:9728
    ds_read_b32 v40, v7 offset:8256
    ds_read_b32 v41, v7 offset:8768
    ds_read_b32 v42, v7 offset:9280
    ds_read_b32 v43, v7 offset:9792
    s_waitcnt lgkmcnt(0)
    v_mov_b32 v62, v60
    v_mov_b32 v63, v62
    s_nop 1
    v_permlane16_swap_b32 v63, v62
    s_nop 1
    v_max_f32 v62, v62, v63
    v_mov_b32 v63, v62
    s_nop 1
    v_permlane32_swap_b32 v63, v62
    s_nop 1
    v_max_f32 v62, v62, v63
    v_sub_f32 v60, v60, v62
    v_exp_f32 v60, v60
    s_nop 0
    v_mul_f32 v61, v61, v60
    v_add_f32 v36, v36, v37
    v_add_f32 v38, v38, v39
    v_add_f32 v36, v36, v38
    v_mul_f32 v36, v36, v60
    v_add_f32 v40, v40, v41
    v_add_f32 v42, v42, v43
    v_add_f32 v40, v40, v42
    v_mul_f32 v40, v40, v60
    v_mov_b32 v63, v61
    v_mov_b32 v44, v36
    v_mov_b32 v45, v40
    s_nop 1
    v_permlane16_swap_b32 v63, v61
    v_permlane16_swap_b32 v44, v36
    v_permlane16_swap_b32 v45, v40
    s_nop 1
    v_add_f32 v61, v61, v63
    v_add_f32 v36, v36, v44
    v_add_f32 v40, v40, v45
    v_mov_b32 v63, v61
    v_mov_b32 v44, v36
    v_mov_b32 v45, v40
    s_nop 1
    v_permlane32_swap_b32 v63, v61
    v_permlane32_swap_b32 v44, v36
    v_permlane32_swap_b32 v45, v40
    s_nop 1
    v_add_f32 v61, v61, v63
    v_add_f32 v36, v36, v44
    v_add_f32 v40, v40, v45
    v_rcp_f32 v61, v61
    s_nop 0
    v_mul_f32 v36, v36, v61
    v_mul_f32 v40, v40, v61
    v_cvt_pk_bf16_f32 v60, v36, 0
    v_cvt_pk_bf16_f32 v61, v40, 0
    v_lshlrev_b32 v62, 16, v60
    v_lshlrev_b32 v63, 16, v61
    v_mov_b32 v12, 0
    v_mov_b32 v13, 0
    v_mov_b32 v14, 0
    v_mov_b32 v15, 0
    v_mov_b32 v16, 0
    v_mov_b32 v17, 0
    v_mov_b32 v18, 0
    v_mov_b32 v19, 0
    s_waitcnt vmcnt(15)
    v_dot2c_f32_bf16_dpp v12, v60, v116 row_newbcast:0 row_mask:0xf bank_mask:0xf
    v_dot2c_f32_bf16_dpp v13, v62, v116 row_newbcast:0 row_mask:0xf bank_mask:0xf
    v_dot2c_f32_bf16_dpp v14, v60, v117 row_newbcast:0 row_mask:0xf bank_mask:0xf
    v_dot2c_f32_bf16_dpp v15, v62, v117 row_newbcast:0 row_mask:0xf bank_mask:0xf
    v_dot2c_f32_bf16_dpp v16, v60, v118 row_newbcast:0 row_mask:0xf bank_mask:0xf
    v_dot2c_f32_bf16_dpp v17, v62, v118 row_newbcast:0 row_mask:0xf bank_mask:0xf
    v_dot2c_f32_bf16_dpp v18, v60, v119 row_newbcast:0 row_mask:0xf bank_mask:0xf
    v_dot2c_f32_bf16_dpp v19, v62, v119 row_newbcast:0 row_mask:0xf bank_mask:0xf
    s_mov_b32 s6, 16384
    buffer_load_dwordx4 v[116:119], v3, s[20:23], s6 offen
    s_waitcnt vmcnt(15)
    v_dot2c_f32_bf16_dpp v12, v60, v120 row_newbcast:1 row_mask:0xf bank_mask:0xf
    v_dot2c_f32_bf16_dpp v13, v62, v120 row_newbcast:1 row_mask:0xf bank_mask:0xf
    v_dot2c_f32_bf16_dpp v14, v60, v121 row_newbcast:1 row_mask:0xf bank_mask:0xf
    v_dot2c_f32_bf16_dpp v15, v62, v121 row_newbcast:1 row_mask:0xf bank_mask:0xf
    v_dot2c_f32_bf16_dpp v16, v60, v122 row_newbcast:1 row_mask:0xf bank_mask:0xf
    v_dot2c_f32_bf16_dpp v17, v62, v122 row_newbcast:1 row_mask:0xf bank_mask:0xf
    v_dot2c_f32_bf16_dpp v18, v60, v123 row_newbcast:1 row_mask:0xf bank_mask:0xf
    v_dot2c_f32_bf16_dpp v19, v62, v123 row_newbcast:1 row_mask:0xf bank_mask:0xf
    buffer_load_dwordx4 v[120:123], v3, s[20:23], s6 offen offset:1024
    s_waitcnt vmcnt(15)
    v_dot2c_f32_bf16_dpp v12, v60, v124 row_newbcast:2 row_mask:0xf bank_mask:0xf
    v_dot2c_f32_bf16_dpp v13, v62, v124 row_newbcast:2 row_mask:0xf bank_mask:0xf
    v_dot2c_f32_bf16_dpp v14, v60, v125 row_newbcast:2 row_mask:0xf bank_mask:0xf
    v_dot2c_f32_bf16_dpp v15, v62, v125 row_newbcast:2 row_mask:0xf bank_mask:0xf
    v_dot2c_f32_bf16_dpp v16, v60, v126 row_newbcast:2 row_mask:0xf bank_mask:0xf
    v_dot2c_f32_bf16_dpp v17, v62, v126 row_newbcast:2 row_mask:0xf bank_mask:0xf
    v_dot2c_f32_bf16_dpp v18, v60, v127 row_newbcast:2 row_mask:0xf bank_mask:0xf
    v_dot2c_f32_bf16_dpp v19, v62, v127 row_newbcast:2 row_mask:0xf bank_mask:0xf
    buffer_load_dwordx4 v[124:127], v3, s[20:23], s6 offen offset:2048
    s_waitcnt vmcnt(15)
    v_dot2c_f32_bf16_dpp v12, v60, v64 row_newbcast:3 row_mask:0xf bank_mask:0xf
    v_dot2c_f32_bf16_dpp v13, v62, v64 row_newbcast:3 row_mask:0xf bank_mask:0xf
    v_dot2c_f32_bf16_dpp v14, v60, v65 row_newbcast:3 row_mask:0xf bank_mask:0xf
    v_dot2c_f32_bf16_dpp v15, v62, v65 row_newbcast:3 row_mask:0xf bank_mask:0xf
    v_dot2c_f32_bf16_dpp v16, v60, v66 row_newbcast:3 row_mask:0xf bank_mask:0xf
    v_dot2c_f32_bf16_dpp v17, v62, v66 row_newbcast:3 row_mask:0xf bank_mask:0xf
    v_dot2c_f32_bf16_dpp v18, v60, v67 row_newbcast:3 row_mask:0xf bank_mask:0xf
    v_dot2c_f32_bf16_dpp v19, v62, v67 row_newbcast:3 row_mask:0xf bank_mask:0xf
    buffer_load_dwordx4 v[64:67], v3, s[20:23], s6 offen offset:3072
    s_waitcnt vmcnt(15)
    v_dot2c_f32_bf16_dpp v12, v60, v68 row_newbcast:4 row_mask:0xf bank_mask:0xf
    v_dot2c_f32_bf16_dpp v13, v62, v68 row_newbcast:4 row_mask:0xf bank_mask:0xf
    v_dot2c_f32_bf16_dpp v14, v60, v69 row_newbcast:4 row_mask:0xf bank_mask:0xf
    v_dot2c_f32_bf16_dpp v15, v62, v69 row_newbcast:4 row_mask:0xf bank_mask:0xf
    v_dot2c_f32_bf16_dpp v16, v60, v70 row_newbcast:4 row_mask:0xf bank_mask:0xf
    v_dot2c_f32_bf16_dpp v17, v62, v70 row_newbcast:4 row_mask:0xf bank_mask:0xf
    v_dot2c_f32_bf16_dpp v18, v60, v71 row_newbcast:4 row_mask:0xf bank_mask:0xf
    v_dot2c_f32_bf16_dpp v19, v62, v71 row_newbcast:4 row_mask:0xf bank_mask:0xf
    s_mov_b32 s6, 20480
    buffer_load_dwordx4 v[68:71], v3, s[20:23], s6 offen
    s_waitcnt vmcnt(15)
    v_dot2c_f32_bf16_dpp v12, v60, v72 row_newbcast:5 row_mask:0xf bank_mask:0xf
    v_dot2c_f32_bf16_dpp v13, v62, v72 row_newbcast:5 row_mask:0xf bank_mask:0xf
    v_dot2c_f32_bf16_dpp v14, v60, v73 row_newbcast:5 row_mask:0xf bank_mask:0xf
    v_dot2c_f32_bf16_dpp v15, v62, v73 row_newbcast:5 row_mask:0xf bank_mask:0xf
    v_dot2c_f32_bf16_dpp v16, v60, v74 row_newbcast:5 row_mask:0xf bank_mask:0xf
    v_dot2c_f32_bf16_dpp v17, v62, v74 row_newbcast:5 row_mask:0xf bank_mask:0xf
    v_dot2c_f32_bf16_dpp v18, v60, v75 row_newbcast:5 row_mask:0xf bank_mask:0xf
    v_dot2c_f32_bf16_dpp v19, v62, v75 row_newbcast:5 row_mask:0xf bank_mask:0xf
    buffer_load_dwordx4 v[72:75], v3, s[20:23], s6 offen offset:1024
    s_waitcnt vmcnt(15)
    v_dot2c_f32_bf16_dpp v12, v60, v76 row_newbcast:6 row_mask:0xf bank_mask:0xf
    v_dot2c_f32_bf16_dpp v13, v62, v76 row_newbcast:6 row_mask:0xf bank_mask:0xf
    v_dot2c_f32_bf16_dpp v14, v60, v77 row_newbcast:6 row_mask:0xf bank_mask:0xf
    v_dot2c_f32_bf16_dpp v15, v62, v77 row_newbcast:6 row_mask:0xf bank_mask:0xf
    v_dot2c_f32_bf16_dpp v16, v60, v78 row_newbcast:6 row_mask:0xf bank_mask:0xf
    v_dot2c_f32_bf16_dpp v17, v62, v78 row_newbcast:6 row_mask:0xf bank_mask:0xf
    v_dot2c_f32_bf16_dpp v18, v60, v79 row_newbcast:6 row_mask:0xf bank_mask:0xf
    v_dot2c_f32_bf16_dpp v19, v62, v79 row_newbcast:6 row_mask:0xf bank_mask:0xf
    buffer_load_dwordx4 v[76:79], v3, s[20:23], s6 offen offset:2048
    s_waitcnt vmcnt(15)
    v_dot2c_f32_bf16_dpp v12, v60, v80 row_newbcast:7 row_mask:0xf bank_mask:0xf
    v_dot2c_f32_bf16_dpp v13, v62, v80 row_newbcast:7 row_mask:0xf bank_mask:0xf
    v_dot2c_f32_bf16_dpp v14, v60, v81 row_newbcast:7 row_mask:0xf bank_mask:0xf
    v_dot2c_f32_bf16_dpp v15, v62, v81 row_newbcast:7 row_mask:0xf bank_mask:0xf
    v_dot2c_f32_bf16_dpp v16, v60, v82 row_newbcast:7 row_mask:0xf bank_mask:0xf
    v_dot2c_f32_bf16_dpp v17, v62, v82 row_newbcast:7 row_mask:0xf bank_mask:0xf
    v_dot2c_f32_bf16_dpp v18, v60, v83 row_newbcast:7 row_mask:0xf bank_mask:0xf
    v_dot2c_f32_bf16_dpp v19, v62, v83 row_newbcast:7 row_mask:0xf bank_mask:0xf
    buffer_load_dwordx4 v[80:83], v3, s[20:23], s6 offen offset:3072
    s_waitcnt vmcnt(15)
    v_dot2c_f32_bf16_dpp v12, v60, v84 row_newbcast:8 row_mask:0xf bank_mask:0xf
    v_dot2c_f32_bf16_dpp v13, v62, v84 row_newbcast:8 row_mask:0xf bank_mask:0xf
    v_dot2c_f32_bf16_dpp v14, v60, v85 row_newbcast:8 row_mask:0xf bank_mask:0xf
    v_dot2c_f32_bf16_dpp v15, v62, v85 row_newbcast:8 row_mask:0xf bank_mask:0xf
    v_dot2c_f32_bf16_dpp v16, v60, v86 row_newbcast:8 row_mask:0xf bank_mask:0xf
    v_dot2c_f32_bf16_dpp v17, v62, v86 row_newbcast:8 row_mask:0xf bank_mask:0xf
    v_dot2c_f32_bf16_dpp v18, v60, v87 row_newbcast:8 row_mask:0xf bank_mask:0xf
    v_dot2c_f32_bf16_dpp v19, v62, v87 row_newbcast:8 row_mask:0xf bank_mask:0xf
    s_mov_b32 s6, 24576
    buffer_load_dwordx4 v[84:87], v3, s[20:23], s6 offen
    s_waitcnt vmcnt(15)
    v_dot2c_f32_bf16_dpp v12, v60, v88 row_newbcast:9 row_mask:0xf bank_mask:0xf
    v_dot2c_f32_bf16_dpp v13, v62, v88 row_newbcast:9 row_mask:0xf bank_mask:0xf
    v_dot2c_f32_bf16_dpp v14, v60, v89 row_newbcast:9 row_mask:0xf bank_mask:0xf
    v_dot2c_f32_bf16_dpp v15, v62, v89 row_newbcast:9 row_mask:0xf bank_mask:0xf
    v_dot2c_f32_bf16_dpp v16, v60, v90 row_newbcast:9 row_mask:0xf bank_mask:0xf
    v_dot2c_f32_bf16_dpp v17, v62, v90 row_newbcast:9 row_mask:0xf bank_mask:0xf
    v_dot2c_f32_bf16_dpp v18, v60, v91 row_newbcast:9 row_mask:0xf bank_mask:0xf
    v_dot2c_f32_bf16_dpp v19, v62, v91 row_newbcast:9 row_mask:0xf bank_mask:0xf
    buffer_load_dwordx4 v[88:91], v3, s[20:23], s6 offen offset:1024
    s_waitcnt vmcnt(15)
    v_dot2c_f32_bf16_dpp v12, v60, v92 row_newbcast:10 row_mask:0xf bank_mask:0xf
    v_dot2c_f32_bf16_dpp v13, v62, v92 row_newbcast:10 row_mask:0xf bank_mask:0xf
    v_dot2c_f32_bf16_dpp v14, v60, v93 row_newbcast:10 row_mask:0xf bank_mask:0xf
    v_dot2c_f32_bf16_dpp v15, v62, v93 row_newbcast:10 row_mask:0xf bank_mask:0xf
    v_dot2c_f32_bf16_dpp v16, v60, v94 row_newbcast:10 row_mask:0xf bank_mask:0xf
    v_dot2c_f32_bf16_dpp v17, v62, v94 row_newbcast:10 row_mask:0xf bank_mask:0xf
    v_dot2c_f32_bf16_dpp v18, v60, v95 row_newbcast:10 row_mask:0xf bank_mask:0xf
    v_dot2c_f32_bf16_dpp v19, v62, v95 row_newbcast:10 row_mask:0xf bank_mask:0xf
    buffer_load_dwordx4 v[92:95], v3, s[20:23], s6 offen offset:2048
    s_waitcnt vmcnt(15)
    v_dot2c_f32_bf16_dpp v12, v60, v96 row_newbcast:11 row_mask:0xf bank_mask:0xf
    v_dot2c_f32_bf16_dpp v13, v62, v96 row_newbcast:11 row_mask:0xf bank_mask:0xf
    v_dot2c_f32_bf16_dpp v14, v60, v97 row_newbcast:11 row_mask:0xf bank_mask:0xf
    v_dot2c_f32_bf16_dpp v15, v62, v97 row_newbcast:11 row_mask:0xf bank_mask:0xf
    v_dot2c_f32_bf16_dpp v16, v60, v98 row_newbcast:11 row_mask:0xf bank_mask:0xf
    v_dot2c_f32_bf16_dpp v17, v62, v98 row_newbcast:11 row_mask:0xf bank_mask:0xf
    v_dot2c_f32_bf16_dpp v18, v60, v99 row_newbcast:11 row_mask:0xf bank_mask:0xf
    v_dot2c_f32_bf16_dpp v19, v62, v99 row_newbcast:11 row_mask:0xf bank_mask:0xf
    buffer_load_dwordx4 v[96:99], v3, s[20:23], s6 offen offset:3072
    s_waitcnt vmcnt(15)
    v_dot2c_f32_bf16_dpp v12, v60, v100 row_newbcast:12 row_mask:0xf bank_mask:0xf
    v_dot2c_f32_bf16_dpp v13, v62, v100 row_newbcast:12 row_mask:0xf bank_mask:0xf
    v_dot2c_f32_bf16_dpp v14, v60, v101 row_newbcast:12 row_mask:0xf bank_mask:0xf
    v_dot2c_f32_bf16_dpp v15, v62, v101 row_newbcast:12 row_mask:0xf bank_mask:0xf
    v_dot2c_f32_bf16_dpp v16, v60, v102 row_newbcast:12 row_mask:0xf bank_mask:0xf
    v_dot2c_f32_bf16_dpp v17, v62, v102 row_newbcast:12 row_mask:0xf bank_mask:0xf
    v_dot2c_f32_bf16_dpp v18, v60, v103 row_newbcast:12 row_mask:0xf bank_mask:0xf
    v_dot2c_f32_bf16_dpp v19, v62, v103 row_newbcast:12 row_mask:0xf bank_mask:0xf
    s_mov_b32 s6, 28672
    buffer_load_dwordx4 v[100:103], v3, s[20:23], s6 offen
    s_waitcnt vmcnt(15)
    v_dot2c_f32_bf16_dpp v12, v60, v104 row_newbcast:13 row_mask:0xf bank_mask:0xf
    v_dot2c_f32_bf16_dpp v13, v62, v104 row_newbcast:13 row_mask:0xf bank_mask:0xf
    v_dot2c_f32_bf16_dpp v14, v60, v105 row_newbcast:13 row_mask:0xf bank_mask:0xf
    v_dot2c_f32_bf16_dpp v15, v62, v105 row_newbcast:13 row_mask:0xf bank_mask:0xf
    v_dot2c_f32_bf16_dpp v16, v60, v106 row_newbcast:13 row_mask:0xf bank_mask:0xf
    v_dot2c_f32_bf16_dpp v17, v62, v106 row_newbcast:13 row_mask:0xf bank_mask:0xf
    v_dot2c_f32_bf16_dpp v18, v60, v107 row_newbcast:13 row_mask:0xf bank_mask:0xf
    v_dot2c_f32_bf16_dpp v19, v62, v107 row_newbcast:13 row_mask:0xf bank_mask:0xf
    buffer_load_dwordx4 v[104:107], v3, s[20:23], s6 offen offset:1024
    s_waitcnt vmcnt(15)
    v_dot2c_f32_bf16_dpp v12, v60, v108 row_newbcast:14 row_mask:0xf bank_mask:0xf
    v_dot2c_f32_bf16_dpp v13, v62, v108 row_newbcast:14 row_mask:0xf bank_mask:0xf
    v_dot2c_f32_bf16_dpp v14, v60, v109 row_newbcast:14 row_mask:0xf bank_mask:0xf
    v_dot2c_f32_bf16_dpp v15, v62, v109 row_newbcast:14 row_mask:0xf bank_mask:0xf
    v_dot2c_f32_bf16_dpp v16, v60, v110 row_newbcast:14 row_mask:0xf bank_mask:0xf
    v_dot2c_f32_bf16_dpp v17, v62, v110 row_newbcast:14 row_mask:0xf bank_mask:0xf
    v_dot2c_f32_bf16_dpp v18, v60, v111 row_newbcast:14 row_mask:0xf bank_mask:0xf
    v_dot2c_f32_bf16_dpp v19, v62, v111 row_newbcast:14 row_mask:0xf bank_mask:0xf
    buffer_load_dwordx4 v[108:111], v3, s[20:23], s6 offen offset:2048
    s_waitcnt vmcnt(15)
    v_dot2c_f32_bf16_dpp v12, v60, v112 row_newbcast:15 row_mask:0xf bank_mask:0xf
    v_dot2c_f32_bf16_dpp v13, v62, v112 row_newbcast:15 row_mask:0xf bank_mask:0xf
    v_dot2c_f32_bf16_dpp v14, v60, v113 row_newbcast:15 row_mask:0xf bank_mask:0xf
    v_dot2c_f32_bf16_dpp v15, v62, v113 row_newbcast:15 row_mask:0xf bank_mask:0xf
    v_dot2c_f32_bf16_dpp v16, v60, v114 row_newbcast:15 row_mask:0xf bank_mask:0xf
    v_dot2c_f32_bf16_dpp v17, v62, v114 row_newbcast:15 row_mask:0xf bank_mask:0xf
    v_dot2c_f32_bf16_dpp v18, v60, v115 row_newbcast:15 row_mask:0xf bank_mask:0xf
    v_dot2c_f32_bf16_dpp v19, v62, v115 row_newbcast:15 row_mask:0xf bank_mask:0xf
    buffer_load_dwordx4 v[112:115], v3, s[20:23], s6 offen offset:3072
    s_waitcnt vmcnt(15)
    v_dot2c_f32_bf16_dpp v12, v61, v116 row_newbcast:0 row_mask:0xf bank_mask:0xf
    v_dot2c_f32_bf16_dpp v13, v63, v116 row_newbcast:0 row_mask:0xf bank_mask:0xf
    v_dot2c_f32_bf16_dpp v14, v61, v117 row_newbcast:0 row_mask:0xf bank_mask:0xf
    v_dot2c_f32_bf16_dpp v15, v63, v117 row_newbcast:0 row_mask:0xf bank_mask:0xf
    v_dot2c_f32_bf16_dpp v16, v61, v118 row_newbcast:0 row_mask:0xf bank_mask:0xf
    v_dot2c_f32_bf16_dpp v17, v63, v118 row_newbcast:0 row_mask:0xf bank_mask:0xf
    v_dot2c_f32_bf16_dpp v18, v61, v119 row_newbcast:0 row_mask:0xf bank_mask:0xf
    v_dot2c_f32_bf16_dpp v19, v63, v119 row_newbcast:0 row_mask:0xf bank_mask:0xf
    buffer_load_dwordx4 v[116:119], v4, s[24:27], 0 offen
    s_waitcnt vmcnt(15)
    v_dot2c_f32_bf16_dpp v12, v61, v120 row_newbcast:1 row_mask:0xf bank_mask:0xf
    v_dot2c_f32_bf16_dpp v13, v63, v120 row_newbcast:1 row_mask:0xf bank_mask:0xf
    v_dot2c_f32_bf16_dpp v14, v61, v121 row_newbcast:1 row_mask:0xf bank_mask:0xf
    v_dot2c_f32_bf16_dpp v15, v63, v121 row_newbcast:1 row_mask:0xf bank_mask:0xf
    v_dot2c_f32_bf16_dpp v16, v61, v122 row_newbcast:1 row_mask:0xf bank_mask:0xf
    v_dot2c_f32_bf16_dpp v17, v63, v122 row_newbcast:1 row_mask:0xf bank_mask:0xf
    v_dot2c_f32_bf16_dpp v18, v61, v123 row_newbcast:1 row_mask:0xf bank_mask:0xf
    v_dot2c_f32_bf16_dpp v19, v63, v123 row_newbcast:1 row_mask:0xf bank_mask:0xf
    s_mov_b32 s6, 3584
    buffer_load_dwordx4 v[120:123], v4, s[24:27], s6 offen
    s_waitcnt vmcnt(15)
    v_dot2c_f32_bf16_dpp v12, v61, v124 row_newbcast:2 row_mask:0xf bank_mask:0xf
    v_dot2c_f32_bf16_dpp v13, v63, v124 row_newbcast:2 row_mask:0xf bank_mask:0xf
    v_dot2c_f32_bf16_dpp v14, v61, v125 row_newbcast:2 row_mask:0xf bank_mask:0xf
    v_dot2c_f32_bf16_dpp v15, v63, v125 row_newbcast:2 row_mask:0xf bank_mask:0xf
    v_dot2c_f32_bf16_dpp v16, v61, v126 row_newbcast:2 row_mask:0xf bank_mask:0xf
    v_dot2c_f32_bf16_dpp v17, v63, v126 row_newbcast:2 row_mask:0xf bank_mask:0xf
    v_dot2c_f32_bf16_dpp v18, v61, v127 row_newbcast:2 row_mask:0xf bank_mask:0xf
    v_dot2c_f32_bf16_dpp v19, v63, v127 row_newbcast:2 row_mask:0xf bank_mask:0xf
    s_mov_b32 s6, 7168
    buffer_load_dwordx4 v[124:127], v4, s[24:27], s6 offen
    s_waitcnt vmcnt(15)
    v_dot2c_f32_bf16_dpp v12, v61, v64 row_newbcast:3 row_mask:0xf bank_mask:0xf
    v_dot2c_f32_bf16_dpp v13, v63, v64 row_newbcast:3 row_mask:0xf bank_mask:0xf
    v_dot2c_f32_bf16_dpp v14, v61, v65 row_newbcast:3 row_mask:0xf bank_mask:0xf
    v_dot2c_f32_bf16_dpp v15, v63, v65 row_newbcast:3 row_mask:0xf bank_mask:0xf
    v_dot2c_f32_bf16_dpp v16, v61, v66 row_newbcast:3 row_mask:0xf bank_mask:0xf
    v_dot2c_f32_bf16_dpp v17, v63, v66 row_newbcast:3 row_mask:0xf bank_mask:0xf
    v_dot2c_f32_bf16_dpp v18, v61, v67 row_newbcast:3 row_mask:0xf bank_mask:0xf
    v_dot2c_f32_bf16_dpp v19, v63, v67 row_newbcast:3 row_mask:0xf bank_mask:0xf
    s_mov_b32 s6, 10752
    buffer_load_dwordx4 v[64:67], v4, s[24:27], s6 offen
    s_waitcnt vmcnt(15)
    v_dot2c_f32_bf16_dpp v12, v61, v68 row_newbcast:4 row_mask:0xf bank_mask:0xf
    v_dot2c_f32_bf16_dpp v13, v63, v68 row_newbcast:4 row_mask:0xf bank_mask:0xf
    v_dot2c_f32_bf16_dpp v14, v61, v69 row_newbcast:4 row_mask:0xf bank_mask:0xf
    v_dot2c_f32_bf16_dpp v15, v63, v69 row_newbcast:4 row_mask:0xf bank_mask:0xf
    v_dot2c_f32_bf16_dpp v16, v61, v70 row_newbcast:4 row_mask:0xf bank_mask:0xf
    v_dot2c_f32_bf16_dpp v17, v63, v70 row_newbcast:4 row_mask:0xf bank_mask:0xf
    v_dot2c_f32_bf16_dpp v18, v61, v71 row_newbcast:4 row_mask:0xf bank_mask:0xf
    v_dot2c_f32_bf16_dpp v19, v63, v71 row_newbcast:4 row_mask:0xf bank_mask:0xf
    s_mov_b32 s6, 14336
    buffer_load_dwordx4 v[68:71], v4, s[24:27], s6 offen
    s_waitcnt vmcnt(15)
    v_dot2c_f32_bf16_dpp v12, v61, v72 row_newbcast:5 row_mask:0xf bank_mask:0xf
    v_dot2c_f32_bf16_dpp v13, v63, v72 row_newbcast:5 row_mask:0xf bank_mask:0xf
    v_dot2c_f32_bf16_dpp v14, v61, v73 row_newbcast:5 row_mask:0xf bank_mask:0xf
    v_dot2c_f32_bf16_dpp v15, v63, v73 row_newbcast:5 row_mask:0xf bank_mask:0xf
    v_dot2c_f32_bf16_dpp v16, v61, v74 row_newbcast:5 row_mask:0xf bank_mask:0xf
    v_dot2c_f32_bf16_dpp v17, v63, v74 row_newbcast:5 row_mask:0xf bank_mask:0xf
    v_dot2c_f32_bf16_dpp v18, v61, v75 row_newbcast:5 row_mask:0xf bank_mask:0xf
    v_dot2c_f32_bf16_dpp v19, v63, v75 row_newbcast:5 row_mask:0xf bank_mask:0xf
    s_mov_b32 s6, 17920
    buffer_load_dwordx4 v[72:75], v4, s[24:27], s6 offen
    s_waitcnt vmcnt(15)
    v_dot2c_f32_bf16_dpp v12, v61, v76 row_newbcast:6 row_mask:0xf bank_mask:0xf
    v_dot2c_f32_bf16_dpp v13, v63, v76 row_newbcast:6 row_mask:0xf bank_mask:0xf
    v_dot2c_f32_bf16_dpp v14, v61, v77 row_newbcast:6 row_mask:0xf bank_mask:0xf
    v_dot2c_f32_bf16_dpp v15, v63, v77 row_newbcast:6 row_mask:0xf bank_mask:0xf
    v_dot2c_f32_bf16_dpp v16, v61, v78 row_newbcast:6 row_mask:0xf bank_mask:0xf
    v_dot2c_f32_bf16_dpp v17, v63, v78 row_newbcast:6 row_mask:0xf bank_mask:0xf
    v_dot2c_f32_bf16_dpp v18, v61, v79 row_newbcast:6 row_mask:0xf bank_mask:0xf
    v_dot2c_f32_bf16_dpp v19, v63, v79 row_newbcast:6 row_mask:0xf bank_mask:0xf
    s_mov_b32 s6, 21504
    buffer_load_dwordx4 v[76:79], v4, s[24:27], s6 offen
    s_waitcnt vmcnt(15)
    v_dot2c_f32_bf16_dpp v12, v61, v80 row_newbcast:7 row_mask:0xf bank_mask:0xf
    v_dot2c_f32_bf16_dpp v13, v63, v80 row_newbcast:7 row_mask:0xf bank_mask:0xf
    v_dot2c_f32_bf16_dpp v14, v61, v81 row_newbcast:7 row_mask:0xf bank_mask:0xf
    v_dot2c_f32_bf16_dpp v15, v63, v81 row_newbcast:7 row_mask:0xf bank_mask:0xf
    v_dot2c_f32_bf16_dpp v16, v61, v82 row_newbcast:7 row_mask:0xf bank_mask:0xf
    v_dot2c_f32_bf16_dpp v17, v63, v82 row_newbcast:7 row_mask:0xf bank_mask:0xf
    v_dot2c_f32_bf16_dpp v18, v61, v83 row_newbcast:7 row_mask:0xf bank_mask:0xf
    v_dot2c_f32_bf16_dpp v19, v63, v83 row_newbcast:7 row_mask:0xf bank_mask:0xf
    s_mov_b32 s6, 25088
    buffer_load_dwordx4 v[80:83], v4, s[24:27], s6 offen
    s_waitcnt vmcnt(15)
    v_dot2c_f32_bf16_dpp v12, v61, v84 row_newbcast:8 row_mask:0xf bank_mask:0xf
    v_dot2c_f32_bf16_dpp v13, v63, v84 row_newbcast:8 row_mask:0xf bank_mask:0xf
    v_dot2c_f32_bf16_dpp v14, v61, v85 row_newbcast:8 row_mask:0xf bank_mask:0xf
    v_dot2c_f32_bf16_dpp v15, v63, v85 row_newbcast:8 row_mask:0xf bank_mask:0xf
    v_dot2c_f32_bf16_dpp v16, v61, v86 row_newbcast:8 row_mask:0xf bank_mask:0xf
    v_dot2c_f32_bf16_dpp v17, v63, v86 row_newbcast:8 row_mask:0xf bank_mask:0xf
    v_dot2c_f32_bf16_dpp v18, v61, v87 row_newbcast:8 row_mask:0xf bank_mask:0xf
    v_dot2c_f32_bf16_dpp v19, v63, v87 row_newbcast:8 row_mask:0xf bank_mask:0xf
    s_mov_b32 s6, 28672
    buffer_load_dwordx4 v[84:87], v4, s[24:27], s6 offen
    s_waitcnt vmcnt(15)
    v_dot2c_f32_bf16_dpp v12, v61, v88 row_newbcast:9 row_mask:0xf bank_mask:0xf
    v_dot2c_f32_bf16_dpp v13, v63, v88 row_newbcast:9 row_mask:0xf bank_mask:0xf
    v_dot2c_f32_bf16_dpp v14, v61, v89 row_newbcast:9 row_mask:0xf bank_mask:0xf
    v_dot2c_f32_bf16_dpp v15, v63, v89 row_newbcast:9 row_mask:0xf bank_mask:0xf
    v_dot2c_f32_bf16_dpp v16, v61, v90 row_newbcast:9 row_mask:0xf bank_mask:0xf
    v_dot2c_f32_bf16_dpp v17, v63, v90 row_newbcast:9 row_mask:0xf bank_mask:0xf
    v_dot2c_f32_bf16_dpp v18, v61, v91 row_newbcast:9 row_mask:0xf bank_mask:0xf
    v_dot2c_f32_bf16_dpp v19, v63, v91 row_newbcast:9 row_mask:0xf bank_mask:0xf
    s_mov_b32 s6, 32256
    buffer_load_dwordx4 v[88:91], v4, s[24:27], s6 offen
    s_waitcnt vmcnt(15)
    v_dot2c_f32_bf16_dpp v12, v61, v92 row_newbcast:10 row_mask:0xf bank_mask:0xf
    v_dot2c_f32_bf16_dpp v13, v63, v92 row_newbcast:10 row_mask:0xf bank_mask:0xf
    v_dot2c_f32_bf16_dpp v14, v61, v93 row_newbcast:10 row_mask:0xf bank_mask:0xf
    v_dot2c_f32_bf16_dpp v15, v63, v93 row_newbcast:10 row_mask:0xf bank_mask:0xf
    v_dot2c_f32_bf16_dpp v16, v61, v94 row_newbcast:10 row_mask:0xf bank_mask:0xf
    v_dot2c_f32_bf16_dpp v17, v63, v94 row_newbcast:10 row_mask:0xf bank_mask:0xf
    v_dot2c_f32_bf16_dpp v18, v61, v95 row_newbcast:10 row_mask:0xf bank_mask:0xf
    v_dot2c_f32_bf16_dpp v19, v63, v95 row_newbcast:10 row_mask:0xf bank_mask:0xf
    s_mov_b32 s6, 35840
    buffer_load_dwordx4 v[92:95], v4, s[24:27], s6 offen
    s_waitcnt vmcnt(15)
    v_dot2c_f32_bf16_dpp v12, v61, v96 row_newbcast:11 row_mask:0xf bank_mask:0xf
    v_dot2c_f32_bf16_dpp v13, v63, v96 row_newbcast:11 row_mask:0xf bank_mask:0xf
    v_dot2c_f32_bf16_dpp v14, v61, v97 row_newbcast:11 row_mask:0xf bank_mask:0xf
    v_dot2c_f32_bf16_dpp v15, v63, v97 row_newbcast:11 row_mask:0xf bank_mask:0xf
    v_dot2c_f32_bf16_dpp v16, v61, v98 row_newbcast:11 row_mask:0xf bank_mask:0xf
    v_dot2c_f32_bf16_dpp v17, v63, v98 row_newbcast:11 row_mask:0xf bank_mask:0xf
    v_dot2c_f32_bf16_dpp v18, v61, v99 row_newbcast:11 row_mask:0xf bank_mask:0xf
    v_dot2c_f32_bf16_dpp v19, v63, v99 row_newbcast:11 row_mask:0xf bank_mask:0xf
    s_mov_b32 s6, 39424
    buffer_load_dwordx4 v[96:99], v4, s[24:27], s6 offen
    s_waitcnt vmcnt(15)
    v_dot2c_f32_bf16_dpp v12, v61, v100 row_newbcast:12 row_mask:0xf bank_mask:0xf
    v_dot2c_f32_bf16_dpp v13, v63, v100 row_newbcast:12 row_mask:0xf bank_mask:0xf
    v_dot2c_f32_bf16_dpp v14, v61, v101 row_newbcast:12 row_mask:0xf bank_mask:0xf
    v_dot2c_f32_bf16_dpp v15, v63, v101 row_newbcast:12 row_mask:0xf bank_mask:0xf
    v_dot2c_f32_bf16_dpp v16, v61, v102 row_newbcast:12 row_mask:0xf bank_mask:0xf
    v_dot2c_f32_bf16_dpp v17, v63, v102 row_newbcast:12 row_mask:0xf bank_mask:0xf
    v_dot2c_f32_bf16_dpp v18, v61, v103 row_newbcast:12 row_mask:0xf bank_mask:0xf
    v_dot2c_f32_bf16_dpp v19, v63, v103 row_newbcast:12 row_mask:0xf bank_mask:0xf
    s_mov_b32 s6, 43008
    buffer_load_dwordx4 v[100:103], v4, s[24:27], s6 offen
    s_waitcnt vmcnt(15)
    v_dot2c_f32_bf16_dpp v12, v61, v104 row_newbcast:13 row_mask:0xf bank_mask:0xf
    v_dot2c_f32_bf16_dpp v13, v63, v104 row_newbcast:13 row_mask:0xf bank_mask:0xf
    v_dot2c_f32_bf16_dpp v14, v61, v105 row_newbcast:13 row_mask:0xf bank_mask:0xf
    v_dot2c_f32_bf16_dpp v15, v63, v105 row_newbcast:13 row_mask:0xf bank_mask:0xf
    v_dot2c_f32_bf16_dpp v16, v61, v106 row_newbcast:13 row_mask:0xf bank_mask:0xf
    v_dot2c_f32_bf16_dpp v17, v63, v106 row_newbcast:13 row_mask:0xf bank_mask:0xf
    v_dot2c_f32_bf16_dpp v18, v61, v107 row_newbcast:13 row_mask:0xf bank_mask:0xf
    v_dot2c_f32_bf16_dpp v19, v63, v107 row_newbcast:13 row_mask:0xf bank_mask:0xf
    s_mov_b32 s6, 46592
    buffer_load_dwordx4 v[104:107], v4, s[24:27], s6 offen
    s_waitcnt vmcnt(15)
    v_dot2c_f32_bf16_dpp v12, v61, v108 row_newbcast:14 row_mask:0xf bank_mask:0xf
    v_dot2c_f32_bf16_dpp v13, v63, v108 row_newbcast:14 row_mask:0xf bank_mask:0xf
    v_dot2c_f32_bf16_dpp v14, v61, v109 row_newbcast:14 row_mask:0xf bank_mask:0xf
    v_dot2c_f32_bf16_dpp v15, v63, v109 row_newbcast:14 row_mask:0xf bank_mask:0xf
    v_dot2c_f32_bf16_dpp v16, v61, v110 row_newbcast:14 row_mask:0xf bank_mask:0xf
    v_dot2c_f32_bf16_dpp v17, v63, v110 row_newbcast:14 row_mask:0xf bank_mask:0xf
    v_dot2c_f32_bf16_dpp v18, v61, v111 row_newbcast:14 row_mask:0xf bank_mask:0xf
    v_dot2c_f32_bf16_dpp v19, v63, v111 row_newbcast:14 row_mask:0xf bank_mask:0xf
    s_mov_b32 s6, 50176
    buffer_load_dwordx4 v[108:111], v4, s[24:27], s6 offen
    s_waitcnt vmcnt(15)
    v_dot2c_f32_bf16_dpp v12, v61, v112 row_newbcast:15 row_mask:0xf bank_mask:0xf
    v_dot2c_f32_bf16_dpp v13, v63, v112 row_newbcast:15 row_mask:0xf bank_mask:0xf
    v_dot2c_f32_bf16_dpp v14, v61, v113 row_newbcast:15 row_mask:0xf bank_mask:0xf
    v_dot2c_f32_bf16_dpp v15, v63, v113 row_newbcast:15 row_mask:0xf bank_mask:0xf
    v_dot2c_f32_bf16_dpp v16, v61, v114 row_newbcast:15 row_mask:0xf bank_mask:0xf
    v_dot2c_f32_bf16_dpp v17, v63, v114 row_newbcast:15 row_mask:0xf bank_mask:0xf
    v_dot2c_f32_bf16_dpp v18, v61, v115 row_newbcast:15 row_mask:0xf bank_mask:0xf
    v_dot2c_f32_bf16_dpp v19, v63, v115 row_newbcast:15 row_mask:0xf bank_mask:0xf
    s_mov_b32 s6, 53760
    buffer_load_dwordx4 v[112:115], v4, s[24:27], s6 offen
    s_nop 2
    ds_write_b128 v6, v[12:15] offset:0
    ds_write_b128 v6, v[16:19] offset:16
    s_waitcnt lgkmcnt(0)
    s_barrier
    s_cmp_ge_u32 s5, 2
    s_cbranch_scc1 NOPUB_260
    s_lshl_b32 s7, s5, 10
    v_lshl_add_u32 v7, v0, 4, s7
    ds_read_b128 v[36:39], v7 offset:0
    ds_read_b128 v[40:43], v7 offset:2048
    ds_read_b128 v[44:47], v7 offset:4096
    ds_read_b128 v[48:51], v7 offset:6144
    v_lshrrev_b32 v55, 6, v7
    v_lshlrev_b32 v55, 11, v55
    v_and_b32 v7, 48, v7
    v_add_u32 v55, v55, v7
    s_lshl_b32 s7, s3, 16
    s_lshl_b32 s6, s4, 6
    s_add_u32 s7, s7, s6
    s_add_u32 s7, s7, 0
    s_lshl_b32 s6, s3, 5
    v_mov_b32 v62, s6
    s_mov_b32 s78, 0x20000
    s_mov_b32 s80, 32
    v_cmp_le_u32 vcc, s80, v9
    s_cbranch_vccnz STARTOK_262
START_261:
    buffer_load_dword v63, v62, s[44:47], 0 offen sc0 sc1
    s_waitcnt vmcnt(0)
    v_cmp_le_u32 vcc, s80, v63
    s_cbranch_vccnz STARTOK_262
    s_sub_u32 s78, s78, 1
    s_cmp_eq_u32 s78, 0
    s_cbranch_scc0 START_261
STARTOK_262:
    s_waitcnt lgkmcnt(0)
    v_add_f32 v36, v36, v40
    v_add_f32 v44, v44, v48
    v_add_f32 v37, v37, v41
    v_add_f32 v45, v45, v49
    v_add_f32 v38, v38, v42
    v_add_f32 v46, v46, v50
    v_add_f32 v39, v39, v43
    v_add_f32 v47, v47, v51
    v_add_f32 v36, v36, v44
    v_add_f32 v37, v37, v45
    v_add_f32 v38, v38, v46
    v_add_f32 v39, v39, v47
    buffer_store_dwordx4 v[36:39], v55, s[32:35], s7 offen sc0 sc1
NOPUB_260:
    s_cmp_lg_u32 s5, 0
    s_cbranch_scc1 NOHOP_263
    s_lshl_b32 s7, s3, 16
    s_lshl_b32 s6, s4, 11
    s_add_u32 s7, s7, s6
    s_add_u32 s7, s7, 0
    v_lshlrev_b32 v7, 4, v0
    s_mov_b32 s78, 0x20000
HA_265:
    buffer_load_dwordx4 v[36:39], v7, s[32:35], s7 offen sc0 sc1
    buffer_load_dwordx4 v[40:43], v7, s[32:35], s7 offen offset:1024 sc0 sc1
    s_waitcnt vmcnt(0)
    v_max3_u32 v63, v36, v37, v38
    v_max3_u32 v63, v63, v39, v40
    v_max3_u32 v63, v63, v41, v42
    v_max_u32 v63, v63, v43
    v_cmp_eq_u32 vcc, -1, v63
    s_cbranch_vccz HAOK_266
    s_sub_u32 s78, s78, 1
    s_cmp_eq_u32 s78, 0
    s_cbranch_scc0 HA_265
HAOK_266:
    v_add_f32 v36, v36, v40
    v_add_f32 v37, v37, v41
    v_add_f32 v38, v38, v42
    v_add_f32 v39, v39, v43
    s_nop 1
    v_add_f32_dpp v36, v36, v36 row_ror:4 row_mask:0xf bank_mask:0xf
    v_add_f32_dpp v37, v37, v37 row_ror:4 row_mask:0xf bank_mask:0xf
    v_add_f32_dpp v38, v38, v38 row_ror:4 row_mask:0xf bank_mask:0xf
    v_add_f32_dpp v39, v39, v39 row_ror:4 row_mask:0xf bank_mask:0xf
    s_nop 1
    v_add_f32_dpp v36, v36, v36 row_ror:8 row_mask:0xf bank_mask:0xf
    v_add_f32_dpp v37, v37, v37 row_ror:8 row_mask:0xf bank_mask:0xf
    v_add_f32_dpp v38, v38, v38 row_ror:8 row_mask:0xf bank_mask:0xf
    v_add_f32_dpp v39, v39, v39 row_ror:8 row_mask:0xf bank_mask:0xf
    v_mov_b32 v40, v36
    v_mov_b32 v41, v37
    v_mov_b32 v42, v38
    v_mov_b32 v43, v39
    s_nop 1
    v_permlane16_swap_b32 v40, v36
    v_permlane16_swap_b32 v41, v37
    v_permlane16_swap_b32 v42, v38
    v_permlane16_swap_b32 v43, v39
    s_nop 1
    v_add_f32 v36, v36, v40
    v_add_f32 v37, v37, v41
    v_add_f32 v38, v38, v42
    v_add_f32 v39, v39, v43
    v_mov_b32 v40, v36
    v_mov_b32 v41, v37
    v_mov_b32 v42, v38
    v_mov_b32 v43, v39
    s_nop 1
    v_permlane32_swap_b32 v40, v36
    v_permlane32_swap_b32 v41, v37
    v_permlane32_swap_b32 v42, v38
    v_permlane32_swap_b32 v43, v39
    s_nop 1
    v_add_f32 v36, v36, v40
    v_add_f32 v37, v37, v41
    v_add_f32 v38, v38, v42
    v_add_f32 v39, v39, v43
    v_cvt_pk_bf16_f32 v40, v36, v37
    v_cvt_pk_bf16_f32 v41, v38, v39
    v_lshlrev_b32 v36, 16, v40
    v_and_b32 v37, 0xffff0000, v40
    v_lshlrev_b32 v38, 16, v41
    v_and_b32 v39, 0xffff0000, v41
    v_add_f32 v36, v36, v56
    v_add_f32 v37, v37, v57
    v_add_f32 v38, v38, v58
    v_add_f32 v39, v39, v59
    v_cvt_pk_bf16_f32 v40, v36, v37
    v_cvt_pk_bf16_f32 v41, v38, v39
    v_lshlrev_b32 v56, 16, v40
    v_and_b32 v57, 0xffff0000, v40
    v_lshlrev_b32 v58, 16, v41
    v_and_b32 v59, 0xffff0000, v41
    v_lshrrev_b32 v55, 2, v0
    v_lshlrev_b32 v55, 11, v55
    v_and_b32 v7, 3, v0
    v_lshl_add_u32 v55, v7, 4, v55
    s_lshl_b32 s7, s3, 16
    s_lshl_b32 s6, s4, 6
    s_add_u32 s7, s7, s6
    s_add_u32 s7, s7, 2097152
    s_add_u32 s6, s7, 32768
    buffer_store_dwordx4 v[56:59], v55, s[32:35], s7 offen sc0 sc1
    buffer_store_dwordx4 v[56:59], v55, s[32:35], s6 offen sc0 sc1
    s_lshl_b32 s7, s3, 16
    s_lshl_b32 s6, s4, 11
    s_add_u32 s7, s7, s6
    s_add_u32 s7, s7, 2097152
    v_lshlrev_b32 v7, 5, v0
    s_mov_b32 s78, 0x20000
HB_267:
    buffer_load_dwordx4 v[36:39], v7, s[32:35], s7 offen sc0 sc1
    buffer_load_dwordx4 v[40:43], v7, s[32:35], s7 offen offset:16 sc0 sc1
    s_waitcnt vmcnt(0)
    v_max3_u32 v63, v36, v37, v38
    v_max3_u32 v63, v63, v39, v40
    v_max3_u32 v63, v63, v41, v42
    v_max_u32 v63, v63, v43
    v_cmp_eq_u32 vcc, -1, v63
    s_cbranch_vccz HBOK_268
    s_sub_u32 s78, s78, 1
    s_cmp_eq_u32 s78, 0
    s_cbranch_scc0 HB_267
HBOK_268:
    v_add_f32 v60, v36, v37
    v_add_f32 v60, v60, v38
    v_add_f32 v60, v60, v39
    v_add_f32 v60, v60, v40
    v_add_f32 v60, v60, v41
    v_add_f32 v60, v60, v42
    v_add_f32 v60, v60, v43
    s_nop 1
    v_add_f32_dpp v60, v60, v60 row_ror:8 row_mask:0xf bank_mask:0xf
    s_nop 1
    v_add_f32_dpp v60, v60, v60 row_ror:4 row_mask:0xf bank_mask:0xf
    s_nop 1
    v_add_f32_dpp v60, v60, v60 row_ror:2 row_mask:0xf bank_mask:0xf
    s_nop 1
    v_add_f32_dpp v60, v60, v60 row_ror:1 row_mask:0xf bank_mask:0xf
    v_mov_b32 v61, v60
    s_nop 1
    v_permlane16_swap_b32 v61, v60
    s_nop 1
    v_add_f32 v60, v60, v61
    v_mov_b32 v61, v60
    s_nop 1
    v_permlane32_swap_b32 v61, v60
    s_nop 1
    v_add_f32 v60, v60, v61
    v_mul_f32 v60, 0x3b000000, v60
    v_sub_f32 v36, v36, v60
    v_sub_f32 v37, v37, v60
    v_sub_f32 v38, v38, v60
    v_sub_f32 v39, v39, v60
    v_sub_f32 v40, v40, v60
    v_sub_f32 v41, v41, v60
    v_sub_f32 v42, v42, v60
    v_sub_f32 v43, v43, v60
    v_mul_f32 v60, v36, v36
    v_fma_f32 v60, v37, v37, v60
    v_fma_f32 v60, v38, v38, v60
    v_fma_f32 v60, v39, v39, v60
    v_fma_f32 v60, v40, v40, v60
    v_fma_f32 v60, v41, v41, v60
    v_fma_f32 v60, v42, v42, v60
    v_fma_f32 v60, v43, v43, v60
    s_nop 1
    v_add_f32_dpp v60, v60, v60 row_ror:8 row_mask:0xf bank_mask:0xf
    s_nop 1
    v_add_f32_dpp v60, v60, v60 row_ror:4 row_mask:0xf bank_mask:0xf
    s_nop 1
    v_add_f32_dpp v60, v60, v60 row_ror:2 row_mask:0xf bank_mask:0xf
    s_nop 1
    v_add_f32_dpp v60, v60, v60 row_ror:1 row_mask:0xf bank_mask:0xf
    v_mov_b32 v61, v60
    s_nop 1
    v_permlane16_swap_b32 v61, v60
    s_nop 1
    v_add_f32 v60, v60, v61
    v_mov_b32 v61, v60
    s_nop 1
    v_permlane32_swap_b32 v61, v60
    s_nop 1
    v_add_f32 v60, v60, v61
    v_mov_b32 v61, 0x3727c5ac
    v_fmac_f32 v61, 0x3b000000, v60
    v_rsq_f32 v60, v61
    s_nop 0
    v_mul_f32 v36, v36, v60
    v_mul_f32 v37, v37, v60
    v_mul_f32 v38, v38, v60
    v_mul_f32 v39, v39, v60
    v_mul_f32 v40, v40, v60
    v_mul_f32 v41, v41, v60
    v_mul_f32 v42, v42, v60
    v_mul_f32 v43, v43, v60
    v_cvt_pk_bf16_f32 v36, v36, 0
    v_cvt_pk_bf16_f32 v37, v37, 0
    v_cvt_pk_bf16_f32 v38, v38, 0
    v_cvt_pk_bf16_f32 v39, v39, 0
    v_cvt_pk_bf16_f32 v40, v40, 0
    v_cvt_pk_bf16_f32 v41, v41, 0
    v_cvt_pk_bf16_f32 v42, v42, 0
    v_cvt_pk_bf16_f32 v43, v43, 0
    v_lshlrev_b32 v7, 5, v0
    ds_write_b128 v7, v[36:39] offset:16384
    ds_write_b128 v7, v[40:43] offset:16400
    s_waitcnt lgkmcnt(0)
    s_branch HOPJOIN_264
NOHOP_263:
HOPJOIN_264:
    s_waitcnt lgkmcnt(0)
    s_barrier
    v_lshrrev_b32 v7, 3, v0
    v_lshlrev_b32 v7, 6, v7
    s_lshl_b32 s7, s5, 9
    v_add_u32 v7, s7, v7
    ds_read_b128 v[20:23], v7 offset:16384
    ds_read_b128 v[24:27], v7 offset:16400
    ds_read_b128 v[28:31], v7 offset:16416
    ds_read_b128 v[32:35], v7 offset:16432
    v_mov_b32 v12, 0
    v_mov_b32 v13, 0
    v_mov_b32 v14, 0
    v_mov_b32 v15, 0
    v_mov_b32 v16, 0
    v_mov_b32 v17, 0
    v_mov_b32 v18, 0
    v_mov_b32 v19, 0
    s_waitcnt lgkmcnt(0)
    v_lshlrev_b32 v52, 16, v20
    s_waitcnt vmcnt(15)
    v_dot2c_f32_bf16 v12, v20, v116
    v_dot2c_f32_bf16 v13, v52, v116
    v_dot2c_f32_bf16 v14, v20, v117
    v_dot2c_f32_bf16 v15, v52, v117
    v_dot2c_f32_bf16 v16, v20, v118
    v_dot2c_f32_bf16 v17, v52, v118
    v_dot2c_f32_bf16 v18, v20, v119
    v_dot2c_f32_bf16 v19, v52, v119
    buffer_load_dwordx4 v[116:119], v5, s[28:31], 0 offen
    v_lshlrev_b32 v54, 16, v21
    s_waitcnt vmcnt(15)
    v_dot2c_f32_bf16 v12, v21, v120
    v_dot2c_f32_bf16 v13, v54, v120
    v_dot2c_f32_bf16 v14, v21, v121
    v_dot2c_f32_bf16 v15, v54, v121
    v_dot2c_f32_bf16 v16, v21, v122
    v_dot2c_f32_bf16 v17, v54, v122
    v_dot2c_f32_bf16 v18, v21, v123
    v_dot2c_f32_bf16 v19, v54, v123
    buffer_load_dwordx4 v[120:123], v5, s[28:31], 0 offen offset:1024
    v_lshlrev_b32 v52, 16, v22
    s_waitcnt vmcnt(15)
    v_dot2c_f32_bf16 v12, v22, v124
    v_dot2c_f32_bf16 v13, v52, v124
    v_dot2c_f32_bf16 v14, v22, v125
    v_dot2c_f32_bf16 v15, v52, v125
    v_dot2c_f32_bf16 v16, v22, v126
    v_dot2c_f32_bf16 v17, v52, v126
    v_dot2c_f32_bf16 v18, v22, v127
    v_dot2c_f32_bf16 v19, v52, v127
    buffer_load_dwordx4 v[124:127], v5, s[28:31], 0 offen offset:2048
    v_lshlrev_b32 v54, 16, v23
    s_waitcnt vmcnt(15)
    v_dot2c_f32_bf16 v12, v23, v64
    v_dot2c_f32_bf16 v13, v54, v64
    v_dot2c_f32_bf16 v14, v23, v65
    v_dot2c_f32_bf16 v15, v54, v65
    v_dot2c_f32_bf16 v16, v23, v66
    v_dot2c_f32_bf16 v17, v54, v66
    v_dot2c_f32_bf16 v18, v23, v67
    v_dot2c_f32_bf16 v19, v54, v67
    buffer_load_dwordx4 v[64:67], v5, s[28:31], 0 offen offset:3072
    v_lshlrev_b32 v52, 16, v24
    s_waitcnt vmcnt(15)
    v_dot2c_f32_bf16 v12, v24, v68
    v_dot2c_f32_bf16 v13, v52, v68
    v_dot2c_f32_bf16 v14, v24, v69
    v_dot2c_f32_bf16 v15, v52, v69
    v_dot2c_f32_bf16 v16, v24, v70
    v_dot2c_f32_bf16 v17, v52, v70
    v_dot2c_f32_bf16 v18, v24, v71
    v_dot2c_f32_bf16 v19, v52, v71
    s_mov_b32 s6, 4096
    buffer_load_dwordx4 v[68:71], v5, s[28:31], s6 offen
    v_lshlrev_b32 v54, 16, v25
    s_waitcnt vmcnt(15)
    v_dot2c_f32_bf16 v12, v25, v72
    v_dot2c_f32_bf16 v13, v54, v72
    v_dot2c_f32_bf16 v14, v25, v73
    v_dot2c_f32_bf16 v15, v54, v73
    v_dot2c_f32_bf16 v16, v25, v74
    v_dot2c_f32_bf16 v17, v54, v74
    v_dot2c_f32_bf16 v18, v25, v75
    v_dot2c_f32_bf16 v19, v54, v75
    buffer_load_dwordx4 v[72:75], v5, s[28:31], s6 offen offset:1024
    v_lshlrev_b32 v52, 16, v26
    s_waitcnt vmcnt(15)
    v_dot2c_f32_bf16 v12, v26, v76
    v_dot2c_f32_bf16 v13, v52, v76
    v_dot2c_f32_bf16 v14, v26, v77
    v_dot2c_f32_bf16 v15, v52, v77
    v_dot2c_f32_bf16 v16, v26, v78
    v_dot2c_f32_bf16 v17, v52, v78
    v_dot2c_f32_bf16 v18, v26, v79
    v_dot2c_f32_bf16 v19, v52, v79
    buffer_load_dwordx4 v[76:79], v5, s[28:31], s6 offen offset:2048
    v_lshlrev_b32 v54, 16, v27
    s_waitcnt vmcnt(15)
    v_dot2c_f32_bf16 v12, v27, v80
    v_dot2c_f32_bf16 v13, v54, v80
    v_dot2c_f32_bf16 v14, v27, v81
    v_dot2c_f32_bf16 v15, v54, v81
    v_dot2c_f32_bf16 v16, v27, v82
    v_dot2c_f32_bf16 v17, v54, v82
    v_dot2c_f32_bf16 v18, v27, v83
    v_dot2c_f32_bf16 v19, v54, v83
    buffer_load_dwordx4 v[80:83], v5, s[28:31], s6 offen offset:3072
    v_lshlrev_b32 v52, 16, v28
    s_waitcnt vmcnt(15)
    v_dot2c_f32_bf16 v12, v28, v84
    v_dot2c_f32_bf16 v13, v52, v84
    v_dot2c_f32_bf16 v14, v28, v85
    v_dot2c_f32_bf16 v15, v52, v85
    v_dot2c_f32_bf16 v16, v28, v86
    v_dot2c_f32_bf16 v17, v52, v86
    v_dot2c_f32_bf16 v18, v28, v87
    v_dot2c_f32_bf16 v19, v52, v87
    s_mov_b32 s6, 8192
    buffer_load_dwordx4 v[84:87], v5, s[28:31], s6 offen
    v_lshlrev_b32 v54, 16, v29
    s_waitcnt vmcnt(15)
    v_dot2c_f32_bf16 v12, v29, v88
    v_dot2c_f32_bf16 v13, v54, v88
    v_dot2c_f32_bf16 v14, v29, v89
    v_dot2c_f32_bf16 v15, v54, v89
    v_dot2c_f32_bf16 v16, v29, v90
    v_dot2c_f32_bf16 v17, v54, v90
    v_dot2c_f32_bf16 v18, v29, v91
    v_dot2c_f32_bf16 v19, v54, v91
    buffer_load_dwordx4 v[88:91], v5, s[28:31], s6 offen offset:1024
    v_lshlrev_b32 v52, 16, v30
    s_waitcnt vmcnt(15)
    v_dot2c_f32_bf16 v12, v30, v92
    v_dot2c_f32_bf16 v13, v52, v92
    v_dot2c_f32_bf16 v14, v30, v93
    v_dot2c_f32_bf16 v15, v52, v93
    v_dot2c_f32_bf16 v16, v30, v94
    v_dot2c_f32_bf16 v17, v52, v94
    v_dot2c_f32_bf16 v18, v30, v95
    v_dot2c_f32_bf16 v19, v52, v95
    buffer_load_dwordx4 v[92:95], v5, s[28:31], s6 offen offset:2048
    v_lshlrev_b32 v54, 16, v31
    s_waitcnt vmcnt(15)
    v_dot2c_f32_bf16 v12, v31, v96
    v_dot2c_f32_bf16 v13, v54, v96
    v_dot2c_f32_bf16 v14, v31, v97
    v_dot2c_f32_bf16 v15, v54, v97
    v_dot2c_f32_bf16 v16, v31, v98
    v_dot2c_f32_bf16 v17, v54, v98
    v_dot2c_f32_bf16 v18, v31, v99
    v_dot2c_f32_bf16 v19, v54, v99
    buffer_load_dwordx4 v[96:99], v5, s[28:31], s6 offen offset:3072
    v_lshlrev_b32 v52, 16, v32
    s_waitcnt vmcnt(15)
    v_dot2c_f32_bf16 v12, v32, v100
    v_dot2c_f32_bf16 v13, v52, v100
    v_dot2c_f32_bf16 v14, v32, v101
    v_dot2c_f32_bf16 v15, v52, v101
    v_dot2c_f32_bf16 v16, v32, v102
    v_dot2c_f32_bf16 v17, v52, v102
    v_dot2c_f32_bf16 v18, v32, v103
    v_dot2c_f32_bf16 v19, v52, v103
    s_mov_b32 s6, 12288
    buffer_load_dwordx4 v[100:103], v5, s[28:31], s6 offen
    v_lshlrev_b32 v54, 16, v33
    s_waitcnt vmcnt(15)
    v_dot2c_f32_bf16 v12, v33, v104
    v_dot2c_f32_bf16 v13, v54, v104
    v_dot2c_f32_bf16 v14, v33, v105
    v_dot2c_f32_bf16 v15, v54, v105
    v_dot2c_f32_bf16 v16, v33, v106
    v_dot2c_f32_bf16 v17, v54, v106
    v_dot2c_f32_bf16 v18, v33, v107
    v_dot2c_f32_bf16 v19, v54, v107
    buffer_load_dwordx4 v[104:107], v5, s[28:31], s6 offen offset:1024
    v_lshlrev_b32 v52, 16, v34
    s_waitcnt vmcnt(15)
    v_dot2c_f32_bf16 v12, v34, v108
    v_dot2c_f32_bf16 v13, v52, v108
    v_dot2c_f32_bf16 v14, v34, v109
    v_dot2c_f32_bf16 v15, v52, v109
    v_dot2c_f32_bf16 v16, v34, v110
    v_dot2c_f32_bf16 v17, v52, v110
    v_dot2c_f32_bf16 v18, v34, v111
    v_dot2c_f32_bf16 v19, v52, v111
    buffer_load_dwordx4 v[108:111], v2, s[16:19], 0 offen
    v_lshlrev_b32 v54, 16, v35
    s_waitcnt vmcnt(15)
    v_dot2c_f32_bf16 v12, v35, v112
    v_dot2c_f32_bf16 v13, v54, v112
    v_dot2c_f32_bf16 v14, v35, v113
    v_dot2c_f32_bf16 v15, v54, v113
    v_dot2c_f32_bf16 v16, v35, v114
    v_dot2c_f32_bf16 v17, v54, v114
    v_dot2c_f32_bf16 v18, v35, v115
    v_dot2c_f32_bf16 v19, v54, v115
    s_mov_b32 s6, 32768
    buffer_load_dwordx4 v[112:115], v2, s[16:19], s6 offen
    s_nop 2
    ds_write_b128 v6, v[12:15] offset:8192
    ds_write_b128 v6, v[16:19] offset:8208
    s_waitcnt lgkmcnt(0)
    s_barrier
    v_lshrrev_b32 v7, 4, v0
    v_lshlrev_b32 v7, 11, v7
    v_and_b32 v55, 15, v0
    v_lshl_add_u32 v7, v55, 2, v7
    s_mul_i32 s7, s5, 56
    v_add_u32 v7, s7, v7
    ds_read_b32 v36, v7 offset:8192
    ds_read_b32 v37, v7 offset:8448
    ds_read_b32 v38, v7 offset:8704
    ds_read_b32 v39, v7 offset:8960
    ds_read_b32 v40, v7 offset:9216
    ds_read_b32 v41, v7 offset:9472
    ds_read_b32 v42, v7 offset:9728
    ds_read_b32 v43, v7 offset:9984
    s_waitcnt lgkmcnt(0)
    v_add_f32 v36, v36, v40
    v_add_f32 v37, v37, v41
    v_add_f32 v38, v38, v42
    v_add_f32 v39, v39, v43
    v_add_f32 v36, v36, v37
    v_add_f32 v38, v38, v39
    v_add_f32 v36, v36, v38
    v_mov_b32 v37, v36
    s_nop 1
    v_permlane16_swap_b32 v37, v36
    s_nop 1
    v_add_f32 v36, v36, v37
    v_mov_b32 v37, v36
    s_nop 1
    v_permlane32_swap_b32 v37, v36
    s_nop 1
    v_add_f32 v36, v36, v37
    v_cvt_pk_bf16_f32 v36, v36, 0
    v_lshlrev_b32 v36, 16, v36
    v_mul_f32 v37, 0xbfb8aa3b, v36
    v_exp_f32 v37, v37
    s_nop 0
    v_add_f32 v37, 1.0, v37
    v_rcp_f32 v37, v37
    s_nop 0
    v_mul_f32 v36, v36, v37
    v_cvt_pk_bf16_f32 v60, v36, 0
    v_lshlrev_b32 v62, 16, v60
    v_mov_b32 v12, 0
    v_mov_b32 v13, 0
    v_mov_b32 v14, 0
    v_mov_b32 v15, 0
    v_mov_b32 v16, 0
    v_mov_b32 v17, 0
    v_mov_b32 v18, 0
    v_mov_b32 v19, 0
    s_waitcnt vmcnt(15)
    v_dot2c_f32_bf16_dpp v12, v60, v116 row_newbcast:0 row_mask:0xf bank_mask:0xf
    v_dot2c_f32_bf16_dpp v13, v62, v116 row_newbcast:0 row_mask:0xf bank_mask:0xf
    v_dot2c_f32_bf16_dpp v14, v60, v117 row_newbcast:0 row_mask:0xf bank_mask:0xf
    v_dot2c_f32_bf16_dpp v15, v62, v117 row_newbcast:0 row_mask:0xf bank_mask:0xf
    v_dot2c_f32_bf16_dpp v16, v60, v118 row_newbcast:0 row_mask:0xf bank_mask:0xf
    v_dot2c_f32_bf16_dpp v17, v62, v118 row_newbcast:0 row_mask:0xf bank_mask:0xf
    v_dot2c_f32_bf16_dpp v18, v60, v119 row_newbcast:0 row_mask:0xf bank_mask:0xf
    v_dot2c_f32_bf16_dpp v19, v62, v119 row_newbcast:0 row_mask:0xf bank_mask:0xf
    s_mov_b32 s6, 65536
    buffer_load_dwordx4 v[116:119], v2, s[16:19], s6 offen
    s_waitcnt vmcnt(15)
    v_dot2c_f32_bf16_dpp v12, v60, v120 row_newbcast:1 row_mask:0xf bank_mask:0xf
    v_dot2c_f32_bf16_dpp v13, v62, v120 row_newbcast:1 row_mask:0xf bank_mask:0xf
    v_dot2c_f32_bf16_dpp v14, v60, v121 row_newbcast:1 row_mask:0xf bank_mask:0xf
    v_dot2c_f32_bf16_dpp v15, v62, v121 row_newbcast:1 row_mask:0xf bank_mask:0xf
    v_dot2c_f32_bf16_dpp v16, v60, v122 row_newbcast:1 row_mask:0xf bank_mask:0xf
    v_dot2c_f32_bf16_dpp v17, v62, v122 row_newbcast:1 row_mask:0xf bank_mask:0xf
    v_dot2c_f32_bf16_dpp v18, v60, v123 row_newbcast:1 row_mask:0xf bank_mask:0xf
    v_dot2c_f32_bf16_dpp v19, v62, v123 row_newbcast:1 row_mask:0xf bank_mask:0xf
    s_mov_b32 s6, 98304
    buffer_load_dwordx4 v[120:123], v2, s[16:19], s6 offen
    s_waitcnt vmcnt(15)
    v_dot2c_f32_bf16_dpp v12, v60, v124 row_newbcast:2 row_mask:0xf bank_mask:0xf
    v_dot2c_f32_bf16_dpp v13, v62, v124 row_newbcast:2 row_mask:0xf bank_mask:0xf
    v_dot2c_f32_bf16_dpp v14, v60, v125 row_newbcast:2 row_mask:0xf bank_mask:0xf
    v_dot2c_f32_bf16_dpp v15, v62, v125 row_newbcast:2 row_mask:0xf bank_mask:0xf
    v_dot2c_f32_bf16_dpp v16, v60, v126 row_newbcast:2 row_mask:0xf bank_mask:0xf
    v_dot2c_f32_bf16_dpp v17, v62, v126 row_newbcast:2 row_mask:0xf bank_mask:0xf
    v_dot2c_f32_bf16_dpp v18, v60, v127 row_newbcast:2 row_mask:0xf bank_mask:0xf
    v_dot2c_f32_bf16_dpp v19, v62, v127 row_newbcast:2 row_mask:0xf bank_mask:0xf
    s_mov_b32 s6, 131072
    buffer_load_dwordx4 v[124:127], v2, s[16:19], s6 offen
    s_waitcnt vmcnt(15)
    v_dot2c_f32_bf16_dpp v12, v60, v64 row_newbcast:3 row_mask:0xf bank_mask:0xf
    v_dot2c_f32_bf16_dpp v13, v62, v64 row_newbcast:3 row_mask:0xf bank_mask:0xf
    v_dot2c_f32_bf16_dpp v14, v60, v65 row_newbcast:3 row_mask:0xf bank_mask:0xf
    v_dot2c_f32_bf16_dpp v15, v62, v65 row_newbcast:3 row_mask:0xf bank_mask:0xf
    v_dot2c_f32_bf16_dpp v16, v60, v66 row_newbcast:3 row_mask:0xf bank_mask:0xf
    v_dot2c_f32_bf16_dpp v17, v62, v66 row_newbcast:3 row_mask:0xf bank_mask:0xf
    v_dot2c_f32_bf16_dpp v18, v60, v67 row_newbcast:3 row_mask:0xf bank_mask:0xf
    v_dot2c_f32_bf16_dpp v19, v62, v67 row_newbcast:3 row_mask:0xf bank_mask:0xf
    s_mov_b32 s6, 163840
    buffer_load_dwordx4 v[64:67], v2, s[16:19], s6 offen
    s_waitcnt vmcnt(15)
    v_dot2c_f32_bf16_dpp v12, v60, v68 row_newbcast:4 row_mask:0xf bank_mask:0xf
    v_dot2c_f32_bf16_dpp v13, v62, v68 row_newbcast:4 row_mask:0xf bank_mask:0xf
    v_dot2c_f32_bf16_dpp v14, v60, v69 row_newbcast:4 row_mask:0xf bank_mask:0xf
    v_dot2c_f32_bf16_dpp v15, v62, v69 row_newbcast:4 row_mask:0xf bank_mask:0xf
    v_dot2c_f32_bf16_dpp v16, v60, v70 row_newbcast:4 row_mask:0xf bank_mask:0xf
    v_dot2c_f32_bf16_dpp v17, v62, v70 row_newbcast:4 row_mask:0xf bank_mask:0xf
    v_dot2c_f32_bf16_dpp v18, v60, v71 row_newbcast:4 row_mask:0xf bank_mask:0xf
    v_dot2c_f32_bf16_dpp v19, v62, v71 row_newbcast:4 row_mask:0xf bank_mask:0xf
    s_mov_b32 s6, 196608
    buffer_load_dwordx4 v[68:71], v2, s[16:19], s6 offen
    s_waitcnt vmcnt(15)
    v_dot2c_f32_bf16_dpp v12, v60, v72 row_newbcast:5 row_mask:0xf bank_mask:0xf
    v_dot2c_f32_bf16_dpp v13, v62, v72 row_newbcast:5 row_mask:0xf bank_mask:0xf
    v_dot2c_f32_bf16_dpp v14, v60, v73 row_newbcast:5 row_mask:0xf bank_mask:0xf
    v_dot2c_f32_bf16_dpp v15, v62, v73 row_newbcast:5 row_mask:0xf bank_mask:0xf
    v_dot2c_f32_bf16_dpp v16, v60, v74 row_newbcast:5 row_mask:0xf bank_mask:0xf
    v_dot2c_f32_bf16_dpp v17, v62, v74 row_newbcast:5 row_mask:0xf bank_mask:0xf
    v_dot2c_f32_bf16_dpp v18, v60, v75 row_newbcast:5 row_mask:0xf bank_mask:0xf
    v_dot2c_f32_bf16_dpp v19, v62, v75 row_newbcast:5 row_mask:0xf bank_mask:0xf
    s_mov_b32 s6, 229376
    buffer_load_dwordx4 v[72:75], v2, s[16:19], s6 offen
    s_waitcnt vmcnt(15)
    v_dot2c_f32_bf16_dpp v12, v60, v76 row_newbcast:6 row_mask:0xf bank_mask:0xf
    v_dot2c_f32_bf16_dpp v13, v62, v76 row_newbcast:6 row_mask:0xf bank_mask:0xf
    v_dot2c_f32_bf16_dpp v14, v60, v77 row_newbcast:6 row_mask:0xf bank_mask:0xf
    v_dot2c_f32_bf16_dpp v15, v62, v77 row_newbcast:6 row_mask:0xf bank_mask:0xf
    v_dot2c_f32_bf16_dpp v16, v60, v78 row_newbcast:6 row_mask:0xf bank_mask:0xf
    v_dot2c_f32_bf16_dpp v17, v62, v78 row_newbcast:6 row_mask:0xf bank_mask:0xf
    v_dot2c_f32_bf16_dpp v18, v60, v79 row_newbcast:6 row_mask:0xf bank_mask:0xf
    v_dot2c_f32_bf16_dpp v19, v62, v79 row_newbcast:6 row_mask:0xf bank_mask:0xf
    s_mov_b32 s6, 262144
    buffer_load_dwordx4 v[76:79], v2, s[16:19], s6 offen
    s_waitcnt vmcnt(15)
    v_dot2c_f32_bf16_dpp v12, v60, v80 row_newbcast:7 row_mask:0xf bank_mask:0xf
    v_dot2c_f32_bf16_dpp v13, v62, v80 row_newbcast:7 row_mask:0xf bank_mask:0xf
    v_dot2c_f32_bf16_dpp v14, v60, v81 row_newbcast:7 row_mask:0xf bank_mask:0xf
    v_dot2c_f32_bf16_dpp v15, v62, v81 row_newbcast:7 row_mask:0xf bank_mask:0xf
    v_dot2c_f32_bf16_dpp v16, v60, v82 row_newbcast:7 row_mask:0xf bank_mask:0xf
    v_dot2c_f32_bf16_dpp v17, v62, v82 row_newbcast:7 row_mask:0xf bank_mask:0xf
    v_dot2c_f32_bf16_dpp v18, v60, v83 row_newbcast:7 row_mask:0xf bank_mask:0xf
    v_dot2c_f32_bf16_dpp v19, v62, v83 row_newbcast:7 row_mask:0xf bank_mask:0xf
    s_mov_b32 s6, 294912
    buffer_load_dwordx4 v[80:83], v2, s[16:19], s6 offen
    s_waitcnt vmcnt(15)
    v_dot2c_f32_bf16_dpp v12, v60, v84 row_newbcast:8 row_mask:0xf bank_mask:0xf
    v_dot2c_f32_bf16_dpp v13, v62, v84 row_newbcast:8 row_mask:0xf bank_mask:0xf
    v_dot2c_f32_bf16_dpp v14, v60, v85 row_newbcast:8 row_mask:0xf bank_mask:0xf
    v_dot2c_f32_bf16_dpp v15, v62, v85 row_newbcast:8 row_mask:0xf bank_mask:0xf
    v_dot2c_f32_bf16_dpp v16, v60, v86 row_newbcast:8 row_mask:0xf bank_mask:0xf
    v_dot2c_f32_bf16_dpp v17, v62, v86 row_newbcast:8 row_mask:0xf bank_mask:0xf
    v_dot2c_f32_bf16_dpp v18, v60, v87 row_newbcast:8 row_mask:0xf bank_mask:0xf
    v_dot2c_f32_bf16_dpp v19, v62, v87 row_newbcast:8 row_mask:0xf bank_mask:0xf
    s_mov_b32 s6, 327680
    buffer_load_dwordx4 v[84:87], v2, s[16:19], s6 offen
    s_waitcnt vmcnt(15)
    v_dot2c_f32_bf16_dpp v12, v60, v88 row_newbcast:9 row_mask:0xf bank_mask:0xf
    v_dot2c_f32_bf16_dpp v13, v62, v88 row_newbcast:9 row_mask:0xf bank_mask:0xf
    v_dot2c_f32_bf16_dpp v14, v60, v89 row_newbcast:9 row_mask:0xf bank_mask:0xf
    v_dot2c_f32_bf16_dpp v15, v62, v89 row_newbcast:9 row_mask:0xf bank_mask:0xf
    v_dot2c_f32_bf16_dpp v16, v60, v90 row_newbcast:9 row_mask:0xf bank_mask:0xf
    v_dot2c_f32_bf16_dpp v17, v62, v90 row_newbcast:9 row_mask:0xf bank_mask:0xf
    v_dot2c_f32_bf16_dpp v18, v60, v91 row_newbcast:9 row_mask:0xf bank_mask:0xf
    v_dot2c_f32_bf16_dpp v19, v62, v91 row_newbcast:9 row_mask:0xf bank_mask:0xf
    s_mov_b32 s6, 360448
    buffer_load_dwordx4 v[88:91], v2, s[16:19], s6 offen
    s_waitcnt vmcnt(15)
    v_dot2c_f32_bf16_dpp v12, v60, v92 row_newbcast:10 row_mask:0xf bank_mask:0xf
    v_dot2c_f32_bf16_dpp v13, v62, v92 row_newbcast:10 row_mask:0xf bank_mask:0xf
    v_dot2c_f32_bf16_dpp v14, v60, v93 row_newbcast:10 row_mask:0xf bank_mask:0xf
    v_dot2c_f32_bf16_dpp v15, v62, v93 row_newbcast:10 row_mask:0xf bank_mask:0xf
    v_dot2c_f32_bf16_dpp v16, v60, v94 row_newbcast:10 row_mask:0xf bank_mask:0xf
    v_dot2c_f32_bf16_dpp v17, v62, v94 row_newbcast:10 row_mask:0xf bank_mask:0xf
    v_dot2c_f32_bf16_dpp v18, v60, v95 row_newbcast:10 row_mask:0xf bank_mask:0xf
    v_dot2c_f32_bf16_dpp v19, v62, v95 row_newbcast:10 row_mask:0xf bank_mask:0xf
    s_mov_b32 s6, 393216
    buffer_load_dwordx4 v[92:95], v2, s[16:19], s6 offen
    s_waitcnt vmcnt(15)
    v_dot2c_f32_bf16_dpp v12, v60, v96 row_newbcast:11 row_mask:0xf bank_mask:0xf
    v_dot2c_f32_bf16_dpp v13, v62, v96 row_newbcast:11 row_mask:0xf bank_mask:0xf
    v_dot2c_f32_bf16_dpp v14, v60, v97 row_newbcast:11 row_mask:0xf bank_mask:0xf
    v_dot2c_f32_bf16_dpp v15, v62, v97 row_newbcast:11 row_mask:0xf bank_mask:0xf
    v_dot2c_f32_bf16_dpp v16, v60, v98 row_newbcast:11 row_mask:0xf bank_mask:0xf
    v_dot2c_f32_bf16_dpp v17, v62, v98 row_newbcast:11 row_mask:0xf bank_mask:0xf
    v_dot2c_f32_bf16_dpp v18, v60, v99 row_newbcast:11 row_mask:0xf bank_mask:0xf
    v_dot2c_f32_bf16_dpp v19, v62, v99 row_newbcast:11 row_mask:0xf bank_mask:0xf
    s_mov_b32 s6, 425984
    buffer_load_dwordx4 v[96:99], v2, s[16:19], s6 offen
    s_waitcnt vmcnt(15)
    v_dot2c_f32_bf16_dpp v12, v60, v100 row_newbcast:12 row_mask:0xf bank_mask:0xf
    v_dot2c_f32_bf16_dpp v13, v62, v100 row_newbcast:12 row_mask:0xf bank_mask:0xf
    v_dot2c_f32_bf16_dpp v14, v60, v101 row_newbcast:12 row_mask:0xf bank_mask:0xf
    v_dot2c_f32_bf16_dpp v15, v62, v101 row_newbcast:12 row_mask:0xf bank_mask:0xf
    v_dot2c_f32_bf16_dpp v16, v60, v102 row_newbcast:12 row_mask:0xf bank_mask:0xf
    v_dot2c_f32_bf16_dpp v17, v62, v102 row_newbcast:12 row_mask:0xf bank_mask:0xf
    v_dot2c_f32_bf16_dpp v18, v60, v103 row_newbcast:12 row_mask:0xf bank_mask:0xf
    v_dot2c_f32_bf16_dpp v19, v62, v103 row_newbcast:12 row_mask:0xf bank_mask:0xf
    s_mov_b32 s6, 458752
    buffer_load_dwordx4 v[100:103], v2, s[16:19], s6 offen
    s_waitcnt vmcnt(15)
    v_dot2c_f32_bf16_dpp v12, v60, v104 row_newbcast:13 row_mask:0xf bank_mask:0xf
    v_dot2c_f32_bf16_dpp v13, v62, v104 row_newbcast:13 row_mask:0xf bank_mask:0xf
    v_dot2c_f32_bf16_dpp v14, v60, v105 row_newbcast:13 row_mask:0xf bank_mask:0xf
    v_dot2c_f32_bf16_dpp v15, v62, v105 row_newbcast:13 row_mask:0xf bank_mask:0xf
    v_dot2c_f32_bf16_dpp v16, v60, v106 row_newbcast:13 row_mask:0xf bank_mask:0xf
    v_dot2c_f32_bf16_dpp v17, v62, v106 row_newbcast:13 row_mask:0xf bank_mask:0xf
    v_dot2c_f32_bf16_dpp v18, v60, v107 row_newbcast:13 row_mask:0xf bank_mask:0xf
    v_dot2c_f32_bf16_dpp v19, v62, v107 row_newbcast:13 row_mask:0xf bank_mask:0xf
    s_mov_b32 s6, 491520
    buffer_load_dwordx4 v[104:107], v2, s[16:19], s6 offen
    s_nop 2
    ds_write_b128 v6, v[12:15] offset:0
    ds_write_b128 v6, v[16:19] offset:16
    s_waitcnt lgkmcnt(0)
    s_barrier
    s_cmp_ge_u32 s5, 2
    s_cbranch_scc1 NOPUB_269
    s_lshl_b32 s7, s5, 10
    v_lshl_add_u32 v7, v0, 4, s7
    ds_read_b128 v[36:39], v7 offset:0
    ds_read_b128 v[40:43], v7 offset:2048
    ds_read_b128 v[44:47], v7 offset:4096
    ds_read_b128 v[48:51], v7 offset:6144
    v_lshrrev_b32 v55, 6, v7
    v_lshlrev_b32 v55, 11, v55
    v_and_b32 v7, 48, v7
    v_add_u32 v55, v55, v7
    s_lshl_b32 s7, s3, 16
    s_lshl_b32 s6, s4, 6
    s_add_u32 s7, s7, s6
    s_add_u32 s7, s7, 524288
    s_waitcnt lgkmcnt(0)
    v_add_f32 v36, v36, v40
    v_add_f32 v44, v44, v48
    v_add_f32 v37, v37, v41
    v_add_f32 v45, v45, v49
    v_add_f32 v38, v38, v42
    v_add_f32 v46, v46, v50
    v_add_f32 v39, v39, v43
    v_add_f32 v47, v47, v51
    v_add_f32 v36, v36, v44
    v_add_f32 v37, v37, v45
    v_add_f32 v38, v38, v46
    v_add_f32 v39, v39, v47
    buffer_store_dwordx4 v[36:39], v55, s[32:35], s7 offen sc0 sc1
NOPUB_269:
    s_cmp_lg_u32 s5, 0
    s_cbranch_scc1 NOHOP_270
    s_lshl_b32 s7, s3, 16
    s_lshl_b32 s6, s4, 11
    s_add_u32 s7, s7, s6
    s_add_u32 s7, s7, 524288
    v_lshlrev_b32 v7, 4, v0
    s_mov_b32 s78, 0x20000
HA_272:
    buffer_load_dwordx4 v[36:39], v7, s[32:35], s7 offen sc0 sc1
    buffer_load_dwordx4 v[40:43], v7, s[32:35], s7 offen offset:1024 sc0 sc1
    s_waitcnt vmcnt(0)
    v_max3_u32 v63, v36, v37, v38
    v_max3_u32 v63, v63, v39, v40
    v_max3_u32 v63, v63, v41, v42
    v_max_u32 v63, v63, v43
    v_cmp_eq_u32 vcc, -1, v63
    s_cbranch_vccz HAOK_273
    s_sub_u32 s78, s78, 1
    s_cmp_eq_u32 s78, 0
    s_cbranch_scc0 HA_272
HAOK_273:
    v_add_f32 v36, v36, v40
    v_add_f32 v37, v37, v41
    v_add_f32 v38, v38, v42
    v_add_f32 v39, v39, v43
    s_nop 1
    v_add_f32_dpp v36, v36, v36 row_ror:4 row_mask:0xf bank_mask:0xf
    v_add_f32_dpp v37, v37, v37 row_ror:4 row_mask:0xf bank_mask:0xf
    v_add_f32_dpp v38, v38, v38 row_ror:4 row_mask:0xf bank_mask:0xf
    v_add_f32_dpp v39, v39, v39 row_ror:4 row_mask:0xf bank_mask:0xf
    s_nop 1
    v_add_f32_dpp v36, v36, v36 row_ror:8 row_mask:0xf bank_mask:0xf
    v_add_f32_dpp v37, v37, v37 row_ror:8 row_mask:0xf bank_mask:0xf
    v_add_f32_dpp v38, v38, v38 row_ror:8 row_mask:0xf bank_mask:0xf
    v_add_f32_dpp v39, v39, v39 row_ror:8 row_mask:0xf bank_mask:0xf
    v_mov_b32 v40, v36
    v_mov_b32 v41, v37
    v_mov_b32 v42, v38
    v_mov_b32 v43, v39
    s_nop 1
    v_permlane16_swap_b32 v40, v36
    v_permlane16_swap_b32 v41, v37
    v_permlane16_swap_b32 v42, v38
    v_permlane16_swap_b32 v43, v39
    s_nop 1
    v_add_f32 v36, v36, v40
    v_add_f32 v37, v37, v41
    v_add_f32 v38, v38, v42
    v_add_f32 v39, v39, v43
    v_mov_b32 v40, v36
    v_mov_b32 v41, v37
    v_mov_b32 v42, v38
    v_mov_b32 v43, v39
    s_nop 1
    v_permlane32_swap_b32 v40, v36
    v_permlane32_swap_b32 v41, v37
    v_permlane32_swap_b32 v42, v38
    v_permlane32_swap_b32 v43, v39
    s_nop 1
    v_add_f32 v36, v36, v40
    v_add_f32 v37, v37, v41
    v_add_f32 v38, v38, v42
    v_add_f32 v39, v39, v43
    v_cvt_pk_bf16_f32 v40, v36, v37
    v_cvt_pk_bf16_f32 v41, v38, v39
    v_lshlrev_b32 v36, 16, v40
    v_and_b32 v37, 0xffff0000, v40
    v_lshlrev_b32 v38, 16, v41
    v_and_b32 v39, 0xffff0000, v41
    v_add_f32 v36, v36, v56
    v_add_f32 v37, v37, v57
    v_add_f32 v38, v38, v58
    v_add_f32 v39, v39, v59
    v_cvt_pk_bf16_f32 v40, v36, v37
    v_cvt_pk_bf16_f32 v41, v38, v39
    v_lshlrev_b32 v56, 16, v40
    v_and_b32 v57, 0xffff0000, v40
    v_lshlrev_b32 v58, 16, v41
    v_and_b32 v59, 0xffff0000, v41
    v_lshrrev_b32 v55, 2, v0
    v_lshlrev_b32 v55, 11, v55
    v_and_b32 v7, 3, v0
    v_lshl_add_u32 v55, v7, 4, v55
    s_lshl_b32 s7, s3, 16
    s_lshl_b32 s6, s4, 6
    s_add_u32 s7, s7, s6
    s_add_u32 s7, s7, 2621440
    s_add_u32 s6, s7, 32768
    buffer_store_dwordx4 v[56:59], v55, s[32:35], s7 offen sc0 sc1
    buffer_store_dwordx4 v[56:59], v55, s[32:35], s6 offen sc0 sc1
    s_lshl_b32 s7, s3, 16
    s_lshl_b32 s6, s4, 11
    s_add_u32 s7, s7, s6
    s_add_u32 s7, s7, 2621440
    v_lshlrev_b32 v7, 5, v0
    s_mov_b32 s78, 0x20000
HB_274:
    buffer_load_dwordx4 v[36:39], v7, s[32:35], s7 offen sc0 sc1
    buffer_load_dwordx4 v[40:43], v7, s[32:35], s7 offen offset:16 sc0 sc1
    s_waitcnt vmcnt(0)
    v_max3_u32 v63, v36, v37, v38
    v_max3_u32 v63, v63, v39, v40
    v_max3_u32 v63, v63, v41, v42
    v_max_u32 v63, v63, v43
    v_cmp_eq_u32 vcc, -1, v63
    s_cbranch_vccz HBOK_275
    s_sub_u32 s78, s78, 1
    s_cmp_eq_u32 s78, 0
    s_cbranch_scc0 HB_274
HBOK_275:
    v_add_f32 v60, v36, v37
    v_add_f32 v60, v60, v38
    v_add_f32 v60, v60, v39
    v_add_f32 v60, v60, v40
    v_add_f32 v60, v60, v41
    v_add_f32 v60, v60, v42
    v_add_f32 v60, v60, v43
    s_nop 1
    v_add_f32_dpp v60, v60, v60 row_ror:8 row_mask:0xf bank_mask:0xf
    s_nop 1
    v_add_f32_dpp v60, v60, v60 row_ror:4 row_mask:0xf bank_mask:0xf
    s_nop 1
    v_add_f32_dpp v60, v60, v60 row_ror:2 row_mask:0xf bank_mask:0xf
    s_nop 1
    v_add_f32_dpp v60, v60, v60 row_ror:1 row_mask:0xf bank_mask:0xf
    v_mov_b32 v61, v60
    s_nop 1
    v_permlane16_swap_b32 v61, v60
    s_nop 1
    v_add_f32 v60, v60, v61
    v_mov_b32 v61, v60
    s_nop 1
    v_permlane32_swap_b32 v61, v60
    s_nop 1
    v_add_f32 v60, v60, v61
    v_mul_f32 v60, 0x3b000000, v60
    v_sub_f32 v36, v36, v60
    v_sub_f32 v37, v37, v60
    v_sub_f32 v38, v38, v60
    v_sub_f32 v39, v39, v60
    v_sub_f32 v40, v40, v60
    v_sub_f32 v41, v41, v60
    v_sub_f32 v42, v42, v60
    v_sub_f32 v43, v43, v60
    v_mul_f32 v60, v36, v36
    v_fma_f32 v60, v37, v37, v60
    v_fma_f32 v60, v38, v38, v60
    v_fma_f32 v60, v39, v39, v60
    v_fma_f32 v60, v40, v40, v60
    v_fma_f32 v60, v41, v41, v60
    v_fma_f32 v60, v42, v42, v60
    v_fma_f32 v60, v43, v43, v60
    s_nop 1
    v_add_f32_dpp v60, v60, v60 row_ror:8 row_mask:0xf bank_mask:0xf
    s_nop 1
    v_add_f32_dpp v60, v60, v60 row_ror:4 row_mask:0xf bank_mask:0xf
    s_nop 1
    v_add_f32_dpp v60, v60, v60 row_ror:2 row_mask:0xf bank_mask:0xf
    s_nop 1
    v_add_f32_dpp v60, v60, v60 row_ror:1 row_mask:0xf bank_mask:0xf
    v_mov_b32 v61, v60
    s_nop 1
    v_permlane16_swap_b32 v61, v60
    s_nop 1
    v_add_f32 v60, v60, v61
    v_mov_b32 v61, v60
    s_nop 1
    v_permlane32_swap_b32 v61, v60
    s_nop 1
    v_add_f32 v60, v60, v61
    v_mov_b32 v61, 0x3727c5ac
    v_fmac_f32 v61, 0x3b000000, v60
    v_rsq_f32 v60, v61
    s_nop 0
    v_mul_f32 v36, v36, v60
    v_mul_f32 v37, v37, v60
    v_mul_f32 v38, v38, v60
    v_mul_f32 v39, v39, v60
    v_mul_f32 v40, v40, v60
    v_mul_f32 v41, v41, v60
    v_mul_f32 v42, v42, v60
    v_mul_f32 v43, v43, v60
    v_cvt_pk_bf16_f32 v36, v36, 0
    v_cvt_pk_bf16_f32 v37, v37, 0
    v_cvt_pk_bf16_f32 v38, v38, 0
    v_cvt_pk_bf16_f32 v39, v39, 0
    v_cvt_pk_bf16_f32 v40, v40, 0
    v_cvt_pk_bf16_f32 v41, v41, 0
    v_cvt_pk_bf16_f32 v42, v42, 0
    v_cvt_pk_bf16_f32 v43, v43, 0
    v_lshlrev_b32 v7, 5, v0
    ds_write_b128 v7, v[36:39] offset:16384
    ds_write_b128 v7, v[40:43] offset:16400
    s_waitcnt lgkmcnt(0)
    s_branch HOPJOIN_271
NOHOP_270:
HOPJOIN_271:
    s_waitcnt lgkmcnt(0)
    s_barrier
    v_and_b32 v7, 15, v0
    v_lshlrev_b32 v7, 4, v7
    v_lshrrev_b32 v55, 4, v0
    v_lshl_add_u32 v7, v55, 2, v7
    s_lshl_b32 s7, s5, 9
    v_add_u32 v7, s7, v7
    ds_read_b32 v60, v7 offset:16384
    ds_read_b32 v61, v7 offset:16640
    v_mov_b32 v12, 0
    v_mov_b32 v13, 0
    v_mov_b32 v14, 0
    v_mov_b32 v15, 0
    v_mov_b32 v16, 0
    v_mov_b32 v17, 0
    v_mov_b32 v18, 0
    v_mov_b32 v19, 0
    s_waitcnt lgkmcnt(0)
    v_lshlrev_b32 v62, 16, v60
    v_lshlrev_b32 v63, 16, v61
    s_nop 1
    s_waitcnt vmcnt(15)
    v_dot2c_f32_bf16_dpp v12, v60, v108 row_newbcast:0 row_mask:0xf bank_mask:0xf
    v_dot2c_f32_bf16_dpp v13, v62, v108 row_newbcast:0 row_mask:0xf bank_mask:0xf
    v_dot2c_f32_bf16_dpp v14, v60, v109 row_newbcast:0 row_mask:0xf bank_mask:0xf
    v_dot2c_f32_bf16_dpp v15, v62, v109 row_newbcast:0 row_mask:0xf bank_mask:0xf
    v_dot2c_f32_bf16_dpp v16, v60, v110 row_newbcast:0 row_mask:0xf bank_mask:0xf
    v_dot2c_f32_bf16_dpp v17, v62, v110 row_newbcast:0 row_mask:0xf bank_mask:0xf
    v_dot2c_f32_bf16_dpp v18, v60, v111 row_newbcast:0 row_mask:0xf bank_mask:0xf
    v_dot2c_f32_bf16_dpp v19, v62, v111 row_newbcast:0 row_mask:0xf bank_mask:0xf
    s_mov_b32 s6, 524288
    buffer_load_dwordx4 v[108:111], v2, s[16:19], s6 offen
    s_waitcnt vmcnt(15)
    v_dot2c_f32_bf16_dpp v12, v60, v112 row_newbcast:1 row_mask:0xf bank_mask:0xf
    v_dot2c_f32_bf16_dpp v13, v62, v112 row_newbcast:1 row_mask:0xf bank_mask:0xf
    v_dot2c_f32_bf16_dpp v14, v60, v113 row_newbcast:1 row_mask:0xf bank_mask:0xf
    v_dot2c_f32_bf16_dpp v15, v62, v113 row_newbcast:1 row_mask:0xf bank_mask:0xf
    v_dot2c_f32_bf16_dpp v16, v60, v114 row_newbcast:1 row_mask:0xf bank_mask:0xf
    v_dot2c_f32_bf16_dpp v17, v62, v114 row_newbcast:1 row_mask:0xf bank_mask:0xf
    v_dot2c_f32_bf16_dpp v18, v60, v115 row_newbcast:1 row_mask:0xf bank_mask:0xf
    v_dot2c_f32_bf16_dpp v19, v62, v115 row_newbcast:1 row_mask:0xf bank_mask:0xf
    s_mov_b32 s6, 557056
    buffer_load_dwordx4 v[112:115], v2, s[16:19], s6 offen
    s_waitcnt vmcnt(15)
    v_dot2c_f32_bf16_dpp v12, v60, v116 row_newbcast:2 row_mask:0xf bank_mask:0xf
    v_dot2c_f32_bf16_dpp v13, v62, v116 row_newbcast:2 row_mask:0xf bank_mask:0xf
    v_dot2c_f32_bf16_dpp v14, v60, v117 row_newbcast:2 row_mask:0xf bank_mask:0xf
    v_dot2c_f32_bf16_dpp v15, v62, v117 row_newbcast:2 row_mask:0xf bank_mask:0xf
    v_dot2c_f32_bf16_dpp v16, v60, v118 row_newbcast:2 row_mask:0xf bank_mask:0xf
    v_dot2c_f32_bf16_dpp v17, v62, v118 row_newbcast:2 row_mask:0xf bank_mask:0xf
    v_dot2c_f32_bf16_dpp v18, v60, v119 row_newbcast:2 row_mask:0xf bank_mask:0xf
    v_dot2c_f32_bf16_dpp v19, v62, v119 row_newbcast:2 row_mask:0xf bank_mask:0xf
    s_mov_b32 s6, 589824
    buffer_load_dwordx4 v[116:119], v2, s[16:19], s6 offen
    s_waitcnt vmcnt(15)
    v_dot2c_f32_bf16_dpp v12, v60, v120 row_newbcast:3 row_mask:0xf bank_mask:0xf
    v_dot2c_f32_bf16_dpp v13, v62, v120 row_newbcast:3 row_mask:0xf bank_mask:0xf
    v_dot2c_f32_bf16_dpp v14, v60, v121 row_newbcast:3 row_mask:0xf bank_mask:0xf
    v_dot2c_f32_bf16_dpp v15, v62, v121 row_newbcast:3 row_mask:0xf bank_mask:0xf
    v_dot2c_f32_bf16_dpp v16, v60, v122 row_newbcast:3 row_mask:0xf bank_mask:0xf
    v_dot2c_f32_bf16_dpp v17, v62, v122 row_newbcast:3 row_mask:0xf bank_mask:0xf
    v_dot2c_f32_bf16_dpp v18, v60, v123 row_newbcast:3 row_mask:0xf bank_mask:0xf
    v_dot2c_f32_bf16_dpp v19, v62, v123 row_newbcast:3 row_mask:0xf bank_mask:0xf
    s_mov_b32 s6, 622592
    buffer_load_dwordx4 v[120:123], v2, s[16:19], s6 offen
    s_waitcnt vmcnt(15)
    v_dot2c_f32_bf16_dpp v12, v60, v124 row_newbcast:4 row_mask:0xf bank_mask:0xf
    v_dot2c_f32_bf16_dpp v13, v62, v124 row_newbcast:4 row_mask:0xf bank_mask:0xf
    v_dot2c_f32_bf16_dpp v14, v60, v125 row_newbcast:4 row_mask:0xf bank_mask:0xf
    v_dot2c_f32_bf16_dpp v15, v62, v125 row_newbcast:4 row_mask:0xf bank_mask:0xf
    v_dot2c_f32_bf16_dpp v16, v60, v126 row_newbcast:4 row_mask:0xf bank_mask:0xf
    v_dot2c_f32_bf16_dpp v17, v62, v126 row_newbcast:4 row_mask:0xf bank_mask:0xf
    v_dot2c_f32_bf16_dpp v18, v60, v127 row_newbcast:4 row_mask:0xf bank_mask:0xf
    v_dot2c_f32_bf16_dpp v19, v62, v127 row_newbcast:4 row_mask:0xf bank_mask:0xf
    s_mov_b32 s6, 655360
    buffer_load_dwordx4 v[124:127], v2, s[16:19], s6 offen
    s_waitcnt vmcnt(15)
    v_dot2c_f32_bf16_dpp v12, v60, v64 row_newbcast:5 row_mask:0xf bank_mask:0xf
    v_dot2c_f32_bf16_dpp v13, v62, v64 row_newbcast:5 row_mask:0xf bank_mask:0xf
    v_dot2c_f32_bf16_dpp v14, v60, v65 row_newbcast:5 row_mask:0xf bank_mask:0xf
    v_dot2c_f32_bf16_dpp v15, v62, v65 row_newbcast:5 row_mask:0xf bank_mask:0xf
    v_dot2c_f32_bf16_dpp v16, v60, v66 row_newbcast:5 row_mask:0xf bank_mask:0xf
    v_dot2c_f32_bf16_dpp v17, v62, v66 row_newbcast:5 row_mask:0xf bank_mask:0xf
    v_dot2c_f32_bf16_dpp v18, v60, v67 row_newbcast:5 row_mask:0xf bank_mask:0xf
    v_dot2c_f32_bf16_dpp v19, v62, v67 row_newbcast:5 row_mask:0xf bank_mask:0xf
    s_mov_b32 s6, 688128
    buffer_load_dwordx4 v[64:67], v2, s[16:19], s6 offen
    s_waitcnt vmcnt(15)
    v_dot2c_f32_bf16_dpp v12, v60, v68 row_newbcast:6 row_mask:0xf bank_mask:0xf
    v_dot2c_f32_bf16_dpp v13, v62, v68 row_newbcast:6 row_mask:0xf bank_mask:0xf
    v_dot2c_f32_bf16_dpp v14, v60, v69 row_newbcast:6 row_mask:0xf bank_mask:0xf
    v_dot2c_f32_bf16_dpp v15, v62, v69 row_newbcast:6 row_mask:0xf bank_mask:0xf
    v_dot2c_f32_bf16_dpp v16, v60, v70 row_newbcast:6 row_mask:0xf bank_mask:0xf
    v_dot2c_f32_bf16_dpp v17, v62, v70 row_newbcast:6 row_mask:0xf bank_mask:0xf
    v_dot2c_f32_bf16_dpp v18, v60, v71 row_newbcast:6 row_mask:0xf bank_mask:0xf
    v_dot2c_f32_bf16_dpp v19, v62, v71 row_newbcast:6 row_mask:0xf bank_mask:0xf
    s_mov_b32 s6, 720896
    buffer_load_dwordx4 v[68:71], v2, s[16:19], s6 offen
    s_waitcnt vmcnt(15)
    v_dot2c_f32_bf16_dpp v12, v60, v72 row_newbcast:7 row_mask:0xf bank_mask:0xf
    v_dot2c_f32_bf16_dpp v13, v62, v72 row_newbcast:7 row_mask:0xf bank_mask:0xf
    v_dot2c_f32_bf16_dpp v14, v60, v73 row_newbcast:7 row_mask:0xf bank_mask:0xf
    v_dot2c_f32_bf16_dpp v15, v62, v73 row_newbcast:7 row_mask:0xf bank_mask:0xf
    v_dot2c_f32_bf16_dpp v16, v60, v74 row_newbcast:7 row_mask:0xf bank_mask:0xf
    v_dot2c_f32_bf16_dpp v17, v62, v74 row_newbcast:7 row_mask:0xf bank_mask:0xf
    v_dot2c_f32_bf16_dpp v18, v60, v75 row_newbcast:7 row_mask:0xf bank_mask:0xf
    v_dot2c_f32_bf16_dpp v19, v62, v75 row_newbcast:7 row_mask:0xf bank_mask:0xf
    s_mov_b32 s6, 753664
    buffer_load_dwordx4 v[72:75], v2, s[16:19], s6 offen
    s_waitcnt vmcnt(15)
    v_dot2c_f32_bf16_dpp v12, v60, v76 row_newbcast:8 row_mask:0xf bank_mask:0xf
    v_dot2c_f32_bf16_dpp v13, v62, v76 row_newbcast:8 row_mask:0xf bank_mask:0xf
    v_dot2c_f32_bf16_dpp v14, v60, v77 row_newbcast:8 row_mask:0xf bank_mask:0xf
    v_dot2c_f32_bf16_dpp v15, v62, v77 row_newbcast:8 row_mask:0xf bank_mask:0xf
    v_dot2c_f32_bf16_dpp v16, v60, v78 row_newbcast:8 row_mask:0xf bank_mask:0xf
    v_dot2c_f32_bf16_dpp v17, v62, v78 row_newbcast:8 row_mask:0xf bank_mask:0xf
    v_dot2c_f32_bf16_dpp v18, v60, v79 row_newbcast:8 row_mask:0xf bank_mask:0xf
    v_dot2c_f32_bf16_dpp v19, v62, v79 row_newbcast:8 row_mask:0xf bank_mask:0xf
    s_mov_b32 s6, 786432
    buffer_load_dwordx4 v[76:79], v2, s[16:19], s6 offen
    s_waitcnt vmcnt(15)
    v_dot2c_f32_bf16_dpp v12, v60, v80 row_newbcast:9 row_mask:0xf bank_mask:0xf
    v_dot2c_f32_bf16_dpp v13, v62, v80 row_newbcast:9 row_mask:0xf bank_mask:0xf
    v_dot2c_f32_bf16_dpp v14, v60, v81 row_newbcast:9 row_mask:0xf bank_mask:0xf
    v_dot2c_f32_bf16_dpp v15, v62, v81 row_newbcast:9 row_mask:0xf bank_mask:0xf
    v_dot2c_f32_bf16_dpp v16, v60, v82 row_newbcast:9 row_mask:0xf bank_mask:0xf
    v_dot2c_f32_bf16_dpp v17, v62, v82 row_newbcast:9 row_mask:0xf bank_mask:0xf
    v_dot2c_f32_bf16_dpp v18, v60, v83 row_newbcast:9 row_mask:0xf bank_mask:0xf
    v_dot2c_f32_bf16_dpp v19, v62, v83 row_newbcast:9 row_mask:0xf bank_mask:0xf
    s_mov_b32 s6, 819200
    buffer_load_dwordx4 v[80:83], v2, s[16:19], s6 offen
    s_waitcnt vmcnt(15)
    v_dot2c_f32_bf16_dpp v12, v60, v84 row_newbcast:10 row_mask:0xf bank_mask:0xf
    v_dot2c_f32_bf16_dpp v13, v62, v84 row_newbcast:10 row_mask:0xf bank_mask:0xf
    v_dot2c_f32_bf16_dpp v14, v60, v85 row_newbcast:10 row_mask:0xf bank_mask:0xf
    v_dot2c_f32_bf16_dpp v15, v62, v85 row_newbcast:10 row_mask:0xf bank_mask:0xf
    v_dot2c_f32_bf16_dpp v16, v60, v86 row_newbcast:10 row_mask:0xf bank_mask:0xf
    v_dot2c_f32_bf16_dpp v17, v62, v86 row_newbcast:10 row_mask:0xf bank_mask:0xf
    v_dot2c_f32_bf16_dpp v18, v60, v87 row_newbcast:10 row_mask:0xf bank_mask:0xf
    v_dot2c_f32_bf16_dpp v19, v62, v87 row_newbcast:10 row_mask:0xf bank_mask:0xf
    s_mov_b32 s6, 851968
    buffer_load_dwordx4 v[84:87], v2, s[16:19], s6 offen
    s_waitcnt vmcnt(15)
    v_dot2c_f32_bf16_dpp v12, v60, v88 row_newbcast:11 row_mask:0xf bank_mask:0xf
    v_dot2c_f32_bf16_dpp v13, v62, v88 row_newbcast:11 row_mask:0xf bank_mask:0xf
    v_dot2c_f32_bf16_dpp v14, v60, v89 row_newbcast:11 row_mask:0xf bank_mask:0xf
    v_dot2c_f32_bf16_dpp v15, v62, v89 row_newbcast:11 row_mask:0xf bank_mask:0xf
    v_dot2c_f32_bf16_dpp v16, v60, v90 row_newbcast:11 row_mask:0xf bank_mask:0xf
    v_dot2c_f32_bf16_dpp v17, v62, v90 row_newbcast:11 row_mask:0xf bank_mask:0xf
    v_dot2c_f32_bf16_dpp v18, v60, v91 row_newbcast:11 row_mask:0xf bank_mask:0xf
    v_dot2c_f32_bf16_dpp v19, v62, v91 row_newbcast:11 row_mask:0xf bank_mask:0xf
    s_mov_b32 s6, 884736
    buffer_load_dwordx4 v[88:91], v2, s[16:19], s6 offen
    s_waitcnt vmcnt(15)
    v_dot2c_f32_bf16_dpp v12, v60, v92 row_newbcast:12 row_mask:0xf bank_mask:0xf
    v_dot2c_f32_bf16_dpp v13, v62, v92 row_newbcast:12 row_mask:0xf bank_mask:0xf
    v_dot2c_f32_bf16_dpp v14, v60, v93 row_newbcast:12 row_mask:0xf bank_mask:0xf
    v_dot2c_f32_bf16_dpp v15, v62, v93 row_newbcast:12 row_mask:0xf bank_mask:0xf
    v_dot2c_f32_bf16_dpp v16, v60, v94 row_newbcast:12 row_mask:0xf bank_mask:0xf
    v_dot2c_f32_bf16_dpp v17, v62, v94 row_newbcast:12 row_mask:0xf bank_mask:0xf
    v_dot2c_f32_bf16_dpp v18, v60, v95 row_newbcast:12 row_mask:0xf bank_mask:0xf
    v_dot2c_f32_bf16_dpp v19, v62, v95 row_newbcast:12 row_mask:0xf bank_mask:0xf
    s_mov_b32 s6, 917504
    buffer_load_dwordx4 v[92:95], v2, s[16:19], s6 offen
    s_waitcnt vmcnt(15)
    v_dot2c_f32_bf16_dpp v12, v60, v96 row_newbcast:13 row_mask:0xf bank_mask:0xf
    v_dot2c_f32_bf16_dpp v13, v62, v96 row_newbcast:13 row_mask:0xf bank_mask:0xf
    v_dot2c_f32_bf16_dpp v14, v60, v97 row_newbcast:13 row_mask:0xf bank_mask:0xf
    v_dot2c_f32_bf16_dpp v15, v62, v97 row_newbcast:13 row_mask:0xf bank_mask:0xf
    v_dot2c_f32_bf16_dpp v16, v60, v98 row_newbcast:13 row_mask:0xf bank_mask:0xf
    v_dot2c_f32_bf16_dpp v17, v62, v98 row_newbcast:13 row_mask:0xf bank_mask:0xf
    v_dot2c_f32_bf16_dpp v18, v60, v99 row_newbcast:13 row_mask:0xf bank_mask:0xf
    v_dot2c_f32_bf16_dpp v19, v62, v99 row_newbcast:13 row_mask:0xf bank_mask:0xf
    s_mov_b32 s6, 950272
    buffer_load_dwordx4 v[96:99], v2, s[16:19], s6 offen
    s_waitcnt vmcnt(15)
    v_dot2c_f32_bf16_dpp v12, v60, v100 row_newbcast:14 row_mask:0xf bank_mask:0xf
    v_dot2c_f32_bf16_dpp v13, v62, v100 row_newbcast:14 row_mask:0xf bank_mask:0xf
    v_dot2c_f32_bf16_dpp v14, v60, v101 row_newbcast:14 row_mask:0xf bank_mask:0xf
    v_dot2c_f32_bf16_dpp v15, v62, v101 row_newbcast:14 row_mask:0xf bank_mask:0xf
    v_dot2c_f32_bf16_dpp v16, v60, v102 row_newbcast:14 row_mask:0xf bank_mask:0xf
    v_dot2c_f32_bf16_dpp v17, v62, v102 row_newbcast:14 row_mask:0xf bank_mask:0xf
    v_dot2c_f32_bf16_dpp v18, v60, v103 row_newbcast:14 row_mask:0xf bank_mask:0xf
    v_dot2c_f32_bf16_dpp v19, v62, v103 row_newbcast:14 row_mask:0xf bank_mask:0xf
    s_mov_b32 s6, 983040
    buffer_load_dwordx4 v[100:103], v2, s[16:19], s6 offen
    s_waitcnt vmcnt(15)
    v_dot2c_f32_bf16_dpp v12, v60, v104 row_newbcast:15 row_mask:0xf bank_mask:0xf
    v_dot2c_f32_bf16_dpp v13, v62, v104 row_newbcast:15 row_mask:0xf bank_mask:0xf
    v_dot2c_f32_bf16_dpp v14, v60, v105 row_newbcast:15 row_mask:0xf bank_mask:0xf
    v_dot2c_f32_bf16_dpp v15, v62, v105 row_newbcast:15 row_mask:0xf bank_mask:0xf
    v_dot2c_f32_bf16_dpp v16, v60, v106 row_newbcast:15 row_mask:0xf bank_mask:0xf
    v_dot2c_f32_bf16_dpp v17, v62, v106 row_newbcast:15 row_mask:0xf bank_mask:0xf
    v_dot2c_f32_bf16_dpp v18, v60, v107 row_newbcast:15 row_mask:0xf bank_mask:0xf
    v_dot2c_f32_bf16_dpp v19, v62, v107 row_newbcast:15 row_mask:0xf bank_mask:0xf
    s_mov_b32 s6, 1015808
    buffer_load_dwordx4 v[104:107], v2, s[16:19], s6 offen
    s_waitcnt vmcnt(15)
    v_dot2c_f32_bf16_dpp v12, v61, v108 row_newbcast:0 row_mask:0xf bank_mask:0xf
    v_dot2c_f32_bf16_dpp v13, v63, v108 row_newbcast:0 row_mask:0xf bank_mask:0xf
    v_dot2c_f32_bf16_dpp v14, v61, v109 row_newbcast:0 row_mask:0xf bank_mask:0xf
    v_dot2c_f32_bf16_dpp v15, v63, v109 row_newbcast:0 row_mask:0xf bank_mask:0xf
    v_dot2c_f32_bf16_dpp v16, v61, v110 row_newbcast:0 row_mask:0xf bank_mask:0xf
    v_dot2c_f32_bf16_dpp v17, v63, v110 row_newbcast:0 row_mask:0xf bank_mask:0xf
    v_dot2c_f32_bf16_dpp v18, v61, v111 row_newbcast:0 row_mask:0xf bank_mask:0xf
    v_dot2c_f32_bf16_dpp v19, v63, v111 row_newbcast:0 row_mask:0xf bank_mask:0xf
    s_add_u32 s6, s56, 0
    s_and_b32 s6, s6, 0xfffff
    s_cmp_lt_u32 s3, 4
    s_cbranch_scc1 W_276
    s_waitcnt vmcnt(4)
W_276:
    buffer_load_dwordx4 v[108:111], v1, s[8:11], s6 offen nt
    s_waitcnt vmcnt(15)
    v_dot2c_f32_bf16_dpp v12, v61, v112 row_newbcast:1 row_mask:0xf bank_mask:0xf
    v_dot2c_f32_bf16_dpp v13, v63, v112 row_newbcast:1 row_mask:0xf bank_mask:0xf
    v_dot2c_f32_bf16_dpp v14, v61, v113 row_newbcast:1 row_mask:0xf bank_mask:0xf
    v_dot2c_f32_bf16_dpp v15, v63, v113 row_newbcast:1 row_mask:0xf bank_mask:0xf
    v_dot2c_f32_bf16_dpp v16, v61, v114 row_newbcast:1 row_mask:0xf bank_mask:0xf
    v_dot2c_f32_bf16_dpp v17, v63, v114 row_newbcast:1 row_mask:0xf bank_mask:0xf
    v_dot2c_f32_bf16_dpp v18, v61, v115 row_newbcast:1 row_mask:0xf bank_mask:0xf
    v_dot2c_f32_bf16_dpp v19, v63, v115 row_newbcast:1 row_mask:0xf bank_mask:0xf
    s_add_u32 s6, s56, 4096
    s_and_b32 s6, s6, 0xfffff
    s_cmp_lt_u32 s3, 4
    s_cbranch_scc1 W_277
    s_waitcnt vmcnt(5)
W_277:
    buffer_load_dwordx4 v[112:115], v1, s[8:11], s6 offen nt
    s_waitcnt vmcnt(15)
    v_dot2c_f32_bf16_dpp v12, v61, v116 row_newbcast:2 row_mask:0xf bank_mask:0xf
    v_dot2c_f32_bf16_dpp v13, v63, v116 row_newbcast:2 row_mask:0xf bank_mask:0xf
    v_dot2c_f32_bf16_dpp v14, v61, v117 row_newbcast:2 row_mask:0xf bank_mask:0xf
    v_dot2c_f32_bf16_dpp v15, v63, v117 row_newbcast:2 row_mask:0xf bank_mask:0xf
    v_dot2c_f32_bf16_dpp v16, v61, v118 row_newbcast:2 row_mask:0xf bank_mask:0xf
    v_dot2c_f32_bf16_dpp v17, v63, v118 row_newbcast:2 row_mask:0xf bank_mask:0xf
    v_dot2c_f32_bf16_dpp v18, v61, v119 row_newbcast:2 row_mask:0xf bank_mask:0xf
    v_dot2c_f32_bf16_dpp v19, v63, v119 row_newbcast:2 row_mask:0xf bank_mask:0xf
    s_add_u32 s6, s56, 8192
    s_and_b32 s6, s6, 0xfffff
    s_cmp_lt_u32 s3, 4
    s_cbranch_scc1 W_278
    s_waitcnt vmcnt(4)
W_278:
    buffer_load_dwordx4 v[116:119], v1, s[8:11], s6 offen nt
    s_waitcnt vmcnt(15)
    v_dot2c_f32_bf16_dpp v12, v61, v120 row_newbcast:3 row_mask:0xf bank_mask:0xf
    v_dot2c_f32_bf16_dpp v13, v63, v120 row_newbcast:3 row_mask:0xf bank_mask:0xf
    v_dot2c_f32_bf16_dpp v14, v61, v121 row_newbcast:3 row_mask:0xf bank_mask:0xf
    v_dot2c_f32_bf16_dpp v15, v63, v121 row_newbcast:3 row_mask:0xf bank_mask:0xf
    v_dot2c_f32_bf16_dpp v16, v61, v122 row_newbcast:3 row_mask:0xf bank_mask:0xf
    v_dot2c_f32_bf16_dpp v17, v63, v122 row_newbcast:3 row_mask:0xf bank_mask:0xf
    v_dot2c_f32_bf16_dpp v18, v61, v123 row_newbcast:3 row_mask:0xf bank_mask:0xf
    v_dot2c_f32_bf16_dpp v19, v63, v123 row_newbcast:3 row_mask:0xf bank_mask:0xf
    s_add_u32 s6, s56, 12288
    s_and_b32 s6, s6, 0xfffff
    s_cmp_lt_u32 s3, 4
    s_cbranch_scc1 W_279
    s_waitcnt vmcnt(5)
W_279:
    buffer_load_dwordx4 v[120:123], v1, s[8:11], s6 offen nt
    s_waitcnt vmcnt(15)
    v_dot2c_f32_bf16_dpp v12, v61, v124 row_newbcast:4 row_mask:0xf bank_mask:0xf
    v_dot2c_f32_bf16_dpp v13, v63, v124 row_newbcast:4 row_mask:0xf bank_mask:0xf
    v_dot2c_f32_bf16_dpp v14, v61, v125 row_newbcast:4 row_mask:0xf bank_mask:0xf
    v_dot2c_f32_bf16_dpp v15, v63, v125 row_newbcast:4 row_mask:0xf bank_mask:0xf
    v_dot2c_f32_bf16_dpp v16, v61, v126 row_newbcast:4 row_mask:0xf bank_mask:0xf
    v_dot2c_f32_bf16_dpp v17, v63, v126 row_newbcast:4 row_mask:0xf bank_mask:0xf
    v_dot2c_f32_bf16_dpp v18, v61, v127 row_newbcast:4 row_mask:0xf bank_mask:0xf
    v_dot2c_f32_bf16_dpp v19, v63, v127 row_newbcast:4 row_mask:0xf bank_mask:0xf
    s_add_u32 s6, s56, 16384
    s_and_b32 s6, s6, 0xfffff
    s_cmp_lt_u32 s3, 4
    s_cbranch_scc1 W_280
    s_waitcnt vmcnt(4)
W_280:
    buffer_load_dwordx4 v[124:127], v1, s[8:11], s6 offen nt
    s_waitcnt vmcnt(15)
    v_dot2c_f32_bf16_dpp v12, v61, v64 row_newbcast:5 row_mask:0xf bank_mask:0xf
    v_dot2c_f32_bf16_dpp v13, v63, v64 row_newbcast:5 row_mask:0xf bank_mask:0xf
    v_dot2c_f32_bf16_dpp v14, v61, v65 row_newbcast:5 row_mask:0xf bank_mask:0xf
    v_dot2c_f32_bf16_dpp v15, v63, v65 row_newbcast:5 row_mask:0xf bank_mask:0xf
    v_dot2c_f32_bf16_dpp v16, v61, v66 row_newbcast:5 row_mask:0xf bank_mask:0xf
    v_dot2c_f32_bf16_dpp v17, v63, v66 row_newbcast:5 row_mask:0xf bank_mask:0xf
    v_dot2c_f32_bf16_dpp v18, v61, v67 row_newbcast:5 row_mask:0xf bank_mask:0xf
    v_dot2c_f32_bf16_dpp v19, v63, v67 row_newbcast:5 row_mask:0xf bank_mask:0xf
    s_add_u32 s6, s56, 20480
    s_and_b32 s6, s6, 0xfffff
    s_cmp_lt_u32 s3, 4
    s_cbranch_scc1 W_281
    s_waitcnt vmcnt(5)
W_281:
    buffer_load_dwordx4 v[64:67], v1, s[8:11], s6 offen nt
    s_waitcnt vmcnt(15)
    v_dot2c_f32_bf16_dpp v12, v61, v68 row_newbcast:6 row_mask:0xf bank_mask:0xf
    v_dot2c_f32_bf16_dpp v13, v63, v68 row_newbcast:6 row_mask:0xf bank_mask:0xf
    v_dot2c_f32_bf16_dpp v14, v61, v69 row_newbcast:6 row_mask:0xf bank_mask:0xf
    v_dot2c_f32_bf16_dpp v15, v63, v69 row_newbcast:6 row_mask:0xf bank_mask:0xf
    v_dot2c_f32_bf16_dpp v16, v61, v70 row_newbcast:6 row_mask:0xf bank_mask:0xf
    v_dot2c_f32_bf16_dpp v17, v63, v70 row_newbcast:6 row_mask:0xf bank_mask:0xf
    v_dot2c_f32_bf16_dpp v18, v61, v71 row_newbcast:6 row_mask:0xf bank_mask:0xf
    v_dot2c_f32_bf16_dpp v19, v63, v71 row_newbcast:6 row_mask:0xf bank_mask:0xf
    s_add_u32 s6, s56, 24576
    s_and_b32 s6, s6, 0xfffff
    s_cmp_lt_u32 s3, 4
    s_cbranch_scc1 W_282
    s_waitcnt vmcnt(4)
W_282:
    buffer_load_dwordx4 v[68:71], v1, s[8:11], s6 offen nt
    s_waitcnt vmcnt(15)
    v_dot2c_f32_bf16_dpp v12, v61, v72 row_newbcast:7 row_mask:0xf bank_mask:0xf
    v_dot2c_f32_bf16_dpp v13, v63, v72 row_newbcast:7 row_mask:0xf bank_mask:0xf
    v_dot2c_f32_bf16_dpp v14, v61, v73 row_newbcast:7 row_mask:0xf bank_mask:0xf
    v_dot2c_f32_bf16_dpp v15, v63, v73 row_newbcast:7 row_mask:0xf bank_mask:0xf
    v_dot2c_f32_bf16_dpp v16, v61, v74 row_newbcast:7 row_mask:0xf bank_mask:0xf
    v_dot2c_f32_bf16_dpp v17, v63, v74 row_newbcast:7 row_mask:0xf bank_mask:0xf
    v_dot2c_f32_bf16_dpp v18, v61, v75 row_newbcast:7 row_mask:0xf bank_mask:0xf
    v_dot2c_f32_bf16_dpp v19, v63, v75 row_newbcast:7 row_mask:0xf bank_mask:0xf
    s_add_u32 s6, s56, 28672
    s_and_b32 s6, s6, 0xfffff
    s_cmp_lt_u32 s3, 4
    s_cbranch_scc1 W_283
    s_waitcnt vmcnt(5)
W_283:
    buffer_load_dwordx4 v[72:75], v1, s[8:11], s6 offen nt
    s_waitcnt vmcnt(15)
    v_dot2c_f32_bf16_dpp v12, v61, v76 row_newbcast:8 row_mask:0xf bank_mask:0xf
    v_dot2c_f32_bf16_dpp v13, v63, v76 row_newbcast:8 row_mask:0xf bank_mask:0xf
    v_dot2c_f32_bf16_dpp v14, v61, v77 row_newbcast:8 row_mask:0xf bank_mask:0xf
    v_dot2c_f32_bf16_dpp v15, v63, v77 row_newbcast:8 row_mask:0xf bank_mask:0xf
    v_dot2c_f32_bf16_dpp v16, v61, v78 row_newbcast:8 row_mask:0xf bank_mask:0xf
    v_dot2c_f32_bf16_dpp v17, v63, v78 row_newbcast:8 row_mask:0xf bank_mask:0xf
    v_dot2c_f32_bf16_dpp v18, v61, v79 row_newbcast:8 row_mask:0xf bank_mask:0xf
    v_dot2c_f32_bf16_dpp v19, v63, v79 row_newbcast:8 row_mask:0xf bank_mask:0xf
    s_add_u32 s6, s56, 32768
    s_and_b32 s6, s6, 0xfffff
    s_cmp_lt_u32 s3, 4
    s_cbranch_scc1 W_284
    s_waitcnt vmcnt(4)
W_284:
    buffer_load_dwordx4 v[76:79], v1, s[8:11], s6 offen nt
    s_waitcnt vmcnt(15)
    v_dot2c_f32_bf16_dpp v12, v61, v80 row_newbcast:9 row_mask:0xf bank_mask:0xf
    v_dot2c_f32_bf16_dpp v13, v63, v80 row_newbcast:9 row_mask:0xf bank_mask:0xf
    v_dot2c_f32_bf16_dpp v14, v61, v81 row_newbcast:9 row_mask:0xf bank_mask:0xf
    v_dot2c_f32_bf16_dpp v15, v63, v81 row_newbcast:9 row_mask:0xf bank_mask:0xf
    v_dot2c_f32_bf16_dpp v16, v61, v82 row_newbcast:9 row_mask:0xf bank_mask:0xf
    v_dot2c_f32_bf16_dpp v17, v63, v82 row_newbcast:9 row_mask:0xf bank_mask:0xf
    v_dot2c_f32_bf16_dpp v18, v61, v83 row_newbcast:9 row_mask:0xf bank_mask:0xf
    v_dot2c_f32_bf16_dpp v19, v63, v83 row_newbcast:9 row_mask:0xf bank_mask:0xf
    s_add_u32 s6, s56, 36864
    s_and_b32 s6, s6, 0xfffff
    s_cmp_lt_u32 s3, 4
    s_cbranch_scc1 W_285
    s_waitcnt vmcnt(5)
W_285:
    buffer_load_dwordx4 v[80:83], v1, s[8:11], s6 offen nt
    s_waitcnt vmcnt(15)
    v_dot2c_f32_bf16_dpp v12, v61, v84 row_newbcast:10 row_mask:0xf bank_mask:0xf
    v_dot2c_f32_bf16_dpp v13, v63, v84 row_newbcast:10 row_mask:0xf bank_mask:0xf
    v_dot2c_f32_bf16_dpp v14, v61, v85 row_newbcast:10 row_mask:0xf bank_mask:0xf
    v_dot2c_f32_bf16_dpp v15, v63, v85 row_newbcast:10 row_mask:0xf bank_mask:0xf
    v_dot2c_f32_bf16_dpp v16, v61, v86 row_newbcast:10 row_mask:0xf bank_mask:0xf
    v_dot2c_f32_bf16_dpp v17, v63, v86 row_newbcast:10 row_mask:0xf bank_mask:0xf
    v_dot2c_f32_bf16_dpp v18, v61, v87 row_newbcast:10 row_mask:0xf bank_mask:0xf
    v_dot2c_f32_bf16_dpp v19, v63, v87 row_newbcast:10 row_mask:0xf bank_mask:0xf
    s_add_u32 s6, s56, 40960
    s_and_b32 s6, s6, 0xfffff
    s_cmp_lt_u32 s3, 4
    s_cbranch_scc1 W_286
    s_waitcnt vmcnt(4)
W_286:
    buffer_load_dwordx4 v[84:87], v1, s[8:11], s6 offen nt
    s_waitcnt vmcnt(15)
    v_dot2c_f32_bf16_dpp v12, v61, v88 row_newbcast:11 row_mask:0xf bank_mask:0xf
    v_dot2c_f32_bf16_dpp v13, v63, v88 row_newbcast:11 row_mask:0xf bank_mask:0xf
    v_dot2c_f32_bf16_dpp v14, v61, v89 row_newbcast:11 row_mask:0xf bank_mask:0xf
    v_dot2c_f32_bf16_dpp v15, v63, v89 row_newbcast:11 row_mask:0xf bank_mask:0xf
    v_dot2c_f32_bf16_dpp v16, v61, v90 row_newbcast:11 row_mask:0xf bank_mask:0xf
    v_dot2c_f32_bf16_dpp v17, v63, v90 row_newbcast:11 row_mask:0xf bank_mask:0xf
    v_dot2c_f32_bf16_dpp v18, v61, v91 row_newbcast:11 row_mask:0xf bank_mask:0xf
    v_dot2c_f32_bf16_dpp v19, v63, v91 row_newbcast:11 row_mask:0xf bank_mask:0xf
    s_add_u32 s6, s56, 45056
    s_and_b32 s6, s6, 0xfffff
    s_cmp_lt_u32 s3, 4
    s_cbranch_scc1 W_287
    s_waitcnt vmcnt(5)
W_287:
    buffer_load_dwordx4 v[88:91], v1, s[8:11], s6 offen nt
    s_waitcnt vmcnt(15)
    v_dot2c_f32_bf16_dpp v12, v61, v92 row_newbcast:12 row_mask:0xf bank_mask:0xf
    v_dot2c_f32_bf16_dpp v13, v63, v92 row_newbcast:12 row_mask:0xf bank_mask:0xf
    v_dot2c_f32_bf16_dpp v14, v61, v93 row_newbcast:12 row_mask:0xf bank_mask:0xf
    v_dot2c_f32_bf16_dpp v15, v63, v93 row_newbcast:12 row_mask:0xf bank_mask:0xf
    v_dot2c_f32_bf16_dpp v16, v61, v94 row_newbcast:12 row_mask:0xf bank_mask:0xf
    v_dot2c_f32_bf16_dpp v17, v63, v94 row_newbcast:12 row_mask:0xf bank_mask:0xf
    v_dot2c_f32_bf16_dpp v18, v61, v95 row_newbcast:12 row_mask:0xf bank_mask:0xf
    v_dot2c_f32_bf16_dpp v19, v63, v95 row_newbcast:12 row_mask:0xf bank_mask:0xf
    s_waitcnt vmcnt(14)
    v_dot2c_f32_bf16_dpp v12, v61, v96 row_newbcast:13 row_mask:0xf bank_mask:0xf
    v_dot2c_f32_bf16_dpp v13, v63, v96 row_newbcast:13 row_mask:0xf bank_mask:0xf
    v_dot2c_f32_bf16_dpp v14, v61, v97 row_newbcast:13 row_mask:0xf bank_mask:0xf
    v_dot2c_f32_bf16_dpp v15, v63, v97 row_newbcast:13 row_mask:0xf bank_mask:0xf
    v_dot2c_f32_bf16_dpp v16, v61, v98 row_newbcast:13 row_mask:0xf bank_mask:0xf
    v_dot2c_f32_bf16_dpp v17, v63, v98 row_newbcast:13 row_mask:0xf bank_mask:0xf
    v_dot2c_f32_bf16_dpp v18, v61, v99 row_newbcast:13 row_mask:0xf bank_mask:0xf
    v_dot2c_f32_bf16_dpp v19, v63, v99 row_newbcast:13 row_mask:0xf bank_mask:0xf
    s_waitcnt vmcnt(13)
    v_dot2c_f32_bf16_dpp v12, v61, v100 row_newbcast:14 row_mask:0xf bank_mask:0xf
    v_dot2c_f32_bf16_dpp v13, v63, v100 row_newbcast:14 row_mask:0xf bank_mask:0xf
    v_dot2c_f32_bf16_dpp v14, v61, v101 row_newbcast:14 row_mask:0xf bank_mask:0xf
    v_dot2c_f32_bf16_dpp v15, v63, v101 row_newbcast:14 row_mask:0xf bank_mask:0xf
    v_dot2c_f32_bf16_dpp v16, v61, v102 row_newbcast:14 row_mask:0xf bank_mask:0xf
    v_dot2c_f32_bf16_dpp v17, v63, v102 row_newbcast:14 row_mask:0xf bank_mask:0xf
    v_dot2c_f32_bf16_dpp v18, v61, v103 row_newbcast:14 row_mask:0xf bank_mask:0xf
    v_dot2c_f32_bf16_dpp v19, v63, v103 row_newbcast:14 row_mask:0xf bank_mask:0xf
    s_waitcnt vmcnt(12)
    v_dot2c_f32_bf16_dpp v12, v61, v104 row_newbcast:15 row_mask:0xf bank_mask:0xf
    v_dot2c_f32_bf16_dpp v13, v63, v104 row_newbcast:15 row_mask:0xf bank_mask:0xf
    v_dot2c_f32_bf16_dpp v14, v61, v105 row_newbcast:15 row_mask:0xf bank_mask:0xf
    v_dot2c_f32_bf16_dpp v15, v63, v105 row_newbcast:15 row_mask:0xf bank_mask:0xf
    v_dot2c_f32_bf16_dpp v16, v61, v106 row_newbcast:15 row_mask:0xf bank_mask:0xf
    v_dot2c_f32_bf16_dpp v17, v63, v106 row_newbcast:15 row_mask:0xf bank_mask:0xf
    v_dot2c_f32_bf16_dpp v18, v61, v107 row_newbcast:15 row_mask:0xf bank_mask:0xf
    v_dot2c_f32_bf16_dpp v19, v63, v107 row_newbcast:15 row_mask:0xf bank_mask:0xf
    s_nop 2
    ds_write_b128 v6, v[12:15] offset:8192
    ds_write_b128 v6, v[16:19] offset:8208
    s_waitcnt lgkmcnt(0)
    s_barrier
    v_lshrrev_b32 v7, 4, v0
    v_lshlrev_b32 v7, 11, v7
    v_and_b32 v55, 15, v0
    v_lshl_add_u32 v7, v55, 5, v7
    ds_read_b128 v[36:39], v7 offset:8192
    ds_read_b128 v[40:43], v7 offset:8704
    ds_read_b128 v[44:47], v7 offset:9216
    ds_read_b128 v[48:51], v7 offset:9728
    s_waitcnt lgkmcnt(0)
    v_add_f32 v36, v36, v40
    v_add_f32 v44, v44, v48
    v_add_f32 v37, v37, v41
    v_add_f32 v45, v45, v49
    v_add_f32 v38, v38, v42
    v_add_f32 v46, v46, v50
    v_add_f32 v39, v39, v43
    v_add_f32 v47, v47, v51
    v_add_f32 v12, v36, v44
    v_add_f32 v13, v37, v45
    v_add_f32 v14, v38, v46
    v_add_f32 v15, v39, v47
    ds_read_b128 v[36:39], v7 offset:8208
    ds_read_b128 v[40:43], v7 offset:8720
    ds_read_b128 v[44:47], v7 offset:9232
    ds_read_b128 v[48:51], v7 offset:9744
    s_waitcnt lgkmcnt(0)
    v_add_f32 v36, v36, v40
    v_add_f32 v44, v44, v48
    v_add_f32 v37, v37, v41
    v_add_f32 v45, v45, v49
    v_add_f32 v38, v38, v42
    v_add_f32 v46, v46, v50
    v_add_f32 v39, v39, v43
    v_add_f32 v47, v47, v51
    v_add_f32 v16, v36, v44
    v_add_f32 v17, v37, v45
    v_add_f32 v18, v38, v46
    v_add_f32 v19, v39, v47
    v_mov_b32 v36, v12
    v_mov_b32 v37, v13
    v_mov_b32 v38, v14
    v_mov_b32 v39, v15
    v_mov_b32 v40, v16
    v_mov_b32 v41, v17
    v_mov_b32 v42, v18
    v_mov_b32 v43, v19
    s_nop 1
    v_permlane16_swap_b32 v36, v12
    v_permlane16_swap_b32 v37, v13
    v_permlane16_swap_b32 v38, v14
    v_permlane16_swap_b32 v39, v15
    v_permlane16_swap_b32 v40, v16
    v_permlane16_swap_b32 v41, v17
    v_permlane16_swap_b32 v42, v18
    v_permlane16_swap_b32 v43, v19
    s_nop 1
    v_add_f32 v12, v12, v36
    v_add_f32 v13, v13, v37
    v_add_f32 v14, v14, v38
    v_add_f32 v15, v15, v39
    v_add_f32 v16, v16, v40
    v_add_f32 v17, v17, v41
    v_add_f32 v18, v18, v42
    v_add_f32 v19, v19, v43
    v_mov_b32 v36, v12
    v_mov_b32 v37, v13
    v_mov_b32 v38, v14
    v_mov_b32 v39, v15
    v_mov_b32 v40, v16
    v_mov_b32 v41, v17
    v_mov_b32 v42, v18
    v_mov_b32 v43, v19
    s_nop 1
    v_permlane32_swap_b32 v36, v12
    v_permlane32_swap_b32 v37, v13
    v_permlane32_swap_b32 v38, v14
    v_permlane32_swap_b32 v39, v15
    v_permlane32_swap_b32 v40, v16
    v_permlane32_swap_b32 v41, v17
    v_permlane32_swap_b32 v42, v18
    v_permlane32_swap_b32 v43, v19
    s_nop 1
    v_add_f32 v12, v12, v36
    v_add_f32 v13, v13, v37
    v_add_f32 v14, v14, v38
    v_add_f32 v15, v15, v39
    v_add_f32 v16, v16, v40
    v_add_f32 v17, v17, v41
    v_add_f32 v18, v18, v42
    v_add_f32 v19, v19, v43
    v_cvt_pk_bf16_f32 v8, v12, v13
    v_cvt_pk_bf16_f32 v9, v14, v15
    v_cvt_pk_bf16_f32 v10, v16, v17
    v_cvt_pk_bf16_f32 v11, v18, v19
    s_add_u32 s76, s56, 0
    s_mov_b32 s77, 15
KLOOP_288:
    s_cmp_gt_u32 s77, 8
    s_cselect_b32 s59, 0, 1
    s_cmp_lt_u32 s3, 4
    s_cselect_b32 s59, s59, 2
    s_waitcnt vmcnt(11)
    v_dot2_f32_bf16 v36, v108, v8, 0
    v_dot2_f32_bf16 v36, v109, v9, v36
    v_dot2_f32_bf16 v36, v110, v10, v36
    v_dot2_f32_bf16 v36, v111, v11, v36
    s_add_u32 s6, s76, 49152
    s_and_b32 s6, s6, 0xfffff
    s_cmp_lg_u32 s59, 1
    s_cbranch_scc1 W_289
    s_waitcnt vmcnt(3)
W_289:
    s_cmp_lg_u32 s59, 2
    s_cbranch_scc1 W_290
    s_waitcnt vmcnt(4)
W_290:
    buffer_load_dwordx4 v[92:95], v1, s[8:11], s6 offen nt
    s_waitcnt vmcnt(11)
    v_dot2_f32_bf16 v37, v112, v8, 0
    v_dot2_f32_bf16 v37, v113, v9, v37
    v_dot2_f32_bf16 v37, v114, v10, v37
    v_dot2_f32_bf16 v37, v115, v11, v37
    s_add_u32 s6, s76, 53248
    s_and_b32 s6, s6, 0xfffff
    s_cmp_lg_u32 s59, 1
    s_cbranch_scc1 W_291
    s_waitcnt vmcnt(4)
W_291:
    s_cmp_lg_u32 s59, 2
    s_cbranch_scc1 W_292
    s_waitcnt vmcnt(5)
W_292:
    buffer_load_dwordx4 v[96:99], v1, s[8:11], s6 offen nt
    s_waitcnt vmcnt(11)
    v_dot2_f32_bf16 v38, v116, v8, 0
    v_dot2_f32_bf16 v38, v117, v9, v38
    v_dot2_f32_bf16 v38, v118, v10, v38
    v_dot2_f32_bf16 v38, v119, v11, v38
    s_add_u32 s6, s76, 57344
    s_and_b32 s6, s6, 0xfffff
    s_cmp_lg_u32 s59, 1
    s_cbranch_scc1 W_293
    s_waitcnt vmcnt(3)
W_293:
    s_cmp_lg_u32 s59, 2
    s_cbranch_scc1 W_294
    s_waitcnt vmcnt(4)
W_294:
    buffer_load_dwordx4 v[100:103], v1, s[8:11], s6 offen nt
    s_waitcnt vmcnt(11)
    v_dot2_f32_bf16 v39, v120, v8, 0
    v_dot2_f32_bf16 v39, v121, v9, v39
    v_dot2_f32_bf16 v39, v122, v10, v39
    v_dot2_f32_bf16 v39, v123, v11, v39
    s_add_u32 s6, s76, 61440
    s_and_b32 s6, s6, 0xfffff
    s_cmp_lg_u32 s59, 1
    s_cbranch_scc1 W_295
    s_waitcnt vmcnt(4)
W_295:
    s_cmp_lg_u32 s59, 2
    s_cbranch_scc1 W_296
    s_waitcnt vmcnt(5)
W_296:
    buffer_load_dwordx4 v[104:107], v1, s[8:11], s6 offen nt
    s_waitcnt vmcnt(11)
    v_dot2_f32_bf16 v40, v124, v8, 0
    v_dot2_f32_bf16 v40, v125, v9, v40
    v_dot2_f32_bf16 v40, v126, v10, v40
    v_dot2_f32_bf16 v40, v127, v11, v40
    s_add_u32 s6, s76, 65536
    s_and_b32 s6, s6, 0xfffff
    s_cmp_lg_u32 s59, 1
    s_cbranch_scc1 W_297
    s_waitcnt vmcnt(3)
W_297:
    s_cmp_lg_u32 s59, 2
    s_cbranch_scc1 W_298
    s_waitcnt vmcnt(4)
W_298:
    buffer_load_dwordx4 v[108:111], v1, s[8:11], s6 offen nt
    s_waitcnt vmcnt(11)
    v_dot2_f32_bf16 v41, v64, v8, 0
    v_dot2_f32_bf16 v41, v65, v9, v41
    v_dot2_f32_bf16 v41, v66, v10, v41
    v_dot2_f32_bf16 v41, v67, v11, v41
    s_add_u32 s6, s76, 69632
    s_and_b32 s6, s6, 0xfffff
    s_cmp_lg_u32 s59, 1
    s_cbranch_scc1 W_299
    s_waitcnt vmcnt(4)
W_299:
    s_cmp_lg_u32 s59, 2
    s_cbranch_scc1 W_300
    s_waitcnt vmcnt(5)
W_300:
    buffer_load_dwordx4 v[112:115], v1, s[8:11], s6 offen nt
    s_waitcnt vmcnt(11)
    v_dot2_f32_bf16 v42, v68, v8, 0
    v_dot2_f32_bf16 v42, v69, v9, v42
    v_dot2_f32_bf16 v42, v70, v10, v42
    v_dot2_f32_bf16 v42, v71, v11, v42
    s_add_u32 s6, s76, 73728
    s_and_b32 s6, s6, 0xfffff
    s_cmp_lg_u32 s59, 1
    s_cbranch_scc1 W_301
    s_waitcnt vmcnt(3)
W_301:
    s_cmp_lg_u32 s59, 2
    s_cbranch_scc1 W_302
    s_waitcnt vmcnt(4)
W_302:
    buffer_load_dwordx4 v[116:119], v1, s[8:11], s6 offen nt
    s_waitcnt vmcnt(11)
    v_dot2_f32_bf16 v43, v72, v8, 0
    v_dot2_f32_bf16 v43, v73, v9, v43
    v_dot2_f32_bf16 v43, v74, v10, v43
    v_dot2_f32_bf16 v43, v75, v11, v43
    s_add_u32 s6, s76, 77824
    s_and_b32 s6, s6, 0xfffff
    s_cmp_lg_u32 s59, 1
    s_cbranch_scc1 W_303
    s_waitcnt vmcnt(4)
W_303:
    s_cmp_lg_u32 s59, 2
    s_cbranch_scc1 W_304
    s_waitcnt vmcnt(5)
W_304:
    buffer_load_dwordx4 v[120:123], v1, s[8:11], s6 offen nt
    s_waitcnt vmcnt(11)
    v_dot2_f32_bf16 v44, v76, v8, 0
    v_dot2_f32_bf16 v44, v77, v9, v44
    v_dot2_f32_bf16 v44, v78, v10, v44
    v_dot2_f32_bf16 v44, v79, v11, v44
    s_add_u32 s6, s76, 81920
    s_and_b32 s6, s6, 0xfffff
    s_cmp_lg_u32 s59, 1
    s_cbranch_scc1 W_305
    s_waitcnt vmcnt(3)
W_305:
    s_cmp_lg_u32 s59, 2
    s_cbranch_scc1 W_306
    s_waitcnt vmcnt(4)
W_306:
    buffer_load_dwordx4 v[124:127], v1, s[8:11], s6 offen nt
    s_waitcnt vmcnt(11)
    v_dot2_f32_bf16 v45, v80, v8, 0
    v_dot2_f32_bf16 v45, v81, v9, v45
    v_dot2_f32_bf16 v45, v82, v10, v45
    v_dot2_f32_bf16 v45, v83, v11, v45
    s_add_u32 s6, s76, 86016
    s_and_b32 s6, s6, 0xfffff
    s_cmp_lg_u32 s59, 1
    s_cbranch_scc1 W_307
    s_waitcnt vmcnt(4)
W_307:
    s_cmp_lg_u32 s59, 2
    s_cbranch_scc1 W_308
    s_waitcnt vmcnt(5)
W_308:
    buffer_load_dwordx4 v[64:67], v1, s[8:11], s6 offen nt
    s_waitcnt vmcnt(11)
    v_dot2_f32_bf16 v46, v84, v8, 0
    v_dot2_f32_bf16 v46, v85, v9, v46
    v_dot2_f32_bf16 v46, v86, v10, v46
    v_dot2_f32_bf16 v46, v87, v11, v46
    s_add_u32 s6, s76, 90112
    s_and_b32 s6, s6, 0xfffff
    s_cmp_lg_u32 s59, 1
    s_cbranch_scc1 W_309
    s_waitcnt vmcnt(3)
W_309:
    s_cmp_lg_u32 s59, 2
    s_cbranch_scc1 W_310
    s_waitcnt vmcnt(4)
W_310:
    buffer_load_dwordx4 v[68:71], v1, s[8:11], s6 offen nt
    s_waitcnt vmcnt(11)
    v_dot2_f32_bf16 v47, v88, v8, 0
    v_dot2_f32_bf16 v47, v89, v9, v47
    v_dot2_f32_bf16 v47, v90, v10, v47
    v_dot2_f32_bf16 v47, v91, v11, v47
    s_add_u32 s6, s76, 94208
    s_and_b32 s6, s6, 0xfffff
    s_cmp_lg_u32 s59, 1
    s_cbranch_scc1 W_311
    s_waitcnt vmcnt(4)
W_311:
    s_cmp_lg_u32 s59, 2
    s_cbranch_scc1 W_312
    s_waitcnt vmcnt(5)
W_312:
    buffer_load_dwordx4 v[72:75], v1, s[8:11], s6 offen nt
    s_waitcnt vmcnt(11)
    v_dot2_f32_bf16 v48, v92, v8, 0
    v_dot2_f32_bf16 v48, v93, v9, v48
    v_dot2_f32_bf16 v48, v94, v10, v48
    v_dot2_f32_bf16 v48, v95, v11, v48
    s_add_u32 s6, s76, 98304
    s_and_b32 s6, s6, 0xfffff
    s_cmp_lg_u32 s59, 1
    s_cbranch_scc1 W_313
    s_waitcnt vmcnt(3)
W_313:
    s_cmp_lg_u32 s59, 2
    s_cbranch_scc1 W_314
    s_waitcnt vmcnt(4)
W_314:
    buffer_load_dwordx4 v[76:79], v1, s[8:11], s6 offen nt
    s_waitcnt vmcnt(11)
    v_dot2_f32_bf16 v49, v96, v8, 0
    v_dot2_f32_bf16 v49, v97, v9, v49
    v_dot2_f32_bf16 v49, v98, v10, v49
    v_dot2_f32_bf16 v49, v99, v11, v49
    s_add_u32 s6, s76, 102400
    s_and_b32 s6, s6, 0xfffff
    s_cmp_lg_u32 s59, 1
    s_cbranch_scc1 W_315
    s_waitcnt vmcnt(4)
W_315:
    s_cmp_lg_u32 s59, 2
    s_cbranch_scc1 W_316
    s_waitcnt vmcnt(5)
W_316:
    buffer_load_dwordx4 v[80:83], v1, s[8:11], s6 offen nt
    s_waitcnt vmcnt(11)
    v_dot2_f32_bf16 v50, v100, v8, 0
    v_dot2_f32_bf16 v50, v101, v9, v50
    v_dot2_f32_bf16 v50, v102, v10, v50
    v_dot2_f32_bf16 v50, v103, v11, v50
    s_add_u32 s6, s76, 106496
    s_and_b32 s6, s6, 0xfffff
    s_cmp_lg_u32 s59, 1
    s_cbranch_scc1 W_317
    s_waitcnt vmcnt(3)
W_317:
    s_cmp_lg_u32 s59, 2
    s_cbranch_scc1 W_318
    s_waitcnt vmcnt(4)
W_318:
    buffer_load_dwordx4 v[84:87], v1, s[8:11], s6 offen nt
    s_waitcnt vmcnt(11)
    v_dot2_f32_bf16 v51, v104, v8, 0
    v_dot2_f32_bf16 v51, v105, v9, v51
    v_dot2_f32_bf16 v51, v106, v10, v51
    v_dot2_f32_bf16 v51, v107, v11, v51
    s_add_u32 s6, s76, 110592
    s_and_b32 s6, s6, 0xfffff
    s_cmp_lg_u32 s59, 1
    s_cbranch_scc1 W_319
    s_waitcnt vmcnt(4)
W_319:
    s_cmp_lg_u32 s59, 2
    s_cbranch_scc1 W_320
    s_waitcnt vmcnt(5)
W_320:
    buffer_load_dwordx4 v[88:91], v1, s[8:11], s6 offen nt
    s_nop 2
    v_add_f32_dpp v36, v36, v36 row_ror:8 row_mask:0xf bank_mask:0x3
    v_add_f32_dpp v37, v37, v37 row_ror:8 row_mask:0xf bank_mask:0x3
    v_add_f32_dpp v38, v38, v38 row_ror:8 row_mask:0xf bank_mask:0x3
    v_add_f32_dpp v39, v39, v39 row_ror:8 row_mask:0xf bank_mask:0x3
    v_add_f32_dpp v40, v40, v40 row_ror:8 row_mask:0xf bank_mask:0x3
    v_add_f32_dpp v41, v41, v41 row_ror:8 row_mask:0xf bank_mask:0x3
    v_add_f32_dpp v42, v42, v42 row_ror:8 row_mask:0xf bank_mask:0x3
    v_add_f32_dpp v43, v43, v43 row_ror:8 row_mask:0xf bank_mask:0x3
    v_add_f32_dpp v36, v44, v44 row_ror:8 row_mask:0xf bank_mask:0xc
    v_add_f32_dpp v37, v45, v45 row_ror:8 row_mask:0xf bank_mask:0xc
    v_add_f32_dpp v38, v46, v46 row_ror:8 row_mask:0xf bank_mask:0xc
    v_add_f32_dpp v39, v47, v47 row_ror:8 row_mask:0xf bank_mask:0xc
    v_add_f32_dpp v40, v48, v48 row_ror:8 row_mask:0xf bank_mask:0xc
    v_add_f32_dpp v41, v49, v49 row_ror:8 row_mask:0xf bank_mask:0xc
    v_add_f32_dpp v42, v50, v50 row_ror:8 row_mask:0xf bank_mask:0xc
    v_add_f32_dpp v43, v51, v51 row_ror:8 row_mask:0xf bank_mask:0xc
    v_add_f32_dpp v36, v36, v36 row_half_mirror row_mask:0xf bank_mask:0x5
    v_add_f32_dpp v37, v37, v37 row_half_mirror row_mask:0xf bank_mask:0x5
    v_add_f32_dpp v38, v38, v38 row_half_mirror row_mask:0xf bank_mask:0x5
    v_add_f32_dpp v39, v39, v39 row_half_mirror row_mask:0xf bank_mask:0x5
    v_add_f32_dpp v36, v40, v40 row_half_mirror row_mask:0xf bank_mask:0xa
    v_add_f32_dpp v37, v41, v41 row_half_mirror row_mask:0xf bank_mask:0xa
    v_add_f32_dpp v38, v42, v42 row_half_mirror row_mask:0xf bank_mask:0xa
    v_add_f32_dpp v39, v43, v43 row_half_mirror row_mask:0xf bank_mask:0xa
    s_nop 1
    v_add_f32_dpp v36, v36, v36 quad_perm:[2,3,0,1] row_mask:0xf bank_mask:0xf
    v_add_f32_dpp v37, v37, v37 quad_perm:[2,3,0,1] row_mask:0xf bank_mask:0xf
    v_add_f32_dpp v38, v38, v38 quad_perm:[2,3,0,1] row_mask:0xf bank_mask:0xf
    v_add_f32_dpp v39, v39, v39 quad_perm:[2,3,0,1] row_mask:0xf bank_mask:0xf
    v_cndmask_b32 v36, v36, v38, s[72:73]
    v_cndmask_b32 v37, v37, v39, s[72:73]
    s_nop 1
    v_add_f32_dpp v36, v36, v36 quad_perm:[1,0,3,2] row_mask:0xf bank_mask:0xf
    v_add_f32_dpp v37, v37, v37 quad_perm:[1,0,3,2] row_mask:0xf bank_mask:0xf
    v_mov_b32 v20, v21
    v_mov_b32 v21, v22
    v_mov_b32 v22, v23
    v_mov_b32 v23, v24
    v_mov_b32 v24, v25
    v_mov_b32 v25, v26
    v_mov_b32 v26, v27
    v_mov_b32 v27, v28
    v_mov_b32 v28, v29
    v_mov_b32 v29, v30
    v_mov_b32 v30, v31
    v_mov_b32 v31, v32
    v_mov_b32 v32, v33
    v_mov_b32 v33, v34
    v_mov_b32 v34, v35
    v_cndmask_b32 v35, v36, v37, s[74:75]
    s_add_u32 s76, s76, 65536
    s_sub_u32 s77, s77, 1
    s_cmp_lg_u32 s77, 0
    s_cbranch_scc1 KLOOP_288
    s_waitcnt vmcnt(11)
    v_dot2_f32_bf16 v36, v108, v8, 0
    v_dot2_f32_bf16 v36, v109, v9, v36
    v_dot2_f32_bf16 v36, v110, v10, v36
    v_dot2_f32_bf16 v36, v111, v11, v36
    s_add_u32 s6, s56, 1032192
    s_and_b32 s6, s6, 0xfffff
    s_waitcnt vmcnt(4)
    s_cmp_lt_u32 s3, 4
    s_cbranch_scc0 W_321
    s_waitcnt vmcnt(3)
W_321:
    buffer_load_dwordx4 v[92:95], v1, s[8:11], s6 offen nt
    s_waitcnt vmcnt(11)
    v_dot2_f32_bf16 v37, v112, v8, 0
    v_dot2_f32_bf16 v37, v113, v9, v37
    v_dot2_f32_bf16 v37, v114, v10, v37
    v_dot2_f32_bf16 v37, v115, v11, v37
    s_add_u32 s6, s56, 1036288
    s_and_b32 s6, s6, 0xfffff
    s_waitcnt vmcnt(5)
    s_cmp_lt_u32 s3, 4
    s_cbranch_scc0 W_322
    s_waitcnt vmcnt(4)
W_322:
    buffer_load_dwordx4 v[96:99], v1, s[8:11], s6 offen nt
    s_waitcnt vmcnt(11)
    v_dot2_f32_bf16 v38, v116, v8, 0
    v_dot2_f32_bf16 v38, v117, v9, v38
    v_dot2_f32_bf16 v38, v118, v10, v38
    v_dot2_f32_bf16 v38, v119, v11, v38
    s_add_u32 s6, s56, 1040384
    s_and_b32 s6, s6, 0xfffff
    s_waitcnt vmcnt(4)
    s_cmp_lt_u32 s3, 4
    s_cbranch_scc0 W_323
    s_waitcnt vmcnt(3)
W_323:
    buffer_load_dwordx4 v[100:103], v1, s[8:11], s6 offen nt
    s_waitcnt vmcnt(11)
    v_dot2_f32_bf16 v39, v120, v8, 0
    v_dot2_f32_bf16 v39, v121, v9, v39
    v_dot2_f32_bf16 v39, v122, v10, v39
    v_dot2_f32_bf16 v39, v123, v11, v39
    s_add_u32 s6, s56, 1044480
    s_and_b32 s6, s6, 0xfffff
    s_waitcnt vmcnt(5)
    s_cmp_lt_u32 s3, 4
    s_cbranch_scc0 W_324
    s_waitcnt vmcnt(4)
W_324:
    buffer_load_dwordx4 v[104:107], v1, s[8:11], s6 offen nt
    s_waitcnt vmcnt(11)
    v_dot2_f32_bf16 v40, v124, v8, 0
    v_dot2_f32_bf16 v40, v125, v9, v40
    v_dot2_f32_bf16 v40, v126, v10, v40
    v_dot2_f32_bf16 v40, v127, v11, v40
    s_add_u32 s6, s56, 0
    s_and_b32 s6, s6, 0xfffff
    s_waitcnt vmcnt(4)
    s_cmp_lt_u32 s3, 4
    s_cbranch_scc0 W_325
    s_waitcnt vmcnt(3)
W_325:
    buffer_load_dwordx4 v[108:111], v1, s[12:15], s6 offen nt
    s_waitcnt vmcnt(11)
    v_dot2_f32_bf16 v41, v64, v8, 0
    v_dot2_f32_bf16 v41, v65, v9, v41
    v_dot2_f32_bf16 v41, v66, v10, v41
    v_dot2_f32_bf16 v41, v67, v11, v41
    s_add_u32 s6, s56, 4096
    s_and_b32 s6, s6, 0xfffff
    s_waitcnt vmcnt(5)
    s_cmp_lt_u32 s3, 4
    s_cbranch_scc0 W_326
    s_waitcnt vmcnt(4)
W_326:
    buffer_load_dwordx4 v[112:115], v1, s[12:15], s6 offen nt
    s_waitcnt vmcnt(11)
    v_dot2_f32_bf16 v42, v68, v8, 0
    v_dot2_f32_bf16 v42, v69, v9, v42
    v_dot2_f32_bf16 v42, v70, v10, v42
    v_dot2_f32_bf16 v42, v71, v11, v42
    s_add_u32 s6, s56, 8192
    s_and_b32 s6, s6, 0xfffff
    s_waitcnt vmcnt(4)
    s_cmp_lt_u32 s3, 4
    s_cbranch_scc0 W_327
    s_waitcnt vmcnt(3)
W_327:
    buffer_load_dwordx4 v[116:119], v1, s[12:15], s6 offen nt
    s_waitcnt vmcnt(11)
    v_dot2_f32_bf16 v43, v72, v8, 0
    v_dot2_f32_bf16 v43, v73, v9, v43
    v_dot2_f32_bf16 v43, v74, v10, v43
    v_dot2_f32_bf16 v43, v75, v11, v43
    s_add_u32 s6, s56, 12288
    s_and_b32 s6, s6, 0xfffff
    s_waitcnt vmcnt(5)
    s_cmp_lt_u32 s3, 4
    s_cbranch_scc0 W_328
    s_waitcnt vmcnt(4)
W_328:
    buffer_load_dwordx4 v[120:123], v1, s[12:15], s6 offen nt
    s_waitcnt vmcnt(11)
    v_dot2_f32_bf16 v44, v76, v8, 0
    v_dot2_f32_bf16 v44, v77, v9, v44
    v_dot2_f32_bf16 v44, v78, v10, v44
    v_dot2_f32_bf16 v44, v79, v11, v44
    s_add_u32 s6, s56, 16384
    s_and_b32 s6, s6, 0xfffff
    s_waitcnt vmcnt(4)
    s_cmp_lt_u32 s3, 4
    s_cbranch_scc0 W_329
    s_waitcnt vmcnt(3)
W_329:
    buffer_load_dwordx4 v[124:127], v1, s[12:15], s6 offen nt
    s_waitcnt vmcnt(11)
    v_dot2_f32_bf16 v45, v80, v8, 0
    v_dot2_f32_bf16 v45, v81, v9, v45
    v_dot2_f32_bf16 v45, v82, v10, v45
    v_dot2_f32_bf16 v45, v83, v11, v45
    s_add_u32 s6, s56, 20480
    s_and_b32 s6, s6, 0xfffff
    s_waitcnt vmcnt(5)
    s_cmp_lt_u32 s3, 4
    s_cbranch_scc0 W_330
    s_waitcnt vmcnt(4)
W_330:
    buffer_load_dwordx4 v[64:67], v1, s[12:15], s6 offen nt
    s_waitcnt vmcnt(11)
    v_dot2_f32_bf16 v46, v84, v8, 0
    v_dot2_f32_bf16 v46, v85, v9, v46
    v_dot2_f32_bf16 v46, v86, v10, v46
    v_dot2_f32_bf16 v46, v87, v11, v46
    s_add_u32 s6, s56, 24576
    s_and_b32 s6, s6, 0xfffff
    s_waitcnt vmcnt(4)
    s_cmp_lt_u32 s3, 4
    s_cbranch_scc0 W_331
    s_waitcnt vmcnt(3)
W_331:
    buffer_load_dwordx4 v[68:71], v1, s[12:15], s6 offen nt
    s_waitcnt vmcnt(11)
    v_dot2_f32_bf16 v47, v88, v8, 0
    v_dot2_f32_bf16 v47, v89, v9, v47
    v_dot2_f32_bf16 v47, v90, v10, v47
    v_dot2_f32_bf16 v47, v91, v11, v47
    s_add_u32 s6, s56, 28672
    s_and_b32 s6, s6, 0xfffff
    s_waitcnt vmcnt(5)
    s_cmp_lt_u32 s3, 4
    s_cbranch_scc0 W_332
    s_waitcnt vmcnt(4)
W_332:
    buffer_load_dwordx4 v[72:75], v1, s[12:15], s6 offen nt
    s_waitcnt vmcnt(11)
    v_dot2_f32_bf16 v48, v92, v8, 0
    v_dot2_f32_bf16 v48, v93, v9, v48
    v_dot2_f32_bf16 v48, v94, v10, v48
    v_dot2_f32_bf16 v48, v95, v11, v48
    s_add_u32 s6, s56, 32768
    s_and_b32 s6, s6, 0xfffff
    s_waitcnt vmcnt(4)
    s_cmp_lt_u32 s3, 4
    s_cbranch_scc0 W_333
    s_waitcnt vmcnt(3)
W_333:
    buffer_load_dwordx4 v[76:79], v1, s[12:15], s6 offen nt
    s_waitcnt vmcnt(11)
    v_dot2_f32_bf16 v49, v96, v8, 0
    v_dot2_f32_bf16 v49, v97, v9, v49
    v_dot2_f32_bf16 v49, v98, v10, v49
    v_dot2_f32_bf16 v49, v99, v11, v49
    s_add_u32 s6, s56, 36864
    s_and_b32 s6, s6, 0xfffff
    s_waitcnt vmcnt(5)
    s_cmp_lt_u32 s3, 4
    s_cbranch_scc0 W_334
    s_waitcnt vmcnt(4)
W_334:
    buffer_load_dwordx4 v[80:83], v1, s[12:15], s6 offen nt
    s_waitcnt vmcnt(11)
    v_dot2_f32_bf16 v50, v100, v8, 0
    v_dot2_f32_bf16 v50, v101, v9, v50
    v_dot2_f32_bf16 v50, v102, v10, v50
    v_dot2_f32_bf16 v50, v103, v11, v50
    s_add_u32 s6, s56, 40960
    s_and_b32 s6, s6, 0xfffff
    s_waitcnt vmcnt(4)
    s_cmp_lt_u32 s3, 4
    s_cbranch_scc0 W_335
    s_waitcnt vmcnt(3)
W_335:
    buffer_load_dwordx4 v[84:87], v1, s[12:15], s6 offen nt
    s_waitcnt vmcnt(11)
    v_dot2_f32_bf16 v51, v104, v8, 0
    v_dot2_f32_bf16 v51, v105, v9, v51
    v_dot2_f32_bf16 v51, v106, v10, v51
    v_dot2_f32_bf16 v51, v107, v11, v51
    s_add_u32 s6, s56, 45056
    s_and_b32 s6, s6, 0xfffff
    s_waitcnt vmcnt(5)
    s_cmp_lt_u32 s3, 4
    s_cbranch_scc0 W_336
    s_waitcnt vmcnt(4)
W_336:
    buffer_load_dwordx4 v[88:91], v1, s[12:15], s6 offen nt
    s_nop 2
    v_add_f32_dpp v36, v36, v36 row_ror:8 row_mask:0xf bank_mask:0x3
    v_add_f32_dpp v37, v37, v37 row_ror:8 row_mask:0xf bank_mask:0x3
    v_add_f32_dpp v38, v38, v38 row_ror:8 row_mask:0xf bank_mask:0x3
    v_add_f32_dpp v39, v39, v39 row_ror:8 row_mask:0xf bank_mask:0x3
    v_add_f32_dpp v40, v40, v40 row_ror:8 row_mask:0xf bank_mask:0x3
    v_add_f32_dpp v41, v41, v41 row_ror:8 row_mask:0xf bank_mask:0x3
    v_add_f32_dpp v42, v42, v42 row_ror:8 row_mask:0xf bank_mask:0x3
    v_add_f32_dpp v43, v43, v43 row_ror:8 row_mask:0xf bank_mask:0x3
    v_add_f32_dpp v36, v44, v44 row_ror:8 row_mask:0xf bank_mask:0xc
    v_add_f32_dpp v37, v45, v45 row_ror:8 row_mask:0xf bank_mask:0xc
    v_add_f32_dpp v38, v46, v46 row_ror:8 row_mask:0xf bank_mask:0xc
    v_add_f32_dpp v39, v47, v47 row_ror:8 row_mask:0xf bank_mask:0xc
    v_add_f32_dpp v40, v48, v48 row_ror:8 row_mask:0xf bank_mask:0xc
    v_add_f32_dpp v41, v49, v49 row_ror:8 row_mask:0xf bank_mask:0xc
    v_add_f32_dpp v42, v50, v50 row_ror:8 row_mask:0xf bank_mask:0xc
    v_add_f32_dpp v43, v51, v51 row_ror:8 row_mask:0xf bank_mask:0xc
    v_add_f32_dpp v36, v36, v36 row_half_mirror row_mask:0xf bank_mask:0x5
    v_add_f32_dpp v37, v37, v37 row_half_mirror row_mask:0xf bank_mask:0x5
    v_add_f32_dpp v38, v38, v38 row_half_mirror row_mask:0xf bank_mask:0x5
    v_add_f32_dpp v39, v39, v39 row_half_mirror row_mask:0xf bank_mask:0x5
    v_add_f32_dpp v36, v40, v40 row_half_mirror row_mask:0xf bank_mask:0xa
    v_add_f32_dpp v37, v41, v41 row_half_mirror row_mask:0xf bank_mask:0xa
    v_add_f32_dpp v38, v42, v42 row_half_mirror row_mask:0xf bank_mask:0xa
    v_add_f32_dpp v39, v43, v43 row_half_mirror row_mask:0xf bank_mask:0xa
    s_nop 1
    v_add_f32_dpp v36, v36, v36 quad_perm:[2,3,0,1] row_mask:0xf bank_mask:0xf
    v_add_f32_dpp v37, v37, v37 quad_perm:[2,3,0,1] row_mask:0xf bank_mask:0xf
    v_add_f32_dpp v38, v38, v38 quad_perm:[2,3,0,1] row_mask:0xf bank_mask:0xf
    v_add_f32_dpp v39, v39, v39 quad_perm:[2,3,0,1] row_mask:0xf bank_mask:0xf
    v_cndmask_b32 v36, v36, v38, s[72:73]
    v_cndmask_b32 v37, v37, v39, s[72:73]
    s_nop 1
    v_add_f32_dpp v36, v36, v36 quad_perm:[1,0,3,2] row_mask:0xf bank_mask:0xf
    v_add_f32_dpp v37, v37, v37 quad_perm:[1,0,3,2] row_mask:0xf bank_mask:0xf
    v_mov_b32 v20, v21
    v_mov_b32 v21, v22
    v_mov_b32 v22, v23
    v_mov_b32 v23, v24
    v_mov_b32 v24, v25
    v_mov_b32 v25, v26
    v_mov_b32 v26, v27
    v_mov_b32 v27, v28
    v_mov_b32 v28, v29
    v_mov_b32 v29, v30
    v_mov_b32 v30, v31
    v_mov_b32 v31, v32
    v_mov_b32 v32, v33
    v_mov_b32 v33, v34
    v_mov_b32 v34, v35
    v_cndmask_b32 v35, v36, v37, s[74:75]
    s_mov_b32 s80, 0x3e0293ee
    v_max3_f32 v60, v20, v21, v22
    v_max3_f32 v60, v60, v23, v24
    v_max3_f32 v60, v60, v25, v26
    v_max3_f32 v60, v60, v27, v28
    v_max3_f32 v60, v60, v29, v30
    v_max3_f32 v60, v60, v31, v32
    v_max3_f32 v60, v60, v33, v34
    v_max_f32 v60, v60, v35
    s_nop 1
    v_max_f32_dpp v60, v60, v60 row_ror:8 row_mask:0xf bank_mask:0xf
    s_nop 1
    v_max_f32_dpp v60, v60, v60 row_ror:4 row_mask:0xf bank_mask:0xf
    s_nop 1
    v_max_f32_dpp v60, v60, v60 row_ror:2 row_mask:0xf bank_mask:0xf
    s_nop 1
    v_max_f32_dpp v60, v60, v60 row_ror:1 row_mask:0xf bank_mask:0xf
    v_mov_b32 v61, v60
    s_nop 1
    v_permlane16_swap_b32 v61, v60
    s_nop 1
    v_max_f32 v60, v60, v61
    v_mov_b32 v61, v60
    s_nop 1
    v_permlane32_swap_b32 v61, v60
    s_nop 1
    v_max_f32 v60, v60, v61
    v_mul_f32 v60, s80, v60
    v_fma_f32 v20, v20, s80, -v60
    v_fma_f32 v21, v21, s80, -v60
    v_fma_f32 v22, v22, s80, -v60
    v_fma_f32 v23, v23, s80, -v60
    v_fma_f32 v24, v24, s80, -v60
    v_fma_f32 v25, v25, s80, -v60
    v_fma_f32 v26, v26, s80, -v60
    v_fma_f32 v27, v27, s80, -v60
    v_fma_f32 v28, v28, s80, -v60
    v_fma_f32 v29, v29, s80, -v60
    v_fma_f32 v30, v30, s80, -v60
    v_fma_f32 v31, v31, s80, -v60
    v_fma_f32 v32, v32, s80, -v60
    v_fma_f32 v33, v33, s80, -v60
    v_fma_f32 v34, v34, s80, -v60
    v_fma_f32 v35, v35, s80, -v60
    v_exp_f32 v20, v20
    v_exp_f32 v21, v21
    v_exp_f32 v22, v22
    v_exp_f32 v23, v23
    v_exp_f32 v24, v24
    v_exp_f32 v25, v25
    v_exp_f32 v26, v26
    v_exp_f32 v27, v27
    v_exp_f32 v28, v28
    v_exp_f32 v29, v29
    v_exp_f32 v30, v30
    v_exp_f32 v31, v31
    v_exp_f32 v32, v32
    v_exp_f32 v33, v33
    v_exp_f32 v34, v34
    v_exp_f32 v35, v35
    s_nop 0
    v_cvt_pk_bf16_f32 v20, v20, 0
    v_cvt_pk_bf16_f32 v21, v21, 0
    v_cvt_pk_bf16_f32 v22, v22, 0
    v_cvt_pk_bf16_f32 v23, v23, 0
    v_cvt_pk_bf16_f32 v24, v24, 0
    v_cvt_pk_bf16_f32 v25, v25, 0
    v_cvt_pk_bf16_f32 v26, v26, 0
    v_cvt_pk_bf16_f32 v27, v27, 0
    v_cvt_pk_bf16_f32 v28, v28, 0
    v_cvt_pk_bf16_f32 v29, v29, 0
    v_cvt_pk_bf16_f32 v30, v30, 0
    v_cvt_pk_bf16_f32 v31, v31, 0
    v_cvt_pk_bf16_f32 v32, v32, 0
    v_cvt_pk_bf16_f32 v33, v33, 0
    v_cvt_pk_bf16_f32 v34, v34, 0
    v_cvt_pk_bf16_f32 v35, v35, 0
    v_mov_b32 v61, 0
    v_lshlrev_b32 v62, 16, v20
    v_add_f32 v61, v61, v62
    v_lshlrev_b32 v62, 16, v21
    v_add_f32 v61, v61, v62
    v_lshlrev_b32 v62, 16, v22
    v_add_f32 v61, v61, v62
    v_lshlrev_b32 v62, 16, v23
    v_add_f32 v61, v61, v62
    v_lshlrev_b32 v62, 16, v24
    v_add_f32 v61, v61, v62
    v_lshlrev_b32 v62, 16, v25
    v_add_f32 v61, v61, v62
    v_lshlrev_b32 v62, 16, v26
    v_add_f32 v61, v61, v62
    v_lshlrev_b32 v62, 16, v27
    v_add_f32 v61, v61, v62
    v_lshlrev_b32 v62, 16, v28
    v_add_f32 v61, v61, v62
    v_lshlrev_b32 v62, 16, v29
    v_add_f32 v61, v61, v62
    v_lshlrev_b32 v62, 16, v30
    v_add_f32 v61, v61, v62
    v_lshlrev_b32 v62, 16, v31
    v_add_f32 v61, v61, v62
    v_lshlrev_b32 v62, 16, v32
    v_add_f32 v61, v61, v62
    v_lshlrev_b32 v62, 16, v33
    v_add_f32 v61, v61, v62
    v_lshlrev_b32 v62, 16, v34
    v_add_f32 v61, v61, v62
    v_lshlrev_b32 v62, 16, v35
    v_add_f32 v61, v61, v62
    s_nop 1
    v_add_f32_dpp v61, v61, v61 row_ror:8 row_mask:0xf bank_mask:0xf
    s_nop 1
    v_add_f32_dpp v61, v61, v61 row_ror:4 row_mask:0xf bank_mask:0xf
    s_nop 1
    v_add_f32_dpp v61, v61, v61 row_ror:2 row_mask:0xf bank_mask:0xf
    s_nop 1
    v_add_f32_dpp v61, v61, v61 row_ror:1 row_mask:0xf bank_mask:0xf
    v_mov_b32 v62, v61
    s_nop 1
    v_permlane16_swap_b32 v62, v61
    s_nop 1
    v_add_f32 v61, v61, v62
    v_mov_b32 v62, v61
    s_nop 1
    v_permlane32_swap_b32 v62, v61
    s_nop 1
    v_add_f32 v61, v61, v62
    v_mov_b32 v12, 0
    v_mov_b32 v13, 0
    v_mov_b32 v14, 0
    v_mov_b32 v15, 0
    v_mov_b32 v16, 0
    v_mov_b32 v17, 0
    v_mov_b32 v18, 0
    v_mov_b32 v19, 0
    v_lshlrev_b32 v52, 16, v20
    s_nop 1
    ds_read_b128 v[36:39], v53 offset:0
    ds_read_b128 v[40:43], v53 offset:1024
    ds_read_b128 v[44:47], v53 offset:2048
    s_waitcnt vmcnt(11)
    v_dot2c_f32_bf16_dpp v12, v20, v108 row_newbcast:0 row_mask:0xf bank_mask:0xf
    v_dot2c_f32_bf16_dpp v13, v52, v108 row_newbcast:0 row_mask:0xf bank_mask:0xf
    v_dot2c_f32_bf16_dpp v14, v20, v109 row_newbcast:0 row_mask:0xf bank_mask:0xf
    v_dot2c_f32_bf16_dpp v15, v52, v109 row_newbcast:0 row_mask:0xf bank_mask:0xf
    v_dot2c_f32_bf16_dpp v16, v20, v110 row_newbcast:0 row_mask:0xf bank_mask:0xf
    v_dot2c_f32_bf16_dpp v17, v52, v110 row_newbcast:0 row_mask:0xf bank_mask:0xf
    v_dot2c_f32_bf16_dpp v18, v20, v111 row_newbcast:0 row_mask:0xf bank_mask:0xf
    v_dot2c_f32_bf16_dpp v19, v52, v111 row_newbcast:0 row_mask:0xf bank_mask:0xf
    s_add_u32 s6, s56, 49152
    s_and_b32 s6, s6, 0xfffff
    s_waitcnt vmcnt(4)
    s_cmp_lt_u32 s3, 4
    s_cbranch_scc0 W_337
    s_waitcnt vmcnt(3)
W_337:
    buffer_load_dwordx4 v[92:95], v1, s[12:15], s6 offen nt
    v_lshlrev_b32 v54, 16, v27
    s_nop 1
    s_waitcnt lgkmcnt(2)
    v_dot2c_f32_bf16_dpp v12, v27, v36 row_newbcast:13 row_mask:0xf bank_mask:0xf
    v_dot2c_f32_bf16_dpp v13, v54, v36 row_newbcast:13 row_mask:0xf bank_mask:0xf
    v_dot2c_f32_bf16_dpp v14, v27, v37 row_newbcast:13 row_mask:0xf bank_mask:0xf
    v_dot2c_f32_bf16_dpp v15, v54, v37 row_newbcast:13 row_mask:0xf bank_mask:0xf
    v_dot2c_f32_bf16_dpp v16, v27, v38 row_newbcast:13 row_mask:0xf bank_mask:0xf
    v_dot2c_f32_bf16_dpp v17, v54, v38 row_newbcast:13 row_mask:0xf bank_mask:0xf
    v_dot2c_f32_bf16_dpp v18, v27, v39 row_newbcast:13 row_mask:0xf bank_mask:0xf
    v_dot2c_f32_bf16_dpp v19, v54, v39 row_newbcast:13 row_mask:0xf bank_mask:0xf
    ds_read_b128 v[36:39], v53 offset:3072
    s_waitcnt lgkmcnt(2)
    v_dot2c_f32_bf16_dpp v12, v27, v40 row_newbcast:14 row_mask:0xf bank_mask:0xf
    v_dot2c_f32_bf16_dpp v13, v54, v40 row_newbcast:14 row_mask:0xf bank_mask:0xf
    v_dot2c_f32_bf16_dpp v14, v27, v41 row_newbcast:14 row_mask:0xf bank_mask:0xf
    v_dot2c_f32_bf16_dpp v15, v54, v41 row_newbcast:14 row_mask:0xf bank_mask:0xf
    v_dot2c_f32_bf16_dpp v16, v27, v42 row_newbcast:14 row_mask:0xf bank_mask:0xf
    v_dot2c_f32_bf16_dpp v17, v54, v42 row_newbcast:14 row_mask:0xf bank_mask:0xf
    v_dot2c_f32_bf16_dpp v18, v27, v43 row_newbcast:14 row_mask:0xf bank_mask:0xf
    v_dot2c_f32_bf16_dpp v19, v54, v43 row_newbcast:14 row_mask:0xf bank_mask:0xf
    ds_read_b128 v[40:43], v53 offset:4096
    s_waitcnt vmcnt(11)
    v_dot2c_f32_bf16_dpp v12, v20, v112 row_newbcast:1 row_mask:0xf bank_mask:0xf
    v_dot2c_f32_bf16_dpp v13, v52, v112 row_newbcast:1 row_mask:0xf bank_mask:0xf
    v_dot2c_f32_bf16_dpp v14, v20, v113 row_newbcast:1 row_mask:0xf bank_mask:0xf
    v_dot2c_f32_bf16_dpp v15, v52, v113 row_newbcast:1 row_mask:0xf bank_mask:0xf
    v_dot2c_f32_bf16_dpp v16, v20, v114 row_newbcast:1 row_mask:0xf bank_mask:0xf
    v_dot2c_f32_bf16_dpp v17, v52, v114 row_newbcast:1 row_mask:0xf bank_mask:0xf
    v_dot2c_f32_bf16_dpp v18, v20, v115 row_newbcast:1 row_mask:0xf bank_mask:0xf
    v_dot2c_f32_bf16_dpp v19, v52, v115 row_newbcast:1 row_mask:0xf bank_mask:0xf
    s_add_u32 s6, s56, 53248
    s_and_b32 s6, s6, 0xfffff
    s_waitcnt vmcnt(5)
    s_cmp_lt_u32 s3, 4
    s_cbranch_scc0 W_338
    s_waitcnt vmcnt(4)
W_338:
    buffer_load_dwordx4 v[96:99], v1, s[12:15], s6 offen nt
    s_waitcnt lgkmcnt(2)
    v_dot2c_f32_bf16_dpp v12, v27, v44 row_newbcast:15 row_mask:0xf bank_mask:0xf
    v_dot2c_f32_bf16_dpp v13, v54, v44 row_newbcast:15 row_mask:0xf bank_mask:0xf
    v_dot2c_f32_bf16_dpp v14, v27, v45 row_newbcast:15 row_mask:0xf bank_mask:0xf
    v_dot2c_f32_bf16_dpp v15, v54, v45 row_newbcast:15 row_mask:0xf bank_mask:0xf
    v_dot2c_f32_bf16_dpp v16, v27, v46 row_newbcast:15 row_mask:0xf bank_mask:0xf
    v_dot2c_f32_bf16_dpp v17, v54, v46 row_newbcast:15 row_mask:0xf bank_mask:0xf
    v_dot2c_f32_bf16_dpp v18, v27, v47 row_newbcast:15 row_mask:0xf bank_mask:0xf
    v_dot2c_f32_bf16_dpp v19, v54, v47 row_newbcast:15 row_mask:0xf bank_mask:0xf
    ds_read_b128 v[44:47], v53 offset:5120
    s_waitcnt vmcnt(11)
    v_dot2c_f32_bf16_dpp v12, v20, v116 row_newbcast:2 row_mask:0xf bank_mask:0xf
    v_dot2c_f32_bf16_dpp v13, v52, v116 row_newbcast:2 row_mask:0xf bank_mask:0xf
    v_dot2c_f32_bf16_dpp v14, v20, v117 row_newbcast:2 row_mask:0xf bank_mask:0xf
    v_dot2c_f32_bf16_dpp v15, v52, v117 row_newbcast:2 row_mask:0xf bank_mask:0xf
    v_dot2c_f32_bf16_dpp v16, v20, v118 row_newbcast:2 row_mask:0xf bank_mask:0xf
    v_dot2c_f32_bf16_dpp v17, v52, v118 row_newbcast:2 row_mask:0xf bank_mask:0xf
    v_dot2c_f32_bf16_dpp v18, v20, v119 row_newbcast:2 row_mask:0xf bank_mask:0xf
    v_dot2c_f32_bf16_dpp v19, v52, v119 row_newbcast:2 row_mask:0xf bank_mask:0xf
    s_add_u32 s6, s56, 57344
    s_and_b32 s6, s6, 0xfffff
    s_waitcnt vmcnt(4)
    s_cmp_lt_u32 s3, 4
    s_cbranch_scc0 W_339
    s_waitcnt vmcnt(3)
W_339:
    buffer_load_dwordx4 v[100:103], v1, s[12:15], s6 offen nt
    v_lshlrev_b32 v54, 16, v28
    s_nop 1
    s_waitcnt lgkmcnt(2)
    v_dot2c_f32_bf16_dpp v12, v28, v36 row_newbcast:0 row_mask:0xf bank_mask:0xf
    v_dot2c_f32_bf16_dpp v13, v54, v36 row_newbcast:0 row_mask:0xf bank_mask:0xf
    v_dot2c_f32_bf16_dpp v14, v28, v37 row_newbcast:0 row_mask:0xf bank_mask:0xf
    v_dot2c_f32_bf16_dpp v15, v54, v37 row_newbcast:0 row_mask:0xf bank_mask:0xf
    v_dot2c_f32_bf16_dpp v16, v28, v38 row_newbcast:0 row_mask:0xf bank_mask:0xf
    v_dot2c_f32_bf16_dpp v17, v54, v38 row_newbcast:0 row_mask:0xf bank_mask:0xf
    v_dot2c_f32_bf16_dpp v18, v28, v39 row_newbcast:0 row_mask:0xf bank_mask:0xf
    v_dot2c_f32_bf16_dpp v19, v54, v39 row_newbcast:0 row_mask:0xf bank_mask:0xf
    ds_read_b128 v[36:39], v53 offset:6144
    s_waitcnt vmcnt(11)
    v_dot2c_f32_bf16_dpp v12, v20, v120 row_newbcast:3 row_mask:0xf bank_mask:0xf
    v_dot2c_f32_bf16_dpp v13, v52, v120 row_newbcast:3 row_mask:0xf bank_mask:0xf
    v_dot2c_f32_bf16_dpp v14, v20, v121 row_newbcast:3 row_mask:0xf bank_mask:0xf
    v_dot2c_f32_bf16_dpp v15, v52, v121 row_newbcast:3 row_mask:0xf bank_mask:0xf
    v_dot2c_f32_bf16_dpp v16, v20, v122 row_newbcast:3 row_mask:0xf bank_mask:0xf
    v_dot2c_f32_bf16_dpp v17, v52, v122 row_newbcast:3 row_mask:0xf bank_mask:0xf
    v_dot2c_f32_bf16_dpp v18, v20, v123 row_newbcast:3 row_mask:0xf bank_mask:0xf
    v_dot2c_f32_bf16_dpp v19, v52, v123 row_newbcast:3 row_mask:0xf bank_mask:0xf
    s_add_u32 s6, s56, 61440
    s_and_b32 s6, s6, 0xfffff
    s_waitcnt vmcnt(5)
    s_cmp_lt_u32 s3, 4
    s_cbranch_scc0 W_340
    s_waitcnt vmcnt(4)
W_340:
    buffer_load_dwordx4 v[104:107], v1, s[12:15], s6 offen nt
    s_waitcnt lgkmcnt(2)
    v_dot2c_f32_bf16_dpp v12, v28, v40 row_newbcast:1 row_mask:0xf bank_mask:0xf
    v_dot2c_f32_bf16_dpp v13, v54, v40 row_newbcast:1 row_mask:0xf bank_mask:0xf
    v_dot2c_f32_bf16_dpp v14, v28, v41 row_newbcast:1 row_mask:0xf bank_mask:0xf
    v_dot2c_f32_bf16_dpp v15, v54, v41 row_newbcast:1 row_mask:0xf bank_mask:0xf
    v_dot2c_f32_bf16_dpp v16, v28, v42 row_newbcast:1 row_mask:0xf bank_mask:0xf
    v_dot2c_f32_bf16_dpp v17, v54, v42 row_newbcast:1 row_mask:0xf bank_mask:0xf
    v_dot2c_f32_bf16_dpp v18, v28, v43 row_newbcast:1 row_mask:0xf bank_mask:0xf
    v_dot2c_f32_bf16_dpp v19, v54, v43 row_newbcast:1 row_mask:0xf bank_mask:0xf
    ds_read_b128 v[40:43], v53 offset:7168
    s_waitcnt vmcnt(11)
    v_dot2c_f32_bf16_dpp v12, v20, v124 row_newbcast:4 row_mask:0xf bank_mask:0xf
    v_dot2c_f32_bf16_dpp v13, v52, v124 row_newbcast:4 row_mask:0xf bank_mask:0xf
    v_dot2c_f32_bf16_dpp v14, v20, v125 row_newbcast:4 row_mask:0xf bank_mask:0xf
    v_dot2c_f32_bf16_dpp v15, v52, v125 row_newbcast:4 row_mask:0xf bank_mask:0xf
    v_dot2c_f32_bf16_dpp v16, v20, v126 row_newbcast:4 row_mask:0xf bank_mask:0xf
    v_dot2c_f32_bf16_dpp v17, v52, v126 row_newbcast:4 row_mask:0xf bank_mask:0xf
    v_dot2c_f32_bf16_dpp v18, v20, v127 row_newbcast:4 row_mask:0xf bank_mask:0xf
    v_dot2c_f32_bf16_dpp v19, v52, v127 row_newbcast:4 row_mask:0xf bank_mask:0xf
    s_add_u32 s6, s56, 65536
    s_and_b32 s6, s6, 0xfffff
    s_waitcnt vmcnt(4)
    s_cmp_lt_u32 s3, 4
    s_cbranch_scc0 W_341
    s_waitcnt vmcnt(3)
W_341:
    buffer_load_dwordx4 v[108:111], v1, s[12:15], s6 offen nt
    s_waitcnt lgkmcnt(2)
    v_dot2c_f32_bf16_dpp v12, v28, v44 row_newbcast:2 row_mask:0xf bank_mask:0xf
    v_dot2c_f32_bf16_dpp v13, v54, v44 row_newbcast:2 row_mask:0xf bank_mask:0xf
    v_dot2c_f32_bf16_dpp v14, v28, v45 row_newbcast:2 row_mask:0xf bank_mask:0xf
    v_dot2c_f32_bf16_dpp v15, v54, v45 row_newbcast:2 row_mask:0xf bank_mask:0xf
    v_dot2c_f32_bf16_dpp v16, v28, v46 row_newbcast:2 row_mask:0xf bank_mask:0xf
    v_dot2c_f32_bf16_dpp v17, v54, v46 row_newbcast:2 row_mask:0xf bank_mask:0xf
    v_dot2c_f32_bf16_dpp v18, v28, v47 row_newbcast:2 row_mask:0xf bank_mask:0xf
    v_dot2c_f32_bf16_dpp v19, v54, v47 row_newbcast:2 row_mask:0xf bank_mask:0xf
    ds_read_b128 v[44:47], v53 offset:8192
    s_waitcnt vmcnt(11)
    v_dot2c_f32_bf16_dpp v12, v20, v64 row_newbcast:5 row_mask:0xf bank_mask:0xf
    v_dot2c_f32_bf16_dpp v13, v52, v64 row_newbcast:5 row_mask:0xf bank_mask:0xf
    v_dot2c_f32_bf16_dpp v14, v20, v65 row_newbcast:5 row_mask:0xf bank_mask:0xf
    v_dot2c_f32_bf16_dpp v15, v52, v65 row_newbcast:5 row_mask:0xf bank_mask:0xf
    v_dot2c_f32_bf16_dpp v16, v20, v66 row_newbcast:5 row_mask:0xf bank_mask:0xf
    v_dot2c_f32_bf16_dpp v17, v52, v66 row_newbcast:5 row_mask:0xf bank_mask:0xf
    v_dot2c_f32_bf16_dpp v18, v20, v67 row_newbcast:5 row_mask:0xf bank_mask:0xf
    v_dot2c_f32_bf16_dpp v19, v52, v67 row_newbcast:5 row_mask:0xf bank_mask:0xf
    s_add_u32 s6, s56, 69632
    s_and_b32 s6, s6, 0xfffff
    s_waitcnt vmcnt(5)
    s_cmp_lt_u32 s3, 4
    s_cbranch_scc0 W_342
    s_waitcnt vmcnt(4)
W_342:
    buffer_load_dwordx4 v[112:115], v1, s[12:15], s6 offen nt
    s_waitcnt lgkmcnt(2)
    v_dot2c_f32_bf16_dpp v12, v28, v36 row_newbcast:3 row_mask:0xf bank_mask:0xf
    v_dot2c_f32_bf16_dpp v13, v54, v36 row_newbcast:3 row_mask:0xf bank_mask:0xf
    v_dot2c_f32_bf16_dpp v14, v28, v37 row_newbcast:3 row_mask:0xf bank_mask:0xf
    v_dot2c_f32_bf16_dpp v15, v54, v37 row_newbcast:3 row_mask:0xf bank_mask:0xf
    v_dot2c_f32_bf16_dpp v16, v28, v38 row_newbcast:3 row_mask:0xf bank_mask:0xf
    v_dot2c_f32_bf16_dpp v17, v54, v38 row_newbcast:3 row_mask:0xf bank_mask:0xf
    v_dot2c_f32_bf16_dpp v18, v28, v39 row_newbcast:3 row_mask:0xf bank_mask:0xf
    v_dot2c_f32_bf16_dpp v19, v54, v39 row_newbcast:3 row_mask:0xf bank_mask:0xf
    ds_read_b128 v[36:39], v53 offset:9216
    s_waitcnt vmcnt(11)
    v_dot2c_f32_bf16_dpp v12, v20, v68 row_newbcast:6 row_mask:0xf bank_mask:0xf
    v_dot2c_f32_bf16_dpp v13, v52, v68 row_newbcast:6 row_mask:0xf bank_mask:0xf
    v_dot2c_f32_bf16_dpp v14, v20, v69 row_newbcast:6 row_mask:0xf bank_mask:0xf
    v_dot2c_f32_bf16_dpp v15, v52, v69 row_newbcast:6 row_mask:0xf bank_mask:0xf
    v_dot2c_f32_bf16_dpp v16, v20, v70 row_newbcast:6 row_mask:0xf bank_mask:0xf
    v_dot2c_f32_bf16_dpp v17, v52, v70 row_newbcast:6 row_mask:0xf bank_mask:0xf
    v_dot2c_f32_bf16_dpp v18, v20, v71 row_newbcast:6 row_mask:0xf bank_mask:0xf
    v_dot2c_f32_bf16_dpp v19, v52, v71 row_newbcast:6 row_mask:0xf bank_mask:0xf
    s_add_u32 s6, s56, 73728
    s_and_b32 s6, s6, 0xfffff
    s_waitcnt vmcnt(4)
    s_cmp_lt_u32 s3, 4
    s_cbranch_scc0 W_343
    s_waitcnt vmcnt(3)
W_343:
    buffer_load_dwordx4 v[116:119], v1, s[12:15], s6 offen nt
    s_waitcnt lgkmcnt(2)
    v_dot2c_f32_bf16_dpp v12, v28, v40 row_newbcast:4 row_mask:0xf bank_mask:0xf
    v_dot2c_f32_bf16_dpp v13, v54, v40 row_newbcast:4 row_mask:0xf bank_mask:0xf
    v_dot2c_f32_bf16_dpp v14, v28, v41 row_newbcast:4 row_mask:0xf bank_mask:0xf
    v_dot2c_f32_bf16_dpp v15, v54, v41 row_newbcast:4 row_mask:0xf bank_mask:0xf
    v_dot2c_f32_bf16_dpp v16, v28, v42 row_newbcast:4 row_mask:0xf bank_mask:0xf
    v_dot2c_f32_bf16_dpp v17, v54, v42 row_newbcast:4 row_mask:0xf bank_mask:0xf
    v_dot2c_f32_bf16_dpp v18, v28, v43 row_newbcast:4 row_mask:0xf bank_mask:0xf
    v_dot2c_f32_bf16_dpp v19, v54, v43 row_newbcast:4 row_mask:0xf bank_mask:0xf
    ds_read_b128 v[40:43], v53 offset:10240
    s_waitcnt vmcnt(11)
    v_dot2c_f32_bf16_dpp v12, v20, v72 row_newbcast:7 row_mask:0xf bank_mask:0xf
    v_dot2c_f32_bf16_dpp v13, v52, v72 row_newbcast:7 row_mask:0xf bank_mask:0xf
    v_dot2c_f32_bf16_dpp v14, v20, v73 row_newbcast:7 row_mask:0xf bank_mask:0xf
    v_dot2c_f32_bf16_dpp v15, v52, v73 row_newbcast:7 row_mask:0xf bank_mask:0xf
    v_dot2c_f32_bf16_dpp v16, v20, v74 row_newbcast:7 row_mask:0xf bank_mask:0xf
    v_dot2c_f32_bf16_dpp v17, v52, v74 row_newbcast:7 row_mask:0xf bank_mask:0xf
    v_dot2c_f32_bf16_dpp v18, v20, v75 row_newbcast:7 row_mask:0xf bank_mask:0xf
    v_dot2c_f32_bf16_dpp v19, v52, v75 row_newbcast:7 row_mask:0xf bank_mask:0xf
    s_add_u32 s6, s56, 77824
    s_and_b32 s6, s6, 0xfffff
    s_waitcnt vmcnt(5)
    s_cmp_lt_u32 s3, 4
    s_cbranch_scc0 W_344
    s_waitcnt vmcnt(4)
W_344:
    buffer_load_dwordx4 v[120:123], v1, s[12:15], s6 offen nt
    s_waitcnt lgkmcnt(2)
    v_dot2c_f32_bf16_dpp v12, v28, v44 row_newbcast:5 row_mask:0xf bank_mask:0xf
    v_dot2c_f32_bf16_dpp v13, v54, v44 row_newbcast:5 row_mask:0xf bank_mask:0xf
    v_dot2c_f32_bf16_dpp v14, v28, v45 row_newbcast:5 row_mask:0xf bank_mask:0xf
    v_dot2c_f32_bf16_dpp v15, v54, v45 row_newbcast:5 row_mask:0xf bank_mask:0xf
    v_dot2c_f32_bf16_dpp v16, v28, v46 row_newbcast:5 row_mask:0xf bank_mask:0xf
    v_dot2c_f32_bf16_dpp v17, v54, v46 row_newbcast:5 row_mask:0xf bank_mask:0xf
    v_dot2c_f32_bf16_dpp v18, v28, v47 row_newbcast:5 row_mask:0xf bank_mask:0xf
    v_dot2c_f32_bf16_dpp v19, v54, v47 row_newbcast:5 row_mask:0xf bank_mask:0xf
    ds_read_b128 v[44:47], v53 offset:11264
    s_waitcnt vmcnt(11)
    v_dot2c_f32_bf16_dpp v12, v20, v76 row_newbcast:8 row_mask:0xf bank_mask:0xf
    v_dot2c_f32_bf16_dpp v13, v52, v76 row_newbcast:8 row_mask:0xf bank_mask:0xf
    v_dot2c_f32_bf16_dpp v14, v20, v77 row_newbcast:8 row_mask:0xf bank_mask:0xf
    v_dot2c_f32_bf16_dpp v15, v52, v77 row_newbcast:8 row_mask:0xf bank_mask:0xf
    v_dot2c_f32_bf16_dpp v16, v20, v78 row_newbcast:8 row_mask:0xf bank_mask:0xf
    v_dot2c_f32_bf16_dpp v17, v52, v78 row_newbcast:8 row_mask:0xf bank_mask:0xf
    v_dot2c_f32_bf16_dpp v18, v20, v79 row_newbcast:8 row_mask:0xf bank_mask:0xf
    v_dot2c_f32_bf16_dpp v19, v52, v79 row_newbcast:8 row_mask:0xf bank_mask:0xf
    s_add_u32 s6, s56, 81920
    s_and_b32 s6, s6, 0xfffff
    s_waitcnt vmcnt(4)
    s_cmp_lt_u32 s3, 4
    s_cbranch_scc0 W_345
    s_waitcnt vmcnt(3)
W_345:
    buffer_load_dwordx4 v[124:127], v1, s[12:15], s6 offen nt
    s_waitcnt lgkmcnt(2)
    v_dot2c_f32_bf16_dpp v12, v28, v36 row_newbcast:6 row_mask:0xf bank_mask:0xf
    v_dot2c_f32_bf16_dpp v13, v54, v36 row_newbcast:6 row_mask:0xf bank_mask:0xf
    v_dot2c_f32_bf16_dpp v14, v28, v37 row_newbcast:6 row_mask:0xf bank_mask:0xf
    v_dot2c_f32_bf16_dpp v15, v54, v37 row_newbcast:6 row_mask:0xf bank_mask:0xf
    v_dot2c_f32_bf16_dpp v16, v28, v38 row_newbcast:6 row_mask:0xf bank_mask:0xf
    v_dot2c_f32_bf16_dpp v17, v54, v38 row_newbcast:6 row_mask:0xf bank_mask:0xf
    v_dot2c_f32_bf16_dpp v18, v28, v39 row_newbcast:6 row_mask:0xf bank_mask:0xf
    v_dot2c_f32_bf16_dpp v19, v54, v39 row_newbcast:6 row_mask:0xf bank_mask:0xf
    ds_read_b128 v[36:39], v53 offset:12288
    s_waitcnt vmcnt(11)
    v_dot2c_f32_bf16_dpp v12, v20, v80 row_newbcast:9 row_mask:0xf bank_mask:0xf
    v_dot2c_f32_bf16_dpp v13, v52, v80 row_newbcast:9 row_mask:0xf bank_mask:0xf
    v_dot2c_f32_bf16_dpp v14, v20, v81 row_newbcast:9 row_mask:0xf bank_mask:0xf
    v_dot2c_f32_bf16_dpp v15, v52, v81 row_newbcast:9 row_mask:0xf bank_mask:0xf
    v_dot2c_f32_bf16_dpp v16, v20, v82 row_newbcast:9 row_mask:0xf bank_mask:0xf
    v_dot2c_f32_bf16_dpp v17, v52, v82 row_newbcast:9 row_mask:0xf bank_mask:0xf
    v_dot2c_f32_bf16_dpp v18, v20, v83 row_newbcast:9 row_mask:0xf bank_mask:0xf
    v_dot2c_f32_bf16_dpp v19, v52, v83 row_newbcast:9 row_mask:0xf bank_mask:0xf
    s_add_u32 s6, s56, 86016
    s_and_b32 s6, s6, 0xfffff
    s_waitcnt vmcnt(5)
    s_cmp_lt_u32 s3, 4
    s_cbranch_scc0 W_346
    s_waitcnt vmcnt(4)
W_346:
    buffer_load_dwordx4 v[64:67], v1, s[12:15], s6 offen nt
    s_waitcnt lgkmcnt(2)
    v_dot2c_f32_bf16_dpp v12, v28, v40 row_newbcast:7 row_mask:0xf bank_mask:0xf
    v_dot2c_f32_bf16_dpp v13, v54, v40 row_newbcast:7 row_mask:0xf bank_mask:0xf
    v_dot2c_f32_bf16_dpp v14, v28, v41 row_newbcast:7 row_mask:0xf bank_mask:0xf
    v_dot2c_f32_bf16_dpp v15, v54, v41 row_newbcast:7 row_mask:0xf bank_mask:0xf
    v_dot2c_f32_bf16_dpp v16, v28, v42 row_newbcast:7 row_mask:0xf bank_mask:0xf
    v_dot2c_f32_bf16_dpp v17, v54, v42 row_newbcast:7 row_mask:0xf bank_mask:0xf
    v_dot2c_f32_bf16_dpp v18, v28, v43 row_newbcast:7 row_mask:0xf bank_mask:0xf
    v_dot2c_f32_bf16_dpp v19, v54, v43 row_newbcast:7 row_mask:0xf bank_mask:0xf
    ds_read_b128 v[40:43], v53 offset:13312
    s_waitcnt vmcnt(11)
    v_dot2c_f32_bf16_dpp v12, v20, v84 row_newbcast:10 row_mask:0xf bank_mask:0xf
    v_dot2c_f32_bf16_dpp v13, v52, v84 row_newbcast:10 row_mask:0xf bank_mask:0xf
    v_dot2c_f32_bf16_dpp v14, v20, v85 row_newbcast:10 row_mask:0xf bank_mask:0xf
    v_dot2c_f32_bf16_dpp v15, v52, v85 row_newbcast:10 row_mask:0xf bank_mask:0xf
    v_dot2c_f32_bf16_dpp v16, v20, v86 row_newbcast:10 row_mask:0xf bank_mask:0xf
    v_dot2c_f32_bf16_dpp v17, v52, v86 row_newbcast:10 row_mask:0xf bank_mask:0xf
    v_dot2c_f32_bf16_dpp v18, v20, v87 row_newbcast:10 row_mask:0xf bank_mask:0xf
    v_dot2c_f32_bf16_dpp v19, v52, v87 row_newbcast:10 row_mask:0xf bank_mask:0xf
    s_add_u32 s6, s56, 90112
    s_and_b32 s6, s6, 0xfffff
    s_waitcnt vmcnt(4)
    s_cmp_lt_u32 s3, 4
    s_cbranch_scc0 W_347
    s_waitcnt vmcnt(3)
W_347:
    buffer_load_dwordx4 v[68:71], v1, s[12:15], s6 offen nt
    s_waitcnt lgkmcnt(2)
    v_dot2c_f32_bf16_dpp v12, v28, v44 row_newbcast:8 row_mask:0xf bank_mask:0xf
    v_dot2c_f32_bf16_dpp v13, v54, v44 row_newbcast:8 row_mask:0xf bank_mask:0xf
    v_dot2c_f32_bf16_dpp v14, v28, v45 row_newbcast:8 row_mask:0xf bank_mask:0xf
    v_dot2c_f32_bf16_dpp v15, v54, v45 row_newbcast:8 row_mask:0xf bank_mask:0xf
    v_dot2c_f32_bf16_dpp v16, v28, v46 row_newbcast:8 row_mask:0xf bank_mask:0xf
    v_dot2c_f32_bf16_dpp v17, v54, v46 row_newbcast:8 row_mask:0xf bank_mask:0xf
    v_dot2c_f32_bf16_dpp v18, v28, v47 row_newbcast:8 row_mask:0xf bank_mask:0xf
    v_dot2c_f32_bf16_dpp v19, v54, v47 row_newbcast:8 row_mask:0xf bank_mask:0xf
    ds_read_b128 v[44:47], v53 offset:14336
    s_waitcnt vmcnt(11)
    v_dot2c_f32_bf16_dpp v12, v20, v88 row_newbcast:11 row_mask:0xf bank_mask:0xf
    v_dot2c_f32_bf16_dpp v13, v52, v88 row_newbcast:11 row_mask:0xf bank_mask:0xf
    v_dot2c_f32_bf16_dpp v14, v20, v89 row_newbcast:11 row_mask:0xf bank_mask:0xf
    v_dot2c_f32_bf16_dpp v15, v52, v89 row_newbcast:11 row_mask:0xf bank_mask:0xf
    v_dot2c_f32_bf16_dpp v16, v20, v90 row_newbcast:11 row_mask:0xf bank_mask:0xf
    v_dot2c_f32_bf16_dpp v17, v52, v90 row_newbcast:11 row_mask:0xf bank_mask:0xf
    v_dot2c_f32_bf16_dpp v18, v20, v91 row_newbcast:11 row_mask:0xf bank_mask:0xf
    v_dot2c_f32_bf16_dpp v19, v52, v91 row_newbcast:11 row_mask:0xf bank_mask:0xf
    s_add_u32 s6, s56, 94208
    s_and_b32 s6, s6, 0xfffff
    s_waitcnt vmcnt(5)
    s_cmp_lt_u32 s3, 4
    s_cbranch_scc0 W_348
    s_waitcnt vmcnt(4)
W_348:
    buffer_load_dwordx4 v[72:75], v1, s[12:15], s6 offen nt
    s_waitcnt lgkmcnt(2)
    v_dot2c_f32_bf16_dpp v12, v28, v36 row_newbcast:9 row_mask:0xf bank_mask:0xf
    v_dot2c_f32_bf16_dpp v13, v54, v36 row_newbcast:9 row_mask:0xf bank_mask:0xf
    v_dot2c_f32_bf16_dpp v14, v28, v37 row_newbcast:9 row_mask:0xf bank_mask:0xf
    v_dot2c_f32_bf16_dpp v15, v54, v37 row_newbcast:9 row_mask:0xf bank_mask:0xf
    v_dot2c_f32_bf16_dpp v16, v28, v38 row_newbcast:9 row_mask:0xf bank_mask:0xf
    v_dot2c_f32_bf16_dpp v17, v54, v38 row_newbcast:9 row_mask:0xf bank_mask:0xf
    v_dot2c_f32_bf16_dpp v18, v28, v39 row_newbcast:9 row_mask:0xf bank_mask:0xf
    v_dot2c_f32_bf16_dpp v19, v54, v39 row_newbcast:9 row_mask:0xf bank_mask:0xf
    ds_read_b128 v[36:39], v53 offset:15360
    s_waitcnt vmcnt(11)
    v_dot2c_f32_bf16_dpp v12, v20, v92 row_newbcast:12 row_mask:0xf bank_mask:0xf
    v_dot2c_f32_bf16_dpp v13, v52, v92 row_newbcast:12 row_mask:0xf bank_mask:0xf
    v_dot2c_f32_bf16_dpp v14, v20, v93 row_newbcast:12 row_mask:0xf bank_mask:0xf
    v_dot2c_f32_bf16_dpp v15, v52, v93 row_newbcast:12 row_mask:0xf bank_mask:0xf
    v_dot2c_f32_bf16_dpp v16, v20, v94 row_newbcast:12 row_mask:0xf bank_mask:0xf
    v_dot2c_f32_bf16_dpp v17, v52, v94 row_newbcast:12 row_mask:0xf bank_mask:0xf
    v_dot2c_f32_bf16_dpp v18, v20, v95 row_newbcast:12 row_mask:0xf bank_mask:0xf
    v_dot2c_f32_bf16_dpp v19, v52, v95 row_newbcast:12 row_mask:0xf bank_mask:0xf
    s_add_u32 s6, s56, 98304
    s_and_b32 s6, s6, 0xfffff
    s_waitcnt vmcnt(4)
    s_cmp_lt_u32 s3, 4
    s_cbranch_scc0 W_349
    s_waitcnt vmcnt(3)
W_349:
    buffer_load_dwordx4 v[76:79], v1, s[12:15], s6 offen nt
    s_waitcnt lgkmcnt(2)
    v_dot2c_f32_bf16_dpp v12, v28, v40 row_newbcast:10 row_mask:0xf bank_mask:0xf
    v_dot2c_f32_bf16_dpp v13, v54, v40 row_newbcast:10 row_mask:0xf bank_mask:0xf
    v_dot2c_f32_bf16_dpp v14, v28, v41 row_newbcast:10 row_mask:0xf bank_mask:0xf
    v_dot2c_f32_bf16_dpp v15, v54, v41 row_newbcast:10 row_mask:0xf bank_mask:0xf
    v_dot2c_f32_bf16_dpp v16, v28, v42 row_newbcast:10 row_mask:0xf bank_mask:0xf
    v_dot2c_f32_bf16_dpp v17, v54, v42 row_newbcast:10 row_mask:0xf bank_mask:0xf
    v_dot2c_f32_bf16_dpp v18, v28, v43 row_newbcast:10 row_mask:0xf bank_mask:0xf
    v_dot2c_f32_bf16_dpp v19, v54, v43 row_newbcast:10 row_mask:0xf bank_mask:0xf
    ds_read_b128 v[40:43], v53 offset:16384
    s_waitcnt vmcnt(11)
    v_dot2c_f32_bf16_dpp v12, v20, v96 row_newbcast:13 row_mask:0xf bank_mask:0xf
    v_dot2c_f32_bf16_dpp v13, v52, v96 row_newbcast:13 row_mask:0xf bank_mask:0xf
    v_dot2c_f32_bf16_dpp v14, v20, v97 row_newbcast:13 row_mask:0xf bank_mask:0xf
    v_dot2c_f32_bf16_dpp v15, v52, v97 row_newbcast:13 row_mask:0xf bank_mask:0xf
    v_dot2c_f32_bf16_dpp v16, v20, v98 row_newbcast:13 row_mask:0xf bank_mask:0xf
    v_dot2c_f32_bf16_dpp v17, v52, v98 row_newbcast:13 row_mask:0xf bank_mask:0xf
    v_dot2c_f32_bf16_dpp v18, v20, v99 row_newbcast:13 row_mask:0xf bank_mask:0xf
    v_dot2c_f32_bf16_dpp v19, v52, v99 row_newbcast:13 row_mask:0xf bank_mask:0xf
    s_add_u32 s6, s56, 102400
    s_and_b32 s6, s6, 0xfffff
    s_waitcnt vmcnt(5)
    s_cmp_lt_u32 s3, 4
    s_cbranch_scc0 W_350
    s_waitcnt vmcnt(4)
W_350:
    buffer_load_dwordx4 v[80:83], v1, s[12:15], s6 offen nt
    s_waitcnt lgkmcnt(2)
    v_dot2c_f32_bf16_dpp v12, v28, v44 row_newbcast:11 row_mask:0xf bank_mask:0xf
    v_dot2c_f32_bf16_dpp v13, v54, v44 row_newbcast:11 row_mask:0xf bank_mask:0xf
    v_dot2c_f32_bf16_dpp v14, v28, v45 row_newbcast:11 row_mask:0xf bank_mask:0xf
    v_dot2c_f32_bf16_dpp v15, v54, v45 row_newbcast:11 row_mask:0xf bank_mask:0xf
    v_dot2c_f32_bf16_dpp v16, v28, v46 row_newbcast:11 row_mask:0xf bank_mask:0xf
    v_dot2c_f32_bf16_dpp v17, v54, v46 row_newbcast:11 row_mask:0xf bank_mask:0xf
    v_dot2c_f32_bf16_dpp v18, v28, v47 row_newbcast:11 row_mask:0xf bank_mask:0xf
    v_dot2c_f32_bf16_dpp v19, v54, v47 row_newbcast:11 row_mask:0xf bank_mask:0xf
    ds_read_b128 v[44:47], v53 offset:17408
    s_waitcnt vmcnt(11)
    v_dot2c_f32_bf16_dpp v12, v20, v100 row_newbcast:14 row_mask:0xf bank_mask:0xf
    v_dot2c_f32_bf16_dpp v13, v52, v100 row_newbcast:14 row_mask:0xf bank_mask:0xf
    v_dot2c_f32_bf16_dpp v14, v20, v101 row_newbcast:14 row_mask:0xf bank_mask:0xf
    v_dot2c_f32_bf16_dpp v15, v52, v101 row_newbcast:14 row_mask:0xf bank_mask:0xf
    v_dot2c_f32_bf16_dpp v16, v20, v102 row_newbcast:14 row_mask:0xf bank_mask:0xf
    v_dot2c_f32_bf16_dpp v17, v52, v102 row_newbcast:14 row_mask:0xf bank_mask:0xf
    v_dot2c_f32_bf16_dpp v18, v20, v103 row_newbcast:14 row_mask:0xf bank_mask:0xf
    v_dot2c_f32_bf16_dpp v19, v52, v103 row_newbcast:14 row_mask:0xf bank_mask:0xf
    s_add_u32 s6, s56, 106496
    s_and_b32 s6, s6, 0xfffff
    s_waitcnt vmcnt(4)
    s_cmp_lt_u32 s3, 4
    s_cbranch_scc0 W_351
    s_waitcnt vmcnt(3)
W_351:
    buffer_load_dwordx4 v[84:87], v1, s[12:15], s6 offen nt
    s_waitcnt lgkmcnt(2)
    v_dot2c_f32_bf16_dpp v12, v28, v36 row_newbcast:12 row_mask:0xf bank_mask:0xf
    v_dot2c_f32_bf16_dpp v13, v54, v36 row_newbcast:12 row_mask:0xf bank_mask:0xf
    v_dot2c_f32_bf16_dpp v14, v28, v37 row_newbcast:12 row_mask:0xf bank_mask:0xf
    v_dot2c_f32_bf16_dpp v15, v54, v37 row_newbcast:12 row_mask:0xf bank_mask:0xf
    v_dot2c_f32_bf16_dpp v16, v28, v38 row_newbcast:12 row_mask:0xf bank_mask:0xf
    v_dot2c_f32_bf16_dpp v17, v54, v38 row_newbcast:12 row_mask:0xf bank_mask:0xf
    v_dot2c_f32_bf16_dpp v18, v28, v39 row_newbcast:12 row_mask:0xf bank_mask:0xf
    v_dot2c_f32_bf16_dpp v19, v54, v39 row_newbcast:12 row_mask:0xf bank_mask:0xf
    ds_read_b128 v[36:39], v53 offset:18432
    s_waitcnt vmcnt(11)
    v_dot2c_f32_bf16_dpp v12, v20, v104 row_newbcast:15 row_mask:0xf bank_mask:0xf
    v_dot2c_f32_bf16_dpp v13, v52, v104 row_newbcast:15 row_mask:0xf bank_mask:0xf
    v_dot2c_f32_bf16_dpp v14, v20, v105 row_newbcast:15 row_mask:0xf bank_mask:0xf
    v_dot2c_f32_bf16_dpp v15, v52, v105 row_newbcast:15 row_mask:0xf bank_mask:0xf
    v_dot2c_f32_bf16_dpp v16, v20, v106 row_newbcast:15 row_mask:0xf bank_mask:0xf
    v_dot2c_f32_bf16_dpp v17, v52, v106 row_newbcast:15 row_mask:0xf bank_mask:0xf
    v_dot2c_f32_bf16_dpp v18, v20, v107 row_newbcast:15 row_mask:0xf bank_mask:0xf
    v_dot2c_f32_bf16_dpp v19, v52, v107 row_newbcast:15 row_mask:0xf bank_mask:0xf
    s_add_u32 s6, s56, 110592
    s_and_b32 s6, s6, 0xfffff
    s_waitcnt vmcnt(5)
    s_cmp_lt_u32 s3, 4
    s_cbranch_scc0 W_352
    s_waitcnt vmcnt(4)
W_352:
    buffer_load_dwordx4 v[88:91], v1, s[12:15], s6 offen nt
    s_waitcnt lgkmcnt(2)
    v_dot2c_f32_bf16_dpp v12, v28, v40 row_newbcast:13 row_mask:0xf bank_mask:0xf
    v_dot2c_f32_bf16_dpp v13, v54, v40 row_newbcast:13 row_mask:0xf bank_mask:0xf
    v_dot2c_f32_bf16_dpp v14, v28, v41 row_newbcast:13 row_mask:0xf bank_mask:0xf
    v_dot2c_f32_bf16_dpp v15, v54, v41 row_newbcast:13 row_mask:0xf bank_mask:0xf
    v_dot2c_f32_bf16_dpp v16, v28, v42 row_newbcast:13 row_mask:0xf bank_mask:0xf
    v_dot2c_f32_bf16_dpp v17, v54, v42 row_newbcast:13 row_mask:0xf bank_mask:0xf
    v_dot2c_f32_bf16_dpp v18, v28, v43 row_newbcast:13 row_mask:0xf bank_mask:0xf
    v_dot2c_f32_bf16_dpp v19, v54, v43 row_newbcast:13 row_mask:0xf bank_mask:0xf
    v_lshlrev_b32 v52, 16, v21
    s_nop 1
    ds_read_b128 v[40:43], v53 offset:19456
    s_waitcnt vmcnt(11)
    v_dot2c_f32_bf16_dpp v12, v21, v108 row_newbcast:0 row_mask:0xf bank_mask:0xf
    v_dot2c_f32_bf16_dpp v13, v52, v108 row_newbcast:0 row_mask:0xf bank_mask:0xf
    v_dot2c_f32_bf16_dpp v14, v21, v109 row_newbcast:0 row_mask:0xf bank_mask:0xf
    v_dot2c_f32_bf16_dpp v15, v52, v109 row_newbcast:0 row_mask:0xf bank_mask:0xf
    v_dot2c_f32_bf16_dpp v16, v21, v110 row_newbcast:0 row_mask:0xf bank_mask:0xf
    v_dot2c_f32_bf16_dpp v17, v52, v110 row_newbcast:0 row_mask:0xf bank_mask:0xf
    v_dot2c_f32_bf16_dpp v18, v21, v111 row_newbcast:0 row_mask:0xf bank_mask:0xf
    v_dot2c_f32_bf16_dpp v19, v52, v111 row_newbcast:0 row_mask:0xf bank_mask:0xf
    s_add_u32 s6, s56, 114688
    s_and_b32 s6, s6, 0xfffff
    s_waitcnt vmcnt(4)
    s_cmp_lt_u32 s3, 4
    s_cbranch_scc0 W_353
    s_waitcnt vmcnt(3)
W_353:
    buffer_load_dwordx4 v[92:95], v1, s[12:15], s6 offen nt
    s_waitcnt lgkmcnt(2)
    v_dot2c_f32_bf16_dpp v12, v28, v44 row_newbcast:14 row_mask:0xf bank_mask:0xf
    v_dot2c_f32_bf16_dpp v13, v54, v44 row_newbcast:14 row_mask:0xf bank_mask:0xf
    v_dot2c_f32_bf16_dpp v14, v28, v45 row_newbcast:14 row_mask:0xf bank_mask:0xf
    v_dot2c_f32_bf16_dpp v15, v54, v45 row_newbcast:14 row_mask:0xf bank_mask:0xf
    v_dot2c_f32_bf16_dpp v16, v28, v46 row_newbcast:14 row_mask:0xf bank_mask:0xf
    v_dot2c_f32_bf16_dpp v17, v54, v46 row_newbcast:14 row_mask:0xf bank_mask:0xf
    v_dot2c_f32_bf16_dpp v18, v28, v47 row_newbcast:14 row_mask:0xf bank_mask:0xf
    v_dot2c_f32_bf16_dpp v19, v54, v47 row_newbcast:14 row_mask:0xf bank_mask:0xf
    ds_read_b128 v[44:47], v53 offset:20480
    s_waitcnt vmcnt(11)
    v_dot2c_f32_bf16_dpp v12, v21, v112 row_newbcast:1 row_mask:0xf bank_mask:0xf
    v_dot2c_f32_bf16_dpp v13, v52, v112 row_newbcast:1 row_mask:0xf bank_mask:0xf
    v_dot2c_f32_bf16_dpp v14, v21, v113 row_newbcast:1 row_mask:0xf bank_mask:0xf
    v_dot2c_f32_bf16_dpp v15, v52, v113 row_newbcast:1 row_mask:0xf bank_mask:0xf
    v_dot2c_f32_bf16_dpp v16, v21, v114 row_newbcast:1 row_mask:0xf bank_mask:0xf
    v_dot2c_f32_bf16_dpp v17, v52, v114 row_newbcast:1 row_mask:0xf bank_mask:0xf
    v_dot2c_f32_bf16_dpp v18, v21, v115 row_newbcast:1 row_mask:0xf bank_mask:0xf
    v_dot2c_f32_bf16_dpp v19, v52, v115 row_newbcast:1 row_mask:0xf bank_mask:0xf
    s_add_u32 s6, s56, 118784
    s_and_b32 s6, s6, 0xfffff
    s_waitcnt vmcnt(5)
    s_cmp_lt_u32 s3, 4
    s_cbranch_scc0 W_354
    s_waitcnt vmcnt(4)
W_354:
    buffer_load_dwordx4 v[96:99], v1, s[12:15], s6 offen nt
    s_waitcnt lgkmcnt(2)
    v_dot2c_f32_bf16_dpp v12, v28, v36 row_newbcast:15 row_mask:0xf bank_mask:0xf
    v_dot2c_f32_bf16_dpp v13, v54, v36 row_newbcast:15 row_mask:0xf bank_mask:0xf
    v_dot2c_f32_bf16_dpp v14, v28, v37 row_newbcast:15 row_mask:0xf bank_mask:0xf
    v_dot2c_f32_bf16_dpp v15, v54, v37 row_newbcast:15 row_mask:0xf bank_mask:0xf
    v_dot2c_f32_bf16_dpp v16, v28, v38 row_newbcast:15 row_mask:0xf bank_mask:0xf
    v_dot2c_f32_bf16_dpp v17, v54, v38 row_newbcast:15 row_mask:0xf bank_mask:0xf
    v_dot2c_f32_bf16_dpp v18, v28, v39 row_newbcast:15 row_mask:0xf bank_mask:0xf
    v_dot2c_f32_bf16_dpp v19, v54, v39 row_newbcast:15 row_mask:0xf bank_mask:0xf
    ds_read_b128 v[36:39], v53 offset:21504
    s_waitcnt vmcnt(11)
    v_dot2c_f32_bf16_dpp v12, v21, v116 row_newbcast:2 row_mask:0xf bank_mask:0xf
    v_dot2c_f32_bf16_dpp v13, v52, v116 row_newbcast:2 row_mask:0xf bank_mask:0xf
    v_dot2c_f32_bf16_dpp v14, v21, v117 row_newbcast:2 row_mask:0xf bank_mask:0xf
    v_dot2c_f32_bf16_dpp v15, v52, v117 row_newbcast:2 row_mask:0xf bank_mask:0xf
    v_dot2c_f32_bf16_dpp v16, v21, v118 row_newbcast:2 row_mask:0xf bank_mask:0xf
    v_dot2c_f32_bf16_dpp v17, v52, v118 row_newbcast:2 row_mask:0xf bank_mask:0xf
    v_dot2c_f32_bf16_dpp v18, v21, v119 row_newbcast:2 row_mask:0xf bank_mask:0xf
    v_dot2c_f32_bf16_dpp v19, v52, v119 row_newbcast:2 row_mask:0xf bank_mask:0xf
    s_add_u32 s6, s56, 122880
    s_and_b32 s6, s6, 0xfffff
    s_waitcnt vmcnt(4)
    s_cmp_lt_u32 s3, 4
    s_cbranch_scc0 W_355
    s_waitcnt vmcnt(3)
W_355:
    buffer_load_dwordx4 v[100:103], v1, s[12:15], s6 offen nt
    v_lshlrev_b32 v54, 16, v29
    s_nop 1
    s_waitcnt lgkmcnt(2)
    v_dot2c_f32_bf16_dpp v12, v29, v40 row_newbcast:0 row_mask:0xf bank_mask:0xf
    v_dot2c_f32_bf16_dpp v13, v54, v40 row_newbcast:0 row_mask:0xf bank_mask:0xf
    v_dot2c_f32_bf16_dpp v14, v29, v41 row_newbcast:0 row_mask:0xf bank_mask:0xf
    v_dot2c_f32_bf16_dpp v15, v54, v41 row_newbcast:0 row_mask:0xf bank_mask:0xf
    v_dot2c_f32_bf16_dpp v16, v29, v42 row_newbcast:0 row_mask:0xf bank_mask:0xf
    v_dot2c_f32_bf16_dpp v17, v54, v42 row_newbcast:0 row_mask:0xf bank_mask:0xf
    v_dot2c_f32_bf16_dpp v18, v29, v43 row_newbcast:0 row_mask:0xf bank_mask:0xf
    v_dot2c_f32_bf16_dpp v19, v54, v43 row_newbcast:0 row_mask:0xf bank_mask:0xf
    ds_read_b128 v[40:43], v53 offset:22528
    s_waitcnt vmcnt(11)
    v_dot2c_f32_bf16_dpp v12, v21, v120 row_newbcast:3 row_mask:0xf bank_mask:0xf
    v_dot2c_f32_bf16_dpp v13, v52, v120 row_newbcast:3 row_mask:0xf bank_mask:0xf
    v_dot2c_f32_bf16_dpp v14, v21, v121 row_newbcast:3 row_mask:0xf bank_mask:0xf
    v_dot2c_f32_bf16_dpp v15, v52, v121 row_newbcast:3 row_mask:0xf bank_mask:0xf
    v_dot2c_f32_bf16_dpp v16, v21, v122 row_newbcast:3 row_mask:0xf bank_mask:0xf
    v_dot2c_f32_bf16_dpp v17, v52, v122 row_newbcast:3 row_mask:0xf bank_mask:0xf
    v_dot2c_f32_bf16_dpp v18, v21, v123 row_newbcast:3 row_mask:0xf bank_mask:0xf
    v_dot2c_f32_bf16_dpp v19, v52, v123 row_newbcast:3 row_mask:0xf bank_mask:0xf
    s_add_u32 s6, s56, 126976
    s_and_b32 s6, s6, 0xfffff
    s_waitcnt vmcnt(5)
    s_cmp_lt_u32 s3, 4
    s_cbranch_scc0 W_356
    s_waitcnt vmcnt(4)
W_356:
    buffer_load_dwordx4 v[104:107], v1, s[12:15], s6 offen nt
    s_waitcnt lgkmcnt(2)
    v_dot2c_f32_bf16_dpp v12, v29, v44 row_newbcast:1 row_mask:0xf bank_mask:0xf
    v_dot2c_f32_bf16_dpp v13, v54, v44 row_newbcast:1 row_mask:0xf bank_mask:0xf
    v_dot2c_f32_bf16_dpp v14, v29, v45 row_newbcast:1 row_mask:0xf bank_mask:0xf
    v_dot2c_f32_bf16_dpp v15, v54, v45 row_newbcast:1 row_mask:0xf bank_mask:0xf
    v_dot2c_f32_bf16_dpp v16, v29, v46 row_newbcast:1 row_mask:0xf bank_mask:0xf
    v_dot2c_f32_bf16_dpp v17, v54, v46 row_newbcast:1 row_mask:0xf bank_mask:0xf
    v_dot2c_f32_bf16_dpp v18, v29, v47 row_newbcast:1 row_mask:0xf bank_mask:0xf
    v_dot2c_f32_bf16_dpp v19, v54, v47 row_newbcast:1 row_mask:0xf bank_mask:0xf
    ds_read_b128 v[44:47], v53 offset:23552
    s_waitcnt vmcnt(11)
    v_dot2c_f32_bf16_dpp v12, v21, v124 row_newbcast:4 row_mask:0xf bank_mask:0xf
    v_dot2c_f32_bf16_dpp v13, v52, v124 row_newbcast:4 row_mask:0xf bank_mask:0xf
    v_dot2c_f32_bf16_dpp v14, v21, v125 row_newbcast:4 row_mask:0xf bank_mask:0xf
    v_dot2c_f32_bf16_dpp v15, v52, v125 row_newbcast:4 row_mask:0xf bank_mask:0xf
    v_dot2c_f32_bf16_dpp v16, v21, v126 row_newbcast:4 row_mask:0xf bank_mask:0xf
    v_dot2c_f32_bf16_dpp v17, v52, v126 row_newbcast:4 row_mask:0xf bank_mask:0xf
    v_dot2c_f32_bf16_dpp v18, v21, v127 row_newbcast:4 row_mask:0xf bank_mask:0xf
    v_dot2c_f32_bf16_dpp v19, v52, v127 row_newbcast:4 row_mask:0xf bank_mask:0xf
    s_add_u32 s6, s56, 131072
    s_and_b32 s6, s6, 0xfffff
    s_waitcnt vmcnt(4)
    s_cmp_lt_u32 s3, 4
    s_cbranch_scc0 W_357
    s_waitcnt vmcnt(3)
W_357:
    buffer_load_dwordx4 v[108:111], v1, s[12:15], s6 offen nt
    s_waitcnt lgkmcnt(2)
    v_dot2c_f32_bf16_dpp v12, v29, v36 row_newbcast:2 row_mask:0xf bank_mask:0xf
    v_dot2c_f32_bf16_dpp v13, v54, v36 row_newbcast:2 row_mask:0xf bank_mask:0xf
    v_dot2c_f32_bf16_dpp v14, v29, v37 row_newbcast:2 row_mask:0xf bank_mask:0xf
    v_dot2c_f32_bf16_dpp v15, v54, v37 row_newbcast:2 row_mask:0xf bank_mask:0xf
    v_dot2c_f32_bf16_dpp v16, v29, v38 row_newbcast:2 row_mask:0xf bank_mask:0xf
    v_dot2c_f32_bf16_dpp v17, v54, v38 row_newbcast:2 row_mask:0xf bank_mask:0xf
    v_dot2c_f32_bf16_dpp v18, v29, v39 row_newbcast:2 row_mask:0xf bank_mask:0xf
    v_dot2c_f32_bf16_dpp v19, v54, v39 row_newbcast:2 row_mask:0xf bank_mask:0xf
    ds_read_b128 v[36:39], v53 offset:24576
    s_waitcnt lgkmcnt(2)
    v_dot2c_f32_bf16_dpp v12, v29, v40 row_newbcast:3 row_mask:0xf bank_mask:0xf
    v_dot2c_f32_bf16_dpp v13, v54, v40 row_newbcast:3 row_mask:0xf bank_mask:0xf
    v_dot2c_f32_bf16_dpp v14, v29, v41 row_newbcast:3 row_mask:0xf bank_mask:0xf
    v_dot2c_f32_bf16_dpp v15, v54, v41 row_newbcast:3 row_mask:0xf bank_mask:0xf
    v_dot2c_f32_bf16_dpp v16, v29, v42 row_newbcast:3 row_mask:0xf bank_mask:0xf
    v_dot2c_f32_bf16_dpp v17, v54, v42 row_newbcast:3 row_mask:0xf bank_mask:0xf
    v_dot2c_f32_bf16_dpp v18, v29, v43 row_newbcast:3 row_mask:0xf bank_mask:0xf
    v_dot2c_f32_bf16_dpp v19, v54, v43 row_newbcast:3 row_mask:0xf bank_mask:0xf
    ds_read_b128 v[40:43], v53 offset:25600
    s_waitcnt vmcnt(11)
    v_dot2c_f32_bf16_dpp v12, v21, v64 row_newbcast:5 row_mask:0xf bank_mask:0xf
    v_dot2c_f32_bf16_dpp v13, v52, v64 row_newbcast:5 row_mask:0xf bank_mask:0xf
    v_dot2c_f32_bf16_dpp v14, v21, v65 row_newbcast:5 row_mask:0xf bank_mask:0xf
    v_dot2c_f32_bf16_dpp v15, v52, v65 row_newbcast:5 row_mask:0xf bank_mask:0xf
    v_dot2c_f32_bf16_dpp v16, v21, v66 row_newbcast:5 row_mask:0xf bank_mask:0xf
    v_dot2c_f32_bf16_dpp v17, v52, v66 row_newbcast:5 row_mask:0xf bank_mask:0xf
    v_dot2c_f32_bf16_dpp v18, v21, v67 row_newbcast:5 row_mask:0xf bank_mask:0xf
    v_dot2c_f32_bf16_dpp v19, v52, v67 row_newbcast:5 row_mask:0xf bank_mask:0xf
    s_add_u32 s6, s56, 135168
    s_and_b32 s6, s6, 0xfffff
    s_waitcnt vmcnt(5)
    s_cmp_lt_u32 s3, 4
    s_cbranch_scc0 W_358
    s_waitcnt vmcnt(4)
W_358:
    buffer_load_dwordx4 v[112:115], v1, s[12:15], s6 offen nt
    s_waitcnt lgkmcnt(2)
    v_dot2c_f32_bf16_dpp v12, v29, v44 row_newbcast:4 row_mask:0xf bank_mask:0xf
    v_dot2c_f32_bf16_dpp v13, v54, v44 row_newbcast:4 row_mask:0xf bank_mask:0xf
    v_dot2c_f32_bf16_dpp v14, v29, v45 row_newbcast:4 row_mask:0xf bank_mask:0xf
    v_dot2c_f32_bf16_dpp v15, v54, v45 row_newbcast:4 row_mask:0xf bank_mask:0xf
    v_dot2c_f32_bf16_dpp v16, v29, v46 row_newbcast:4 row_mask:0xf bank_mask:0xf
    v_dot2c_f32_bf16_dpp v17, v54, v46 row_newbcast:4 row_mask:0xf bank_mask:0xf
    v_dot2c_f32_bf16_dpp v18, v29, v47 row_newbcast:4 row_mask:0xf bank_mask:0xf
    v_dot2c_f32_bf16_dpp v19, v54, v47 row_newbcast:4 row_mask:0xf bank_mask:0xf
    ds_read_b128 v[44:47], v53 offset:26624
    s_waitcnt vmcnt(11)
    v_dot2c_f32_bf16_dpp v12, v21, v68 row_newbcast:6 row_mask:0xf bank_mask:0xf
    v_dot2c_f32_bf16_dpp v13, v52, v68 row_newbcast:6 row_mask:0xf bank_mask:0xf
    v_dot2c_f32_bf16_dpp v14, v21, v69 row_newbcast:6 row_mask:0xf bank_mask:0xf
    v_dot2c_f32_bf16_dpp v15, v52, v69 row_newbcast:6 row_mask:0xf bank_mask:0xf
    v_dot2c_f32_bf16_dpp v16, v21, v70 row_newbcast:6 row_mask:0xf bank_mask:0xf
    v_dot2c_f32_bf16_dpp v17, v52, v70 row_newbcast:6 row_mask:0xf bank_mask:0xf
    v_dot2c_f32_bf16_dpp v18, v21, v71 row_newbcast:6 row_mask:0xf bank_mask:0xf
    v_dot2c_f32_bf16_dpp v19, v52, v71 row_newbcast:6 row_mask:0xf bank_mask:0xf
    s_add_u32 s6, s56, 139264
    s_and_b32 s6, s6, 0xfffff
    s_waitcnt vmcnt(4)
    s_cmp_lt_u32 s3, 4
    s_cbranch_scc0 W_359
    s_waitcnt vmcnt(3)
W_359:
    buffer_load_dwordx4 v[116:119], v1, s[12:15], s6 offen nt
    s_waitcnt lgkmcnt(2)
    v_dot2c_f32_bf16_dpp v12, v29, v36 row_newbcast:5 row_mask:0xf bank_mask:0xf
    v_dot2c_f32_bf16_dpp v13, v54, v36 row_newbcast:5 row_mask:0xf bank_mask:0xf
    v_dot2c_f32_bf16_dpp v14, v29, v37 row_newbcast:5 row_mask:0xf bank_mask:0xf
    v_dot2c_f32_bf16_dpp v15, v54, v37 row_newbcast:5 row_mask:0xf bank_mask:0xf
    v_dot2c_f32_bf16_dpp v16, v29, v38 row_newbcast:5 row_mask:0xf bank_mask:0xf
    v_dot2c_f32_bf16_dpp v17, v54, v38 row_newbcast:5 row_mask:0xf bank_mask:0xf
    v_dot2c_f32_bf16_dpp v18, v29, v39 row_newbcast:5 row_mask:0xf bank_mask:0xf
    v_dot2c_f32_bf16_dpp v19, v54, v39 row_newbcast:5 row_mask:0xf bank_mask:0xf
    ds_read_b128 v[36:39], v53 offset:27648
    s_waitcnt vmcnt(11)
    v_dot2c_f32_bf16_dpp v12, v21, v72 row_newbcast:7 row_mask:0xf bank_mask:0xf
    v_dot2c_f32_bf16_dpp v13, v52, v72 row_newbcast:7 row_mask:0xf bank_mask:0xf
    v_dot2c_f32_bf16_dpp v14, v21, v73 row_newbcast:7 row_mask:0xf bank_mask:0xf
    v_dot2c_f32_bf16_dpp v15, v52, v73 row_newbcast:7 row_mask:0xf bank_mask:0xf
    v_dot2c_f32_bf16_dpp v16, v21, v74 row_newbcast:7 row_mask:0xf bank_mask:0xf
    v_dot2c_f32_bf16_dpp v17, v52, v74 row_newbcast:7 row_mask:0xf bank_mask:0xf
    v_dot2c_f32_bf16_dpp v18, v21, v75 row_newbcast:7 row_mask:0xf bank_mask:0xf
    v_dot2c_f32_bf16_dpp v19, v52, v75 row_newbcast:7 row_mask:0xf bank_mask:0xf
    s_add_u32 s6, s56, 143360
    s_and_b32 s6, s6, 0xfffff
    s_waitcnt vmcnt(5)
    s_cmp_lt_u32 s3, 4
    s_cbranch_scc0 W_360
    s_waitcnt vmcnt(4)
W_360:
    buffer_load_dwordx4 v[120:123], v1, s[12:15], s6 offen nt
    s_waitcnt lgkmcnt(2)
    v_dot2c_f32_bf16_dpp v12, v29, v40 row_newbcast:6 row_mask:0xf bank_mask:0xf
    v_dot2c_f32_bf16_dpp v13, v54, v40 row_newbcast:6 row_mask:0xf bank_mask:0xf
    v_dot2c_f32_bf16_dpp v14, v29, v41 row_newbcast:6 row_mask:0xf bank_mask:0xf
    v_dot2c_f32_bf16_dpp v15, v54, v41 row_newbcast:6 row_mask:0xf bank_mask:0xf
    v_dot2c_f32_bf16_dpp v16, v29, v42 row_newbcast:6 row_mask:0xf bank_mask:0xf
    v_dot2c_f32_bf16_dpp v17, v54, v42 row_newbcast:6 row_mask:0xf bank_mask:0xf
    v_dot2c_f32_bf16_dpp v18, v29, v43 row_newbcast:6 row_mask:0xf bank_mask:0xf
    v_dot2c_f32_bf16_dpp v19, v54, v43 row_newbcast:6 row_mask:0xf bank_mask:0xf
    ds_read_b128 v[40:43], v53 offset:28672
    s_waitcnt vmcnt(11)
    v_dot2c_f32_bf16_dpp v12, v21, v76 row_newbcast:8 row_mask:0xf bank_mask:0xf
    v_dot2c_f32_bf16_dpp v13, v52, v76 row_newbcast:8 row_mask:0xf bank_mask:0xf
    v_dot2c_f32_bf16_dpp v14, v21, v77 row_newbcast:8 row_mask:0xf bank_mask:0xf
    v_dot2c_f32_bf16_dpp v15, v52, v77 row_newbcast:8 row_mask:0xf bank_mask:0xf
    v_dot2c_f32_bf16_dpp v16, v21, v78 row_newbcast:8 row_mask:0xf bank_mask:0xf
    v_dot2c_f32_bf16_dpp v17, v52, v78 row_newbcast:8 row_mask:0xf bank_mask:0xf
    v_dot2c_f32_bf16_dpp v18, v21, v79 row_newbcast:8 row_mask:0xf bank_mask:0xf
    v_dot2c_f32_bf16_dpp v19, v52, v79 row_newbcast:8 row_mask:0xf bank_mask:0xf
    s_add_u32 s6, s56, 147456
    s_and_b32 s6, s6, 0xfffff
    s_waitcnt vmcnt(4)
    s_cmp_lt_u32 s3, 4
    s_cbranch_scc0 W_361
    s_waitcnt vmcnt(3)
W_361:
    buffer_load_dwordx4 v[124:127], v1, s[12:15], s6 offen nt
    s_waitcnt lgkmcnt(2)
    v_dot2c_f32_bf16_dpp v12, v29, v44 row_newbcast:7 row_mask:0xf bank_mask:0xf
    v_dot2c_f32_bf16_dpp v13, v54, v44 row_newbcast:7 row_mask:0xf bank_mask:0xf
    v_dot2c_f32_bf16_dpp v14, v29, v45 row_newbcast:7 row_mask:0xf bank_mask:0xf
    v_dot2c_f32_bf16_dpp v15, v54, v45 row_newbcast:7 row_mask:0xf bank_mask:0xf
    v_dot2c_f32_bf16_dpp v16, v29, v46 row_newbcast:7 row_mask:0xf bank_mask:0xf
    v_dot2c_f32_bf16_dpp v17, v54, v46 row_newbcast:7 row_mask:0xf bank_mask:0xf
    v_dot2c_f32_bf16_dpp v18, v29, v47 row_newbcast:7 row_mask:0xf bank_mask:0xf
    v_dot2c_f32_bf16_dpp v19, v54, v47 row_newbcast:7 row_mask:0xf bank_mask:0xf
    ds_read_b128 v[44:47], v53 offset:29696
    s_waitcnt vmcnt(11)
    v_dot2c_f32_bf16_dpp v12, v21, v80 row_newbcast:9 row_mask:0xf bank_mask:0xf
    v_dot2c_f32_bf16_dpp v13, v52, v80 row_newbcast:9 row_mask:0xf bank_mask:0xf
    v_dot2c_f32_bf16_dpp v14, v21, v81 row_newbcast:9 row_mask:0xf bank_mask:0xf
    v_dot2c_f32_bf16_dpp v15, v52, v81 row_newbcast:9 row_mask:0xf bank_mask:0xf
    v_dot2c_f32_bf16_dpp v16, v21, v82 row_newbcast:9 row_mask:0xf bank_mask:0xf
    v_dot2c_f32_bf16_dpp v17, v52, v82 row_newbcast:9 row_mask:0xf bank_mask:0xf
    v_dot2c_f32_bf16_dpp v18, v21, v83 row_newbcast:9 row_mask:0xf bank_mask:0xf
    v_dot2c_f32_bf16_dpp v19, v52, v83 row_newbcast:9 row_mask:0xf bank_mask:0xf
    s_add_u32 s6, s56, 151552
    s_and_b32 s6, s6, 0xfffff
    s_waitcnt vmcnt(5)
    s_cmp_lt_u32 s3, 4
    s_cbranch_scc0 W_362
    s_waitcnt vmcnt(4)
W_362:
    buffer_load_dwordx4 v[64:67], v1, s[12:15], s6 offen nt
    s_waitcnt lgkmcnt(2)
    v_dot2c_f32_bf16_dpp v12, v29, v36 row_newbcast:8 row_mask:0xf bank_mask:0xf
    v_dot2c_f32_bf16_dpp v13, v54, v36 row_newbcast:8 row_mask:0xf bank_mask:0xf
    v_dot2c_f32_bf16_dpp v14, v29, v37 row_newbcast:8 row_mask:0xf bank_mask:0xf
    v_dot2c_f32_bf16_dpp v15, v54, v37 row_newbcast:8 row_mask:0xf bank_mask:0xf
    v_dot2c_f32_bf16_dpp v16, v29, v38 row_newbcast:8 row_mask:0xf bank_mask:0xf
    v_dot2c_f32_bf16_dpp v17, v54, v38 row_newbcast:8 row_mask:0xf bank_mask:0xf
    v_dot2c_f32_bf16_dpp v18, v29, v39 row_newbcast:8 row_mask:0xf bank_mask:0xf
    v_dot2c_f32_bf16_dpp v19, v54, v39 row_newbcast:8 row_mask:0xf bank_mask:0xf
    ds_read_b128 v[36:39], v53 offset:30720
    s_waitcnt vmcnt(11)
    v_dot2c_f32_bf16_dpp v12, v21, v84 row_newbcast:10 row_mask:0xf bank_mask:0xf
    v_dot2c_f32_bf16_dpp v13, v52, v84 row_newbcast:10 row_mask:0xf bank_mask:0xf
    v_dot2c_f32_bf16_dpp v14, v21, v85 row_newbcast:10 row_mask:0xf bank_mask:0xf
    v_dot2c_f32_bf16_dpp v15, v52, v85 row_newbcast:10 row_mask:0xf bank_mask:0xf
    v_dot2c_f32_bf16_dpp v16, v21, v86 row_newbcast:10 row_mask:0xf bank_mask:0xf
    v_dot2c_f32_bf16_dpp v17, v52, v86 row_newbcast:10 row_mask:0xf bank_mask:0xf
    v_dot2c_f32_bf16_dpp v18, v21, v87 row_newbcast:10 row_mask:0xf bank_mask:0xf
    v_dot2c_f32_bf16_dpp v19, v52, v87 row_newbcast:10 row_mask:0xf bank_mask:0xf
    s_add_u32 s6, s56, 155648
    s_and_b32 s6, s6, 0xfffff
    s_waitcnt vmcnt(4)
    s_cmp_lt_u32 s3, 4
    s_cbranch_scc0 W_363
    s_waitcnt vmcnt(3)
W_363:
    buffer_load_dwordx4 v[68:71], v1, s[12:15], s6 offen nt
    s_waitcnt lgkmcnt(2)
    v_dot2c_f32_bf16_dpp v12, v29, v40 row_newbcast:9 row_mask:0xf bank_mask:0xf
    v_dot2c_f32_bf16_dpp v13, v54, v40 row_newbcast:9 row_mask:0xf bank_mask:0xf
    v_dot2c_f32_bf16_dpp v14, v29, v41 row_newbcast:9 row_mask:0xf bank_mask:0xf
    v_dot2c_f32_bf16_dpp v15, v54, v41 row_newbcast:9 row_mask:0xf bank_mask:0xf
    v_dot2c_f32_bf16_dpp v16, v29, v42 row_newbcast:9 row_mask:0xf bank_mask:0xf
    v_dot2c_f32_bf16_dpp v17, v54, v42 row_newbcast:9 row_mask:0xf bank_mask:0xf
    v_dot2c_f32_bf16_dpp v18, v29, v43 row_newbcast:9 row_mask:0xf bank_mask:0xf
    v_dot2c_f32_bf16_dpp v19, v54, v43 row_newbcast:9 row_mask:0xf bank_mask:0xf
    ds_read_b128 v[40:43], v53 offset:31744
    s_waitcnt vmcnt(11)
    v_dot2c_f32_bf16_dpp v12, v21, v88 row_newbcast:11 row_mask:0xf bank_mask:0xf
    v_dot2c_f32_bf16_dpp v13, v52, v88 row_newbcast:11 row_mask:0xf bank_mask:0xf
    v_dot2c_f32_bf16_dpp v14, v21, v89 row_newbcast:11 row_mask:0xf bank_mask:0xf
    v_dot2c_f32_bf16_dpp v15, v52, v89 row_newbcast:11 row_mask:0xf bank_mask:0xf
    v_dot2c_f32_bf16_dpp v16, v21, v90 row_newbcast:11 row_mask:0xf bank_mask:0xf
    v_dot2c_f32_bf16_dpp v17, v52, v90 row_newbcast:11 row_mask:0xf bank_mask:0xf
    v_dot2c_f32_bf16_dpp v18, v21, v91 row_newbcast:11 row_mask:0xf bank_mask:0xf
    v_dot2c_f32_bf16_dpp v19, v52, v91 row_newbcast:11 row_mask:0xf bank_mask:0xf
    s_add_u32 s6, s56, 159744
    s_and_b32 s6, s6, 0xfffff
    s_waitcnt vmcnt(5)
    s_cmp_lt_u32 s3, 4
    s_cbranch_scc0 W_364
    s_waitcnt vmcnt(4)
W_364:
    buffer_load_dwordx4 v[72:75], v1, s[12:15], s6 offen nt
    s_waitcnt lgkmcnt(2)
    v_dot2c_f32_bf16_dpp v12, v29, v44 row_newbcast:10 row_mask:0xf bank_mask:0xf
    v_dot2c_f32_bf16_dpp v13, v54, v44 row_newbcast:10 row_mask:0xf bank_mask:0xf
    v_dot2c_f32_bf16_dpp v14, v29, v45 row_newbcast:10 row_mask:0xf bank_mask:0xf
    v_dot2c_f32_bf16_dpp v15, v54, v45 row_newbcast:10 row_mask:0xf bank_mask:0xf
    v_dot2c_f32_bf16_dpp v16, v29, v46 row_newbcast:10 row_mask:0xf bank_mask:0xf
    v_dot2c_f32_bf16_dpp v17, v54, v46 row_newbcast:10 row_mask:0xf bank_mask:0xf
    v_dot2c_f32_bf16_dpp v18, v29, v47 row_newbcast:10 row_mask:0xf bank_mask:0xf
    v_dot2c_f32_bf16_dpp v19, v54, v47 row_newbcast:10 row_mask:0xf bank_mask:0xf
    ds_read_b128 v[44:47], v53 offset:32768
    s_waitcnt vmcnt(11)
    v_dot2c_f32_bf16_dpp v12, v21, v92 row_newbcast:12 row_mask:0xf bank_mask:0xf
    v_dot2c_f32_bf16_dpp v13, v52, v92 row_newbcast:12 row_mask:0xf bank_mask:0xf
    v_dot2c_f32_bf16_dpp v14, v21, v93 row_newbcast:12 row_mask:0xf bank_mask:0xf
    v_dot2c_f32_bf16_dpp v15, v52, v93 row_newbcast:12 row_mask:0xf bank_mask:0xf
    v_dot2c_f32_bf16_dpp v16, v21, v94 row_newbcast:12 row_mask:0xf bank_mask:0xf
    v_dot2c_f32_bf16_dpp v17, v52, v94 row_newbcast:12 row_mask:0xf bank_mask:0xf
    v_dot2c_f32_bf16_dpp v18, v21, v95 row_newbcast:12 row_mask:0xf bank_mask:0xf
    v_dot2c_f32_bf16_dpp v19, v52, v95 row_newbcast:12 row_mask:0xf bank_mask:0xf
    s_add_u32 s6, s56, 163840
    s_and_b32 s6, s6, 0xfffff
    s_waitcnt vmcnt(4)
    s_cmp_lt_u32 s3, 4
    s_cbranch_scc0 W_365
    s_waitcnt vmcnt(3)
W_365:
    buffer_load_dwordx4 v[76:79], v1, s[12:15], s6 offen nt
    s_waitcnt lgkmcnt(2)
    v_dot2c_f32_bf16_dpp v12, v29, v36 row_newbcast:11 row_mask:0xf bank_mask:0xf
    v_dot2c_f32_bf16_dpp v13, v54, v36 row_newbcast:11 row_mask:0xf bank_mask:0xf
    v_dot2c_f32_bf16_dpp v14, v29, v37 row_newbcast:11 row_mask:0xf bank_mask:0xf
    v_dot2c_f32_bf16_dpp v15, v54, v37 row_newbcast:11 row_mask:0xf bank_mask:0xf
    v_dot2c_f32_bf16_dpp v16, v29, v38 row_newbcast:11 row_mask:0xf bank_mask:0xf
    v_dot2c_f32_bf16_dpp v17, v54, v38 row_newbcast:11 row_mask:0xf bank_mask:0xf
    v_dot2c_f32_bf16_dpp v18, v29, v39 row_newbcast:11 row_mask:0xf bank_mask:0xf
    v_dot2c_f32_bf16_dpp v19, v54, v39 row_newbcast:11 row_mask:0xf bank_mask:0xf
    ds_read_b128 v[36:39], v53 offset:33792
    s_waitcnt vmcnt(11)
    v_dot2c_f32_bf16_dpp v12, v21, v96 row_newbcast:13 row_mask:0xf bank_mask:0xf
    v_dot2c_f32_bf16_dpp v13, v52, v96 row_newbcast:13 row_mask:0xf bank_mask:0xf
    v_dot2c_f32_bf16_dpp v14, v21, v97 row_newbcast:13 row_mask:0xf bank_mask:0xf
    v_dot2c_f32_bf16_dpp v15, v52, v97 row_newbcast:13 row_mask:0xf bank_mask:0xf
    v_dot2c_f32_bf16_dpp v16, v21, v98 row_newbcast:13 row_mask:0xf bank_mask:0xf
    v_dot2c_f32_bf16_dpp v17, v52, v98 row_newbcast:13 row_mask:0xf bank_mask:0xf
    v_dot2c_f32_bf16_dpp v18, v21, v99 row_newbcast:13 row_mask:0xf bank_mask:0xf
    v_dot2c_f32_bf16_dpp v19, v52, v99 row_newbcast:13 row_mask:0xf bank_mask:0xf
    s_add_u32 s6, s56, 167936
    s_and_b32 s6, s6, 0xfffff
    s_waitcnt vmcnt(5)
    s_cmp_lt_u32 s3, 4
    s_cbranch_scc0 W_366
    s_waitcnt vmcnt(4)
W_366:
    buffer_load_dwordx4 v[80:83], v1, s[12:15], s6 offen nt
    s_waitcnt lgkmcnt(2)
    v_dot2c_f32_bf16_dpp v12, v29, v40 row_newbcast:12 row_mask:0xf bank_mask:0xf
    v_dot2c_f32_bf16_dpp v13, v54, v40 row_newbcast:12 row_mask:0xf bank_mask:0xf
    v_dot2c_f32_bf16_dpp v14, v29, v41 row_newbcast:12 row_mask:0xf bank_mask:0xf
    v_dot2c_f32_bf16_dpp v15, v54, v41 row_newbcast:12 row_mask:0xf bank_mask:0xf
    v_dot2c_f32_bf16_dpp v16, v29, v42 row_newbcast:12 row_mask:0xf bank_mask:0xf
    v_dot2c_f32_bf16_dpp v17, v54, v42 row_newbcast:12 row_mask:0xf bank_mask:0xf
    v_dot2c_f32_bf16_dpp v18, v29, v43 row_newbcast:12 row_mask:0xf bank_mask:0xf
    v_dot2c_f32_bf16_dpp v19, v54, v43 row_newbcast:12 row_mask:0xf bank_mask:0xf
    ds_read_b128 v[40:43], v53 offset:34816
    s_waitcnt vmcnt(11)
    v_dot2c_f32_bf16_dpp v12, v21, v100 row_newbcast:14 row_mask:0xf bank_mask:0xf
    v_dot2c_f32_bf16_dpp v13, v52, v100 row_newbcast:14 row_mask:0xf bank_mask:0xf
    v_dot2c_f32_bf16_dpp v14, v21, v101 row_newbcast:14 row_mask:0xf bank_mask:0xf
    v_dot2c_f32_bf16_dpp v15, v52, v101 row_newbcast:14 row_mask:0xf bank_mask:0xf
    v_dot2c_f32_bf16_dpp v16, v21, v102 row_newbcast:14 row_mask:0xf bank_mask:0xf
    v_dot2c_f32_bf16_dpp v17, v52, v102 row_newbcast:14 row_mask:0xf bank_mask:0xf
    v_dot2c_f32_bf16_dpp v18, v21, v103 row_newbcast:14 row_mask:0xf bank_mask:0xf
    v_dot2c_f32_bf16_dpp v19, v52, v103 row_newbcast:14 row_mask:0xf bank_mask:0xf
    s_add_u32 s6, s56, 172032
    s_and_b32 s6, s6, 0xfffff
    s_waitcnt vmcnt(4)
    s_cmp_lt_u32 s3, 4
    s_cbranch_scc0 W_367
    s_waitcnt vmcnt(3)
W_367:
    buffer_load_dwordx4 v[84:87], v1, s[12:15], s6 offen nt
    s_waitcnt lgkmcnt(2)
    v_dot2c_f32_bf16_dpp v12, v29, v44 row_newbcast:13 row_mask:0xf bank_mask:0xf
    v_dot2c_f32_bf16_dpp v13, v54, v44 row_newbcast:13 row_mask:0xf bank_mask:0xf
    v_dot2c_f32_bf16_dpp v14, v29, v45 row_newbcast:13 row_mask:0xf bank_mask:0xf
    v_dot2c_f32_bf16_dpp v15, v54, v45 row_newbcast:13 row_mask:0xf bank_mask:0xf
    v_dot2c_f32_bf16_dpp v16, v29, v46 row_newbcast:13 row_mask:0xf bank_mask:0xf
    v_dot2c_f32_bf16_dpp v17, v54, v46 row_newbcast:13 row_mask:0xf bank_mask:0xf
    v_dot2c_f32_bf16_dpp v18, v29, v47 row_newbcast:13 row_mask:0xf bank_mask:0xf
    v_dot2c_f32_bf16_dpp v19, v54, v47 row_newbcast:13 row_mask:0xf bank_mask:0xf
    s_waitcnt vmcnt(11)
    v_dot2c_f32_bf16_dpp v12, v21, v104 row_newbcast:15 row_mask:0xf bank_mask:0xf
    v_dot2c_f32_bf16_dpp v13, v52, v104 row_newbcast:15 row_mask:0xf bank_mask:0xf
    v_dot2c_f32_bf16_dpp v14, v21, v105 row_newbcast:15 row_mask:0xf bank_mask:0xf
    v_dot2c_f32_bf16_dpp v15, v52, v105 row_newbcast:15 row_mask:0xf bank_mask:0xf
    v_dot2c_f32_bf16_dpp v16, v21, v106 row_newbcast:15 row_mask:0xf bank_mask:0xf
    v_dot2c_f32_bf16_dpp v17, v52, v106 row_newbcast:15 row_mask:0xf bank_mask:0xf
    v_dot2c_f32_bf16_dpp v18, v21, v107 row_newbcast:15 row_mask:0xf bank_mask:0xf
    v_dot2c_f32_bf16_dpp v19, v52, v107 row_newbcast:15 row_mask:0xf bank_mask:0xf
    s_add_u32 s6, s56, 176128
    s_and_b32 s6, s6, 0xfffff
    s_waitcnt vmcnt(5)
    s_cmp_lt_u32 s3, 4
    s_cbranch_scc0 W_368
    s_waitcnt vmcnt(4)
W_368:
    buffer_load_dwordx4 v[88:91], v1, s[12:15], s6 offen nt
    s_waitcnt lgkmcnt(1)
    v_dot2c_f32_bf16_dpp v12, v29, v36 row_newbcast:14 row_mask:0xf bank_mask:0xf
    v_dot2c_f32_bf16_dpp v13, v54, v36 row_newbcast:14 row_mask:0xf bank_mask:0xf
    v_dot2c_f32_bf16_dpp v14, v29, v37 row_newbcast:14 row_mask:0xf bank_mask:0xf
    v_dot2c_f32_bf16_dpp v15, v54, v37 row_newbcast:14 row_mask:0xf bank_mask:0xf
    v_dot2c_f32_bf16_dpp v16, v29, v38 row_newbcast:14 row_mask:0xf bank_mask:0xf
    v_dot2c_f32_bf16_dpp v17, v54, v38 row_newbcast:14 row_mask:0xf bank_mask:0xf
    v_dot2c_f32_bf16_dpp v18, v29, v39 row_newbcast:14 row_mask:0xf bank_mask:0xf
    v_dot2c_f32_bf16_dpp v19, v54, v39 row_newbcast:14 row_mask:0xf bank_mask:0xf
    v_lshlrev_b32 v52, 16, v22
    s_nop 1
    s_waitcnt vmcnt(11)
    v_dot2c_f32_bf16_dpp v12, v22, v108 row_newbcast:0 row_mask:0xf bank_mask:0xf
    v_dot2c_f32_bf16_dpp v13, v52, v108 row_newbcast:0 row_mask:0xf bank_mask:0xf
    v_dot2c_f32_bf16_dpp v14, v22, v109 row_newbcast:0 row_mask:0xf bank_mask:0xf
    v_dot2c_f32_bf16_dpp v15, v52, v109 row_newbcast:0 row_mask:0xf bank_mask:0xf
    v_dot2c_f32_bf16_dpp v16, v22, v110 row_newbcast:0 row_mask:0xf bank_mask:0xf
    v_dot2c_f32_bf16_dpp v17, v52, v110 row_newbcast:0 row_mask:0xf bank_mask:0xf
    v_dot2c_f32_bf16_dpp v18, v22, v111 row_newbcast:0 row_mask:0xf bank_mask:0xf
    v_dot2c_f32_bf16_dpp v19, v52, v111 row_newbcast:0 row_mask:0xf bank_mask:0xf
    s_add_u32 s6, s56, 180224
    s_and_b32 s6, s6, 0xfffff
    s_waitcnt vmcnt(4)
    s_cmp_lt_u32 s3, 4
    s_cbranch_scc0 W_369
    s_waitcnt vmcnt(3)
W_369:
    buffer_load_dwordx4 v[92:95], v1, s[12:15], s6 offen nt
    s_waitcnt lgkmcnt(0)
    v_dot2c_f32_bf16_dpp v12, v29, v40 row_newbcast:15 row_mask:0xf bank_mask:0xf
    v_dot2c_f32_bf16_dpp v13, v54, v40 row_newbcast:15 row_mask:0xf bank_mask:0xf
    v_dot2c_f32_bf16_dpp v14, v29, v41 row_newbcast:15 row_mask:0xf bank_mask:0xf
    v_dot2c_f32_bf16_dpp v15, v54, v41 row_newbcast:15 row_mask:0xf bank_mask:0xf
    v_dot2c_f32_bf16_dpp v16, v29, v42 row_newbcast:15 row_mask:0xf bank_mask:0xf
    v_dot2c_f32_bf16_dpp v17, v54, v42 row_newbcast:15 row_mask:0xf bank_mask:0xf
    v_dot2c_f32_bf16_dpp v18, v29, v43 row_newbcast:15 row_mask:0xf bank_mask:0xf
    v_dot2c_f32_bf16_dpp v19, v54, v43 row_newbcast:15 row_mask:0xf bank_mask:0xf
    s_waitcnt vmcnt(11)
    v_dot2c_f32_bf16_dpp v12, v22, v112 row_newbcast:1 row_mask:0xf bank_mask:0xf
    v_dot2c_f32_bf16_dpp v13, v52, v112 row_newbcast:1 row_mask:0xf bank_mask:0xf
    v_dot2c_f32_bf16_dpp v14, v22, v113 row_newbcast:1 row_mask:0xf bank_mask:0xf
    v_dot2c_f32_bf16_dpp v15, v52, v113 row_newbcast:1 row_mask:0xf bank_mask:0xf
    v_dot2c_f32_bf16_dpp v16, v22, v114 row_newbcast:1 row_mask:0xf bank_mask:0xf
    v_dot2c_f32_bf16_dpp v17, v52, v114 row_newbcast:1 row_mask:0xf bank_mask:0xf
    v_dot2c_f32_bf16_dpp v18, v22, v115 row_newbcast:1 row_mask:0xf bank_mask:0xf
    v_dot2c_f32_bf16_dpp v19, v52, v115 row_newbcast:1 row_mask:0xf bank_mask:0xf
    s_add_u32 s6, s56, 184320
    s_and_b32 s6, s6, 0xfffff
    s_waitcnt vmcnt(5)
    s_cmp_lt_u32 s3, 4
    s_cbranch_scc0 W_370
    s_waitcnt vmcnt(4)
W_370:
    buffer_load_dwordx4 v[96:99], v1, s[12:15], s6 offen nt
    v_lshlrev_b32 v54, 16, v30
    s_nop 1
    v_accvgpr_read_b32 v48, a0
    v_accvgpr_read_b32 v49, a1
    v_accvgpr_read_b32 v50, a2
    v_accvgpr_read_b32 v51, a3
    v_dot2c_f32_bf16_dpp v12, v30, v48 row_newbcast:0 row_mask:0xf bank_mask:0xf
    v_dot2c_f32_bf16_dpp v13, v54, v48 row_newbcast:0 row_mask:0xf bank_mask:0xf
    v_dot2c_f32_bf16_dpp v14, v30, v49 row_newbcast:0 row_mask:0xf bank_mask:0xf
    v_dot2c_f32_bf16_dpp v15, v54, v49 row_newbcast:0 row_mask:0xf bank_mask:0xf
    v_dot2c_f32_bf16_dpp v16, v30, v50 row_newbcast:0 row_mask:0xf bank_mask:0xf
    v_dot2c_f32_bf16_dpp v17, v54, v50 row_newbcast:0 row_mask:0xf bank_mask:0xf
    v_dot2c_f32_bf16_dpp v18, v30, v51 row_newbcast:0 row_mask:0xf bank_mask:0xf
    v_dot2c_f32_bf16_dpp v19, v54, v51 row_newbcast:0 row_mask:0xf bank_mask:0xf
    s_waitcnt vmcnt(11)
    v_dot2c_f32_bf16_dpp v12, v22, v116 row_newbcast:2 row_mask:0xf bank_mask:0xf
    v_dot2c_f32_bf16_dpp v13, v52, v116 row_newbcast:2 row_mask:0xf bank_mask:0xf
    v_dot2c_f32_bf16_dpp v14, v22, v117 row_newbcast:2 row_mask:0xf bank_mask:0xf
    v_dot2c_f32_bf16_dpp v15, v52, v117 row_newbcast:2 row_mask:0xf bank_mask:0xf
    v_dot2c_f32_bf16_dpp v16, v22, v118 row_newbcast:2 row_mask:0xf bank_mask:0xf
    v_dot2c_f32_bf16_dpp v17, v52, v118 row_newbcast:2 row_mask:0xf bank_mask:0xf
    v_dot2c_f32_bf16_dpp v18, v22, v119 row_newbcast:2 row_mask:0xf bank_mask:0xf
    v_dot2c_f32_bf16_dpp v19, v52, v119 row_newbcast:2 row_mask:0xf bank_mask:0xf
    s_add_u32 s6, s56, 188416
    s_and_b32 s6, s6, 0xfffff
    s_waitcnt vmcnt(4)
    s_cmp_lt_u32 s3, 4
    s_cbranch_scc0 W_371
    s_waitcnt vmcnt(3)
W_371:
    buffer_load_dwordx4 v[100:103], v1, s[12:15], s6 offen nt
    v_accvgpr_read_b32 v48, a4
    v_accvgpr_read_b32 v49, a5
    v_accvgpr_read_b32 v50, a6
    v_accvgpr_read_b32 v51, a7
    v_dot2c_f32_bf16_dpp v12, v30, v48 row_newbcast:1 row_mask:0xf bank_mask:0xf
    v_dot2c_f32_bf16_dpp v13, v54, v48 row_newbcast:1 row_mask:0xf bank_mask:0xf
    v_dot2c_f32_bf16_dpp v14, v30, v49 row_newbcast:1 row_mask:0xf bank_mask:0xf
    v_dot2c_f32_bf16_dpp v15, v54, v49 row_newbcast:1 row_mask:0xf bank_mask:0xf
    v_dot2c_f32_bf16_dpp v16, v30, v50 row_newbcast:1 row_mask:0xf bank_mask:0xf
    v_dot2c_f32_bf16_dpp v17, v54, v50 row_newbcast:1 row_mask:0xf bank_mask:0xf
    v_dot2c_f32_bf16_dpp v18, v30, v51 row_newbcast:1 row_mask:0xf bank_mask:0xf
    v_dot2c_f32_bf16_dpp v19, v54, v51 row_newbcast:1 row_mask:0xf bank_mask:0xf
    s_waitcnt vmcnt(11)
    v_dot2c_f32_bf16_dpp v12, v22, v120 row_newbcast:3 row_mask:0xf bank_mask:0xf
    v_dot2c_f32_bf16_dpp v13, v52, v120 row_newbcast:3 row_mask:0xf bank_mask:0xf
    v_dot2c_f32_bf16_dpp v14, v22, v121 row_newbcast:3 row_mask:0xf bank_mask:0xf
    v_dot2c_f32_bf16_dpp v15, v52, v121 row_newbcast:3 row_mask:0xf bank_mask:0xf
    v_dot2c_f32_bf16_dpp v16, v22, v122 row_newbcast:3 row_mask:0xf bank_mask:0xf
    v_dot2c_f32_bf16_dpp v17, v52, v122 row_newbcast:3 row_mask:0xf bank_mask:0xf
    v_dot2c_f32_bf16_dpp v18, v22, v123 row_newbcast:3 row_mask:0xf bank_mask:0xf
    v_dot2c_f32_bf16_dpp v19, v52, v123 row_newbcast:3 row_mask:0xf bank_mask:0xf
    s_add_u32 s6, s56, 192512
    s_and_b32 s6, s6, 0xfffff
    s_waitcnt vmcnt(5)
    s_cmp_lt_u32 s3, 4
    s_cbranch_scc0 W_372
    s_waitcnt vmcnt(4)
W_372:
    buffer_load_dwordx4 v[104:107], v1, s[12:15], s6 offen nt
    v_accvgpr_read_b32 v48, a8
    v_accvgpr_read_b32 v49, a9
    v_accvgpr_read_b32 v50, a10
    v_accvgpr_read_b32 v51, a11
    v_dot2c_f32_bf16_dpp v12, v30, v48 row_newbcast:2 row_mask:0xf bank_mask:0xf
    v_dot2c_f32_bf16_dpp v13, v54, v48 row_newbcast:2 row_mask:0xf bank_mask:0xf
    v_dot2c_f32_bf16_dpp v14, v30, v49 row_newbcast:2 row_mask:0xf bank_mask:0xf
    v_dot2c_f32_bf16_dpp v15, v54, v49 row_newbcast:2 row_mask:0xf bank_mask:0xf
    v_dot2c_f32_bf16_dpp v16, v30, v50 row_newbcast:2 row_mask:0xf bank_mask:0xf
    v_dot2c_f32_bf16_dpp v17, v54, v50 row_newbcast:2 row_mask:0xf bank_mask:0xf
    v_dot2c_f32_bf16_dpp v18, v30, v51 row_newbcast:2 row_mask:0xf bank_mask:0xf
    v_dot2c_f32_bf16_dpp v19, v54, v51 row_newbcast:2 row_mask:0xf bank_mask:0xf
    s_waitcnt vmcnt(11)
    v_dot2c_f32_bf16_dpp v12, v22, v124 row_newbcast:4 row_mask:0xf bank_mask:0xf
    v_dot2c_f32_bf16_dpp v13, v52, v124 row_newbcast:4 row_mask:0xf bank_mask:0xf
    v_dot2c_f32_bf16_dpp v14, v22, v125 row_newbcast:4 row_mask:0xf bank_mask:0xf
    v_dot2c_f32_bf16_dpp v15, v52, v125 row_newbcast:4 row_mask:0xf bank_mask:0xf
    v_dot2c_f32_bf16_dpp v16, v22, v126 row_newbcast:4 row_mask:0xf bank_mask:0xf
    v_dot2c_f32_bf16_dpp v17, v52, v126 row_newbcast:4 row_mask:0xf bank_mask:0xf
    v_dot2c_f32_bf16_dpp v18, v22, v127 row_newbcast:4 row_mask:0xf bank_mask:0xf
    v_dot2c_f32_bf16_dpp v19, v52, v127 row_newbcast:4 row_mask:0xf bank_mask:0xf
    s_add_u32 s6, s56, 196608
    s_and_b32 s6, s6, 0xfffff
    s_waitcnt vmcnt(4)
    s_cmp_lt_u32 s3, 4
    s_cbranch_scc0 W_373
    s_waitcnt vmcnt(3)
W_373:
    buffer_load_dwordx4 v[108:111], v1, s[12:15], s6 offen nt
    v_accvgpr_read_b32 v48, a12
    v_accvgpr_read_b32 v49, a13
    v_accvgpr_read_b32 v50, a14
    v_accvgpr_read_b32 v51, a15
    v_dot2c_f32_bf16_dpp v12, v30, v48 row_newbcast:3 row_mask:0xf bank_mask:0xf
    v_dot2c_f32_bf16_dpp v13, v54, v48 row_newbcast:3 row_mask:0xf bank_mask:0xf
    v_dot2c_f32_bf16_dpp v14, v30, v49 row_newbcast:3 row_mask:0xf bank_mask:0xf
    v_dot2c_f32_bf16_dpp v15, v54, v49 row_newbcast:3 row_mask:0xf bank_mask:0xf
    v_dot2c_f32_bf16_dpp v16, v30, v50 row_newbcast:3 row_mask:0xf bank_mask:0xf
    v_dot2c_f32_bf16_dpp v17, v54, v50 row_newbcast:3 row_mask:0xf bank_mask:0xf
    v_dot2c_f32_bf16_dpp v18, v30, v51 row_newbcast:3 row_mask:0xf bank_mask:0xf
    v_dot2c_f32_bf16_dpp v19, v54, v51 row_newbcast:3 row_mask:0xf bank_mask:0xf
    s_waitcnt vmcnt(11)
    v_dot2c_f32_bf16_dpp v12, v22, v64 row_newbcast:5 row_mask:0xf bank_mask:0xf
    v_dot2c_f32_bf16_dpp v13, v52, v64 row_newbcast:5 row_mask:0xf bank_mask:0xf
    v_dot2c_f32_bf16_dpp v14, v22, v65 row_newbcast:5 row_mask:0xf bank_mask:0xf
    v_dot2c_f32_bf16_dpp v15, v52, v65 row_newbcast:5 row_mask:0xf bank_mask:0xf
    v_dot2c_f32_bf16_dpp v16, v22, v66 row_newbcast:5 row_mask:0xf bank_mask:0xf
    v_dot2c_f32_bf16_dpp v17, v52, v66 row_newbcast:5 row_mask:0xf bank_mask:0xf
    v_dot2c_f32_bf16_dpp v18, v22, v67 row_newbcast:5 row_mask:0xf bank_mask:0xf
    v_dot2c_f32_bf16_dpp v19, v52, v67 row_newbcast:5 row_mask:0xf bank_mask:0xf
    s_add_u32 s6, s56, 200704
    s_and_b32 s6, s6, 0xfffff
    s_waitcnt vmcnt(5)
    s_cmp_lt_u32 s3, 4
    s_cbranch_scc0 W_374
    s_waitcnt vmcnt(4)
W_374:
    buffer_load_dwordx4 v[112:115], v1, s[12:15], s6 offen nt
    v_accvgpr_read_b32 v48, a16
    v_accvgpr_read_b32 v49, a17
    v_accvgpr_read_b32 v50, a18
    v_accvgpr_read_b32 v51, a19
    v_dot2c_f32_bf16_dpp v12, v30, v48 row_newbcast:4 row_mask:0xf bank_mask:0xf
    v_dot2c_f32_bf16_dpp v13, v54, v48 row_newbcast:4 row_mask:0xf bank_mask:0xf
    v_dot2c_f32_bf16_dpp v14, v30, v49 row_newbcast:4 row_mask:0xf bank_mask:0xf
    v_dot2c_f32_bf16_dpp v15, v54, v49 row_newbcast:4 row_mask:0xf bank_mask:0xf
    v_dot2c_f32_bf16_dpp v16, v30, v50 row_newbcast:4 row_mask:0xf bank_mask:0xf
    v_dot2c_f32_bf16_dpp v17, v54, v50 row_newbcast:4 row_mask:0xf bank_mask:0xf
    v_dot2c_f32_bf16_dpp v18, v30, v51 row_newbcast:4 row_mask:0xf bank_mask:0xf
    v_dot2c_f32_bf16_dpp v19, v54, v51 row_newbcast:4 row_mask:0xf bank_mask:0xf
    s_waitcnt vmcnt(11)
    v_dot2c_f32_bf16_dpp v12, v22, v68 row_newbcast:6 row_mask:0xf bank_mask:0xf
    v_dot2c_f32_bf16_dpp v13, v52, v68 row_newbcast:6 row_mask:0xf bank_mask:0xf
    v_dot2c_f32_bf16_dpp v14, v22, v69 row_newbcast:6 row_mask:0xf bank_mask:0xf
    v_dot2c_f32_bf16_dpp v15, v52, v69 row_newbcast:6 row_mask:0xf bank_mask:0xf
    v_dot2c_f32_bf16_dpp v16, v22, v70 row_newbcast:6 row_mask:0xf bank_mask:0xf
    v_dot2c_f32_bf16_dpp v17, v52, v70 row_newbcast:6 row_mask:0xf bank_mask:0xf
    v_dot2c_f32_bf16_dpp v18, v22, v71 row_newbcast:6 row_mask:0xf bank_mask:0xf
    v_dot2c_f32_bf16_dpp v19, v52, v71 row_newbcast:6 row_mask:0xf bank_mask:0xf
    s_add_u32 s6, s56, 204800
    s_and_b32 s6, s6, 0xfffff
    s_cmp_lt_u32 s3, 4
    s_cbranch_scc0 W_375
    s_waitcnt vmcnt(3)
W_375:
    buffer_load_dwordx4 v[116:119], v1, s[12:15], s6 offen nt
    v_accvgpr_read_b32 v48, a20
    v_accvgpr_read_b32 v49, a21
    v_accvgpr_read_b32 v50, a22
    v_accvgpr_read_b32 v51, a23
    v_dot2c_f32_bf16_dpp v12, v30, v48 row_newbcast:5 row_mask:0xf bank_mask:0xf
    v_dot2c_f32_bf16_dpp v13, v54, v48 row_newbcast:5 row_mask:0xf bank_mask:0xf
    v_dot2c_f32_bf16_dpp v14, v30, v49 row_newbcast:5 row_mask:0xf bank_mask:0xf
    v_dot2c_f32_bf16_dpp v15, v54, v49 row_newbcast:5 row_mask:0xf bank_mask:0xf
    v_dot2c_f32_bf16_dpp v16, v30, v50 row_newbcast:5 row_mask:0xf bank_mask:0xf
    v_dot2c_f32_bf16_dpp v17, v54, v50 row_newbcast:5 row_mask:0xf bank_mask:0xf
    v_dot2c_f32_bf16_dpp v18, v30, v51 row_newbcast:5 row_mask:0xf bank_mask:0xf
    v_dot2c_f32_bf16_dpp v19, v54, v51 row_newbcast:5 row_mask:0xf bank_mask:0xf
    s_waitcnt vmcnt(11)
    v_dot2c_f32_bf16_dpp v12, v22, v72 row_newbcast:7 row_mask:0xf bank_mask:0xf
    v_dot2c_f32_bf16_dpp v13, v52, v72 row_newbcast:7 row_mask:0xf bank_mask:0xf
    v_dot2c_f32_bf16_dpp v14, v22, v73 row_newbcast:7 row_mask:0xf bank_mask:0xf
    v_dot2c_f32_bf16_dpp v15, v52, v73 row_newbcast:7 row_mask:0xf bank_mask:0xf
    v_dot2c_f32_bf16_dpp v16, v22, v74 row_newbcast:7 row_mask:0xf bank_mask:0xf
    v_dot2c_f32_bf16_dpp v17, v52, v74 row_newbcast:7 row_mask:0xf bank_mask:0xf
    v_dot2c_f32_bf16_dpp v18, v22, v75 row_newbcast:7 row_mask:0xf bank_mask:0xf
    v_dot2c_f32_bf16_dpp v19, v52, v75 row_newbcast:7 row_mask:0xf bank_mask:0xf
    s_add_u32 s6, s56, 208896
    s_and_b32 s6, s6, 0xfffff
    s_cmp_lt_u32 s3, 4
    s_cbranch_scc0 W_376
    s_waitcnt vmcnt(4)
W_376:
    buffer_load_dwordx4 v[120:123], v1, s[12:15], s6 offen nt
    v_accvgpr_read_b32 v48, a24
    v_accvgpr_read_b32 v49, a25
    v_accvgpr_read_b32 v50, a26
    v_accvgpr_read_b32 v51, a27
    v_dot2c_f32_bf16_dpp v12, v30, v48 row_newbcast:6 row_mask:0xf bank_mask:0xf
    v_dot2c_f32_bf16_dpp v13, v54, v48 row_newbcast:6 row_mask:0xf bank_mask:0xf
    v_dot2c_f32_bf16_dpp v14, v30, v49 row_newbcast:6 row_mask:0xf bank_mask:0xf
    v_dot2c_f32_bf16_dpp v15, v54, v49 row_newbcast:6 row_mask:0xf bank_mask:0xf
    v_dot2c_f32_bf16_dpp v16, v30, v50 row_newbcast:6 row_mask:0xf bank_mask:0xf
    v_dot2c_f32_bf16_dpp v17, v54, v50 row_newbcast:6 row_mask:0xf bank_mask:0xf
    v_dot2c_f32_bf16_dpp v18, v30, v51 row_newbcast:6 row_mask:0xf bank_mask:0xf
    v_dot2c_f32_bf16_dpp v19, v54, v51 row_newbcast:6 row_mask:0xf bank_mask:0xf
    s_waitcnt vmcnt(11)
    v_dot2c_f32_bf16_dpp v12, v22, v76 row_newbcast:8 row_mask:0xf bank_mask:0xf
    v_dot2c_f32_bf16_dpp v13, v52, v76 row_newbcast:8 row_mask:0xf bank_mask:0xf
    v_dot2c_f32_bf16_dpp v14, v22, v77 row_newbcast:8 row_mask:0xf bank_mask:0xf
    v_dot2c_f32_bf16_dpp v15, v52, v77 row_newbcast:8 row_mask:0xf bank_mask:0xf
    v_dot2c_f32_bf16_dpp v16, v22, v78 row_newbcast:8 row_mask:0xf bank_mask:0xf
    v_dot2c_f32_bf16_dpp v17, v52, v78 row_newbcast:8 row_mask:0xf bank_mask:0xf
    v_dot2c_f32_bf16_dpp v18, v22, v79 row_newbcast:8 row_mask:0xf bank_mask:0xf
    v_dot2c_f32_bf16_dpp v19, v52, v79 row_newbcast:8 row_mask:0xf bank_mask:0xf
    s_add_u32 s6, s56, 212992
    s_and_b32 s6, s6, 0xfffff
    s_cmp_lt_u32 s3, 4
    s_cbranch_scc0 W_377
    s_waitcnt vmcnt(3)
W_377:
    buffer_load_dwordx4 v[124:127], v1, s[12:15], s6 offen nt
    v_accvgpr_read_b32 v48, a28
    v_accvgpr_read_b32 v49, a29
    v_accvgpr_read_b32 v50, a30
    v_accvgpr_read_b32 v51, a31
    v_dot2c_f32_bf16_dpp v12, v30, v48 row_newbcast:7 row_mask:0xf bank_mask:0xf
    v_dot2c_f32_bf16_dpp v13, v54, v48 row_newbcast:7 row_mask:0xf bank_mask:0xf
    v_dot2c_f32_bf16_dpp v14, v30, v49 row_newbcast:7 row_mask:0xf bank_mask:0xf
    v_dot2c_f32_bf16_dpp v15, v54, v49 row_newbcast:7 row_mask:0xf bank_mask:0xf
    v_dot2c_f32_bf16_dpp v16, v30, v50 row_newbcast:7 row_mask:0xf bank_mask:0xf
    v_dot2c_f32_bf16_dpp v17, v54, v50 row_newbcast:7 row_mask:0xf bank_mask:0xf
    v_dot2c_f32_bf16_dpp v18, v30, v51 row_newbcast:7 row_mask:0xf bank_mask:0xf
    v_dot2c_f32_bf16_dpp v19, v54, v51 row_newbcast:7 row_mask:0xf bank_mask:0xf
    s_waitcnt vmcnt(11)
    v_dot2c_f32_bf16_dpp v12, v22, v80 row_newbcast:9 row_mask:0xf bank_mask:0xf
    v_dot2c_f32_bf16_dpp v13, v52, v80 row_newbcast:9 row_mask:0xf bank_mask:0xf
    v_dot2c_f32_bf16_dpp v14, v22, v81 row_newbcast:9 row_mask:0xf bank_mask:0xf
    v_dot2c_f32_bf16_dpp v15, v52, v81 row_newbcast:9 row_mask:0xf bank_mask:0xf
    v_dot2c_f32_bf16_dpp v16, v22, v82 row_newbcast:9 row_mask:0xf bank_mask:0xf
    v_dot2c_f32_bf16_dpp v17, v52, v82 row_newbcast:9 row_mask:0xf bank_mask:0xf
    v_dot2c_f32_bf16_dpp v18, v22, v83 row_newbcast:9 row_mask:0xf bank_mask:0xf
    v_dot2c_f32_bf16_dpp v19, v52, v83 row_newbcast:9 row_mask:0xf bank_mask:0xf
    s_add_u32 s6, s56, 217088
    s_and_b32 s6, s6, 0xfffff
    s_cmp_lt_u32 s3, 4
    s_cbranch_scc0 W_378
    s_waitcnt vmcnt(4)
W_378:
    buffer_load_dwordx4 v[64:67], v1, s[12:15], s6 offen nt
    v_accvgpr_read_b32 v48, a32
    v_accvgpr_read_b32 v49, a33
    v_accvgpr_read_b32 v50, a34
    v_accvgpr_read_b32 v51, a35
    v_dot2c_f32_bf16_dpp v12, v30, v48 row_newbcast:8 row_mask:0xf bank_mask:0xf
    v_dot2c_f32_bf16_dpp v13, v54, v48 row_newbcast:8 row_mask:0xf bank_mask:0xf
    v_dot2c_f32_bf16_dpp v14, v30, v49 row_newbcast:8 row_mask:0xf bank_mask:0xf
    v_dot2c_f32_bf16_dpp v15, v54, v49 row_newbcast:8 row_mask:0xf bank_mask:0xf
    v_dot2c_f32_bf16_dpp v16, v30, v50 row_newbcast:8 row_mask:0xf bank_mask:0xf
    v_dot2c_f32_bf16_dpp v17, v54, v50 row_newbcast:8 row_mask:0xf bank_mask:0xf
    v_dot2c_f32_bf16_dpp v18, v30, v51 row_newbcast:8 row_mask:0xf bank_mask:0xf
    v_dot2c_f32_bf16_dpp v19, v54, v51 row_newbcast:8 row_mask:0xf bank_mask:0xf
    v_accvgpr_read_b32 v48, a36
    v_accvgpr_read_b32 v49, a37
    v_accvgpr_read_b32 v50, a38
    v_accvgpr_read_b32 v51, a39
    v_dot2c_f32_bf16_dpp v12, v30, v48 row_newbcast:9 row_mask:0xf bank_mask:0xf
    v_dot2c_f32_bf16_dpp v13, v54, v48 row_newbcast:9 row_mask:0xf bank_mask:0xf
    v_dot2c_f32_bf16_dpp v14, v30, v49 row_newbcast:9 row_mask:0xf bank_mask:0xf
    v_dot2c_f32_bf16_dpp v15, v54, v49 row_newbcast:9 row_mask:0xf bank_mask:0xf
    v_dot2c_f32_bf16_dpp v16, v30, v50 row_newbcast:9 row_mask:0xf bank_mask:0xf
    v_dot2c_f32_bf16_dpp v17, v54, v50 row_newbcast:9 row_mask:0xf bank_mask:0xf
    v_dot2c_f32_bf16_dpp v18, v30, v51 row_newbcast:9 row_mask:0xf bank_mask:0xf
    v_dot2c_f32_bf16_dpp v19, v54, v51 row_newbcast:9 row_mask:0xf bank_mask:0xf
    s_waitcnt vmcnt(11)
    v_dot2c_f32_bf16_dpp v12, v22, v84 row_newbcast:10 row_mask:0xf bank_mask:0xf
    v_dot2c_f32_bf16_dpp v13, v52, v84 row_newbcast:10 row_mask:0xf bank_mask:0xf
    v_dot2c_f32_bf16_dpp v14, v22, v85 row_newbcast:10 row_mask:0xf bank_mask:0xf
    v_dot2c_f32_bf16_dpp v15, v52, v85 row_newbcast:10 row_mask:0xf bank_mask:0xf
    v_dot2c_f32_bf16_dpp v16, v22, v86 row_newbcast:10 row_mask:0xf bank_mask:0xf
    v_dot2c_f32_bf16_dpp v17, v52, v86 row_newbcast:10 row_mask:0xf bank_mask:0xf
    v_dot2c_f32_bf16_dpp v18, v22, v87 row_newbcast:10 row_mask:0xf bank_mask:0xf
    v_dot2c_f32_bf16_dpp v19, v52, v87 row_newbcast:10 row_mask:0xf bank_mask:0xf
    s_add_u32 s6, s56, 221184
    s_and_b32 s6, s6, 0xfffff
    s_cmp_lt_u32 s3, 4
    s_cbranch_scc0 W_379
    s_waitcnt vmcnt(3)
W_379:
    buffer_load_dwordx4 v[68:71], v1, s[12:15], s6 offen nt
    v_accvgpr_read_b32 v48, a40
    v_accvgpr_read_b32 v49, a41
    v_accvgpr_read_b32 v50, a42
    v_accvgpr_read_b32 v51, a43
    v_dot2c_f32_bf16_dpp v12, v30, v48 row_newbcast:10 row_mask:0xf bank_mask:0xf
    v_dot2c_f32_bf16_dpp v13, v54, v48 row_newbcast:10 row_mask:0xf bank_mask:0xf
    v_dot2c_f32_bf16_dpp v14, v30, v49 row_newbcast:10 row_mask:0xf bank_mask:0xf
    v_dot2c_f32_bf16_dpp v15, v54, v49 row_newbcast:10 row_mask:0xf bank_mask:0xf
    v_dot2c_f32_bf16_dpp v16, v30, v50 row_newbcast:10 row_mask:0xf bank_mask:0xf
    v_dot2c_f32_bf16_dpp v17, v54, v50 row_newbcast:10 row_mask:0xf bank_mask:0xf
    v_dot2c_f32_bf16_dpp v18, v30, v51 row_newbcast:10 row_mask:0xf bank_mask:0xf
    v_dot2c_f32_bf16_dpp v19, v54, v51 row_newbcast:10 row_mask:0xf bank_mask:0xf
    s_waitcnt vmcnt(11)
    v_dot2c_f32_bf16_dpp v12, v22, v88 row_newbcast:11 row_mask:0xf bank_mask:0xf
    v_dot2c_f32_bf16_dpp v13, v52, v88 row_newbcast:11 row_mask:0xf bank_mask:0xf
    v_dot2c_f32_bf16_dpp v14, v22, v89 row_newbcast:11 row_mask:0xf bank_mask:0xf
    v_dot2c_f32_bf16_dpp v15, v52, v89 row_newbcast:11 row_mask:0xf bank_mask:0xf
    v_dot2c_f32_bf16_dpp v16, v22, v90 row_newbcast:11 row_mask:0xf bank_mask:0xf
    v_dot2c_f32_bf16_dpp v17, v52, v90 row_newbcast:11 row_mask:0xf bank_mask:0xf
    v_dot2c_f32_bf16_dpp v18, v22, v91 row_newbcast:11 row_mask:0xf bank_mask:0xf
    v_dot2c_f32_bf16_dpp v19, v52, v91 row_newbcast:11 row_mask:0xf bank_mask:0xf
    s_add_u32 s6, s56, 225280
    s_and_b32 s6, s6, 0xfffff
    s_cmp_lt_u32 s3, 4
    s_cbranch_scc0 W_380
    s_waitcnt vmcnt(4)
W_380:
    buffer_load_dwordx4 v[72:75], v1, s[12:15], s6 offen nt
    v_accvgpr_read_b32 v48, a44
    v_accvgpr_read_b32 v49, a45
    v_accvgpr_read_b32 v50, a46
    v_accvgpr_read_b32 v51, a47
    v_dot2c_f32_bf16_dpp v12, v30, v48 row_newbcast:11 row_mask:0xf bank_mask:0xf
    v_dot2c_f32_bf16_dpp v13, v54, v48 row_newbcast:11 row_mask:0xf bank_mask:0xf
    v_dot2c_f32_bf16_dpp v14, v30, v49 row_newbcast:11 row_mask:0xf bank_mask:0xf
    v_dot2c_f32_bf16_dpp v15, v54, v49 row_newbcast:11 row_mask:0xf bank_mask:0xf
    v_dot2c_f32_bf16_dpp v16, v30, v50 row_newbcast:11 row_mask:0xf bank_mask:0xf
    v_dot2c_f32_bf16_dpp v17, v54, v50 row_newbcast:11 row_mask:0xf bank_mask:0xf
    v_dot2c_f32_bf16_dpp v18, v30, v51 row_newbcast:11 row_mask:0xf bank_mask:0xf
    v_dot2c_f32_bf16_dpp v19, v54, v51 row_newbcast:11 row_mask:0xf bank_mask:0xf
    s_waitcnt vmcnt(11)
    v_dot2c_f32_bf16_dpp v12, v22, v92 row_newbcast:12 row_mask:0xf bank_mask:0xf
    v_dot2c_f32_bf16_dpp v13, v52, v92 row_newbcast:12 row_mask:0xf bank_mask:0xf
    v_dot2c_f32_bf16_dpp v14, v22, v93 row_newbcast:12 row_mask:0xf bank_mask:0xf
    v_dot2c_f32_bf16_dpp v15, v52, v93 row_newbcast:12 row_mask:0xf bank_mask:0xf
    v_dot2c_f32_bf16_dpp v16, v22, v94 row_newbcast:12 row_mask:0xf bank_mask:0xf
    v_dot2c_f32_bf16_dpp v17, v52, v94 row_newbcast:12 row_mask:0xf bank_mask:0xf
    v_dot2c_f32_bf16_dpp v18, v22, v95 row_newbcast:12 row_mask:0xf bank_mask:0xf
    v_dot2c_f32_bf16_dpp v19, v52, v95 row_newbcast:12 row_mask:0xf bank_mask:0xf
    s_add_u32 s6, s56, 229376
    s_and_b32 s6, s6, 0xfffff
    s_cmp_lt_u32 s3, 4
    s_cbranch_scc0 W_381
    s_waitcnt vmcnt(3)
W_381:
    buffer_load_dwordx4 v[76:79], v1, s[12:15], s6 offen nt
    v_accvgpr_read_b32 v48, a48
    v_accvgpr_read_b32 v49, a49
    v_accvgpr_read_b32 v50, a50
    v_accvgpr_read_b32 v51, a51
    v_dot2c_f32_bf16_dpp v12, v30, v48 row_newbcast:12 row_mask:0xf bank_mask:0xf
    v_dot2c_f32_bf16_dpp v13, v54, v48 row_newbcast:12 row_mask:0xf bank_mask:0xf
    v_dot2c_f32_bf16_dpp v14, v30, v49 row_newbcast:12 row_mask:0xf bank_mask:0xf
    v_dot2c_f32_bf16_dpp v15, v54, v49 row_newbcast:12 row_mask:0xf bank_mask:0xf
    v_dot2c_f32_bf16_dpp v16, v30, v50 row_newbcast:12 row_mask:0xf bank_mask:0xf
    v_dot2c_f32_bf16_dpp v17, v54, v50 row_newbcast:12 row_mask:0xf bank_mask:0xf
    v_dot2c_f32_bf16_dpp v18, v30, v51 row_newbcast:12 row_mask:0xf bank_mask:0xf
    v_dot2c_f32_bf16_dpp v19, v54, v51 row_newbcast:12 row_mask:0xf bank_mask:0xf
    s_waitcnt vmcnt(11)
    v_dot2c_f32_bf16_dpp v12, v22, v96 row_newbcast:13 row_mask:0xf bank_mask:0xf
    v_dot2c_f32_bf16_dpp v13, v52, v96 row_newbcast:13 row_mask:0xf bank_mask:0xf
    v_dot2c_f32_bf16_dpp v14, v22, v97 row_newbcast:13 row_mask:0xf bank_mask:0xf
    v_dot2c_f32_bf16_dpp v15, v52, v97 row_newbcast:13 row_mask:0xf bank_mask:0xf
    v_dot2c_f32_bf16_dpp v16, v22, v98 row_newbcast:13 row_mask:0xf bank_mask:0xf
    v_dot2c_f32_bf16_dpp v17, v52, v98 row_newbcast:13 row_mask:0xf bank_mask:0xf
    v_dot2c_f32_bf16_dpp v18, v22, v99 row_newbcast:13 row_mask:0xf bank_mask:0xf
    v_dot2c_f32_bf16_dpp v19, v52, v99 row_newbcast:13 row_mask:0xf bank_mask:0xf
    s_add_u32 s6, s56, 233472
    s_and_b32 s6, s6, 0xfffff
    s_cmp_lt_u32 s3, 4
    s_cbranch_scc0 W_382
    s_waitcnt vmcnt(4)
W_382:
    buffer_load_dwordx4 v[80:83], v1, s[12:15], s6 offen nt
    v_accvgpr_read_b32 v48, a52
    v_accvgpr_read_b32 v49, a53
    v_accvgpr_read_b32 v50, a54
    v_accvgpr_read_b32 v51, a55
    v_dot2c_f32_bf16_dpp v12, v30, v48 row_newbcast:13 row_mask:0xf bank_mask:0xf
    v_dot2c_f32_bf16_dpp v13, v54, v48 row_newbcast:13 row_mask:0xf bank_mask:0xf
    v_dot2c_f32_bf16_dpp v14, v30, v49 row_newbcast:13 row_mask:0xf bank_mask:0xf
    v_dot2c_f32_bf16_dpp v15, v54, v49 row_newbcast:13 row_mask:0xf bank_mask:0xf
    v_dot2c_f32_bf16_dpp v16, v30, v50 row_newbcast:13 row_mask:0xf bank_mask:0xf
    v_dot2c_f32_bf16_dpp v17, v54, v50 row_newbcast:13 row_mask:0xf bank_mask:0xf
    v_dot2c_f32_bf16_dpp v18, v30, v51 row_newbcast:13 row_mask:0xf bank_mask:0xf
    v_dot2c_f32_bf16_dpp v19, v54, v51 row_newbcast:13 row_mask:0xf bank_mask:0xf
    s_waitcnt vmcnt(11)
    v_dot2c_f32_bf16_dpp v12, v22, v100 row_newbcast:14 row_mask:0xf bank_mask:0xf
    v_dot2c_f32_bf16_dpp v13, v52, v100 row_newbcast:14 row_mask:0xf bank_mask:0xf
    v_dot2c_f32_bf16_dpp v14, v22, v101 row_newbcast:14 row_mask:0xf bank_mask:0xf
    v_dot2c_f32_bf16_dpp v15, v52, v101 row_newbcast:14 row_mask:0xf bank_mask:0xf
    v_dot2c_f32_bf16_dpp v16, v22, v102 row_newbcast:14 row_mask:0xf bank_mask:0xf
    v_dot2c_f32_bf16_dpp v17, v52, v102 row_newbcast:14 row_mask:0xf bank_mask:0xf
    v_dot2c_f32_bf16_dpp v18, v22, v103 row_newbcast:14 row_mask:0xf bank_mask:0xf
    v_dot2c_f32_bf16_dpp v19, v52, v103 row_newbcast:14 row_mask:0xf bank_mask:0xf
    s_add_u32 s6, s56, 237568
    s_and_b32 s6, s6, 0xfffff
    s_cmp_lt_u32 s3, 4
    s_cbranch_scc0 W_383
    s_waitcnt vmcnt(3)
W_383:
    buffer_load_dwordx4 v[84:87], v1, s[12:15], s6 offen nt
    v_accvgpr_read_b32 v48, a56
    v_accvgpr_read_b32 v49, a57
    v_accvgpr_read_b32 v50, a58
    v_accvgpr_read_b32 v51, a59
    v_dot2c_f32_bf16_dpp v12, v30, v48 row_newbcast:14 row_mask:0xf bank_mask:0xf
    v_dot2c_f32_bf16_dpp v13, v54, v48 row_newbcast:14 row_mask:0xf bank_mask:0xf
    v_dot2c_f32_bf16_dpp v14, v30, v49 row_newbcast:14 row_mask:0xf bank_mask:0xf
    v_dot2c_f32_bf16_dpp v15, v54, v49 row_newbcast:14 row_mask:0xf bank_mask:0xf
    v_dot2c_f32_bf16_dpp v16, v30, v50 row_newbcast:14 row_mask:0xf bank_mask:0xf
    v_dot2c_f32_bf16_dpp v17, v54, v50 row_newbcast:14 row_mask:0xf bank_mask:0xf
    v_dot2c_f32_bf16_dpp v18, v30, v51 row_newbcast:14 row_mask:0xf bank_mask:0xf
    v_dot2c_f32_bf16_dpp v19, v54, v51 row_newbcast:14 row_mask:0xf bank_mask:0xf
    s_waitcnt vmcnt(11)
    v_dot2c_f32_bf16_dpp v12, v22, v104 row_newbcast:15 row_mask:0xf bank_mask:0xf
    v_dot2c_f32_bf16_dpp v13, v52, v104 row_newbcast:15 row_mask:0xf bank_mask:0xf
    v_dot2c_f32_bf16_dpp v14, v22, v105 row_newbcast:15 row_mask:0xf bank_mask:0xf
    v_dot2c_f32_bf16_dpp v15, v52, v105 row_newbcast:15 row_mask:0xf bank_mask:0xf
    v_dot2c_f32_bf16_dpp v16, v22, v106 row_newbcast:15 row_mask:0xf bank_mask:0xf
    v_dot2c_f32_bf16_dpp v17, v52, v106 row_newbcast:15 row_mask:0xf bank_mask:0xf
    v_dot2c_f32_bf16_dpp v18, v22, v107 row_newbcast:15 row_mask:0xf bank_mask:0xf
    v_dot2c_f32_bf16_dpp v19, v52, v107 row_newbcast:15 row_mask:0xf bank_mask:0xf
    s_add_u32 s6, s56, 241664
    s_and_b32 s6, s6, 0xfffff
    s_cmp_lt_u32 s3, 4
    s_cbranch_scc0 W_384
    s_waitcnt vmcnt(4)
W_384:
    buffer_load_dwordx4 v[88:91], v1, s[12:15], s6 offen nt
    v_accvgpr_read_b32 v48, a60
    v_accvgpr_read_b32 v49, a61
    v_accvgpr_read_b32 v50, a62
    v_accvgpr_read_b32 v51, a63
    v_dot2c_f32_bf16_dpp v12, v30, v48 row_newbcast:15 row_mask:0xf bank_mask:0xf
    v_dot2c_f32_bf16_dpp v13, v54, v48 row_newbcast:15 row_mask:0xf bank_mask:0xf
    v_dot2c_f32_bf16_dpp v14, v30, v49 row_newbcast:15 row_mask:0xf bank_mask:0xf
    v_dot2c_f32_bf16_dpp v15, v54, v49 row_newbcast:15 row_mask:0xf bank_mask:0xf
    v_dot2c_f32_bf16_dpp v16, v30, v50 row_newbcast:15 row_mask:0xf bank_mask:0xf
    v_dot2c_f32_bf16_dpp v17, v54, v50 row_newbcast:15 row_mask:0xf bank_mask:0xf
    v_dot2c_f32_bf16_dpp v18, v30, v51 row_newbcast:15 row_mask:0xf bank_mask:0xf
    v_dot2c_f32_bf16_dpp v19, v54, v51 row_newbcast:15 row_mask:0xf bank_mask:0xf
    v_lshlrev_b32 v52, 16, v23
    s_nop 1
    s_waitcnt vmcnt(11)
    v_dot2c_f32_bf16_dpp v12, v23, v108 row_newbcast:0 row_mask:0xf bank_mask:0xf
    v_dot2c_f32_bf16_dpp v13, v52, v108 row_newbcast:0 row_mask:0xf bank_mask:0xf
    v_dot2c_f32_bf16_dpp v14, v23, v109 row_newbcast:0 row_mask:0xf bank_mask:0xf
    v_dot2c_f32_bf16_dpp v15, v52, v109 row_newbcast:0 row_mask:0xf bank_mask:0xf
    v_dot2c_f32_bf16_dpp v16, v23, v110 row_newbcast:0 row_mask:0xf bank_mask:0xf
    v_dot2c_f32_bf16_dpp v17, v52, v110 row_newbcast:0 row_mask:0xf bank_mask:0xf
    v_dot2c_f32_bf16_dpp v18, v23, v111 row_newbcast:0 row_mask:0xf bank_mask:0xf
    v_dot2c_f32_bf16_dpp v19, v52, v111 row_newbcast:0 row_mask:0xf bank_mask:0xf
    s_add_u32 s6, s56, 245760
    s_and_b32 s6, s6, 0xfffff
    s_cmp_lt_u32 s3, 4
    s_cbranch_scc0 W_385
    s_waitcnt vmcnt(3)
W_385:
    buffer_load_dwordx4 v[92:95], v1, s[12:15], s6 offen nt
    v_lshlrev_b32 v54, 16, v31
    s_nop 1
    v_accvgpr_read_b32 v48, a64
    v_accvgpr_read_b32 v49, a65
    v_accvgpr_read_b32 v50, a66
    v_accvgpr_read_b32 v51, a67
    v_dot2c_f32_bf16_dpp v12, v31, v48 row_newbcast:0 row_mask:0xf bank_mask:0xf
    v_dot2c_f32_bf16_dpp v13, v54, v48 row_newbcast:0 row_mask:0xf bank_mask:0xf
    v_dot2c_f32_bf16_dpp v14, v31, v49 row_newbcast:0 row_mask:0xf bank_mask:0xf
    v_dot2c_f32_bf16_dpp v15, v54, v49 row_newbcast:0 row_mask:0xf bank_mask:0xf
    v_dot2c_f32_bf16_dpp v16, v31, v50 row_newbcast:0 row_mask:0xf bank_mask:0xf
    v_dot2c_f32_bf16_dpp v17, v54, v50 row_newbcast:0 row_mask:0xf bank_mask:0xf
    v_dot2c_f32_bf16_dpp v18, v31, v51 row_newbcast:0 row_mask:0xf bank_mask:0xf
    v_dot2c_f32_bf16_dpp v19, v54, v51 row_newbcast:0 row_mask:0xf bank_mask:0xf
    s_waitcnt vmcnt(11)
    v_dot2c_f32_bf16_dpp v12, v23, v112 row_newbcast:1 row_mask:0xf bank_mask:0xf
    v_dot2c_f32_bf16_dpp v13, v52, v112 row_newbcast:1 row_mask:0xf bank_mask:0xf
    v_dot2c_f32_bf16_dpp v14, v23, v113 row_newbcast:1 row_mask:0xf bank_mask:0xf
    v_dot2c_f32_bf16_dpp v15, v52, v113 row_newbcast:1 row_mask:0xf bank_mask:0xf
    v_dot2c_f32_bf16_dpp v16, v23, v114 row_newbcast:1 row_mask:0xf bank_mask:0xf
    v_dot2c_f32_bf16_dpp v17, v52, v114 row_newbcast:1 row_mask:0xf bank_mask:0xf
    v_dot2c_f32_bf16_dpp v18, v23, v115 row_newbcast:1 row_mask:0xf bank_mask:0xf
    v_dot2c_f32_bf16_dpp v19, v52, v115 row_newbcast:1 row_mask:0xf bank_mask:0xf
    s_add_u32 s6, s56, 249856
    s_and_b32 s6, s6, 0xfffff
    s_cmp_lt_u32 s3, 4
    s_cbranch_scc0 W_386
    s_waitcnt vmcnt(4)
W_386:
    buffer_load_dwordx4 v[96:99], v1, s[12:15], s6 offen nt
    v_accvgpr_read_b32 v48, a68
    v_accvgpr_read_b32 v49, a69
    v_accvgpr_read_b32 v50, a70
    v_accvgpr_read_b32 v51, a71
    v_dot2c_f32_bf16_dpp v12, v31, v48 row_newbcast:1 row_mask:0xf bank_mask:0xf
    v_dot2c_f32_bf16_dpp v13, v54, v48 row_newbcast:1 row_mask:0xf bank_mask:0xf
    v_dot2c_f32_bf16_dpp v14, v31, v49 row_newbcast:1 row_mask:0xf bank_mask:0xf
    v_dot2c_f32_bf16_dpp v15, v54, v49 row_newbcast:1 row_mask:0xf bank_mask:0xf
    v_dot2c_f32_bf16_dpp v16, v31, v50 row_newbcast:1 row_mask:0xf bank_mask:0xf
    v_dot2c_f32_bf16_dpp v17, v54, v50 row_newbcast:1 row_mask:0xf bank_mask:0xf
    v_dot2c_f32_bf16_dpp v18, v31, v51 row_newbcast:1 row_mask:0xf bank_mask:0xf
    v_dot2c_f32_bf16_dpp v19, v54, v51 row_newbcast:1 row_mask:0xf bank_mask:0xf
    s_waitcnt vmcnt(11)
    v_dot2c_f32_bf16_dpp v12, v23, v116 row_newbcast:2 row_mask:0xf bank_mask:0xf
    v_dot2c_f32_bf16_dpp v13, v52, v116 row_newbcast:2 row_mask:0xf bank_mask:0xf
    v_dot2c_f32_bf16_dpp v14, v23, v117 row_newbcast:2 row_mask:0xf bank_mask:0xf
    v_dot2c_f32_bf16_dpp v15, v52, v117 row_newbcast:2 row_mask:0xf bank_mask:0xf
    v_dot2c_f32_bf16_dpp v16, v23, v118 row_newbcast:2 row_mask:0xf bank_mask:0xf
    v_dot2c_f32_bf16_dpp v17, v52, v118 row_newbcast:2 row_mask:0xf bank_mask:0xf
    v_dot2c_f32_bf16_dpp v18, v23, v119 row_newbcast:2 row_mask:0xf bank_mask:0xf
    v_dot2c_f32_bf16_dpp v19, v52, v119 row_newbcast:2 row_mask:0xf bank_mask:0xf
    s_add_u32 s6, s56, 253952
    s_and_b32 s6, s6, 0xfffff
    s_cmp_lt_u32 s3, 4
    s_cbranch_scc0 W_387
    s_waitcnt vmcnt(3)
W_387:
    buffer_load_dwordx4 v[100:103], v1, s[12:15], s6 offen nt
    v_accvgpr_read_b32 v48, a72
    v_accvgpr_read_b32 v49, a73
    v_accvgpr_read_b32 v50, a74
    v_accvgpr_read_b32 v51, a75
    v_dot2c_f32_bf16_dpp v12, v31, v48 row_newbcast:2 row_mask:0xf bank_mask:0xf
    v_dot2c_f32_bf16_dpp v13, v54, v48 row_newbcast:2 row_mask:0xf bank_mask:0xf
    v_dot2c_f32_bf16_dpp v14, v31, v49 row_newbcast:2 row_mask:0xf bank_mask:0xf
    v_dot2c_f32_bf16_dpp v15, v54, v49 row_newbcast:2 row_mask:0xf bank_mask:0xf
    v_dot2c_f32_bf16_dpp v16, v31, v50 row_newbcast:2 row_mask:0xf bank_mask:0xf
    v_dot2c_f32_bf16_dpp v17, v54, v50 row_newbcast:2 row_mask:0xf bank_mask:0xf
    v_dot2c_f32_bf16_dpp v18, v31, v51 row_newbcast:2 row_mask:0xf bank_mask:0xf
    v_dot2c_f32_bf16_dpp v19, v54, v51 row_newbcast:2 row_mask:0xf bank_mask:0xf
    s_waitcnt vmcnt(11)
    v_dot2c_f32_bf16_dpp v12, v23, v120 row_newbcast:3 row_mask:0xf bank_mask:0xf
    v_dot2c_f32_bf16_dpp v13, v52, v120 row_newbcast:3 row_mask:0xf bank_mask:0xf
    v_dot2c_f32_bf16_dpp v14, v23, v121 row_newbcast:3 row_mask:0xf bank_mask:0xf
    v_dot2c_f32_bf16_dpp v15, v52, v121 row_newbcast:3 row_mask:0xf bank_mask:0xf
    v_dot2c_f32_bf16_dpp v16, v23, v122 row_newbcast:3 row_mask:0xf bank_mask:0xf
    v_dot2c_f32_bf16_dpp v17, v52, v122 row_newbcast:3 row_mask:0xf bank_mask:0xf
    v_dot2c_f32_bf16_dpp v18, v23, v123 row_newbcast:3 row_mask:0xf bank_mask:0xf
    v_dot2c_f32_bf16_dpp v19, v52, v123 row_newbcast:3 row_mask:0xf bank_mask:0xf
    s_add_u32 s6, s56, 258048
    s_and_b32 s6, s6, 0xfffff
    s_cmp_lt_u32 s3, 4
    s_cbranch_scc0 W_388
    s_waitcnt vmcnt(4)
W_388:
    buffer_load_dwordx4 v[104:107], v1, s[12:15], s6 offen nt
    v_accvgpr_read_b32 v48, a76
    v_accvgpr_read_b32 v49, a77
    v_accvgpr_read_b32 v50, a78
    v_accvgpr_read_b32 v51, a79
    v_dot2c_f32_bf16_dpp v12, v31, v48 row_newbcast:3 row_mask:0xf bank_mask:0xf
    v_dot2c_f32_bf16_dpp v13, v54, v48 row_newbcast:3 row_mask:0xf bank_mask:0xf
    v_dot2c_f32_bf16_dpp v14, v31, v49 row_newbcast:3 row_mask:0xf bank_mask:0xf
    v_dot2c_f32_bf16_dpp v15, v54, v49 row_newbcast:3 row_mask:0xf bank_mask:0xf
    v_dot2c_f32_bf16_dpp v16, v31, v50 row_newbcast:3 row_mask:0xf bank_mask:0xf
    v_dot2c_f32_bf16_dpp v17, v54, v50 row_newbcast:3 row_mask:0xf bank_mask:0xf
    v_dot2c_f32_bf16_dpp v18, v31, v51 row_newbcast:3 row_mask:0xf bank_mask:0xf
    v_dot2c_f32_bf16_dpp v19, v54, v51 row_newbcast:3 row_mask:0xf bank_mask:0xf
    s_waitcnt vmcnt(11)
    v_dot2c_f32_bf16_dpp v12, v23, v124 row_newbcast:4 row_mask:0xf bank_mask:0xf
    v_dot2c_f32_bf16_dpp v13, v52, v124 row_newbcast:4 row_mask:0xf bank_mask:0xf
    v_dot2c_f32_bf16_dpp v14, v23, v125 row_newbcast:4 row_mask:0xf bank_mask:0xf
    v_dot2c_f32_bf16_dpp v15, v52, v125 row_newbcast:4 row_mask:0xf bank_mask:0xf
    v_dot2c_f32_bf16_dpp v16, v23, v126 row_newbcast:4 row_mask:0xf bank_mask:0xf
    v_dot2c_f32_bf16_dpp v17, v52, v126 row_newbcast:4 row_mask:0xf bank_mask:0xf
    v_dot2c_f32_bf16_dpp v18, v23, v127 row_newbcast:4 row_mask:0xf bank_mask:0xf
    v_dot2c_f32_bf16_dpp v19, v52, v127 row_newbcast:4 row_mask:0xf bank_mask:0xf
    s_add_u32 s6, s56, 262144
    s_and_b32 s6, s6, 0xfffff
    s_cmp_lt_u32 s3, 4
    s_cbranch_scc0 W_389
    s_waitcnt vmcnt(3)
W_389:
    buffer_load_dwordx4 v[108:111], v1, s[12:15], s6 offen nt
    v_accvgpr_read_b32 v48, a80
    v_accvgpr_read_b32 v49, a81
    v_accvgpr_read_b32 v50, a82
    v_accvgpr_read_b32 v51, a83
    v_dot2c_f32_bf16_dpp v12, v31, v48 row_newbcast:4 row_mask:0xf bank_mask:0xf
    v_dot2c_f32_bf16_dpp v13, v54, v48 row_newbcast:4 row_mask:0xf bank_mask:0xf
    v_dot2c_f32_bf16_dpp v14, v31, v49 row_newbcast:4 row_mask:0xf bank_mask:0xf
    v_dot2c_f32_bf16_dpp v15, v54, v49 row_newbcast:4 row_mask:0xf bank_mask:0xf
    v_dot2c_f32_bf16_dpp v16, v31, v50 row_newbcast:4 row_mask:0xf bank_mask:0xf
    v_dot2c_f32_bf16_dpp v17, v54, v50 row_newbcast:4 row_mask:0xf bank_mask:0xf
    v_dot2c_f32_bf16_dpp v18, v31, v51 row_newbcast:4 row_mask:0xf bank_mask:0xf
    v_dot2c_f32_bf16_dpp v19, v54, v51 row_newbcast:4 row_mask:0xf bank_mask:0xf
    s_waitcnt vmcnt(11)
    v_dot2c_f32_bf16_dpp v12, v23, v64 row_newbcast:5 row_mask:0xf bank_mask:0xf
    v_dot2c_f32_bf16_dpp v13, v52, v64 row_newbcast:5 row_mask:0xf bank_mask:0xf
    v_dot2c_f32_bf16_dpp v14, v23, v65 row_newbcast:5 row_mask:0xf bank_mask:0xf
    v_dot2c_f32_bf16_dpp v15, v52, v65 row_newbcast:5 row_mask:0xf bank_mask:0xf
    v_dot2c_f32_bf16_dpp v16, v23, v66 row_newbcast:5 row_mask:0xf bank_mask:0xf
    v_dot2c_f32_bf16_dpp v17, v52, v66 row_newbcast:5 row_mask:0xf bank_mask:0xf
    v_dot2c_f32_bf16_dpp v18, v23, v67 row_newbcast:5 row_mask:0xf bank_mask:0xf
    v_dot2c_f32_bf16_dpp v19, v52, v67 row_newbcast:5 row_mask:0xf bank_mask:0xf
    s_add_u32 s6, s56, 266240
    s_and_b32 s6, s6, 0xfffff
    s_cmp_lt_u32 s3, 4
    s_cbranch_scc0 W_390
    s_waitcnt vmcnt(4)
W_390:
    buffer_load_dwordx4 v[112:115], v1, s[12:15], s6 offen nt
    v_accvgpr_read_b32 v48, a84
    v_accvgpr_read_b32 v49, a85
    v_accvgpr_read_b32 v50, a86
    v_accvgpr_read_b32 v51, a87
    v_dot2c_f32_bf16_dpp v12, v31, v48 row_newbcast:5 row_mask:0xf bank_mask:0xf
    v_dot2c_f32_bf16_dpp v13, v54, v48 row_newbcast:5 row_mask:0xf bank_mask:0xf
    v_dot2c_f32_bf16_dpp v14, v31, v49 row_newbcast:5 row_mask:0xf bank_mask:0xf
    v_dot2c_f32_bf16_dpp v15, v54, v49 row_newbcast:5 row_mask:0xf bank_mask:0xf
    v_dot2c_f32_bf16_dpp v16, v31, v50 row_newbcast:5 row_mask:0xf bank_mask:0xf
    v_dot2c_f32_bf16_dpp v17, v54, v50 row_newbcast:5 row_mask:0xf bank_mask:0xf
    v_dot2c_f32_bf16_dpp v18, v31, v51 row_newbcast:5 row_mask:0xf bank_mask:0xf
    v_dot2c_f32_bf16_dpp v19, v54, v51 row_newbcast:5 row_mask:0xf bank_mask:0xf
    s_waitcnt vmcnt(11)
    v_dot2c_f32_bf16_dpp v12, v23, v68 row_newbcast:6 row_mask:0xf bank_mask:0xf
    v_dot2c_f32_bf16_dpp v13, v52, v68 row_newbcast:6 row_mask:0xf bank_mask:0xf
    v_dot2c_f32_bf16_dpp v14, v23, v69 row_newbcast:6 row_mask:0xf bank_mask:0xf
    v_dot2c_f32_bf16_dpp v15, v52, v69 row_newbcast:6 row_mask:0xf bank_mask:0xf
    v_dot2c_f32_bf16_dpp v16, v23, v70 row_newbcast:6 row_mask:0xf bank_mask:0xf
    v_dot2c_f32_bf16_dpp v17, v52, v70 row_newbcast:6 row_mask:0xf bank_mask:0xf
    v_dot2c_f32_bf16_dpp v18, v23, v71 row_newbcast:6 row_mask:0xf bank_mask:0xf
    v_dot2c_f32_bf16_dpp v19, v52, v71 row_newbcast:6 row_mask:0xf bank_mask:0xf
    s_add_u32 s6, s56, 270336
    s_and_b32 s6, s6, 0xfffff
    s_cmp_lt_u32 s3, 4
    s_cbranch_scc0 W_391
    s_waitcnt vmcnt(3)
W_391:
    buffer_load_dwordx4 v[116:119], v1, s[12:15], s6 offen nt
    v_accvgpr_read_b32 v48, a88
    v_accvgpr_read_b32 v49, a89
    v_accvgpr_read_b32 v50, a90
    v_accvgpr_read_b32 v51, a91
    v_dot2c_f32_bf16_dpp v12, v31, v48 row_newbcast:6 row_mask:0xf bank_mask:0xf
    v_dot2c_f32_bf16_dpp v13, v54, v48 row_newbcast:6 row_mask:0xf bank_mask:0xf
    v_dot2c_f32_bf16_dpp v14, v31, v49 row_newbcast:6 row_mask:0xf bank_mask:0xf
    v_dot2c_f32_bf16_dpp v15, v54, v49 row_newbcast:6 row_mask:0xf bank_mask:0xf
    v_dot2c_f32_bf16_dpp v16, v31, v50 row_newbcast:6 row_mask:0xf bank_mask:0xf
    v_dot2c_f32_bf16_dpp v17, v54, v50 row_newbcast:6 row_mask:0xf bank_mask:0xf
    v_dot2c_f32_bf16_dpp v18, v31, v51 row_newbcast:6 row_mask:0xf bank_mask:0xf
    v_dot2c_f32_bf16_dpp v19, v54, v51 row_newbcast:6 row_mask:0xf bank_mask:0xf
    s_waitcnt vmcnt(11)
    v_dot2c_f32_bf16_dpp v12, v23, v72 row_newbcast:7 row_mask:0xf bank_mask:0xf
    v_dot2c_f32_bf16_dpp v13, v52, v72 row_newbcast:7 row_mask:0xf bank_mask:0xf
    v_dot2c_f32_bf16_dpp v14, v23, v73 row_newbcast:7 row_mask:0xf bank_mask:0xf
    v_dot2c_f32_bf16_dpp v15, v52, v73 row_newbcast:7 row_mask:0xf bank_mask:0xf
    v_dot2c_f32_bf16_dpp v16, v23, v74 row_newbcast:7 row_mask:0xf bank_mask:0xf
    v_dot2c_f32_bf16_dpp v17, v52, v74 row_newbcast:7 row_mask:0xf bank_mask:0xf
    v_dot2c_f32_bf16_dpp v18, v23, v75 row_newbcast:7 row_mask:0xf bank_mask:0xf
    v_dot2c_f32_bf16_dpp v19, v52, v75 row_newbcast:7 row_mask:0xf bank_mask:0xf
    s_add_u32 s6, s56, 274432
    s_and_b32 s6, s6, 0xfffff
    s_cmp_lt_u32 s3, 4
    s_cbranch_scc0 W_392
    s_waitcnt vmcnt(4)
W_392:
    buffer_load_dwordx4 v[120:123], v1, s[12:15], s6 offen nt
    v_accvgpr_read_b32 v48, a92
    v_accvgpr_read_b32 v49, a93
    v_accvgpr_read_b32 v50, a94
    v_accvgpr_read_b32 v51, a95
    v_dot2c_f32_bf16_dpp v12, v31, v48 row_newbcast:7 row_mask:0xf bank_mask:0xf
    v_dot2c_f32_bf16_dpp v13, v54, v48 row_newbcast:7 row_mask:0xf bank_mask:0xf
    v_dot2c_f32_bf16_dpp v14, v31, v49 row_newbcast:7 row_mask:0xf bank_mask:0xf
    v_dot2c_f32_bf16_dpp v15, v54, v49 row_newbcast:7 row_mask:0xf bank_mask:0xf
    v_dot2c_f32_bf16_dpp v16, v31, v50 row_newbcast:7 row_mask:0xf bank_mask:0xf
    v_dot2c_f32_bf16_dpp v17, v54, v50 row_newbcast:7 row_mask:0xf bank_mask:0xf
    v_dot2c_f32_bf16_dpp v18, v31, v51 row_newbcast:7 row_mask:0xf bank_mask:0xf
    v_dot2c_f32_bf16_dpp v19, v54, v51 row_newbcast:7 row_mask:0xf bank_mask:0xf
    s_waitcnt vmcnt(11)
    v_dot2c_f32_bf16_dpp v12, v23, v76 row_newbcast:8 row_mask:0xf bank_mask:0xf
    v_dot2c_f32_bf16_dpp v13, v52, v76 row_newbcast:8 row_mask:0xf bank_mask:0xf
    v_dot2c_f32_bf16_dpp v14, v23, v77 row_newbcast:8 row_mask:0xf bank_mask:0xf
    v_dot2c_f32_bf16_dpp v15, v52, v77 row_newbcast:8 row_mask:0xf bank_mask:0xf
    v_dot2c_f32_bf16_dpp v16, v23, v78 row_newbcast:8 row_mask:0xf bank_mask:0xf
    v_dot2c_f32_bf16_dpp v17, v52, v78 row_newbcast:8 row_mask:0xf bank_mask:0xf
    v_dot2c_f32_bf16_dpp v18, v23, v79 row_newbcast:8 row_mask:0xf bank_mask:0xf
    v_dot2c_f32_bf16_dpp v19, v52, v79 row_newbcast:8 row_mask:0xf bank_mask:0xf
    s_add_u32 s6, s56, 278528
    s_and_b32 s6, s6, 0xfffff
    s_cmp_lt_u32 s3, 4
    s_cbranch_scc0 W_393
    s_waitcnt vmcnt(3)
W_393:
    buffer_load_dwordx4 v[124:127], v1, s[12:15], s6 offen nt
    v_accvgpr_read_b32 v48, a96
    v_accvgpr_read_b32 v49, a97
    v_accvgpr_read_b32 v50, a98
    v_accvgpr_read_b32 v51, a99
    v_dot2c_f32_bf16_dpp v12, v31, v48 row_newbcast:8 row_mask:0xf bank_mask:0xf
    v_dot2c_f32_bf16_dpp v13, v54, v48 row_newbcast:8 row_mask:0xf bank_mask:0xf
    v_dot2c_f32_bf16_dpp v14, v31, v49 row_newbcast:8 row_mask:0xf bank_mask:0xf
    v_dot2c_f32_bf16_dpp v15, v54, v49 row_newbcast:8 row_mask:0xf bank_mask:0xf
    v_dot2c_f32_bf16_dpp v16, v31, v50 row_newbcast:8 row_mask:0xf bank_mask:0xf
    v_dot2c_f32_bf16_dpp v17, v54, v50 row_newbcast:8 row_mask:0xf bank_mask:0xf
    v_dot2c_f32_bf16_dpp v18, v31, v51 row_newbcast:8 row_mask:0xf bank_mask:0xf
    v_dot2c_f32_bf16_dpp v19, v54, v51 row_newbcast:8 row_mask:0xf bank_mask:0xf
    s_waitcnt vmcnt(11)
    v_dot2c_f32_bf16_dpp v12, v23, v80 row_newbcast:9 row_mask:0xf bank_mask:0xf
    v_dot2c_f32_bf16_dpp v13, v52, v80 row_newbcast:9 row_mask:0xf bank_mask:0xf
    v_dot2c_f32_bf16_dpp v14, v23, v81 row_newbcast:9 row_mask:0xf bank_mask:0xf
    v_dot2c_f32_bf16_dpp v15, v52, v81 row_newbcast:9 row_mask:0xf bank_mask:0xf
    v_dot2c_f32_bf16_dpp v16, v23, v82 row_newbcast:9 row_mask:0xf bank_mask:0xf
    v_dot2c_f32_bf16_dpp v17, v52, v82 row_newbcast:9 row_mask:0xf bank_mask:0xf
    v_dot2c_f32_bf16_dpp v18, v23, v83 row_newbcast:9 row_mask:0xf bank_mask:0xf
    v_dot2c_f32_bf16_dpp v19, v52, v83 row_newbcast:9 row_mask:0xf bank_mask:0xf
    s_add_u32 s6, s56, 282624
    s_and_b32 s6, s6, 0xfffff
    s_cmp_lt_u32 s3, 4
    s_cbranch_scc0 W_394
    s_waitcnt vmcnt(4)
W_394:
    buffer_load_dwordx4 v[64:67], v1, s[12:15], s6 offen nt
    v_accvgpr_read_b32 v48, a100
    v_accvgpr_read_b32 v49, a101
    v_accvgpr_read_b32 v50, a102
    v_accvgpr_read_b32 v51, a103
    v_dot2c_f32_bf16_dpp v12, v31, v48 row_newbcast:9 row_mask:0xf bank_mask:0xf
    v_dot2c_f32_bf16_dpp v13, v54, v48 row_newbcast:9 row_mask:0xf bank_mask:0xf
    v_dot2c_f32_bf16_dpp v14, v31, v49 row_newbcast:9 row_mask:0xf bank_mask:0xf
    v_dot2c_f32_bf16_dpp v15, v54, v49 row_newbcast:9 row_mask:0xf bank_mask:0xf
    v_dot2c_f32_bf16_dpp v16, v31, v50 row_newbcast:9 row_mask:0xf bank_mask:0xf
    v_dot2c_f32_bf16_dpp v17, v54, v50 row_newbcast:9 row_mask:0xf bank_mask:0xf
    v_dot2c_f32_bf16_dpp v18, v31, v51 row_newbcast:9 row_mask:0xf bank_mask:0xf
    v_dot2c_f32_bf16_dpp v19, v54, v51 row_newbcast:9 row_mask:0xf bank_mask:0xf
    s_waitcnt vmcnt(11)
    v_dot2c_f32_bf16_dpp v12, v23, v84 row_newbcast:10 row_mask:0xf bank_mask:0xf
    v_dot2c_f32_bf16_dpp v13, v52, v84 row_newbcast:10 row_mask:0xf bank_mask:0xf
    v_dot2c_f32_bf16_dpp v14, v23, v85 row_newbcast:10 row_mask:0xf bank_mask:0xf
    v_dot2c_f32_bf16_dpp v15, v52, v85 row_newbcast:10 row_mask:0xf bank_mask:0xf
    v_dot2c_f32_bf16_dpp v16, v23, v86 row_newbcast:10 row_mask:0xf bank_mask:0xf
    v_dot2c_f32_bf16_dpp v17, v52, v86 row_newbcast:10 row_mask:0xf bank_mask:0xf
    v_dot2c_f32_bf16_dpp v18, v23, v87 row_newbcast:10 row_mask:0xf bank_mask:0xf
    v_dot2c_f32_bf16_dpp v19, v52, v87 row_newbcast:10 row_mask:0xf bank_mask:0xf
    s_add_u32 s6, s56, 286720
    s_and_b32 s6, s6, 0xfffff
    s_cmp_lt_u32 s3, 4
    s_cbranch_scc0 W_395
    s_waitcnt vmcnt(3)
W_395:
    buffer_load_dwordx4 v[68:71], v1, s[12:15], s6 offen nt
    v_accvgpr_read_b32 v48, a104
    v_accvgpr_read_b32 v49, a105
    v_accvgpr_read_b32 v50, a106
    v_accvgpr_read_b32 v51, a107
    v_dot2c_f32_bf16_dpp v12, v31, v48 row_newbcast:10 row_mask:0xf bank_mask:0xf
    v_dot2c_f32_bf16_dpp v13, v54, v48 row_newbcast:10 row_mask:0xf bank_mask:0xf
    v_dot2c_f32_bf16_dpp v14, v31, v49 row_newbcast:10 row_mask:0xf bank_mask:0xf
    v_dot2c_f32_bf16_dpp v15, v54, v49 row_newbcast:10 row_mask:0xf bank_mask:0xf
    v_dot2c_f32_bf16_dpp v16, v31, v50 row_newbcast:10 row_mask:0xf bank_mask:0xf
    v_dot2c_f32_bf16_dpp v17, v54, v50 row_newbcast:10 row_mask:0xf bank_mask:0xf
    v_dot2c_f32_bf16_dpp v18, v31, v51 row_newbcast:10 row_mask:0xf bank_mask:0xf
    v_dot2c_f32_bf16_dpp v19, v54, v51 row_newbcast:10 row_mask:0xf bank_mask:0xf
    s_waitcnt vmcnt(11)
    v_dot2c_f32_bf16_dpp v12, v23, v88 row_newbcast:11 row_mask:0xf bank_mask:0xf
    v_dot2c_f32_bf16_dpp v13, v52, v88 row_newbcast:11 row_mask:0xf bank_mask:0xf
    v_dot2c_f32_bf16_dpp v14, v23, v89 row_newbcast:11 row_mask:0xf bank_mask:0xf
    v_dot2c_f32_bf16_dpp v15, v52, v89 row_newbcast:11 row_mask:0xf bank_mask:0xf
    v_dot2c_f32_bf16_dpp v16, v23, v90 row_newbcast:11 row_mask:0xf bank_mask:0xf
    v_dot2c_f32_bf16_dpp v17, v52, v90 row_newbcast:11 row_mask:0xf bank_mask:0xf
    v_dot2c_f32_bf16_dpp v18, v23, v91 row_newbcast:11 row_mask:0xf bank_mask:0xf
    v_dot2c_f32_bf16_dpp v19, v52, v91 row_newbcast:11 row_mask:0xf bank_mask:0xf
    s_add_u32 s6, s56, 290816
    s_and_b32 s6, s6, 0xfffff
    s_cmp_lt_u32 s3, 4
    s_cbranch_scc0 W_396
    s_waitcnt vmcnt(4)
W_396:
    buffer_load_dwordx4 v[72:75], v1, s[12:15], s6 offen nt
    v_accvgpr_read_b32 v48, a108
    v_accvgpr_read_b32 v49, a109
    v_accvgpr_read_b32 v50, a110
    v_accvgpr_read_b32 v51, a111
    v_dot2c_f32_bf16_dpp v12, v31, v48 row_newbcast:11 row_mask:0xf bank_mask:0xf
    v_dot2c_f32_bf16_dpp v13, v54, v48 row_newbcast:11 row_mask:0xf bank_mask:0xf
    v_dot2c_f32_bf16_dpp v14, v31, v49 row_newbcast:11 row_mask:0xf bank_mask:0xf
    v_dot2c_f32_bf16_dpp v15, v54, v49 row_newbcast:11 row_mask:0xf bank_mask:0xf
    v_dot2c_f32_bf16_dpp v16, v31, v50 row_newbcast:11 row_mask:0xf bank_mask:0xf
    v_dot2c_f32_bf16_dpp v17, v54, v50 row_newbcast:11 row_mask:0xf bank_mask:0xf
    v_dot2c_f32_bf16_dpp v18, v31, v51 row_newbcast:11 row_mask:0xf bank_mask:0xf
    v_dot2c_f32_bf16_dpp v19, v54, v51 row_newbcast:11 row_mask:0xf bank_mask:0xf
    s_waitcnt vmcnt(11)
    v_dot2c_f32_bf16_dpp v12, v23, v92 row_newbcast:12 row_mask:0xf bank_mask:0xf
    v_dot2c_f32_bf16_dpp v13, v52, v92 row_newbcast:12 row_mask:0xf bank_mask:0xf
    v_dot2c_f32_bf16_dpp v14, v23, v93 row_newbcast:12 row_mask:0xf bank_mask:0xf
    v_dot2c_f32_bf16_dpp v15, v52, v93 row_newbcast:12 row_mask:0xf bank_mask:0xf
    v_dot2c_f32_bf16_dpp v16, v23, v94 row_newbcast:12 row_mask:0xf bank_mask:0xf
    v_dot2c_f32_bf16_dpp v17, v52, v94 row_newbcast:12 row_mask:0xf bank_mask:0xf
    v_dot2c_f32_bf16_dpp v18, v23, v95 row_newbcast:12 row_mask:0xf bank_mask:0xf
    v_dot2c_f32_bf16_dpp v19, v52, v95 row_newbcast:12 row_mask:0xf bank_mask:0xf
    s_add_u32 s6, s56, 294912
    s_and_b32 s6, s6, 0xfffff
    s_cmp_lt_u32 s3, 4
    s_cbranch_scc0 W_397
    s_waitcnt vmcnt(3)
W_397:
    buffer_load_dwordx4 v[76:79], v1, s[12:15], s6 offen nt
    v_accvgpr_read_b32 v48, a112
    v_accvgpr_read_b32 v49, a113
    v_accvgpr_read_b32 v50, a114
    v_accvgpr_read_b32 v51, a115
    v_dot2c_f32_bf16_dpp v12, v31, v48 row_newbcast:12 row_mask:0xf bank_mask:0xf
    v_dot2c_f32_bf16_dpp v13, v54, v48 row_newbcast:12 row_mask:0xf bank_mask:0xf
    v_dot2c_f32_bf16_dpp v14, v31, v49 row_newbcast:12 row_mask:0xf bank_mask:0xf
    v_dot2c_f32_bf16_dpp v15, v54, v49 row_newbcast:12 row_mask:0xf bank_mask:0xf
    v_dot2c_f32_bf16_dpp v16, v31, v50 row_newbcast:12 row_mask:0xf bank_mask:0xf
    v_dot2c_f32_bf16_dpp v17, v54, v50 row_newbcast:12 row_mask:0xf bank_mask:0xf
    v_dot2c_f32_bf16_dpp v18, v31, v51 row_newbcast:12 row_mask:0xf bank_mask:0xf
    v_dot2c_f32_bf16_dpp v19, v54, v51 row_newbcast:12 row_mask:0xf bank_mask:0xf
    s_waitcnt vmcnt(11)
    v_dot2c_f32_bf16_dpp v12, v23, v96 row_newbcast:13 row_mask:0xf bank_mask:0xf
    v_dot2c_f32_bf16_dpp v13, v52, v96 row_newbcast:13 row_mask:0xf bank_mask:0xf
    v_dot2c_f32_bf16_dpp v14, v23, v97 row_newbcast:13 row_mask:0xf bank_mask:0xf
    v_dot2c_f32_bf16_dpp v15, v52, v97 row_newbcast:13 row_mask:0xf bank_mask:0xf
    v_dot2c_f32_bf16_dpp v16, v23, v98 row_newbcast:13 row_mask:0xf bank_mask:0xf
    v_dot2c_f32_bf16_dpp v17, v52, v98 row_newbcast:13 row_mask:0xf bank_mask:0xf
    v_dot2c_f32_bf16_dpp v18, v23, v99 row_newbcast:13 row_mask:0xf bank_mask:0xf
    v_dot2c_f32_bf16_dpp v19, v52, v99 row_newbcast:13 row_mask:0xf bank_mask:0xf
    s_add_u32 s6, s56, 299008
    s_and_b32 s6, s6, 0xfffff
    s_cmp_lt_u32 s3, 4
    s_cbranch_scc0 W_398
    s_waitcnt vmcnt(4)
W_398:
    buffer_load_dwordx4 v[80:83], v1, s[12:15], s6 offen nt
    v_accvgpr_read_b32 v48, a116
    v_accvgpr_read_b32 v49, a117
    v_accvgpr_read_b32 v50, a118
    v_accvgpr_read_b32 v51, a119
    v_dot2c_f32_bf16_dpp v12, v31, v48 row_newbcast:13 row_mask:0xf bank_mask:0xf
    v_dot2c_f32_bf16_dpp v13, v54, v48 row_newbcast:13 row_mask:0xf bank_mask:0xf
    v_dot2c_f32_bf16_dpp v14, v31, v49 row_newbcast:13 row_mask:0xf bank_mask:0xf
    v_dot2c_f32_bf16_dpp v15, v54, v49 row_newbcast:13 row_mask:0xf bank_mask:0xf
    v_dot2c_f32_bf16_dpp v16, v31, v50 row_newbcast:13 row_mask:0xf bank_mask:0xf
    v_dot2c_f32_bf16_dpp v17, v54, v50 row_newbcast:13 row_mask:0xf bank_mask:0xf
    v_dot2c_f32_bf16_dpp v18, v31, v51 row_newbcast:13 row_mask:0xf bank_mask:0xf
    v_dot2c_f32_bf16_dpp v19, v54, v51 row_newbcast:13 row_mask:0xf bank_mask:0xf
    s_waitcnt vmcnt(11)
    v_dot2c_f32_bf16_dpp v12, v23, v100 row_newbcast:14 row_mask:0xf bank_mask:0xf
    v_dot2c_f32_bf16_dpp v13, v52, v100 row_newbcast:14 row_mask:0xf bank_mask:0xf
    v_dot2c_f32_bf16_dpp v14, v23, v101 row_newbcast:14 row_mask:0xf bank_mask:0xf
    v_dot2c_f32_bf16_dpp v15, v52, v101 row_newbcast:14 row_mask:0xf bank_mask:0xf
    v_dot2c_f32_bf16_dpp v16, v23, v102 row_newbcast:14 row_mask:0xf bank_mask:0xf
    v_dot2c_f32_bf16_dpp v17, v52, v102 row_newbcast:14 row_mask:0xf bank_mask:0xf
    v_dot2c_f32_bf16_dpp v18, v23, v103 row_newbcast:14 row_mask:0xf bank_mask:0xf
    v_dot2c_f32_bf16_dpp v19, v52, v103 row_newbcast:14 row_mask:0xf bank_mask:0xf
    s_add_u32 s6, s56, 303104
    s_and_b32 s6, s6, 0xfffff
    s_cmp_lt_u32 s3, 4
    s_cbranch_scc0 W_399
    s_waitcnt vmcnt(3)
W_399:
    buffer_load_dwordx4 v[84:87], v1, s[12:15], s6 offen nt
    v_accvgpr_read_b32 v48, a120
    v_accvgpr_read_b32 v49, a121
    v_accvgpr_read_b32 v50, a122
    v_accvgpr_read_b32 v51, a123
    v_dot2c_f32_bf16_dpp v12, v31, v48 row_newbcast:14 row_mask:0xf bank_mask:0xf
    v_dot2c_f32_bf16_dpp v13, v54, v48 row_newbcast:14 row_mask:0xf bank_mask:0xf
    v_dot2c_f32_bf16_dpp v14, v31, v49 row_newbcast:14 row_mask:0xf bank_mask:0xf
    v_dot2c_f32_bf16_dpp v15, v54, v49 row_newbcast:14 row_mask:0xf bank_mask:0xf
    v_dot2c_f32_bf16_dpp v16, v31, v50 row_newbcast:14 row_mask:0xf bank_mask:0xf
    v_dot2c_f32_bf16_dpp v17, v54, v50 row_newbcast:14 row_mask:0xf bank_mask:0xf
    v_dot2c_f32_bf16_dpp v18, v31, v51 row_newbcast:14 row_mask:0xf bank_mask:0xf
    v_dot2c_f32_bf16_dpp v19, v54, v51 row_newbcast:14 row_mask:0xf bank_mask:0xf
    v_accvgpr_read_b32 v48, a124
    v_accvgpr_read_b32 v49, a125
    v_accvgpr_read_b32 v50, a126
    v_accvgpr_read_b32 v51, a127
    v_dot2c_f32_bf16_dpp v12, v31, v48 row_newbcast:15 row_mask:0xf bank_mask:0xf
    v_dot2c_f32_bf16_dpp v13, v54, v48 row_newbcast:15 row_mask:0xf bank_mask:0xf
    v_dot2c_f32_bf16_dpp v14, v31, v49 row_newbcast:15 row_mask:0xf bank_mask:0xf
    v_dot2c_f32_bf16_dpp v15, v54, v49 row_newbcast:15 row_mask:0xf bank_mask:0xf
    v_dot2c_f32_bf16_dpp v16, v31, v50 row_newbcast:15 row_mask:0xf bank_mask:0xf
    v_dot2c_f32_bf16_dpp v17, v54, v50 row_newbcast:15 row_mask:0xf bank_mask:0xf
    v_dot2c_f32_bf16_dpp v18, v31, v51 row_newbcast:15 row_mask:0xf bank_mask:0xf
    v_dot2c_f32_bf16_dpp v19, v54, v51 row_newbcast:15 row_mask:0xf bank_mask:0xf
    s_waitcnt vmcnt(11)
    v_dot2c_f32_bf16_dpp v12, v23, v104 row_newbcast:15 row_mask:0xf bank_mask:0xf
    v_dot2c_f32_bf16_dpp v13, v52, v104 row_newbcast:15 row_mask:0xf bank_mask:0xf
    v_dot2c_f32_bf16_dpp v14, v23, v105 row_newbcast:15 row_mask:0xf bank_mask:0xf
    v_dot2c_f32_bf16_dpp v15, v52, v105 row_newbcast:15 row_mask:0xf bank_mask:0xf
    v_dot2c_f32_bf16_dpp v16, v23, v106 row_newbcast:15 row_mask:0xf bank_mask:0xf
    v_dot2c_f32_bf16_dpp v17, v52, v106 row_newbcast:15 row_mask:0xf bank_mask:0xf
    v_dot2c_f32_bf16_dpp v18, v23, v107 row_newbcast:15 row_mask:0xf bank_mask:0xf
    v_dot2c_f32_bf16_dpp v19, v52, v107 row_newbcast:15 row_mask:0xf bank_mask:0xf
    s_add_u32 s6, s56, 307200
    s_and_b32 s6, s6, 0xfffff
    s_cmp_lt_u32 s3, 4
    s_cbranch_scc0 W_400
    s_waitcnt vmcnt(4)
W_400:
    buffer_load_dwordx4 v[88:91], v1, s[12:15], s6 offen nt
    v_lshlrev_b32 v54, 16, v32
    s_nop 1
    v_accvgpr_read_b32 v48, a128
    v_accvgpr_read_b32 v49, a129
    v_accvgpr_read_b32 v50, a130
    v_accvgpr_read_b32 v51, a131
    v_dot2c_f32_bf16_dpp v12, v32, v48 row_newbcast:0 row_mask:0xf bank_mask:0xf
    v_dot2c_f32_bf16_dpp v13, v54, v48 row_newbcast:0 row_mask:0xf bank_mask:0xf
    v_dot2c_f32_bf16_dpp v14, v32, v49 row_newbcast:0 row_mask:0xf bank_mask:0xf
    v_dot2c_f32_bf16_dpp v15, v54, v49 row_newbcast:0 row_mask:0xf bank_mask:0xf
    v_dot2c_f32_bf16_dpp v16, v32, v50 row_newbcast:0 row_mask:0xf bank_mask:0xf
    v_dot2c_f32_bf16_dpp v17, v54, v50 row_newbcast:0 row_mask:0xf bank_mask:0xf
    v_dot2c_f32_bf16_dpp v18, v32, v51 row_newbcast:0 row_mask:0xf bank_mask:0xf
    v_dot2c_f32_bf16_dpp v19, v54, v51 row_newbcast:0 row_mask:0xf bank_mask:0xf
    v_lshlrev_b32 v52, 16, v24
    s_nop 1
    s_waitcnt vmcnt(11)
    v_dot2c_f32_bf16_dpp v12, v24, v108 row_newbcast:0 row_mask:0xf bank_mask:0xf
    v_dot2c_f32_bf16_dpp v13, v52, v108 row_newbcast:0 row_mask:0xf bank_mask:0xf
    v_dot2c_f32_bf16_dpp v14, v24, v109 row_newbcast:0 row_mask:0xf bank_mask:0xf
    v_dot2c_f32_bf16_dpp v15, v52, v109 row_newbcast:0 row_mask:0xf bank_mask:0xf
    v_dot2c_f32_bf16_dpp v16, v24, v110 row_newbcast:0 row_mask:0xf bank_mask:0xf
    v_dot2c_f32_bf16_dpp v17, v52, v110 row_newbcast:0 row_mask:0xf bank_mask:0xf
    v_dot2c_f32_bf16_dpp v18, v24, v111 row_newbcast:0 row_mask:0xf bank_mask:0xf
    v_dot2c_f32_bf16_dpp v19, v52, v111 row_newbcast:0 row_mask:0xf bank_mask:0xf
    s_add_u32 s6, s56, 311296
    s_and_b32 s6, s6, 0xfffff
    s_cmp_lt_u32 s3, 4
    s_cbranch_scc0 W_401
    s_waitcnt vmcnt(3)
W_401:
    buffer_load_dwordx4 v[92:95], v1, s[12:15], s6 offen nt
    v_accvgpr_read_b32 v48, a132
    v_accvgpr_read_b32 v49, a133
    v_accvgpr_read_b32 v50, a134
    v_accvgpr_read_b32 v51, a135
    v_dot2c_f32_bf16_dpp v12, v32, v48 row_newbcast:1 row_mask:0xf bank_mask:0xf
    v_dot2c_f32_bf16_dpp v13, v54, v48 row_newbcast:1 row_mask:0xf bank_mask:0xf
    v_dot2c_f32_bf16_dpp v14, v32, v49 row_newbcast:1 row_mask:0xf bank_mask:0xf
    v_dot2c_f32_bf16_dpp v15, v54, v49 row_newbcast:1 row_mask:0xf bank_mask:0xf
    v_dot2c_f32_bf16_dpp v16, v32, v50 row_newbcast:1 row_mask:0xf bank_mask:0xf
    v_dot2c_f32_bf16_dpp v17, v54, v50 row_newbcast:1 row_mask:0xf bank_mask:0xf
    v_dot2c_f32_bf16_dpp v18, v32, v51 row_newbcast:1 row_mask:0xf bank_mask:0xf
    v_dot2c_f32_bf16_dpp v19, v54, v51 row_newbcast:1 row_mask:0xf bank_mask:0xf
    s_waitcnt vmcnt(11)
    v_dot2c_f32_bf16_dpp v12, v24, v112 row_newbcast:1 row_mask:0xf bank_mask:0xf
    v_dot2c_f32_bf16_dpp v13, v52, v112 row_newbcast:1 row_mask:0xf bank_mask:0xf
    v_dot2c_f32_bf16_dpp v14, v24, v113 row_newbcast:1 row_mask:0xf bank_mask:0xf
    v_dot2c_f32_bf16_dpp v15, v52, v113 row_newbcast:1 row_mask:0xf bank_mask:0xf
    v_dot2c_f32_bf16_dpp v16, v24, v114 row_newbcast:1 row_mask:0xf bank_mask:0xf
    v_dot2c_f32_bf16_dpp v17, v52, v114 row_newbcast:1 row_mask:0xf bank_mask:0xf
    v_dot2c_f32_bf16_dpp v18, v24, v115 row_newbcast:1 row_mask:0xf bank_mask:0xf
    v_dot2c_f32_bf16_dpp v19, v52, v115 row_newbcast:1 row_mask:0xf bank_mask:0xf
    s_add_u32 s6, s56, 315392
    s_and_b32 s6, s6, 0xfffff
    s_cmp_lt_u32 s3, 4
    s_cbranch_scc0 W_402
    s_waitcnt vmcnt(4)
W_402:
    buffer_load_dwordx4 v[96:99], v1, s[12:15], s6 offen nt
    v_accvgpr_read_b32 v48, a136
    v_accvgpr_read_b32 v49, a137
    v_accvgpr_read_b32 v50, a138
    v_accvgpr_read_b32 v51, a139
    v_dot2c_f32_bf16_dpp v12, v32, v48 row_newbcast:2 row_mask:0xf bank_mask:0xf
    v_dot2c_f32_bf16_dpp v13, v54, v48 row_newbcast:2 row_mask:0xf bank_mask:0xf
    v_dot2c_f32_bf16_dpp v14, v32, v49 row_newbcast:2 row_mask:0xf bank_mask:0xf
    v_dot2c_f32_bf16_dpp v15, v54, v49 row_newbcast:2 row_mask:0xf bank_mask:0xf
    v_dot2c_f32_bf16_dpp v16, v32, v50 row_newbcast:2 row_mask:0xf bank_mask:0xf
    v_dot2c_f32_bf16_dpp v17, v54, v50 row_newbcast:2 row_mask:0xf bank_mask:0xf
    v_dot2c_f32_bf16_dpp v18, v32, v51 row_newbcast:2 row_mask:0xf bank_mask:0xf
    v_dot2c_f32_bf16_dpp v19, v54, v51 row_newbcast:2 row_mask:0xf bank_mask:0xf
    s_waitcnt vmcnt(11)
    v_dot2c_f32_bf16_dpp v12, v24, v116 row_newbcast:2 row_mask:0xf bank_mask:0xf
    v_dot2c_f32_bf16_dpp v13, v52, v116 row_newbcast:2 row_mask:0xf bank_mask:0xf
    v_dot2c_f32_bf16_dpp v14, v24, v117 row_newbcast:2 row_mask:0xf bank_mask:0xf
    v_dot2c_f32_bf16_dpp v15, v52, v117 row_newbcast:2 row_mask:0xf bank_mask:0xf
    v_dot2c_f32_bf16_dpp v16, v24, v118 row_newbcast:2 row_mask:0xf bank_mask:0xf
    v_dot2c_f32_bf16_dpp v17, v52, v118 row_newbcast:2 row_mask:0xf bank_mask:0xf
    v_dot2c_f32_bf16_dpp v18, v24, v119 row_newbcast:2 row_mask:0xf bank_mask:0xf
    v_dot2c_f32_bf16_dpp v19, v52, v119 row_newbcast:2 row_mask:0xf bank_mask:0xf
    s_add_u32 s6, s56, 319488
    s_and_b32 s6, s6, 0xfffff
    s_cmp_lt_u32 s3, 4
    s_cbranch_scc0 W_403
    s_waitcnt vmcnt(3)
W_403:
    buffer_load_dwordx4 v[100:103], v1, s[12:15], s6 offen nt
    v_accvgpr_read_b32 v48, a140
    v_accvgpr_read_b32 v49, a141
    v_accvgpr_read_b32 v50, a142
    v_accvgpr_read_b32 v51, a143
    v_dot2c_f32_bf16_dpp v12, v32, v48 row_newbcast:3 row_mask:0xf bank_mask:0xf
    v_dot2c_f32_bf16_dpp v13, v54, v48 row_newbcast:3 row_mask:0xf bank_mask:0xf
    v_dot2c_f32_bf16_dpp v14, v32, v49 row_newbcast:3 row_mask:0xf bank_mask:0xf
    v_dot2c_f32_bf16_dpp v15, v54, v49 row_newbcast:3 row_mask:0xf bank_mask:0xf
    v_dot2c_f32_bf16_dpp v16, v32, v50 row_newbcast:3 row_mask:0xf bank_mask:0xf
    v_dot2c_f32_bf16_dpp v17, v54, v50 row_newbcast:3 row_mask:0xf bank_mask:0xf
    v_dot2c_f32_bf16_dpp v18, v32, v51 row_newbcast:3 row_mask:0xf bank_mask:0xf
    v_dot2c_f32_bf16_dpp v19, v54, v51 row_newbcast:3 row_mask:0xf bank_mask:0xf
    s_waitcnt vmcnt(11)
    v_dot2c_f32_bf16_dpp v12, v24, v120 row_newbcast:3 row_mask:0xf bank_mask:0xf
    v_dot2c_f32_bf16_dpp v13, v52, v120 row_newbcast:3 row_mask:0xf bank_mask:0xf
    v_dot2c_f32_bf16_dpp v14, v24, v121 row_newbcast:3 row_mask:0xf bank_mask:0xf
    v_dot2c_f32_bf16_dpp v15, v52, v121 row_newbcast:3 row_mask:0xf bank_mask:0xf
    v_dot2c_f32_bf16_dpp v16, v24, v122 row_newbcast:3 row_mask:0xf bank_mask:0xf
    v_dot2c_f32_bf16_dpp v17, v52, v122 row_newbcast:3 row_mask:0xf bank_mask:0xf
    v_dot2c_f32_bf16_dpp v18, v24, v123 row_newbcast:3 row_mask:0xf bank_mask:0xf
    v_dot2c_f32_bf16_dpp v19, v52, v123 row_newbcast:3 row_mask:0xf bank_mask:0xf
    s_add_u32 s6, s56, 323584
    s_and_b32 s6, s6, 0xfffff
    s_cmp_lt_u32 s3, 4
    s_cbranch_scc0 W_404
    s_waitcnt vmcnt(4)
W_404:
    buffer_load_dwordx4 v[104:107], v1, s[12:15], s6 offen nt
    v_accvgpr_read_b32 v48, a144
    v_accvgpr_read_b32 v49, a145
    v_accvgpr_read_b32 v50, a146
    v_accvgpr_read_b32 v51, a147
    v_dot2c_f32_bf16_dpp v12, v32, v48 row_newbcast:4 row_mask:0xf bank_mask:0xf
    v_dot2c_f32_bf16_dpp v13, v54, v48 row_newbcast:4 row_mask:0xf bank_mask:0xf
    v_dot2c_f32_bf16_dpp v14, v32, v49 row_newbcast:4 row_mask:0xf bank_mask:0xf
    v_dot2c_f32_bf16_dpp v15, v54, v49 row_newbcast:4 row_mask:0xf bank_mask:0xf
    v_dot2c_f32_bf16_dpp v16, v32, v50 row_newbcast:4 row_mask:0xf bank_mask:0xf
    v_dot2c_f32_bf16_dpp v17, v54, v50 row_newbcast:4 row_mask:0xf bank_mask:0xf
    v_dot2c_f32_bf16_dpp v18, v32, v51 row_newbcast:4 row_mask:0xf bank_mask:0xf
    v_dot2c_f32_bf16_dpp v19, v54, v51 row_newbcast:4 row_mask:0xf bank_mask:0xf
    s_waitcnt vmcnt(11)
    v_dot2c_f32_bf16_dpp v12, v24, v124 row_newbcast:4 row_mask:0xf bank_mask:0xf
    v_dot2c_f32_bf16_dpp v13, v52, v124 row_newbcast:4 row_mask:0xf bank_mask:0xf
    v_dot2c_f32_bf16_dpp v14, v24, v125 row_newbcast:4 row_mask:0xf bank_mask:0xf
    v_dot2c_f32_bf16_dpp v15, v52, v125 row_newbcast:4 row_mask:0xf bank_mask:0xf
    v_dot2c_f32_bf16_dpp v16, v24, v126 row_newbcast:4 row_mask:0xf bank_mask:0xf
    v_dot2c_f32_bf16_dpp v17, v52, v126 row_newbcast:4 row_mask:0xf bank_mask:0xf
    v_dot2c_f32_bf16_dpp v18, v24, v127 row_newbcast:4 row_mask:0xf bank_mask:0xf
    v_dot2c_f32_bf16_dpp v19, v52, v127 row_newbcast:4 row_mask:0xf bank_mask:0xf
    s_add_u32 s6, s56, 327680
    s_and_b32 s6, s6, 0xfffff
    s_cmp_lt_u32 s3, 4
    s_cbranch_scc0 W_405
    s_waitcnt vmcnt(3)
W_405:
    buffer_load_dwordx4 v[108:111], v1, s[12:15], s6 offen nt
    v_accvgpr_read_b32 v48, a148
    v_accvgpr_read_b32 v49, a149
    v_accvgpr_read_b32 v50, a150
    v_accvgpr_read_b32 v51, a151
    v_dot2c_f32_bf16_dpp v12, v32, v48 row_newbcast:5 row_mask:0xf bank_mask:0xf
    v_dot2c_f32_bf16_dpp v13, v54, v48 row_newbcast:5 row_mask:0xf bank_mask:0xf
    v_dot2c_f32_bf16_dpp v14, v32, v49 row_newbcast:5 row_mask:0xf bank_mask:0xf
    v_dot2c_f32_bf16_dpp v15, v54, v49 row_newbcast:5 row_mask:0xf bank_mask:0xf
    v_dot2c_f32_bf16_dpp v16, v32, v50 row_newbcast:5 row_mask:0xf bank_mask:0xf
    v_dot2c_f32_bf16_dpp v17, v54, v50 row_newbcast:5 row_mask:0xf bank_mask:0xf
    v_dot2c_f32_bf16_dpp v18, v32, v51 row_newbcast:5 row_mask:0xf bank_mask:0xf
    v_dot2c_f32_bf16_dpp v19, v54, v51 row_newbcast:5 row_mask:0xf bank_mask:0xf
    s_waitcnt vmcnt(11)
    v_dot2c_f32_bf16_dpp v12, v24, v64 row_newbcast:5 row_mask:0xf bank_mask:0xf
    v_dot2c_f32_bf16_dpp v13, v52, v64 row_newbcast:5 row_mask:0xf bank_mask:0xf
    v_dot2c_f32_bf16_dpp v14, v24, v65 row_newbcast:5 row_mask:0xf bank_mask:0xf
    v_dot2c_f32_bf16_dpp v15, v52, v65 row_newbcast:5 row_mask:0xf bank_mask:0xf
    v_dot2c_f32_bf16_dpp v16, v24, v66 row_newbcast:5 row_mask:0xf bank_mask:0xf
    v_dot2c_f32_bf16_dpp v17, v52, v66 row_newbcast:5 row_mask:0xf bank_mask:0xf
    v_dot2c_f32_bf16_dpp v18, v24, v67 row_newbcast:5 row_mask:0xf bank_mask:0xf
    v_dot2c_f32_bf16_dpp v19, v52, v67 row_newbcast:5 row_mask:0xf bank_mask:0xf
    s_add_u32 s6, s56, 331776
    s_and_b32 s6, s6, 0xfffff
    s_cmp_lt_u32 s3, 4
    s_cbranch_scc0 W_406
    s_waitcnt vmcnt(4)
W_406:
    buffer_load_dwordx4 v[112:115], v1, s[12:15], s6 offen nt
    v_accvgpr_read_b32 v48, a152
    v_accvgpr_read_b32 v49, a153
    v_accvgpr_read_b32 v50, a154
    v_accvgpr_read_b32 v51, a155
    v_dot2c_f32_bf16_dpp v12, v32, v48 row_newbcast:6 row_mask:0xf bank_mask:0xf
    v_dot2c_f32_bf16_dpp v13, v54, v48 row_newbcast:6 row_mask:0xf bank_mask:0xf
    v_dot2c_f32_bf16_dpp v14, v32, v49 row_newbcast:6 row_mask:0xf bank_mask:0xf
    v_dot2c_f32_bf16_dpp v15, v54, v49 row_newbcast:6 row_mask:0xf bank_mask:0xf
    v_dot2c_f32_bf16_dpp v16, v32, v50 row_newbcast:6 row_mask:0xf bank_mask:0xf
    v_dot2c_f32_bf16_dpp v17, v54, v50 row_newbcast:6 row_mask:0xf bank_mask:0xf
    v_dot2c_f32_bf16_dpp v18, v32, v51 row_newbcast:6 row_mask:0xf bank_mask:0xf
    v_dot2c_f32_bf16_dpp v19, v54, v51 row_newbcast:6 row_mask:0xf bank_mask:0xf
    s_waitcnt vmcnt(11)
    v_dot2c_f32_bf16_dpp v12, v24, v68 row_newbcast:6 row_mask:0xf bank_mask:0xf
    v_dot2c_f32_bf16_dpp v13, v52, v68 row_newbcast:6 row_mask:0xf bank_mask:0xf
    v_dot2c_f32_bf16_dpp v14, v24, v69 row_newbcast:6 row_mask:0xf bank_mask:0xf
    v_dot2c_f32_bf16_dpp v15, v52, v69 row_newbcast:6 row_mask:0xf bank_mask:0xf
    v_dot2c_f32_bf16_dpp v16, v24, v70 row_newbcast:6 row_mask:0xf bank_mask:0xf
    v_dot2c_f32_bf16_dpp v17, v52, v70 row_newbcast:6 row_mask:0xf bank_mask:0xf
    v_dot2c_f32_bf16_dpp v18, v24, v71 row_newbcast:6 row_mask:0xf bank_mask:0xf
    v_dot2c_f32_bf16_dpp v19, v52, v71 row_newbcast:6 row_mask:0xf bank_mask:0xf
    s_add_u32 s6, s56, 335872
    s_and_b32 s6, s6, 0xfffff
    s_cmp_lt_u32 s3, 4
    s_cbranch_scc0 W_407
    s_waitcnt vmcnt(3)
W_407:
    buffer_load_dwordx4 v[116:119], v1, s[12:15], s6 offen nt
    v_accvgpr_read_b32 v48, a156
    v_accvgpr_read_b32 v49, a157
    v_accvgpr_read_b32 v50, a158
    v_accvgpr_read_b32 v51, a159
    v_dot2c_f32_bf16_dpp v12, v32, v48 row_newbcast:7 row_mask:0xf bank_mask:0xf
    v_dot2c_f32_bf16_dpp v13, v54, v48 row_newbcast:7 row_mask:0xf bank_mask:0xf
    v_dot2c_f32_bf16_dpp v14, v32, v49 row_newbcast:7 row_mask:0xf bank_mask:0xf
    v_dot2c_f32_bf16_dpp v15, v54, v49 row_newbcast:7 row_mask:0xf bank_mask:0xf
    v_dot2c_f32_bf16_dpp v16, v32, v50 row_newbcast:7 row_mask:0xf bank_mask:0xf
    v_dot2c_f32_bf16_dpp v17, v54, v50 row_newbcast:7 row_mask:0xf bank_mask:0xf
    v_dot2c_f32_bf16_dpp v18, v32, v51 row_newbcast:7 row_mask:0xf bank_mask:0xf
    v_dot2c_f32_bf16_dpp v19, v54, v51 row_newbcast:7 row_mask:0xf bank_mask:0xf
    s_waitcnt vmcnt(11)
    v_dot2c_f32_bf16_dpp v12, v24, v72 row_newbcast:7 row_mask:0xf bank_mask:0xf
    v_dot2c_f32_bf16_dpp v13, v52, v72 row_newbcast:7 row_mask:0xf bank_mask:0xf
    v_dot2c_f32_bf16_dpp v14, v24, v73 row_newbcast:7 row_mask:0xf bank_mask:0xf
    v_dot2c_f32_bf16_dpp v15, v52, v73 row_newbcast:7 row_mask:0xf bank_mask:0xf
    v_dot2c_f32_bf16_dpp v16, v24, v74 row_newbcast:7 row_mask:0xf bank_mask:0xf
    v_dot2c_f32_bf16_dpp v17, v52, v74 row_newbcast:7 row_mask:0xf bank_mask:0xf
    v_dot2c_f32_bf16_dpp v18, v24, v75 row_newbcast:7 row_mask:0xf bank_mask:0xf
    v_dot2c_f32_bf16_dpp v19, v52, v75 row_newbcast:7 row_mask:0xf bank_mask:0xf
    s_add_u32 s6, s56, 339968
    s_and_b32 s6, s6, 0xfffff
    s_cmp_lt_u32 s3, 4
    s_cbranch_scc0 W_408
    s_waitcnt vmcnt(4)
W_408:
    buffer_load_dwordx4 v[120:123], v1, s[12:15], s6 offen nt
    v_accvgpr_read_b32 v48, a160
    v_accvgpr_read_b32 v49, a161
    v_accvgpr_read_b32 v50, a162
    v_accvgpr_read_b32 v51, a163
    v_dot2c_f32_bf16_dpp v12, v32, v48 row_newbcast:8 row_mask:0xf bank_mask:0xf
    v_dot2c_f32_bf16_dpp v13, v54, v48 row_newbcast:8 row_mask:0xf bank_mask:0xf
    v_dot2c_f32_bf16_dpp v14, v32, v49 row_newbcast:8 row_mask:0xf bank_mask:0xf
    v_dot2c_f32_bf16_dpp v15, v54, v49 row_newbcast:8 row_mask:0xf bank_mask:0xf
    v_dot2c_f32_bf16_dpp v16, v32, v50 row_newbcast:8 row_mask:0xf bank_mask:0xf
    v_dot2c_f32_bf16_dpp v17, v54, v50 row_newbcast:8 row_mask:0xf bank_mask:0xf
    v_dot2c_f32_bf16_dpp v18, v32, v51 row_newbcast:8 row_mask:0xf bank_mask:0xf
    v_dot2c_f32_bf16_dpp v19, v54, v51 row_newbcast:8 row_mask:0xf bank_mask:0xf
    s_waitcnt vmcnt(11)
    v_dot2c_f32_bf16_dpp v12, v24, v76 row_newbcast:8 row_mask:0xf bank_mask:0xf
    v_dot2c_f32_bf16_dpp v13, v52, v76 row_newbcast:8 row_mask:0xf bank_mask:0xf
    v_dot2c_f32_bf16_dpp v14, v24, v77 row_newbcast:8 row_mask:0xf bank_mask:0xf
    v_dot2c_f32_bf16_dpp v15, v52, v77 row_newbcast:8 row_mask:0xf bank_mask:0xf
    v_dot2c_f32_bf16_dpp v16, v24, v78 row_newbcast:8 row_mask:0xf bank_mask:0xf
    v_dot2c_f32_bf16_dpp v17, v52, v78 row_newbcast:8 row_mask:0xf bank_mask:0xf
    v_dot2c_f32_bf16_dpp v18, v24, v79 row_newbcast:8 row_mask:0xf bank_mask:0xf
    v_dot2c_f32_bf16_dpp v19, v52, v79 row_newbcast:8 row_mask:0xf bank_mask:0xf
    s_add_u32 s6, s56, 344064
    s_and_b32 s6, s6, 0xfffff
    s_cmp_lt_u32 s3, 4
    s_cbranch_scc0 W_409
    s_waitcnt vmcnt(3)
W_409:
    buffer_load_dwordx4 v[124:127], v1, s[12:15], s6 offen nt
    v_accvgpr_read_b32 v48, a164
    v_accvgpr_read_b32 v49, a165
    v_accvgpr_read_b32 v50, a166
    v_accvgpr_read_b32 v51, a167
    v_dot2c_f32_bf16_dpp v12, v32, v48 row_newbcast:9 row_mask:0xf bank_mask:0xf
    v_dot2c_f32_bf16_dpp v13, v54, v48 row_newbcast:9 row_mask:0xf bank_mask:0xf
    v_dot2c_f32_bf16_dpp v14, v32, v49 row_newbcast:9 row_mask:0xf bank_mask:0xf
    v_dot2c_f32_bf16_dpp v15, v54, v49 row_newbcast:9 row_mask:0xf bank_mask:0xf
    v_dot2c_f32_bf16_dpp v16, v32, v50 row_newbcast:9 row_mask:0xf bank_mask:0xf
    v_dot2c_f32_bf16_dpp v17, v54, v50 row_newbcast:9 row_mask:0xf bank_mask:0xf
    v_dot2c_f32_bf16_dpp v18, v32, v51 row_newbcast:9 row_mask:0xf bank_mask:0xf
    v_dot2c_f32_bf16_dpp v19, v54, v51 row_newbcast:9 row_mask:0xf bank_mask:0xf
    s_waitcnt vmcnt(11)
    v_dot2c_f32_bf16_dpp v12, v24, v80 row_newbcast:9 row_mask:0xf bank_mask:0xf
    v_dot2c_f32_bf16_dpp v13, v52, v80 row_newbcast:9 row_mask:0xf bank_mask:0xf
    v_dot2c_f32_bf16_dpp v14, v24, v81 row_newbcast:9 row_mask:0xf bank_mask:0xf
    v_dot2c_f32_bf16_dpp v15, v52, v81 row_newbcast:9 row_mask:0xf bank_mask:0xf
    v_dot2c_f32_bf16_dpp v16, v24, v82 row_newbcast:9 row_mask:0xf bank_mask:0xf
    v_dot2c_f32_bf16_dpp v17, v52, v82 row_newbcast:9 row_mask:0xf bank_mask:0xf
    v_dot2c_f32_bf16_dpp v18, v24, v83 row_newbcast:9 row_mask:0xf bank_mask:0xf
    v_dot2c_f32_bf16_dpp v19, v52, v83 row_newbcast:9 row_mask:0xf bank_mask:0xf
    s_add_u32 s6, s56, 348160
    s_and_b32 s6, s6, 0xfffff
    s_cmp_lt_u32 s3, 4
    s_cbranch_scc0 W_410
    s_waitcnt vmcnt(4)
W_410:
    buffer_load_dwordx4 v[64:67], v1, s[12:15], s6 offen nt
    v_accvgpr_read_b32 v48, a168
    v_accvgpr_read_b32 v49, a169
    v_accvgpr_read_b32 v50, a170
    v_accvgpr_read_b32 v51, a171
    v_dot2c_f32_bf16_dpp v12, v32, v48 row_newbcast:10 row_mask:0xf bank_mask:0xf
    v_dot2c_f32_bf16_dpp v13, v54, v48 row_newbcast:10 row_mask:0xf bank_mask:0xf
    v_dot2c_f32_bf16_dpp v14, v32, v49 row_newbcast:10 row_mask:0xf bank_mask:0xf
    v_dot2c_f32_bf16_dpp v15, v54, v49 row_newbcast:10 row_mask:0xf bank_mask:0xf
    v_dot2c_f32_bf16_dpp v16, v32, v50 row_newbcast:10 row_mask:0xf bank_mask:0xf
    v_dot2c_f32_bf16_dpp v17, v54, v50 row_newbcast:10 row_mask:0xf bank_mask:0xf
    v_dot2c_f32_bf16_dpp v18, v32, v51 row_newbcast:10 row_mask:0xf bank_mask:0xf
    v_dot2c_f32_bf16_dpp v19, v54, v51 row_newbcast:10 row_mask:0xf bank_mask:0xf
    s_waitcnt vmcnt(11)
    v_dot2c_f32_bf16_dpp v12, v24, v84 row_newbcast:10 row_mask:0xf bank_mask:0xf
    v_dot2c_f32_bf16_dpp v13, v52, v84 row_newbcast:10 row_mask:0xf bank_mask:0xf
    v_dot2c_f32_bf16_dpp v14, v24, v85 row_newbcast:10 row_mask:0xf bank_mask:0xf
    v_dot2c_f32_bf16_dpp v15, v52, v85 row_newbcast:10 row_mask:0xf bank_mask:0xf
    v_dot2c_f32_bf16_dpp v16, v24, v86 row_newbcast:10 row_mask:0xf bank_mask:0xf
    v_dot2c_f32_bf16_dpp v17, v52, v86 row_newbcast:10 row_mask:0xf bank_mask:0xf
    v_dot2c_f32_bf16_dpp v18, v24, v87 row_newbcast:10 row_mask:0xf bank_mask:0xf
    v_dot2c_f32_bf16_dpp v19, v52, v87 row_newbcast:10 row_mask:0xf bank_mask:0xf
    s_add_u32 s6, s56, 352256
    s_and_b32 s6, s6, 0xfffff
    s_cmp_lt_u32 s3, 4
    s_cbranch_scc0 W_411
    s_waitcnt vmcnt(3)
W_411:
    buffer_load_dwordx4 v[68:71], v1, s[12:15], s6 offen nt
    v_accvgpr_read_b32 v48, a172
    v_accvgpr_read_b32 v49, a173
    v_accvgpr_read_b32 v50, a174
    v_accvgpr_read_b32 v51, a175
    v_dot2c_f32_bf16_dpp v12, v32, v48 row_newbcast:11 row_mask:0xf bank_mask:0xf
    v_dot2c_f32_bf16_dpp v13, v54, v48 row_newbcast:11 row_mask:0xf bank_mask:0xf
    v_dot2c_f32_bf16_dpp v14, v32, v49 row_newbcast:11 row_mask:0xf bank_mask:0xf
    v_dot2c_f32_bf16_dpp v15, v54, v49 row_newbcast:11 row_mask:0xf bank_mask:0xf
    v_dot2c_f32_bf16_dpp v16, v32, v50 row_newbcast:11 row_mask:0xf bank_mask:0xf
    v_dot2c_f32_bf16_dpp v17, v54, v50 row_newbcast:11 row_mask:0xf bank_mask:0xf
    v_dot2c_f32_bf16_dpp v18, v32, v51 row_newbcast:11 row_mask:0xf bank_mask:0xf
    v_dot2c_f32_bf16_dpp v19, v54, v51 row_newbcast:11 row_mask:0xf bank_mask:0xf
    s_waitcnt vmcnt(11)
    v_dot2c_f32_bf16_dpp v12, v24, v88 row_newbcast:11 row_mask:0xf bank_mask:0xf
    v_dot2c_f32_bf16_dpp v13, v52, v88 row_newbcast:11 row_mask:0xf bank_mask:0xf
    v_dot2c_f32_bf16_dpp v14, v24, v89 row_newbcast:11 row_mask:0xf bank_mask:0xf
    v_dot2c_f32_bf16_dpp v15, v52, v89 row_newbcast:11 row_mask:0xf bank_mask:0xf
    v_dot2c_f32_bf16_dpp v16, v24, v90 row_newbcast:11 row_mask:0xf bank_mask:0xf
    v_dot2c_f32_bf16_dpp v17, v52, v90 row_newbcast:11 row_mask:0xf bank_mask:0xf
    v_dot2c_f32_bf16_dpp v18, v24, v91 row_newbcast:11 row_mask:0xf bank_mask:0xf
    v_dot2c_f32_bf16_dpp v19, v52, v91 row_newbcast:11 row_mask:0xf bank_mask:0xf
    s_add_u32 s6, s56, 356352
    s_and_b32 s6, s6, 0xfffff
    s_cmp_lt_u32 s3, 4
    s_cbranch_scc0 W_412
    s_waitcnt vmcnt(4)
W_412:
    buffer_load_dwordx4 v[72:75], v1, s[12:15], s6 offen nt
    v_accvgpr_read_b32 v48, a176
    v_accvgpr_read_b32 v49, a177
    v_accvgpr_read_b32 v50, a178
    v_accvgpr_read_b32 v51, a179
    v_dot2c_f32_bf16_dpp v12, v32, v48 row_newbcast:12 row_mask:0xf bank_mask:0xf
    v_dot2c_f32_bf16_dpp v13, v54, v48 row_newbcast:12 row_mask:0xf bank_mask:0xf
    v_dot2c_f32_bf16_dpp v14, v32, v49 row_newbcast:12 row_mask:0xf bank_mask:0xf
    v_dot2c_f32_bf16_dpp v15, v54, v49 row_newbcast:12 row_mask:0xf bank_mask:0xf
    v_dot2c_f32_bf16_dpp v16, v32, v50 row_newbcast:12 row_mask:0xf bank_mask:0xf
    v_dot2c_f32_bf16_dpp v17, v54, v50 row_newbcast:12 row_mask:0xf bank_mask:0xf
    v_dot2c_f32_bf16_dpp v18, v32, v51 row_newbcast:12 row_mask:0xf bank_mask:0xf
    v_dot2c_f32_bf16_dpp v19, v54, v51 row_newbcast:12 row_mask:0xf bank_mask:0xf
    s_waitcnt vmcnt(11)
    v_dot2c_f32_bf16_dpp v12, v24, v92 row_newbcast:12 row_mask:0xf bank_mask:0xf
    v_dot2c_f32_bf16_dpp v13, v52, v92 row_newbcast:12 row_mask:0xf bank_mask:0xf
    v_dot2c_f32_bf16_dpp v14, v24, v93 row_newbcast:12 row_mask:0xf bank_mask:0xf
    v_dot2c_f32_bf16_dpp v15, v52, v93 row_newbcast:12 row_mask:0xf bank_mask:0xf
    v_dot2c_f32_bf16_dpp v16, v24, v94 row_newbcast:12 row_mask:0xf bank_mask:0xf
    v_dot2c_f32_bf16_dpp v17, v52, v94 row_newbcast:12 row_mask:0xf bank_mask:0xf
    v_dot2c_f32_bf16_dpp v18, v24, v95 row_newbcast:12 row_mask:0xf bank_mask:0xf
    v_dot2c_f32_bf16_dpp v19, v52, v95 row_newbcast:12 row_mask:0xf bank_mask:0xf
    s_add_u32 s6, s56, 360448
    s_and_b32 s6, s6, 0xfffff
    s_cmp_lt_u32 s3, 4
    s_cbranch_scc0 W_413
    s_waitcnt vmcnt(3)
W_413:
    buffer_load_dwordx4 v[76:79], v1, s[12:15], s6 offen nt
    v_accvgpr_read_b32 v48, a180
    v_accvgpr_read_b32 v49, a181
    v_accvgpr_read_b32 v50, a182
    v_accvgpr_read_b32 v51, a183
    v_dot2c_f32_bf16_dpp v12, v32, v48 row_newbcast:13 row_mask:0xf bank_mask:0xf
    v_dot2c_f32_bf16_dpp v13, v54, v48 row_newbcast:13 row_mask:0xf bank_mask:0xf
    v_dot2c_f32_bf16_dpp v14, v32, v49 row_newbcast:13 row_mask:0xf bank_mask:0xf
    v_dot2c_f32_bf16_dpp v15, v54, v49 row_newbcast:13 row_mask:0xf bank_mask:0xf
    v_dot2c_f32_bf16_dpp v16, v32, v50 row_newbcast:13 row_mask:0xf bank_mask:0xf
    v_dot2c_f32_bf16_dpp v17, v54, v50 row_newbcast:13 row_mask:0xf bank_mask:0xf
    v_dot2c_f32_bf16_dpp v18, v32, v51 row_newbcast:13 row_mask:0xf bank_mask:0xf
    v_dot2c_f32_bf16_dpp v19, v54, v51 row_newbcast:13 row_mask:0xf bank_mask:0xf
    s_waitcnt vmcnt(11)
    v_dot2c_f32_bf16_dpp v12, v24, v96 row_newbcast:13 row_mask:0xf bank_mask:0xf
    v_dot2c_f32_bf16_dpp v13, v52, v96 row_newbcast:13 row_mask:0xf bank_mask:0xf
    v_dot2c_f32_bf16_dpp v14, v24, v97 row_newbcast:13 row_mask:0xf bank_mask:0xf
    v_dot2c_f32_bf16_dpp v15, v52, v97 row_newbcast:13 row_mask:0xf bank_mask:0xf
    v_dot2c_f32_bf16_dpp v16, v24, v98 row_newbcast:13 row_mask:0xf bank_mask:0xf
    v_dot2c_f32_bf16_dpp v17, v52, v98 row_newbcast:13 row_mask:0xf bank_mask:0xf
    v_dot2c_f32_bf16_dpp v18, v24, v99 row_newbcast:13 row_mask:0xf bank_mask:0xf
    v_dot2c_f32_bf16_dpp v19, v52, v99 row_newbcast:13 row_mask:0xf bank_mask:0xf
    s_add_u32 s6, s56, 364544
    s_and_b32 s6, s6, 0xfffff
    s_cmp_lt_u32 s3, 4
    s_cbranch_scc0 W_414
    s_waitcnt vmcnt(4)
W_414:
    buffer_load_dwordx4 v[80:83], v1, s[12:15], s6 offen nt
    v_accvgpr_read_b32 v48, a184
    v_accvgpr_read_b32 v49, a185
    v_accvgpr_read_b32 v50, a186
    v_accvgpr_read_b32 v51, a187
    v_dot2c_f32_bf16_dpp v12, v32, v48 row_newbcast:14 row_mask:0xf bank_mask:0xf
    v_dot2c_f32_bf16_dpp v13, v54, v48 row_newbcast:14 row_mask:0xf bank_mask:0xf
    v_dot2c_f32_bf16_dpp v14, v32, v49 row_newbcast:14 row_mask:0xf bank_mask:0xf
    v_dot2c_f32_bf16_dpp v15, v54, v49 row_newbcast:14 row_mask:0xf bank_mask:0xf
    v_dot2c_f32_bf16_dpp v16, v32, v50 row_newbcast:14 row_mask:0xf bank_mask:0xf
    v_dot2c_f32_bf16_dpp v17, v54, v50 row_newbcast:14 row_mask:0xf bank_mask:0xf
    v_dot2c_f32_bf16_dpp v18, v32, v51 row_newbcast:14 row_mask:0xf bank_mask:0xf
    v_dot2c_f32_bf16_dpp v19, v54, v51 row_newbcast:14 row_mask:0xf bank_mask:0xf
    s_waitcnt vmcnt(11)
    v_dot2c_f32_bf16_dpp v12, v24, v100 row_newbcast:14 row_mask:0xf bank_mask:0xf
    v_dot2c_f32_bf16_dpp v13, v52, v100 row_newbcast:14 row_mask:0xf bank_mask:0xf
    v_dot2c_f32_bf16_dpp v14, v24, v101 row_newbcast:14 row_mask:0xf bank_mask:0xf
    v_dot2c_f32_bf16_dpp v15, v52, v101 row_newbcast:14 row_mask:0xf bank_mask:0xf
    v_dot2c_f32_bf16_dpp v16, v24, v102 row_newbcast:14 row_mask:0xf bank_mask:0xf
    v_dot2c_f32_bf16_dpp v17, v52, v102 row_newbcast:14 row_mask:0xf bank_mask:0xf
    v_dot2c_f32_bf16_dpp v18, v24, v103 row_newbcast:14 row_mask:0xf bank_mask:0xf
    v_dot2c_f32_bf16_dpp v19, v52, v103 row_newbcast:14 row_mask:0xf bank_mask:0xf
    s_add_u32 s6, s56, 368640
    s_and_b32 s6, s6, 0xfffff
    s_cmp_lt_u32 s3, 4
    s_cbranch_scc0 W_415
    s_waitcnt vmcnt(3)
W_415:
    buffer_load_dwordx4 v[84:87], v1, s[12:15], s6 offen nt
    v_accvgpr_read_b32 v48, a188
    v_accvgpr_read_b32 v49, a189
    v_accvgpr_read_b32 v50, a190
    v_accvgpr_read_b32 v51, a191
    v_dot2c_f32_bf16_dpp v12, v32, v48 row_newbcast:15 row_mask:0xf bank_mask:0xf
    v_dot2c_f32_bf16_dpp v13, v54, v48 row_newbcast:15 row_mask:0xf bank_mask:0xf
    v_dot2c_f32_bf16_dpp v14, v32, v49 row_newbcast:15 row_mask:0xf bank_mask:0xf
    v_dot2c_f32_bf16_dpp v15, v54, v49 row_newbcast:15 row_mask:0xf bank_mask:0xf
    v_dot2c_f32_bf16_dpp v16, v32, v50 row_newbcast:15 row_mask:0xf bank_mask:0xf
    v_dot2c_f32_bf16_dpp v17, v54, v50 row_newbcast:15 row_mask:0xf bank_mask:0xf
    v_dot2c_f32_bf16_dpp v18, v32, v51 row_newbcast:15 row_mask:0xf bank_mask:0xf
    v_dot2c_f32_bf16_dpp v19, v54, v51 row_newbcast:15 row_mask:0xf bank_mask:0xf
    s_waitcnt vmcnt(11)
    v_dot2c_f32_bf16_dpp v12, v24, v104 row_newbcast:15 row_mask:0xf bank_mask:0xf
    v_dot2c_f32_bf16_dpp v13, v52, v104 row_newbcast:15 row_mask:0xf bank_mask:0xf
    v_dot2c_f32_bf16_dpp v14, v24, v105 row_newbcast:15 row_mask:0xf bank_mask:0xf
    v_dot2c_f32_bf16_dpp v15, v52, v105 row_newbcast:15 row_mask:0xf bank_mask:0xf
    v_dot2c_f32_bf16_dpp v16, v24, v106 row_newbcast:15 row_mask:0xf bank_mask:0xf
    v_dot2c_f32_bf16_dpp v17, v52, v106 row_newbcast:15 row_mask:0xf bank_mask:0xf
    v_dot2c_f32_bf16_dpp v18, v24, v107 row_newbcast:15 row_mask:0xf bank_mask:0xf
    v_dot2c_f32_bf16_dpp v19, v52, v107 row_newbcast:15 row_mask:0xf bank_mask:0xf
    s_add_u32 s6, s56, 372736
    s_and_b32 s6, s6, 0xfffff
    s_cmp_lt_u32 s3, 4
    s_cbranch_scc0 W_416
    s_waitcnt vmcnt(4)
W_416:
    buffer_load_dwordx4 v[88:91], v1, s[12:15], s6 offen nt
    v_lshlrev_b32 v54, 16, v33
    s_nop 1
    v_accvgpr_read_b32 v48, a192
    v_accvgpr_read_b32 v49, a193
    v_accvgpr_read_b32 v50, a194
    v_accvgpr_read_b32 v51, a195
    v_dot2c_f32_bf16_dpp v12, v33, v48 row_newbcast:0 row_mask:0xf bank_mask:0xf
    v_dot2c_f32_bf16_dpp v13, v54, v48 row_newbcast:0 row_mask:0xf bank_mask:0xf
    v_dot2c_f32_bf16_dpp v14, v33, v49 row_newbcast:0 row_mask:0xf bank_mask:0xf
    v_dot2c_f32_bf16_dpp v15, v54, v49 row_newbcast:0 row_mask:0xf bank_mask:0xf
    v_dot2c_f32_bf16_dpp v16, v33, v50 row_newbcast:0 row_mask:0xf bank_mask:0xf
    v_dot2c_f32_bf16_dpp v17, v54, v50 row_newbcast:0 row_mask:0xf bank_mask:0xf
    v_dot2c_f32_bf16_dpp v18, v33, v51 row_newbcast:0 row_mask:0xf bank_mask:0xf
    v_dot2c_f32_bf16_dpp v19, v54, v51 row_newbcast:0 row_mask:0xf bank_mask:0xf
    v_lshlrev_b32 v52, 16, v25
    s_nop 1
    s_waitcnt vmcnt(11)
    v_dot2c_f32_bf16_dpp v12, v25, v108 row_newbcast:0 row_mask:0xf bank_mask:0xf
    v_dot2c_f32_bf16_dpp v13, v52, v108 row_newbcast:0 row_mask:0xf bank_mask:0xf
    v_dot2c_f32_bf16_dpp v14, v25, v109 row_newbcast:0 row_mask:0xf bank_mask:0xf
    v_dot2c_f32_bf16_dpp v15, v52, v109 row_newbcast:0 row_mask:0xf bank_mask:0xf
    v_dot2c_f32_bf16_dpp v16, v25, v110 row_newbcast:0 row_mask:0xf bank_mask:0xf
    v_dot2c_f32_bf16_dpp v17, v52, v110 row_newbcast:0 row_mask:0xf bank_mask:0xf
    v_dot2c_f32_bf16_dpp v18, v25, v111 row_newbcast:0 row_mask:0xf bank_mask:0xf
    v_dot2c_f32_bf16_dpp v19, v52, v111 row_newbcast:0 row_mask:0xf bank_mask:0xf
    s_add_u32 s6, s56, 376832
    s_and_b32 s6, s6, 0xfffff
    s_cmp_lt_u32 s3, 4
    s_cbranch_scc0 W_417
    s_waitcnt vmcnt(3)
W_417:
    buffer_load_dwordx4 v[92:95], v1, s[12:15], s6 offen nt
    v_accvgpr_read_b32 v48, a196
    v_accvgpr_read_b32 v49, a197
    v_accvgpr_read_b32 v50, a198
    v_accvgpr_read_b32 v51, a199
    v_dot2c_f32_bf16_dpp v12, v33, v48 row_newbcast:1 row_mask:0xf bank_mask:0xf
    v_dot2c_f32_bf16_dpp v13, v54, v48 row_newbcast:1 row_mask:0xf bank_mask:0xf
    v_dot2c_f32_bf16_dpp v14, v33, v49 row_newbcast:1 row_mask:0xf bank_mask:0xf
    v_dot2c_f32_bf16_dpp v15, v54, v49 row_newbcast:1 row_mask:0xf bank_mask:0xf
    v_dot2c_f32_bf16_dpp v16, v33, v50 row_newbcast:1 row_mask:0xf bank_mask:0xf
    v_dot2c_f32_bf16_dpp v17, v54, v50 row_newbcast:1 row_mask:0xf bank_mask:0xf
    v_dot2c_f32_bf16_dpp v18, v33, v51 row_newbcast:1 row_mask:0xf bank_mask:0xf
    v_dot2c_f32_bf16_dpp v19, v54, v51 row_newbcast:1 row_mask:0xf bank_mask:0xf
    s_waitcnt vmcnt(11)
    v_dot2c_f32_bf16_dpp v12, v25, v112 row_newbcast:1 row_mask:0xf bank_mask:0xf
    v_dot2c_f32_bf16_dpp v13, v52, v112 row_newbcast:1 row_mask:0xf bank_mask:0xf
    v_dot2c_f32_bf16_dpp v14, v25, v113 row_newbcast:1 row_mask:0xf bank_mask:0xf
    v_dot2c_f32_bf16_dpp v15, v52, v113 row_newbcast:1 row_mask:0xf bank_mask:0xf
    v_dot2c_f32_bf16_dpp v16, v25, v114 row_newbcast:1 row_mask:0xf bank_mask:0xf
    v_dot2c_f32_bf16_dpp v17, v52, v114 row_newbcast:1 row_mask:0xf bank_mask:0xf
    v_dot2c_f32_bf16_dpp v18, v25, v115 row_newbcast:1 row_mask:0xf bank_mask:0xf
    v_dot2c_f32_bf16_dpp v19, v52, v115 row_newbcast:1 row_mask:0xf bank_mask:0xf
    s_add_u32 s6, s56, 380928
    s_and_b32 s6, s6, 0xfffff
    s_cmp_lt_u32 s3, 4
    s_cbranch_scc0 W_418
    s_waitcnt vmcnt(4)
W_418:
    buffer_load_dwordx4 v[96:99], v1, s[12:15], s6 offen nt
    v_accvgpr_read_b32 v48, a200
    v_accvgpr_read_b32 v49, a201
    v_accvgpr_read_b32 v50, a202
    v_accvgpr_read_b32 v51, a203
    v_dot2c_f32_bf16_dpp v12, v33, v48 row_newbcast:2 row_mask:0xf bank_mask:0xf
    v_dot2c_f32_bf16_dpp v13, v54, v48 row_newbcast:2 row_mask:0xf bank_mask:0xf
    v_dot2c_f32_bf16_dpp v14, v33, v49 row_newbcast:2 row_mask:0xf bank_mask:0xf
    v_dot2c_f32_bf16_dpp v15, v54, v49 row_newbcast:2 row_mask:0xf bank_mask:0xf
    v_dot2c_f32_bf16_dpp v16, v33, v50 row_newbcast:2 row_mask:0xf bank_mask:0xf
    v_dot2c_f32_bf16_dpp v17, v54, v50 row_newbcast:2 row_mask:0xf bank_mask:0xf
    v_dot2c_f32_bf16_dpp v18, v33, v51 row_newbcast:2 row_mask:0xf bank_mask:0xf
    v_dot2c_f32_bf16_dpp v19, v54, v51 row_newbcast:2 row_mask:0xf bank_mask:0xf
    s_waitcnt vmcnt(11)
    v_dot2c_f32_bf16_dpp v12, v25, v116 row_newbcast:2 row_mask:0xf bank_mask:0xf
    v_dot2c_f32_bf16_dpp v13, v52, v116 row_newbcast:2 row_mask:0xf bank_mask:0xf
    v_dot2c_f32_bf16_dpp v14, v25, v117 row_newbcast:2 row_mask:0xf bank_mask:0xf
    v_dot2c_f32_bf16_dpp v15, v52, v117 row_newbcast:2 row_mask:0xf bank_mask:0xf
    v_dot2c_f32_bf16_dpp v16, v25, v118 row_newbcast:2 row_mask:0xf bank_mask:0xf
    v_dot2c_f32_bf16_dpp v17, v52, v118 row_newbcast:2 row_mask:0xf bank_mask:0xf
    v_dot2c_f32_bf16_dpp v18, v25, v119 row_newbcast:2 row_mask:0xf bank_mask:0xf
    v_dot2c_f32_bf16_dpp v19, v52, v119 row_newbcast:2 row_mask:0xf bank_mask:0xf
    s_add_u32 s6, s56, 385024
    s_and_b32 s6, s6, 0xfffff
    s_cmp_lt_u32 s3, 4
    s_cbranch_scc0 W_419
    s_waitcnt vmcnt(3)
W_419:
    buffer_load_dwordx4 v[100:103], v1, s[12:15], s6 offen nt
    v_accvgpr_read_b32 v48, a204
    v_accvgpr_read_b32 v49, a205
    v_accvgpr_read_b32 v50, a206
    v_accvgpr_read_b32 v51, a207
    v_dot2c_f32_bf16_dpp v12, v33, v48 row_newbcast:3 row_mask:0xf bank_mask:0xf
    v_dot2c_f32_bf16_dpp v13, v54, v48 row_newbcast:3 row_mask:0xf bank_mask:0xf
    v_dot2c_f32_bf16_dpp v14, v33, v49 row_newbcast:3 row_mask:0xf bank_mask:0xf
    v_dot2c_f32_bf16_dpp v15, v54, v49 row_newbcast:3 row_mask:0xf bank_mask:0xf
    v_dot2c_f32_bf16_dpp v16, v33, v50 row_newbcast:3 row_mask:0xf bank_mask:0xf
    v_dot2c_f32_bf16_dpp v17, v54, v50 row_newbcast:3 row_mask:0xf bank_mask:0xf
    v_dot2c_f32_bf16_dpp v18, v33, v51 row_newbcast:3 row_mask:0xf bank_mask:0xf
    v_dot2c_f32_bf16_dpp v19, v54, v51 row_newbcast:3 row_mask:0xf bank_mask:0xf
    s_waitcnt vmcnt(11)
    v_dot2c_f32_bf16_dpp v12, v25, v120 row_newbcast:3 row_mask:0xf bank_mask:0xf
    v_dot2c_f32_bf16_dpp v13, v52, v120 row_newbcast:3 row_mask:0xf bank_mask:0xf
    v_dot2c_f32_bf16_dpp v14, v25, v121 row_newbcast:3 row_mask:0xf bank_mask:0xf
    v_dot2c_f32_bf16_dpp v15, v52, v121 row_newbcast:3 row_mask:0xf bank_mask:0xf
    v_dot2c_f32_bf16_dpp v16, v25, v122 row_newbcast:3 row_mask:0xf bank_mask:0xf
    v_dot2c_f32_bf16_dpp v17, v52, v122 row_newbcast:3 row_mask:0xf bank_mask:0xf
    v_dot2c_f32_bf16_dpp v18, v25, v123 row_newbcast:3 row_mask:0xf bank_mask:0xf
    v_dot2c_f32_bf16_dpp v19, v52, v123 row_newbcast:3 row_mask:0xf bank_mask:0xf
    s_add_u32 s6, s56, 389120
    s_and_b32 s6, s6, 0xfffff
    s_cmp_lt_u32 s3, 4
    s_cbranch_scc0 W_420
    s_waitcnt vmcnt(4)
W_420:
    buffer_load_dwordx4 v[104:107], v1, s[12:15], s6 offen nt
    v_accvgpr_read_b32 v48, a208
    v_accvgpr_read_b32 v49, a209
    v_accvgpr_read_b32 v50, a210
    v_accvgpr_read_b32 v51, a211
    v_dot2c_f32_bf16_dpp v12, v33, v48 row_newbcast:4 row_mask:0xf bank_mask:0xf
    v_dot2c_f32_bf16_dpp v13, v54, v48 row_newbcast:4 row_mask:0xf bank_mask:0xf
    v_dot2c_f32_bf16_dpp v14, v33, v49 row_newbcast:4 row_mask:0xf bank_mask:0xf
    v_dot2c_f32_bf16_dpp v15, v54, v49 row_newbcast:4 row_mask:0xf bank_mask:0xf
    v_dot2c_f32_bf16_dpp v16, v33, v50 row_newbcast:4 row_mask:0xf bank_mask:0xf
    v_dot2c_f32_bf16_dpp v17, v54, v50 row_newbcast:4 row_mask:0xf bank_mask:0xf
    v_dot2c_f32_bf16_dpp v18, v33, v51 row_newbcast:4 row_mask:0xf bank_mask:0xf
    v_dot2c_f32_bf16_dpp v19, v54, v51 row_newbcast:4 row_mask:0xf bank_mask:0xf
    v_accvgpr_read_b32 v48, a212
    v_accvgpr_read_b32 v49, a213
    v_accvgpr_read_b32 v50, a214
    v_accvgpr_read_b32 v51, a215
    v_dot2c_f32_bf16_dpp v12, v33, v48 row_newbcast:5 row_mask:0xf bank_mask:0xf
    v_dot2c_f32_bf16_dpp v13, v54, v48 row_newbcast:5 row_mask:0xf bank_mask:0xf
    v_dot2c_f32_bf16_dpp v14, v33, v49 row_newbcast:5 row_mask:0xf bank_mask:0xf
    v_dot2c_f32_bf16_dpp v15, v54, v49 row_newbcast:5 row_mask:0xf bank_mask:0xf
    v_dot2c_f32_bf16_dpp v16, v33, v50 row_newbcast:5 row_mask:0xf bank_mask:0xf
    v_dot2c_f32_bf16_dpp v17, v54, v50 row_newbcast:5 row_mask:0xf bank_mask:0xf
    v_dot2c_f32_bf16_dpp v18, v33, v51 row_newbcast:5 row_mask:0xf bank_mask:0xf
    v_dot2c_f32_bf16_dpp v19, v54, v51 row_newbcast:5 row_mask:0xf bank_mask:0xf
    s_waitcnt vmcnt(11)
    v_dot2c_f32_bf16_dpp v12, v25, v124 row_newbcast:4 row_mask:0xf bank_mask:0xf
    v_dot2c_f32_bf16_dpp v13, v52, v124 row_newbcast:4 row_mask:0xf bank_mask:0xf
    v_dot2c_f32_bf16_dpp v14, v25, v125 row_newbcast:4 row_mask:0xf bank_mask:0xf
    v_dot2c_f32_bf16_dpp v15, v52, v125 row_newbcast:4 row_mask:0xf bank_mask:0xf
    v_dot2c_f32_bf16_dpp v16, v25, v126 row_newbcast:4 row_mask:0xf bank_mask:0xf
    v_dot2c_f32_bf16_dpp v17, v52, v126 row_newbcast:4 row_mask:0xf bank_mask:0xf
    v_dot2c_f32_bf16_dpp v18, v25, v127 row_newbcast:4 row_mask:0xf bank_mask:0xf
    v_dot2c_f32_bf16_dpp v19, v52, v127 row_newbcast:4 row_mask:0xf bank_mask:0xf
    s_add_u32 s6, s56, 393216
    s_and_b32 s6, s6, 0xfffff
    s_cmp_lt_u32 s3, 4
    s_cbranch_scc0 W_421
    s_waitcnt vmcnt(3)
W_421:
    buffer_load_dwordx4 v[108:111], v1, s[12:15], s6 offen nt
    v_accvgpr_read_b32 v48, a216
    v_accvgpr_read_b32 v49, a217
    v_accvgpr_read_b32 v50, a218
    v_accvgpr_read_b32 v51, a219
    v_dot2c_f32_bf16_dpp v12, v33, v48 row_newbcast:6 row_mask:0xf bank_mask:0xf
    v_dot2c_f32_bf16_dpp v13, v54, v48 row_newbcast:6 row_mask:0xf bank_mask:0xf
    v_dot2c_f32_bf16_dpp v14, v33, v49 row_newbcast:6 row_mask:0xf bank_mask:0xf
    v_dot2c_f32_bf16_dpp v15, v54, v49 row_newbcast:6 row_mask:0xf bank_mask:0xf
    v_dot2c_f32_bf16_dpp v16, v33, v50 row_newbcast:6 row_mask:0xf bank_mask:0xf
    v_dot2c_f32_bf16_dpp v17, v54, v50 row_newbcast:6 row_mask:0xf bank_mask:0xf
    v_dot2c_f32_bf16_dpp v18, v33, v51 row_newbcast:6 row_mask:0xf bank_mask:0xf
    v_dot2c_f32_bf16_dpp v19, v54, v51 row_newbcast:6 row_mask:0xf bank_mask:0xf
    s_waitcnt vmcnt(11)
    v_dot2c_f32_bf16_dpp v12, v25, v64 row_newbcast:5 row_mask:0xf bank_mask:0xf
    v_dot2c_f32_bf16_dpp v13, v52, v64 row_newbcast:5 row_mask:0xf bank_mask:0xf
    v_dot2c_f32_bf16_dpp v14, v25, v65 row_newbcast:5 row_mask:0xf bank_mask:0xf
    v_dot2c_f32_bf16_dpp v15, v52, v65 row_newbcast:5 row_mask:0xf bank_mask:0xf
    v_dot2c_f32_bf16_dpp v16, v25, v66 row_newbcast:5 row_mask:0xf bank_mask:0xf
    v_dot2c_f32_bf16_dpp v17, v52, v66 row_newbcast:5 row_mask:0xf bank_mask:0xf
    v_dot2c_f32_bf16_dpp v18, v25, v67 row_newbcast:5 row_mask:0xf bank_mask:0xf
    v_dot2c_f32_bf16_dpp v19, v52, v67 row_newbcast:5 row_mask:0xf bank_mask:0xf
    s_add_u32 s6, s56, 397312
    s_and_b32 s6, s6, 0xfffff
    s_cmp_lt_u32 s3, 4
    s_cbranch_scc0 W_422
    s_waitcnt vmcnt(4)
W_422:
    buffer_load_dwordx4 v[112:115], v1, s[12:15], s6 offen nt
    v_accvgpr_read_b32 v48, a220
    v_accvgpr_read_b32 v49, a221
    v_accvgpr_read_b32 v50, a222
    v_accvgpr_read_b32 v51, a223
    v_dot2c_f32_bf16_dpp v12, v33, v48 row_newbcast:7 row_mask:0xf bank_mask:0xf
    v_dot2c_f32_bf16_dpp v13, v54, v48 row_newbcast:7 row_mask:0xf bank_mask:0xf
    v_dot2c_f32_bf16_dpp v14, v33, v49 row_newbcast:7 row_mask:0xf bank_mask:0xf
    v_dot2c_f32_bf16_dpp v15, v54, v49 row_newbcast:7 row_mask:0xf bank_mask:0xf
    v_dot2c_f32_bf16_dpp v16, v33, v50 row_newbcast:7 row_mask:0xf bank_mask:0xf
    v_dot2c_f32_bf16_dpp v17, v54, v50 row_newbcast:7 row_mask:0xf bank_mask:0xf
    v_dot2c_f32_bf16_dpp v18, v33, v51 row_newbcast:7 row_mask:0xf bank_mask:0xf
    v_dot2c_f32_bf16_dpp v19, v54, v51 row_newbcast:7 row_mask:0xf bank_mask:0xf
    s_waitcnt vmcnt(11)
    v_dot2c_f32_bf16_dpp v12, v25, v68 row_newbcast:6 row_mask:0xf bank_mask:0xf
    v_dot2c_f32_bf16_dpp v13, v52, v68 row_newbcast:6 row_mask:0xf bank_mask:0xf
    v_dot2c_f32_bf16_dpp v14, v25, v69 row_newbcast:6 row_mask:0xf bank_mask:0xf
    v_dot2c_f32_bf16_dpp v15, v52, v69 row_newbcast:6 row_mask:0xf bank_mask:0xf
    v_dot2c_f32_bf16_dpp v16, v25, v70 row_newbcast:6 row_mask:0xf bank_mask:0xf
    v_dot2c_f32_bf16_dpp v17, v52, v70 row_newbcast:6 row_mask:0xf bank_mask:0xf
    v_dot2c_f32_bf16_dpp v18, v25, v71 row_newbcast:6 row_mask:0xf bank_mask:0xf
    v_dot2c_f32_bf16_dpp v19, v52, v71 row_newbcast:6 row_mask:0xf bank_mask:0xf
    s_add_u32 s6, s56, 401408
    s_and_b32 s6, s6, 0xfffff
    s_cmp_lt_u32 s3, 4
    s_cbranch_scc0 W_423
    s_waitcnt vmcnt(3)
W_423:
    buffer_load_dwordx4 v[116:119], v1, s[12:15], s6 offen nt
    v_accvgpr_read_b32 v48, a224
    v_accvgpr_read_b32 v49, a225
    v_accvgpr_read_b32 v50, a226
    v_accvgpr_read_b32 v51, a227
    v_dot2c_f32_bf16_dpp v12, v33, v48 row_newbcast:8 row_mask:0xf bank_mask:0xf
    v_dot2c_f32_bf16_dpp v13, v54, v48 row_newbcast:8 row_mask:0xf bank_mask:0xf
    v_dot2c_f32_bf16_dpp v14, v33, v49 row_newbcast:8 row_mask:0xf bank_mask:0xf
    v_dot2c_f32_bf16_dpp v15, v54, v49 row_newbcast:8 row_mask:0xf bank_mask:0xf
    v_dot2c_f32_bf16_dpp v16, v33, v50 row_newbcast:8 row_mask:0xf bank_mask:0xf
    v_dot2c_f32_bf16_dpp v17, v54, v50 row_newbcast:8 row_mask:0xf bank_mask:0xf
    v_dot2c_f32_bf16_dpp v18, v33, v51 row_newbcast:8 row_mask:0xf bank_mask:0xf
    v_dot2c_f32_bf16_dpp v19, v54, v51 row_newbcast:8 row_mask:0xf bank_mask:0xf
    s_waitcnt vmcnt(11)
    v_dot2c_f32_bf16_dpp v12, v25, v72 row_newbcast:7 row_mask:0xf bank_mask:0xf
    v_dot2c_f32_bf16_dpp v13, v52, v72 row_newbcast:7 row_mask:0xf bank_mask:0xf
    v_dot2c_f32_bf16_dpp v14, v25, v73 row_newbcast:7 row_mask:0xf bank_mask:0xf
    v_dot2c_f32_bf16_dpp v15, v52, v73 row_newbcast:7 row_mask:0xf bank_mask:0xf
    v_dot2c_f32_bf16_dpp v16, v25, v74 row_newbcast:7 row_mask:0xf bank_mask:0xf
    v_dot2c_f32_bf16_dpp v17, v52, v74 row_newbcast:7 row_mask:0xf bank_mask:0xf
    v_dot2c_f32_bf16_dpp v18, v25, v75 row_newbcast:7 row_mask:0xf bank_mask:0xf
    v_dot2c_f32_bf16_dpp v19, v52, v75 row_newbcast:7 row_mask:0xf bank_mask:0xf
    s_add_u32 s6, s56, 405504
    s_and_b32 s6, s6, 0xfffff
    s_cmp_lt_u32 s3, 4
    s_cbranch_scc0 W_424
    s_waitcnt vmcnt(4)
W_424:
    buffer_load_dwordx4 v[120:123], v1, s[12:15], s6 offen nt
    v_accvgpr_read_b32 v48, a228
    v_accvgpr_read_b32 v49, a229
    v_accvgpr_read_b32 v50, a230
    v_accvgpr_read_b32 v51, a231
    v_dot2c_f32_bf16_dpp v12, v33, v48 row_newbcast:9 row_mask:0xf bank_mask:0xf
    v_dot2c_f32_bf16_dpp v13, v54, v48 row_newbcast:9 row_mask:0xf bank_mask:0xf
    v_dot2c_f32_bf16_dpp v14, v33, v49 row_newbcast:9 row_mask:0xf bank_mask:0xf
    v_dot2c_f32_bf16_dpp v15, v54, v49 row_newbcast:9 row_mask:0xf bank_mask:0xf
    v_dot2c_f32_bf16_dpp v16, v33, v50 row_newbcast:9 row_mask:0xf bank_mask:0xf
    v_dot2c_f32_bf16_dpp v17, v54, v50 row_newbcast:9 row_mask:0xf bank_mask:0xf
    v_dot2c_f32_bf16_dpp v18, v33, v51 row_newbcast:9 row_mask:0xf bank_mask:0xf
    v_dot2c_f32_bf16_dpp v19, v54, v51 row_newbcast:9 row_mask:0xf bank_mask:0xf
    s_waitcnt vmcnt(11)
    v_dot2c_f32_bf16_dpp v12, v25, v76 row_newbcast:8 row_mask:0xf bank_mask:0xf
    v_dot2c_f32_bf16_dpp v13, v52, v76 row_newbcast:8 row_mask:0xf bank_mask:0xf
    v_dot2c_f32_bf16_dpp v14, v25, v77 row_newbcast:8 row_mask:0xf bank_mask:0xf
    v_dot2c_f32_bf16_dpp v15, v52, v77 row_newbcast:8 row_mask:0xf bank_mask:0xf
    v_dot2c_f32_bf16_dpp v16, v25, v78 row_newbcast:8 row_mask:0xf bank_mask:0xf
    v_dot2c_f32_bf16_dpp v17, v52, v78 row_newbcast:8 row_mask:0xf bank_mask:0xf
    v_dot2c_f32_bf16_dpp v18, v25, v79 row_newbcast:8 row_mask:0xf bank_mask:0xf
    v_dot2c_f32_bf16_dpp v19, v52, v79 row_newbcast:8 row_mask:0xf bank_mask:0xf
    s_add_u32 s6, s56, 409600
    s_and_b32 s6, s6, 0xfffff
    s_cmp_lt_u32 s3, 4
    s_cbranch_scc0 W_425
    s_waitcnt vmcnt(3)
W_425:
    buffer_load_dwordx4 v[124:127], v1, s[12:15], s6 offen nt
    v_accvgpr_read_b32 v48, a232
    v_accvgpr_read_b32 v49, a233
    v_accvgpr_read_b32 v50, a234
    v_accvgpr_read_b32 v51, a235
    v_dot2c_f32_bf16_dpp v12, v33, v48 row_newbcast:10 row_mask:0xf bank_mask:0xf
    v_dot2c_f32_bf16_dpp v13, v54, v48 row_newbcast:10 row_mask:0xf bank_mask:0xf
    v_dot2c_f32_bf16_dpp v14, v33, v49 row_newbcast:10 row_mask:0xf bank_mask:0xf
    v_dot2c_f32_bf16_dpp v15, v54, v49 row_newbcast:10 row_mask:0xf bank_mask:0xf
    v_dot2c_f32_bf16_dpp v16, v33, v50 row_newbcast:10 row_mask:0xf bank_mask:0xf
    v_dot2c_f32_bf16_dpp v17, v54, v50 row_newbcast:10 row_mask:0xf bank_mask:0xf
    v_dot2c_f32_bf16_dpp v18, v33, v51 row_newbcast:10 row_mask:0xf bank_mask:0xf
    v_dot2c_f32_bf16_dpp v19, v54, v51 row_newbcast:10 row_mask:0xf bank_mask:0xf
    s_waitcnt vmcnt(11)
    v_dot2c_f32_bf16_dpp v12, v25, v80 row_newbcast:9 row_mask:0xf bank_mask:0xf
    v_dot2c_f32_bf16_dpp v13, v52, v80 row_newbcast:9 row_mask:0xf bank_mask:0xf
    v_dot2c_f32_bf16_dpp v14, v25, v81 row_newbcast:9 row_mask:0xf bank_mask:0xf
    v_dot2c_f32_bf16_dpp v15, v52, v81 row_newbcast:9 row_mask:0xf bank_mask:0xf
    v_dot2c_f32_bf16_dpp v16, v25, v82 row_newbcast:9 row_mask:0xf bank_mask:0xf
    v_dot2c_f32_bf16_dpp v17, v52, v82 row_newbcast:9 row_mask:0xf bank_mask:0xf
    v_dot2c_f32_bf16_dpp v18, v25, v83 row_newbcast:9 row_mask:0xf bank_mask:0xf
    v_dot2c_f32_bf16_dpp v19, v52, v83 row_newbcast:9 row_mask:0xf bank_mask:0xf
    s_add_u32 s6, s56, 413696
    s_and_b32 s6, s6, 0xfffff
    s_cmp_lt_u32 s3, 4
    s_cbranch_scc0 W_426
    s_waitcnt vmcnt(4)
W_426:
    buffer_load_dwordx4 v[64:67], v1, s[12:15], s6 offen nt
    v_accvgpr_read_b32 v48, a236
    v_accvgpr_read_b32 v49, a237
    v_accvgpr_read_b32 v50, a238
    v_accvgpr_read_b32 v51, a239
    v_dot2c_f32_bf16_dpp v12, v33, v48 row_newbcast:11 row_mask:0xf bank_mask:0xf
    v_dot2c_f32_bf16_dpp v13, v54, v48 row_newbcast:11 row_mask:0xf bank_mask:0xf
    v_dot2c_f32_bf16_dpp v14, v33, v49 row_newbcast:11 row_mask:0xf bank_mask:0xf
    v_dot2c_f32_bf16_dpp v15, v54, v49 row_newbcast:11 row_mask:0xf bank_mask:0xf
    v_dot2c_f32_bf16_dpp v16, v33, v50 row_newbcast:11 row_mask:0xf bank_mask:0xf
    v_dot2c_f32_bf16_dpp v17, v54, v50 row_newbcast:11 row_mask:0xf bank_mask:0xf
    v_dot2c_f32_bf16_dpp v18, v33, v51 row_newbcast:11 row_mask:0xf bank_mask:0xf
    v_dot2c_f32_bf16_dpp v19, v54, v51 row_newbcast:11 row_mask:0xf bank_mask:0xf
    s_waitcnt vmcnt(11)
    v_dot2c_f32_bf16_dpp v12, v25, v84 row_newbcast:10 row_mask:0xf bank_mask:0xf
    v_dot2c_f32_bf16_dpp v13, v52, v84 row_newbcast:10 row_mask:0xf bank_mask:0xf
    v_dot2c_f32_bf16_dpp v14, v25, v85 row_newbcast:10 row_mask:0xf bank_mask:0xf
    v_dot2c_f32_bf16_dpp v15, v52, v85 row_newbcast:10 row_mask:0xf bank_mask:0xf
    v_dot2c_f32_bf16_dpp v16, v25, v86 row_newbcast:10 row_mask:0xf bank_mask:0xf
    v_dot2c_f32_bf16_dpp v17, v52, v86 row_newbcast:10 row_mask:0xf bank_mask:0xf
    v_dot2c_f32_bf16_dpp v18, v25, v87 row_newbcast:10 row_mask:0xf bank_mask:0xf
    v_dot2c_f32_bf16_dpp v19, v52, v87 row_newbcast:10 row_mask:0xf bank_mask:0xf
    s_add_u32 s6, s56, 417792
    s_and_b32 s6, s6, 0xfffff
    s_cmp_lt_u32 s3, 4
    s_cbranch_scc0 W_427
    s_waitcnt vmcnt(3)
W_427:
    buffer_load_dwordx4 v[68:71], v1, s[12:15], s6 offen nt
    v_accvgpr_read_b32 v48, a240
    v_accvgpr_read_b32 v49, a241
    v_accvgpr_read_b32 v50, a242
    v_accvgpr_read_b32 v51, a243
    v_dot2c_f32_bf16_dpp v12, v33, v48 row_newbcast:12 row_mask:0xf bank_mask:0xf
    v_dot2c_f32_bf16_dpp v13, v54, v48 row_newbcast:12 row_mask:0xf bank_mask:0xf
    v_dot2c_f32_bf16_dpp v14, v33, v49 row_newbcast:12 row_mask:0xf bank_mask:0xf
    v_dot2c_f32_bf16_dpp v15, v54, v49 row_newbcast:12 row_mask:0xf bank_mask:0xf
    v_dot2c_f32_bf16_dpp v16, v33, v50 row_newbcast:12 row_mask:0xf bank_mask:0xf
    v_dot2c_f32_bf16_dpp v17, v54, v50 row_newbcast:12 row_mask:0xf bank_mask:0xf
    v_dot2c_f32_bf16_dpp v18, v33, v51 row_newbcast:12 row_mask:0xf bank_mask:0xf
    v_dot2c_f32_bf16_dpp v19, v54, v51 row_newbcast:12 row_mask:0xf bank_mask:0xf
    s_waitcnt vmcnt(11)
    v_dot2c_f32_bf16_dpp v12, v25, v88 row_newbcast:11 row_mask:0xf bank_mask:0xf
    v_dot2c_f32_bf16_dpp v13, v52, v88 row_newbcast:11 row_mask:0xf bank_mask:0xf
    v_dot2c_f32_bf16_dpp v14, v25, v89 row_newbcast:11 row_mask:0xf bank_mask:0xf
    v_dot2c_f32_bf16_dpp v15, v52, v89 row_newbcast:11 row_mask:0xf bank_mask:0xf
    v_dot2c_f32_bf16_dpp v16, v25, v90 row_newbcast:11 row_mask:0xf bank_mask:0xf
    v_dot2c_f32_bf16_dpp v17, v52, v90 row_newbcast:11 row_mask:0xf bank_mask:0xf
    v_dot2c_f32_bf16_dpp v18, v25, v91 row_newbcast:11 row_mask:0xf bank_mask:0xf
    v_dot2c_f32_bf16_dpp v19, v52, v91 row_newbcast:11 row_mask:0xf bank_mask:0xf
    s_add_u32 s6, s56, 421888
    s_and_b32 s6, s6, 0xfffff
    s_cmp_lt_u32 s3, 4
    s_cbranch_scc0 W_428
    s_waitcnt vmcnt(4)
W_428:
    buffer_load_dwordx4 v[72:75], v1, s[12:15], s6 offen nt
    v_accvgpr_read_b32 v48, a244
    v_accvgpr_read_b32 v49, a245
    v_accvgpr_read_b32 v50, a246
    v_accvgpr_read_b32 v51, a247
    v_dot2c_f32_bf16_dpp v12, v33, v48 row_newbcast:13 row_mask:0xf bank_mask:0xf
    v_dot2c_f32_bf16_dpp v13, v54, v48 row_newbcast:13 row_mask:0xf bank_mask:0xf
    v_dot2c_f32_bf16_dpp v14, v33, v49 row_newbcast:13 row_mask:0xf bank_mask:0xf
    v_dot2c_f32_bf16_dpp v15, v54, v49 row_newbcast:13 row_mask:0xf bank_mask:0xf
    v_dot2c_f32_bf16_dpp v16, v33, v50 row_newbcast:13 row_mask:0xf bank_mask:0xf
    v_dot2c_f32_bf16_dpp v17, v54, v50 row_newbcast:13 row_mask:0xf bank_mask:0xf
    v_dot2c_f32_bf16_dpp v18, v33, v51 row_newbcast:13 row_mask:0xf bank_mask:0xf
    v_dot2c_f32_bf16_dpp v19, v54, v51 row_newbcast:13 row_mask:0xf bank_mask:0xf
    s_waitcnt vmcnt(11)
    v_dot2c_f32_bf16_dpp v12, v25, v92 row_newbcast:12 row_mask:0xf bank_mask:0xf
    v_dot2c_f32_bf16_dpp v13, v52, v92 row_newbcast:12 row_mask:0xf bank_mask:0xf
    v_dot2c_f32_bf16_dpp v14, v25, v93 row_newbcast:12 row_mask:0xf bank_mask:0xf
    v_dot2c_f32_bf16_dpp v15, v52, v93 row_newbcast:12 row_mask:0xf bank_mask:0xf
    v_dot2c_f32_bf16_dpp v16, v25, v94 row_newbcast:12 row_mask:0xf bank_mask:0xf
    v_dot2c_f32_bf16_dpp v17, v52, v94 row_newbcast:12 row_mask:0xf bank_mask:0xf
    v_dot2c_f32_bf16_dpp v18, v25, v95 row_newbcast:12 row_mask:0xf bank_mask:0xf
    v_dot2c_f32_bf16_dpp v19, v52, v95 row_newbcast:12 row_mask:0xf bank_mask:0xf
    s_add_u32 s6, s56, 425984
    s_and_b32 s6, s6, 0xfffff
    s_cmp_lt_u32 s3, 4
    s_cbranch_scc0 W_429
    s_waitcnt vmcnt(3)
W_429:
    buffer_load_dwordx4 v[76:79], v1, s[12:15], s6 offen nt
    v_accvgpr_read_b32 v48, a248
    v_accvgpr_read_b32 v49, a249
    v_accvgpr_read_b32 v50, a250
    v_accvgpr_read_b32 v51, a251
    v_dot2c_f32_bf16_dpp v12, v33, v48 row_newbcast:14 row_mask:0xf bank_mask:0xf
    v_dot2c_f32_bf16_dpp v13, v54, v48 row_newbcast:14 row_mask:0xf bank_mask:0xf
    v_dot2c_f32_bf16_dpp v14, v33, v49 row_newbcast:14 row_mask:0xf bank_mask:0xf
    v_dot2c_f32_bf16_dpp v15, v54, v49 row_newbcast:14 row_mask:0xf bank_mask:0xf
    v_dot2c_f32_bf16_dpp v16, v33, v50 row_newbcast:14 row_mask:0xf bank_mask:0xf
    v_dot2c_f32_bf16_dpp v17, v54, v50 row_newbcast:14 row_mask:0xf bank_mask:0xf
    v_dot2c_f32_bf16_dpp v18, v33, v51 row_newbcast:14 row_mask:0xf bank_mask:0xf
    v_dot2c_f32_bf16_dpp v19, v54, v51 row_newbcast:14 row_mask:0xf bank_mask:0xf
    s_waitcnt vmcnt(11)
    v_dot2c_f32_bf16_dpp v12, v25, v96 row_newbcast:13 row_mask:0xf bank_mask:0xf
    v_dot2c_f32_bf16_dpp v13, v52, v96 row_newbcast:13 row_mask:0xf bank_mask:0xf
    v_dot2c_f32_bf16_dpp v14, v25, v97 row_newbcast:13 row_mask:0xf bank_mask:0xf
    v_dot2c_f32_bf16_dpp v15, v52, v97 row_newbcast:13 row_mask:0xf bank_mask:0xf
    v_dot2c_f32_bf16_dpp v16, v25, v98 row_newbcast:13 row_mask:0xf bank_mask:0xf
    v_dot2c_f32_bf16_dpp v17, v52, v98 row_newbcast:13 row_mask:0xf bank_mask:0xf
    v_dot2c_f32_bf16_dpp v18, v25, v99 row_newbcast:13 row_mask:0xf bank_mask:0xf
    v_dot2c_f32_bf16_dpp v19, v52, v99 row_newbcast:13 row_mask:0xf bank_mask:0xf
    s_add_u32 s6, s56, 430080
    s_and_b32 s6, s6, 0xfffff
    buffer_load_dwordx4 v[80:83], v1, s[12:15], s6 offen nt
    v_accvgpr_read_b32 v48, a252
    v_accvgpr_read_b32 v49, a253
    v_accvgpr_read_b32 v50, a254
    v_accvgpr_read_b32 v51, a255
    v_dot2c_f32_bf16_dpp v12, v33, v48 row_newbcast:15 row_mask:0xf bank_mask:0xf
    v_dot2c_f32_bf16_dpp v13, v54, v48 row_newbcast:15 row_mask:0xf bank_mask:0xf
    v_dot2c_f32_bf16_dpp v14, v33, v49 row_newbcast:15 row_mask:0xf bank_mask:0xf
    v_dot2c_f32_bf16_dpp v15, v54, v49 row_newbcast:15 row_mask:0xf bank_mask:0xf
    v_dot2c_f32_bf16_dpp v16, v33, v50 row_newbcast:15 row_mask:0xf bank_mask:0xf
    v_dot2c_f32_bf16_dpp v17, v54, v50 row_newbcast:15 row_mask:0xf bank_mask:0xf
    v_dot2c_f32_bf16_dpp v18, v33, v51 row_newbcast:15 row_mask:0xf bank_mask:0xf
    v_dot2c_f32_bf16_dpp v19, v54, v51 row_newbcast:15 row_mask:0xf bank_mask:0xf
    s_waitcnt vmcnt(11)
    v_dot2c_f32_bf16_dpp v12, v25, v100 row_newbcast:14 row_mask:0xf bank_mask:0xf
    v_dot2c_f32_bf16_dpp v13, v52, v100 row_newbcast:14 row_mask:0xf bank_mask:0xf
    v_dot2c_f32_bf16_dpp v14, v25, v101 row_newbcast:14 row_mask:0xf bank_mask:0xf
    v_dot2c_f32_bf16_dpp v15, v52, v101 row_newbcast:14 row_mask:0xf bank_mask:0xf
    v_dot2c_f32_bf16_dpp v16, v25, v102 row_newbcast:14 row_mask:0xf bank_mask:0xf
    v_dot2c_f32_bf16_dpp v17, v52, v102 row_newbcast:14 row_mask:0xf bank_mask:0xf
    v_dot2c_f32_bf16_dpp v18, v25, v103 row_newbcast:14 row_mask:0xf bank_mask:0xf
    v_dot2c_f32_bf16_dpp v19, v52, v103 row_newbcast:14 row_mask:0xf bank_mask:0xf
    s_add_u32 s6, s56, 434176
    s_and_b32 s6, s6, 0xfffff
    buffer_load_dwordx4 v[84:87], v1, s[12:15], s6 offen nt
    v_lshlrev_b32 v54, 16, v34
    s_nop 1
    v_dot2c_f32_bf16_dpp v12, v34, v128 row_newbcast:0 row_mask:0xf bank_mask:0xf
    v_dot2c_f32_bf16_dpp v13, v54, v128 row_newbcast:0 row_mask:0xf bank_mask:0xf
    v_dot2c_f32_bf16_dpp v14, v34, v129 row_newbcast:0 row_mask:0xf bank_mask:0xf
    v_dot2c_f32_bf16_dpp v15, v54, v129 row_newbcast:0 row_mask:0xf bank_mask:0xf
    v_dot2c_f32_bf16_dpp v16, v34, v130 row_newbcast:0 row_mask:0xf bank_mask:0xf
    v_dot2c_f32_bf16_dpp v17, v54, v130 row_newbcast:0 row_mask:0xf bank_mask:0xf
    v_dot2c_f32_bf16_dpp v18, v34, v131 row_newbcast:0 row_mask:0xf bank_mask:0xf
    v_dot2c_f32_bf16_dpp v19, v54, v131 row_newbcast:0 row_mask:0xf bank_mask:0xf
    s_waitcnt vmcnt(11)
    v_dot2c_f32_bf16_dpp v12, v25, v104 row_newbcast:15 row_mask:0xf bank_mask:0xf
    v_dot2c_f32_bf16_dpp v13, v52, v104 row_newbcast:15 row_mask:0xf bank_mask:0xf
    v_dot2c_f32_bf16_dpp v14, v25, v105 row_newbcast:15 row_mask:0xf bank_mask:0xf
    v_dot2c_f32_bf16_dpp v15, v52, v105 row_newbcast:15 row_mask:0xf bank_mask:0xf
    v_dot2c_f32_bf16_dpp v16, v25, v106 row_newbcast:15 row_mask:0xf bank_mask:0xf
    v_dot2c_f32_bf16_dpp v17, v52, v106 row_newbcast:15 row_mask:0xf bank_mask:0xf
    v_dot2c_f32_bf16_dpp v18, v25, v107 row_newbcast:15 row_mask:0xf bank_mask:0xf
    v_dot2c_f32_bf16_dpp v19, v52, v107 row_newbcast:15 row_mask:0xf bank_mask:0xf
    s_add_u32 s6, s56, 438272
    s_and_b32 s6, s6, 0xfffff
    buffer_load_dwordx4 v[88:91], v1, s[12:15], s6 offen nt
    v_dot2c_f32_bf16_dpp v12, v34, v132 row_newbcast:1 row_mask:0xf bank_mask:0xf
    v_dot2c_f32_bf16_dpp v13, v54, v132 row_newbcast:1 row_mask:0xf bank_mask:0xf
    v_dot2c_f32_bf16_dpp v14, v34, v133 row_newbcast:1 row_mask:0xf bank_mask:0xf
    v_dot2c_f32_bf16_dpp v15, v54, v133 row_newbcast:1 row_mask:0xf bank_mask:0xf
    v_dot2c_f32_bf16_dpp v16, v34, v134 row_newbcast:1 row_mask:0xf bank_mask:0xf
    v_dot2c_f32_bf16_dpp v17, v54, v134 row_newbcast:1 row_mask:0xf bank_mask:0xf
    v_dot2c_f32_bf16_dpp v18, v34, v135 row_newbcast:1 row_mask:0xf bank_mask:0xf
    v_dot2c_f32_bf16_dpp v19, v54, v135 row_newbcast:1 row_mask:0xf bank_mask:0xf
    v_lshlrev_b32 v52, 16, v26
    s_nop 1
    s_waitcnt vmcnt(11)
    v_dot2c_f32_bf16_dpp v12, v26, v108 row_newbcast:0 row_mask:0xf bank_mask:0xf
    v_dot2c_f32_bf16_dpp v13, v52, v108 row_newbcast:0 row_mask:0xf bank_mask:0xf
    v_dot2c_f32_bf16_dpp v14, v26, v109 row_newbcast:0 row_mask:0xf bank_mask:0xf
    v_dot2c_f32_bf16_dpp v15, v52, v109 row_newbcast:0 row_mask:0xf bank_mask:0xf
    v_dot2c_f32_bf16_dpp v16, v26, v110 row_newbcast:0 row_mask:0xf bank_mask:0xf
    v_dot2c_f32_bf16_dpp v17, v52, v110 row_newbcast:0 row_mask:0xf bank_mask:0xf
    v_dot2c_f32_bf16_dpp v18, v26, v111 row_newbcast:0 row_mask:0xf bank_mask:0xf
    v_dot2c_f32_bf16_dpp v19, v52, v111 row_newbcast:0 row_mask:0xf bank_mask:0xf
    s_add_u32 s6, s56, 442368
    s_and_b32 s6, s6, 0xfffff
    buffer_load_dwordx4 v[92:95], v1, s[12:15], s6 offen nt
    v_dot2c_f32_bf16_dpp v12, v34, v136 row_newbcast:2 row_mask:0xf bank_mask:0xf
    v_dot2c_f32_bf16_dpp v13, v54, v136 row_newbcast:2 row_mask:0xf bank_mask:0xf
    v_dot2c_f32_bf16_dpp v14, v34, v137 row_newbcast:2 row_mask:0xf bank_mask:0xf
    v_dot2c_f32_bf16_dpp v15, v54, v137 row_newbcast:2 row_mask:0xf bank_mask:0xf
    v_dot2c_f32_bf16_dpp v16, v34, v138 row_newbcast:2 row_mask:0xf bank_mask:0xf
    v_dot2c_f32_bf16_dpp v17, v54, v138 row_newbcast:2 row_mask:0xf bank_mask:0xf
    v_dot2c_f32_bf16_dpp v18, v34, v139 row_newbcast:2 row_mask:0xf bank_mask:0xf
    v_dot2c_f32_bf16_dpp v19, v54, v139 row_newbcast:2 row_mask:0xf bank_mask:0xf
    s_waitcnt vmcnt(11)
    v_dot2c_f32_bf16_dpp v12, v26, v112 row_newbcast:1 row_mask:0xf bank_mask:0xf
    v_dot2c_f32_bf16_dpp v13, v52, v112 row_newbcast:1 row_mask:0xf bank_mask:0xf
    v_dot2c_f32_bf16_dpp v14, v26, v113 row_newbcast:1 row_mask:0xf bank_mask:0xf
    v_dot2c_f32_bf16_dpp v15, v52, v113 row_newbcast:1 row_mask:0xf bank_mask:0xf
    v_dot2c_f32_bf16_dpp v16, v26, v114 row_newbcast:1 row_mask:0xf bank_mask:0xf
    v_dot2c_f32_bf16_dpp v17, v52, v114 row_newbcast:1 row_mask:0xf bank_mask:0xf
    v_dot2c_f32_bf16_dpp v18, v26, v115 row_newbcast:1 row_mask:0xf bank_mask:0xf
    v_dot2c_f32_bf16_dpp v19, v52, v115 row_newbcast:1 row_mask:0xf bank_mask:0xf
    s_add_u32 s6, s56, 446464
    s_and_b32 s6, s6, 0xfffff
    buffer_load_dwordx4 v[96:99], v1, s[12:15], s6 offen nt
    v_dot2c_f32_bf16_dpp v12, v34, v140 row_newbcast:3 row_mask:0xf bank_mask:0xf
    v_dot2c_f32_bf16_dpp v13, v54, v140 row_newbcast:3 row_mask:0xf bank_mask:0xf
    v_dot2c_f32_bf16_dpp v14, v34, v141 row_newbcast:3 row_mask:0xf bank_mask:0xf
    v_dot2c_f32_bf16_dpp v15, v54, v141 row_newbcast:3 row_mask:0xf bank_mask:0xf
    v_dot2c_f32_bf16_dpp v16, v34, v142 row_newbcast:3 row_mask:0xf bank_mask:0xf
    v_dot2c_f32_bf16_dpp v17, v54, v142 row_newbcast:3 row_mask:0xf bank_mask:0xf
    v_dot2c_f32_bf16_dpp v18, v34, v143 row_newbcast:3 row_mask:0xf bank_mask:0xf
    v_dot2c_f32_bf16_dpp v19, v54, v143 row_newbcast:3 row_mask:0xf bank_mask:0xf
    s_waitcnt vmcnt(11)
    v_dot2c_f32_bf16_dpp v12, v26, v116 row_newbcast:2 row_mask:0xf bank_mask:0xf
    v_dot2c_f32_bf16_dpp v13, v52, v116 row_newbcast:2 row_mask:0xf bank_mask:0xf
    v_dot2c_f32_bf16_dpp v14, v26, v117 row_newbcast:2 row_mask:0xf bank_mask:0xf
    v_dot2c_f32_bf16_dpp v15, v52, v117 row_newbcast:2 row_mask:0xf bank_mask:0xf
    v_dot2c_f32_bf16_dpp v16, v26, v118 row_newbcast:2 row_mask:0xf bank_mask:0xf
    v_dot2c_f32_bf16_dpp v17, v52, v118 row_newbcast:2 row_mask:0xf bank_mask:0xf
    v_dot2c_f32_bf16_dpp v18, v26, v119 row_newbcast:2 row_mask:0xf bank_mask:0xf
    v_dot2c_f32_bf16_dpp v19, v52, v119 row_newbcast:2 row_mask:0xf bank_mask:0xf
    s_add_u32 s6, s56, 450560
    s_and_b32 s6, s6, 0xfffff
    buffer_load_dwordx4 v[100:103], v1, s[12:15], s6 offen nt
    v_dot2c_f32_bf16_dpp v12, v34, v144 row_newbcast:4 row_mask:0xf bank_mask:0xf
    v_dot2c_f32_bf16_dpp v13, v54, v144 row_newbcast:4 row_mask:0xf bank_mask:0xf
    v_dot2c_f32_bf16_dpp v14, v34, v145 row_newbcast:4 row_mask:0xf bank_mask:0xf
    v_dot2c_f32_bf16_dpp v15, v54, v145 row_newbcast:4 row_mask:0xf bank_mask:0xf
    v_dot2c_f32_bf16_dpp v16, v34, v146 row_newbcast:4 row_mask:0xf bank_mask:0xf
    v_dot2c_f32_bf16_dpp v17, v54, v146 row_newbcast:4 row_mask:0xf bank_mask:0xf
    v_dot2c_f32_bf16_dpp v18, v34, v147 row_newbcast:4 row_mask:0xf bank_mask:0xf
    v_dot2c_f32_bf16_dpp v19, v54, v147 row_newbcast:4 row_mask:0xf bank_mask:0xf
    s_waitcnt vmcnt(11)
    v_dot2c_f32_bf16_dpp v12, v26, v120 row_newbcast:3 row_mask:0xf bank_mask:0xf
    v_dot2c_f32_bf16_dpp v13, v52, v120 row_newbcast:3 row_mask:0xf bank_mask:0xf
    v_dot2c_f32_bf16_dpp v14, v26, v121 row_newbcast:3 row_mask:0xf bank_mask:0xf
    v_dot2c_f32_bf16_dpp v15, v52, v121 row_newbcast:3 row_mask:0xf bank_mask:0xf
    v_dot2c_f32_bf16_dpp v16, v26, v122 row_newbcast:3 row_mask:0xf bank_mask:0xf
    v_dot2c_f32_bf16_dpp v17, v52, v122 row_newbcast:3 row_mask:0xf bank_mask:0xf
    v_dot2c_f32_bf16_dpp v18, v26, v123 row_newbcast:3 row_mask:0xf bank_mask:0xf
    v_dot2c_f32_bf16_dpp v19, v52, v123 row_newbcast:3 row_mask:0xf bank_mask:0xf
    s_add_u32 s6, s56, 454656
    s_and_b32 s6, s6, 0xfffff
    buffer_load_dwordx4 v[104:107], v1, s[12:15], s6 offen nt
    v_dot2c_f32_bf16_dpp v12, v34, v148 row_newbcast:5 row_mask:0xf bank_mask:0xf
    v_dot2c_f32_bf16_dpp v13, v54, v148 row_newbcast:5 row_mask:0xf bank_mask:0xf
    v_dot2c_f32_bf16_dpp v14, v34, v149 row_newbcast:5 row_mask:0xf bank_mask:0xf
    v_dot2c_f32_bf16_dpp v15, v54, v149 row_newbcast:5 row_mask:0xf bank_mask:0xf
    v_dot2c_f32_bf16_dpp v16, v34, v150 row_newbcast:5 row_mask:0xf bank_mask:0xf
    v_dot2c_f32_bf16_dpp v17, v54, v150 row_newbcast:5 row_mask:0xf bank_mask:0xf
    v_dot2c_f32_bf16_dpp v18, v34, v151 row_newbcast:5 row_mask:0xf bank_mask:0xf
    v_dot2c_f32_bf16_dpp v19, v54, v151 row_newbcast:5 row_mask:0xf bank_mask:0xf
    s_waitcnt vmcnt(11)
    v_dot2c_f32_bf16_dpp v12, v26, v124 row_newbcast:4 row_mask:0xf bank_mask:0xf
    v_dot2c_f32_bf16_dpp v13, v52, v124 row_newbcast:4 row_mask:0xf bank_mask:0xf
    v_dot2c_f32_bf16_dpp v14, v26, v125 row_newbcast:4 row_mask:0xf bank_mask:0xf
    v_dot2c_f32_bf16_dpp v15, v52, v125 row_newbcast:4 row_mask:0xf bank_mask:0xf
    v_dot2c_f32_bf16_dpp v16, v26, v126 row_newbcast:4 row_mask:0xf bank_mask:0xf
    v_dot2c_f32_bf16_dpp v17, v52, v126 row_newbcast:4 row_mask:0xf bank_mask:0xf
    v_dot2c_f32_bf16_dpp v18, v26, v127 row_newbcast:4 row_mask:0xf bank_mask:0xf
    v_dot2c_f32_bf16_dpp v19, v52, v127 row_newbcast:4 row_mask:0xf bank_mask:0xf
    s_add_u32 s6, s56, 458752
    s_and_b32 s6, s6, 0xfffff
    buffer_load_dwordx4 v[108:111], v1, s[12:15], s6 offen nt
    v_dot2c_f32_bf16_dpp v12, v34, v152 row_newbcast:6 row_mask:0xf bank_mask:0xf
    v_dot2c_f32_bf16_dpp v13, v54, v152 row_newbcast:6 row_mask:0xf bank_mask:0xf
    v_dot2c_f32_bf16_dpp v14, v34, v153 row_newbcast:6 row_mask:0xf bank_mask:0xf
    v_dot2c_f32_bf16_dpp v15, v54, v153 row_newbcast:6 row_mask:0xf bank_mask:0xf
    v_dot2c_f32_bf16_dpp v16, v34, v154 row_newbcast:6 row_mask:0xf bank_mask:0xf
    v_dot2c_f32_bf16_dpp v17, v54, v154 row_newbcast:6 row_mask:0xf bank_mask:0xf
    v_dot2c_f32_bf16_dpp v18, v34, v155 row_newbcast:6 row_mask:0xf bank_mask:0xf
    v_dot2c_f32_bf16_dpp v19, v54, v155 row_newbcast:6 row_mask:0xf bank_mask:0xf
    s_waitcnt vmcnt(11)
    v_dot2c_f32_bf16_dpp v12, v26, v64 row_newbcast:5 row_mask:0xf bank_mask:0xf
    v_dot2c_f32_bf16_dpp v13, v52, v64 row_newbcast:5 row_mask:0xf bank_mask:0xf
    v_dot2c_f32_bf16_dpp v14, v26, v65 row_newbcast:5 row_mask:0xf bank_mask:0xf
    v_dot2c_f32_bf16_dpp v15, v52, v65 row_newbcast:5 row_mask:0xf bank_mask:0xf
    v_dot2c_f32_bf16_dpp v16, v26, v66 row_newbcast:5 row_mask:0xf bank_mask:0xf
    v_dot2c_f32_bf16_dpp v17, v52, v66 row_newbcast:5 row_mask:0xf bank_mask:0xf
    v_dot2c_f32_bf16_dpp v18, v26, v67 row_newbcast:5 row_mask:0xf bank_mask:0xf
    v_dot2c_f32_bf16_dpp v19, v52, v67 row_newbcast:5 row_mask:0xf bank_mask:0xf
    s_add_u32 s6, s56, 462848
    s_and_b32 s6, s6, 0xfffff
    buffer_load_dwordx4 v[112:115], v1, s[12:15], s6 offen nt
    v_dot2c_f32_bf16_dpp v12, v34, v156 row_newbcast:7 row_mask:0xf bank_mask:0xf
    v_dot2c_f32_bf16_dpp v13, v54, v156 row_newbcast:7 row_mask:0xf bank_mask:0xf
    v_dot2c_f32_bf16_dpp v14, v34, v157 row_newbcast:7 row_mask:0xf bank_mask:0xf
    v_dot2c_f32_bf16_dpp v15, v54, v157 row_newbcast:7 row_mask:0xf bank_mask:0xf
    v_dot2c_f32_bf16_dpp v16, v34, v158 row_newbcast:7 row_mask:0xf bank_mask:0xf
    v_dot2c_f32_bf16_dpp v17, v54, v158 row_newbcast:7 row_mask:0xf bank_mask:0xf
    v_dot2c_f32_bf16_dpp v18, v34, v159 row_newbcast:7 row_mask:0xf bank_mask:0xf
    v_dot2c_f32_bf16_dpp v19, v54, v159 row_newbcast:7 row_mask:0xf bank_mask:0xf
    s_waitcnt vmcnt(11)
    v_dot2c_f32_bf16_dpp v12, v26, v68 row_newbcast:6 row_mask:0xf bank_mask:0xf
    v_dot2c_f32_bf16_dpp v13, v52, v68 row_newbcast:6 row_mask:0xf bank_mask:0xf
    v_dot2c_f32_bf16_dpp v14, v26, v69 row_newbcast:6 row_mask:0xf bank_mask:0xf
    v_dot2c_f32_bf16_dpp v15, v52, v69 row_newbcast:6 row_mask:0xf bank_mask:0xf
    v_dot2c_f32_bf16_dpp v16, v26, v70 row_newbcast:6 row_mask:0xf bank_mask:0xf
    v_dot2c_f32_bf16_dpp v17, v52, v70 row_newbcast:6 row_mask:0xf bank_mask:0xf
    v_dot2c_f32_bf16_dpp v18, v26, v71 row_newbcast:6 row_mask:0xf bank_mask:0xf
    v_dot2c_f32_bf16_dpp v19, v52, v71 row_newbcast:6 row_mask:0xf bank_mask:0xf
    s_add_u32 s6, s56, 466944
    s_and_b32 s6, s6, 0xfffff
    buffer_load_dwordx4 v[116:119], v1, s[12:15], s6 offen nt
    v_dot2c_f32_bf16_dpp v12, v34, v160 row_newbcast:8 row_mask:0xf bank_mask:0xf
    v_dot2c_f32_bf16_dpp v13, v54, v160 row_newbcast:8 row_mask:0xf bank_mask:0xf
    v_dot2c_f32_bf16_dpp v14, v34, v161 row_newbcast:8 row_mask:0xf bank_mask:0xf
    v_dot2c_f32_bf16_dpp v15, v54, v161 row_newbcast:8 row_mask:0xf bank_mask:0xf
    v_dot2c_f32_bf16_dpp v16, v34, v162 row_newbcast:8 row_mask:0xf bank_mask:0xf
    v_dot2c_f32_bf16_dpp v17, v54, v162 row_newbcast:8 row_mask:0xf bank_mask:0xf
    v_dot2c_f32_bf16_dpp v18, v34, v163 row_newbcast:8 row_mask:0xf bank_mask:0xf
    v_dot2c_f32_bf16_dpp v19, v54, v163 row_newbcast:8 row_mask:0xf bank_mask:0xf
    s_waitcnt vmcnt(11)
    v_dot2c_f32_bf16_dpp v12, v26, v72 row_newbcast:7 row_mask:0xf bank_mask:0xf
    v_dot2c_f32_bf16_dpp v13, v52, v72 row_newbcast:7 row_mask:0xf bank_mask:0xf
    v_dot2c_f32_bf16_dpp v14, v26, v73 row_newbcast:7 row_mask:0xf bank_mask:0xf
    v_dot2c_f32_bf16_dpp v15, v52, v73 row_newbcast:7 row_mask:0xf bank_mask:0xf
    v_dot2c_f32_bf16_dpp v16, v26, v74 row_newbcast:7 row_mask:0xf bank_mask:0xf
    v_dot2c_f32_bf16_dpp v17, v52, v74 row_newbcast:7 row_mask:0xf bank_mask:0xf
    v_dot2c_f32_bf16_dpp v18, v26, v75 row_newbcast:7 row_mask:0xf bank_mask:0xf
    v_dot2c_f32_bf16_dpp v19, v52, v75 row_newbcast:7 row_mask:0xf bank_mask:0xf
    s_add_u32 s6, s56, 471040
    s_and_b32 s6, s6, 0xfffff
    buffer_load_dwordx4 v[120:123], v1, s[12:15], s6 offen nt
    v_dot2c_f32_bf16_dpp v12, v34, v164 row_newbcast:9 row_mask:0xf bank_mask:0xf
    v_dot2c_f32_bf16_dpp v13, v54, v164 row_newbcast:9 row_mask:0xf bank_mask:0xf
    v_dot2c_f32_bf16_dpp v14, v34, v165 row_newbcast:9 row_mask:0xf bank_mask:0xf
    v_dot2c_f32_bf16_dpp v15, v54, v165 row_newbcast:9 row_mask:0xf bank_mask:0xf
    v_dot2c_f32_bf16_dpp v16, v34, v166 row_newbcast:9 row_mask:0xf bank_mask:0xf
    v_dot2c_f32_bf16_dpp v17, v54, v166 row_newbcast:9 row_mask:0xf bank_mask:0xf
    v_dot2c_f32_bf16_dpp v18, v34, v167 row_newbcast:9 row_mask:0xf bank_mask:0xf
    v_dot2c_f32_bf16_dpp v19, v54, v167 row_newbcast:9 row_mask:0xf bank_mask:0xf
    s_waitcnt vmcnt(11)
    v_dot2c_f32_bf16_dpp v12, v26, v76 row_newbcast:8 row_mask:0xf bank_mask:0xf
    v_dot2c_f32_bf16_dpp v13, v52, v76 row_newbcast:8 row_mask:0xf bank_mask:0xf
    v_dot2c_f32_bf16_dpp v14, v26, v77 row_newbcast:8 row_mask:0xf bank_mask:0xf
    v_dot2c_f32_bf16_dpp v15, v52, v77 row_newbcast:8 row_mask:0xf bank_mask:0xf
    v_dot2c_f32_bf16_dpp v16, v26, v78 row_newbcast:8 row_mask:0xf bank_mask:0xf
    v_dot2c_f32_bf16_dpp v17, v52, v78 row_newbcast:8 row_mask:0xf bank_mask:0xf
    v_dot2c_f32_bf16_dpp v18, v26, v79 row_newbcast:8 row_mask:0xf bank_mask:0xf
    v_dot2c_f32_bf16_dpp v19, v52, v79 row_newbcast:8 row_mask:0xf bank_mask:0xf
    s_add_u32 s6, s56, 475136
    s_and_b32 s6, s6, 0xfffff
    buffer_load_dwordx4 v[124:127], v1, s[12:15], s6 offen nt
    v_dot2c_f32_bf16_dpp v12, v34, v168 row_newbcast:10 row_mask:0xf bank_mask:0xf
    v_dot2c_f32_bf16_dpp v13, v54, v168 row_newbcast:10 row_mask:0xf bank_mask:0xf
    v_dot2c_f32_bf16_dpp v14, v34, v169 row_newbcast:10 row_mask:0xf bank_mask:0xf
    v_dot2c_f32_bf16_dpp v15, v54, v169 row_newbcast:10 row_mask:0xf bank_mask:0xf
    v_dot2c_f32_bf16_dpp v16, v34, v170 row_newbcast:10 row_mask:0xf bank_mask:0xf
    v_dot2c_f32_bf16_dpp v17, v54, v170 row_newbcast:10 row_mask:0xf bank_mask:0xf
    v_dot2c_f32_bf16_dpp v18, v34, v171 row_newbcast:10 row_mask:0xf bank_mask:0xf
    v_dot2c_f32_bf16_dpp v19, v54, v171 row_newbcast:10 row_mask:0xf bank_mask:0xf
    v_dot2c_f32_bf16_dpp v12, v34, v172 row_newbcast:11 row_mask:0xf bank_mask:0xf
    v_dot2c_f32_bf16_dpp v13, v54, v172 row_newbcast:11 row_mask:0xf bank_mask:0xf
    v_dot2c_f32_bf16_dpp v14, v34, v173 row_newbcast:11 row_mask:0xf bank_mask:0xf
    v_dot2c_f32_bf16_dpp v15, v54, v173 row_newbcast:11 row_mask:0xf bank_mask:0xf
    v_dot2c_f32_bf16_dpp v16, v34, v174 row_newbcast:11 row_mask:0xf bank_mask:0xf
    v_dot2c_f32_bf16_dpp v17, v54, v174 row_newbcast:11 row_mask:0xf bank_mask:0xf
    v_dot2c_f32_bf16_dpp v18, v34, v175 row_newbcast:11 row_mask:0xf bank_mask:0xf
    v_dot2c_f32_bf16_dpp v19, v54, v175 row_newbcast:11 row_mask:0xf bank_mask:0xf
    s_waitcnt vmcnt(11)
    v_dot2c_f32_bf16_dpp v12, v26, v80 row_newbcast:9 row_mask:0xf bank_mask:0xf
    v_dot2c_f32_bf16_dpp v13, v52, v80 row_newbcast:9 row_mask:0xf bank_mask:0xf
    v_dot2c_f32_bf16_dpp v14, v26, v81 row_newbcast:9 row_mask:0xf bank_mask:0xf
    v_dot2c_f32_bf16_dpp v15, v52, v81 row_newbcast:9 row_mask:0xf bank_mask:0xf
    v_dot2c_f32_bf16_dpp v16, v26, v82 row_newbcast:9 row_mask:0xf bank_mask:0xf
    v_dot2c_f32_bf16_dpp v17, v52, v82 row_newbcast:9 row_mask:0xf bank_mask:0xf
    v_dot2c_f32_bf16_dpp v18, v26, v83 row_newbcast:9 row_mask:0xf bank_mask:0xf
    v_dot2c_f32_bf16_dpp v19, v52, v83 row_newbcast:9 row_mask:0xf bank_mask:0xf
    s_add_u32 s6, s56, 479232
    s_and_b32 s6, s6, 0xfffff
    buffer_load_dwordx4 v[64:67], v1, s[12:15], s6 offen nt
    v_dot2c_f32_bf16_dpp v12, v34, v176 row_newbcast:12 row_mask:0xf bank_mask:0xf
    v_dot2c_f32_bf16_dpp v13, v54, v176 row_newbcast:12 row_mask:0xf bank_mask:0xf
    v_dot2c_f32_bf16_dpp v14, v34, v177 row_newbcast:12 row_mask:0xf bank_mask:0xf
    v_dot2c_f32_bf16_dpp v15, v54, v177 row_newbcast:12 row_mask:0xf bank_mask:0xf
    v_dot2c_f32_bf16_dpp v16, v34, v178 row_newbcast:12 row_mask:0xf bank_mask:0xf
    v_dot2c_f32_bf16_dpp v17, v54, v178 row_newbcast:12 row_mask:0xf bank_mask:0xf
    v_dot2c_f32_bf16_dpp v18, v34, v179 row_newbcast:12 row_mask:0xf bank_mask:0xf
    v_dot2c_f32_bf16_dpp v19, v54, v179 row_newbcast:12 row_mask:0xf bank_mask:0xf
    s_waitcnt vmcnt(11)
    v_dot2c_f32_bf16_dpp v12, v26, v84 row_newbcast:10 row_mask:0xf bank_mask:0xf
    v_dot2c_f32_bf16_dpp v13, v52, v84 row_newbcast:10 row_mask:0xf bank_mask:0xf
    v_dot2c_f32_bf16_dpp v14, v26, v85 row_newbcast:10 row_mask:0xf bank_mask:0xf
    v_dot2c_f32_bf16_dpp v15, v52, v85 row_newbcast:10 row_mask:0xf bank_mask:0xf
    v_dot2c_f32_bf16_dpp v16, v26, v86 row_newbcast:10 row_mask:0xf bank_mask:0xf
    v_dot2c_f32_bf16_dpp v17, v52, v86 row_newbcast:10 row_mask:0xf bank_mask:0xf
    v_dot2c_f32_bf16_dpp v18, v26, v87 row_newbcast:10 row_mask:0xf bank_mask:0xf
    v_dot2c_f32_bf16_dpp v19, v52, v87 row_newbcast:10 row_mask:0xf bank_mask:0xf
    s_add_u32 s6, s56, 483328
    s_and_b32 s6, s6, 0xfffff
    buffer_load_dwordx4 v[68:71], v1, s[12:15], s6 offen nt
    v_dot2c_f32_bf16_dpp v12, v34, v180 row_newbcast:13 row_mask:0xf bank_mask:0xf
    v_dot2c_f32_bf16_dpp v13, v54, v180 row_newbcast:13 row_mask:0xf bank_mask:0xf
    v_dot2c_f32_bf16_dpp v14, v34, v181 row_newbcast:13 row_mask:0xf bank_mask:0xf
    v_dot2c_f32_bf16_dpp v15, v54, v181 row_newbcast:13 row_mask:0xf bank_mask:0xf
    v_dot2c_f32_bf16_dpp v16, v34, v182 row_newbcast:13 row_mask:0xf bank_mask:0xf
    v_dot2c_f32_bf16_dpp v17, v54, v182 row_newbcast:13 row_mask:0xf bank_mask:0xf
    v_dot2c_f32_bf16_dpp v18, v34, v183 row_newbcast:13 row_mask:0xf bank_mask:0xf
    v_dot2c_f32_bf16_dpp v19, v54, v183 row_newbcast:13 row_mask:0xf bank_mask:0xf
    s_waitcnt vmcnt(11)
    v_dot2c_f32_bf16_dpp v12, v26, v88 row_newbcast:11 row_mask:0xf bank_mask:0xf
    v_dot2c_f32_bf16_dpp v13, v52, v88 row_newbcast:11 row_mask:0xf bank_mask:0xf
    v_dot2c_f32_bf16_dpp v14, v26, v89 row_newbcast:11 row_mask:0xf bank_mask:0xf
    v_dot2c_f32_bf16_dpp v15, v52, v89 row_newbcast:11 row_mask:0xf bank_mask:0xf
    v_dot2c_f32_bf16_dpp v16, v26, v90 row_newbcast:11 row_mask:0xf bank_mask:0xf
    v_dot2c_f32_bf16_dpp v17, v52, v90 row_newbcast:11 row_mask:0xf bank_mask:0xf
    v_dot2c_f32_bf16_dpp v18, v26, v91 row_newbcast:11 row_mask:0xf bank_mask:0xf
    v_dot2c_f32_bf16_dpp v19, v52, v91 row_newbcast:11 row_mask:0xf bank_mask:0xf
    s_add_u32 s6, s56, 487424
    s_and_b32 s6, s6, 0xfffff
    buffer_load_dwordx4 v[72:75], v1, s[12:15], s6 offen nt
    v_dot2c_f32_bf16_dpp v12, v34, v184 row_newbcast:14 row_mask:0xf bank_mask:0xf
    v_dot2c_f32_bf16_dpp v13, v54, v184 row_newbcast:14 row_mask:0xf bank_mask:0xf
    v_dot2c_f32_bf16_dpp v14, v34, v185 row_newbcast:14 row_mask:0xf bank_mask:0xf
    v_dot2c_f32_bf16_dpp v15, v54, v185 row_newbcast:14 row_mask:0xf bank_mask:0xf
    v_dot2c_f32_bf16_dpp v16, v34, v186 row_newbcast:14 row_mask:0xf bank_mask:0xf
    v_dot2c_f32_bf16_dpp v17, v54, v186 row_newbcast:14 row_mask:0xf bank_mask:0xf
    v_dot2c_f32_bf16_dpp v18, v34, v187 row_newbcast:14 row_mask:0xf bank_mask:0xf
    v_dot2c_f32_bf16_dpp v19, v54, v187 row_newbcast:14 row_mask:0xf bank_mask:0xf
    s_waitcnt vmcnt(11)
    v_dot2c_f32_bf16_dpp v12, v26, v92 row_newbcast:12 row_mask:0xf bank_mask:0xf
    v_dot2c_f32_bf16_dpp v13, v52, v92 row_newbcast:12 row_mask:0xf bank_mask:0xf
    v_dot2c_f32_bf16_dpp v14, v26, v93 row_newbcast:12 row_mask:0xf bank_mask:0xf
    v_dot2c_f32_bf16_dpp v15, v52, v93 row_newbcast:12 row_mask:0xf bank_mask:0xf
    v_dot2c_f32_bf16_dpp v16, v26, v94 row_newbcast:12 row_mask:0xf bank_mask:0xf
    v_dot2c_f32_bf16_dpp v17, v52, v94 row_newbcast:12 row_mask:0xf bank_mask:0xf
    v_dot2c_f32_bf16_dpp v18, v26, v95 row_newbcast:12 row_mask:0xf bank_mask:0xf
    v_dot2c_f32_bf16_dpp v19, v52, v95 row_newbcast:12 row_mask:0xf bank_mask:0xf
    s_add_u32 s6, s56, 491520
    s_and_b32 s6, s6, 0xfffff
    buffer_load_dwordx4 v[76:79], v1, s[12:15], s6 offen nt
    v_dot2c_f32_bf16_dpp v12, v34, v188 row_newbcast:15 row_mask:0xf bank_mask:0xf
    v_dot2c_f32_bf16_dpp v13, v54, v188 row_newbcast:15 row_mask:0xf bank_mask:0xf
    v_dot2c_f32_bf16_dpp v14, v34, v189 row_newbcast:15 row_mask:0xf bank_mask:0xf
    v_dot2c_f32_bf16_dpp v15, v54, v189 row_newbcast:15 row_mask:0xf bank_mask:0xf
    v_dot2c_f32_bf16_dpp v16, v34, v190 row_newbcast:15 row_mask:0xf bank_mask:0xf
    v_dot2c_f32_bf16_dpp v17, v54, v190 row_newbcast:15 row_mask:0xf bank_mask:0xf
    v_dot2c_f32_bf16_dpp v18, v34, v191 row_newbcast:15 row_mask:0xf bank_mask:0xf
    v_dot2c_f32_bf16_dpp v19, v54, v191 row_newbcast:15 row_mask:0xf bank_mask:0xf
    s_waitcnt vmcnt(11)
    v_dot2c_f32_bf16_dpp v12, v26, v96 row_newbcast:13 row_mask:0xf bank_mask:0xf
    v_dot2c_f32_bf16_dpp v13, v52, v96 row_newbcast:13 row_mask:0xf bank_mask:0xf
    v_dot2c_f32_bf16_dpp v14, v26, v97 row_newbcast:13 row_mask:0xf bank_mask:0xf
    v_dot2c_f32_bf16_dpp v15, v52, v97 row_newbcast:13 row_mask:0xf bank_mask:0xf
    v_dot2c_f32_bf16_dpp v16, v26, v98 row_newbcast:13 row_mask:0xf bank_mask:0xf
    v_dot2c_f32_bf16_dpp v17, v52, v98 row_newbcast:13 row_mask:0xf bank_mask:0xf
    v_dot2c_f32_bf16_dpp v18, v26, v99 row_newbcast:13 row_mask:0xf bank_mask:0xf
    v_dot2c_f32_bf16_dpp v19, v52, v99 row_newbcast:13 row_mask:0xf bank_mask:0xf
    s_add_u32 s6, s56, 495616
    s_and_b32 s6, s6, 0xfffff
    buffer_load_dwordx4 v[80:83], v1, s[12:15], s6 offen nt
    v_lshlrev_b32 v54, 16, v35
    s_nop 1
    v_dot2c_f32_bf16_dpp v12, v35, v192 row_newbcast:0 row_mask:0xf bank_mask:0xf
    v_dot2c_f32_bf16_dpp v13, v54, v192 row_newbcast:0 row_mask:0xf bank_mask:0xf
    v_dot2c_f32_bf16_dpp v14, v35, v193 row_newbcast:0 row_mask:0xf bank_mask:0xf
    v_dot2c_f32_bf16_dpp v15, v54, v193 row_newbcast:0 row_mask:0xf bank_mask:0xf
    v_dot2c_f32_bf16_dpp v16, v35, v194 row_newbcast:0 row_mask:0xf bank_mask:0xf
    v_dot2c_f32_bf16_dpp v17, v54, v194 row_newbcast:0 row_mask:0xf bank_mask:0xf
    v_dot2c_f32_bf16_dpp v18, v35, v195 row_newbcast:0 row_mask:0xf bank_mask:0xf
    v_dot2c_f32_bf16_dpp v19, v54, v195 row_newbcast:0 row_mask:0xf bank_mask:0xf
    s_waitcnt vmcnt(11)
    v_dot2c_f32_bf16_dpp v12, v26, v100 row_newbcast:14 row_mask:0xf bank_mask:0xf
    v_dot2c_f32_bf16_dpp v13, v52, v100 row_newbcast:14 row_mask:0xf bank_mask:0xf
    v_dot2c_f32_bf16_dpp v14, v26, v101 row_newbcast:14 row_mask:0xf bank_mask:0xf
    v_dot2c_f32_bf16_dpp v15, v52, v101 row_newbcast:14 row_mask:0xf bank_mask:0xf
    v_dot2c_f32_bf16_dpp v16, v26, v102 row_newbcast:14 row_mask:0xf bank_mask:0xf
    v_dot2c_f32_bf16_dpp v17, v52, v102 row_newbcast:14 row_mask:0xf bank_mask:0xf
    v_dot2c_f32_bf16_dpp v18, v26, v103 row_newbcast:14 row_mask:0xf bank_mask:0xf
    v_dot2c_f32_bf16_dpp v19, v52, v103 row_newbcast:14 row_mask:0xf bank_mask:0xf
    s_add_u32 s6, s56, 499712
    s_and_b32 s6, s6, 0xfffff
    buffer_load_dwordx4 v[84:87], v1, s[12:15], s6 offen nt
    v_dot2c_f32_bf16_dpp v12, v35, v196 row_newbcast:1 row_mask:0xf bank_mask:0xf
    v_dot2c_f32_bf16_dpp v13, v54, v196 row_newbcast:1 row_mask:0xf bank_mask:0xf
    v_dot2c_f32_bf16_dpp v14, v35, v197 row_newbcast:1 row_mask:0xf bank_mask:0xf
    v_dot2c_f32_bf16_dpp v15, v54, v197 row_newbcast:1 row_mask:0xf bank_mask:0xf
    v_dot2c_f32_bf16_dpp v16, v35, v198 row_newbcast:1 row_mask:0xf bank_mask:0xf
    v_dot2c_f32_bf16_dpp v17, v54, v198 row_newbcast:1 row_mask:0xf bank_mask:0xf
    v_dot2c_f32_bf16_dpp v18, v35, v199 row_newbcast:1 row_mask:0xf bank_mask:0xf
    v_dot2c_f32_bf16_dpp v19, v54, v199 row_newbcast:1 row_mask:0xf bank_mask:0xf
    s_waitcnt vmcnt(11)
    v_dot2c_f32_bf16_dpp v12, v26, v104 row_newbcast:15 row_mask:0xf bank_mask:0xf
    v_dot2c_f32_bf16_dpp v13, v52, v104 row_newbcast:15 row_mask:0xf bank_mask:0xf
    v_dot2c_f32_bf16_dpp v14, v26, v105 row_newbcast:15 row_mask:0xf bank_mask:0xf
    v_dot2c_f32_bf16_dpp v15, v52, v105 row_newbcast:15 row_mask:0xf bank_mask:0xf
    v_dot2c_f32_bf16_dpp v16, v26, v106 row_newbcast:15 row_mask:0xf bank_mask:0xf
    v_dot2c_f32_bf16_dpp v17, v52, v106 row_newbcast:15 row_mask:0xf bank_mask:0xf
    v_dot2c_f32_bf16_dpp v18, v26, v107 row_newbcast:15 row_mask:0xf bank_mask:0xf
    v_dot2c_f32_bf16_dpp v19, v52, v107 row_newbcast:15 row_mask:0xf bank_mask:0xf
    s_add_u32 s6, s56, 503808
    s_and_b32 s6, s6, 0xfffff
    buffer_load_dwordx4 v[88:91], v1, s[12:15], s6 offen nt
    v_dot2c_f32_bf16_dpp v12, v35, v200 row_newbcast:2 row_mask:0xf bank_mask:0xf
    v_dot2c_f32_bf16_dpp v13, v54, v200 row_newbcast:2 row_mask:0xf bank_mask:0xf
    v_dot2c_f32_bf16_dpp v14, v35, v201 row_newbcast:2 row_mask:0xf bank_mask:0xf
    v_dot2c_f32_bf16_dpp v15, v54, v201 row_newbcast:2 row_mask:0xf bank_mask:0xf
    v_dot2c_f32_bf16_dpp v16, v35, v202 row_newbcast:2 row_mask:0xf bank_mask:0xf
    v_dot2c_f32_bf16_dpp v17, v54, v202 row_newbcast:2 row_mask:0xf bank_mask:0xf
    v_dot2c_f32_bf16_dpp v18, v35, v203 row_newbcast:2 row_mask:0xf bank_mask:0xf
    v_dot2c_f32_bf16_dpp v19, v54, v203 row_newbcast:2 row_mask:0xf bank_mask:0xf
    v_lshlrev_b32 v52, 16, v27
    s_nop 1
    s_waitcnt vmcnt(11)
    v_dot2c_f32_bf16_dpp v12, v27, v108 row_newbcast:0 row_mask:0xf bank_mask:0xf
    v_dot2c_f32_bf16_dpp v13, v52, v108 row_newbcast:0 row_mask:0xf bank_mask:0xf
    v_dot2c_f32_bf16_dpp v14, v27, v109 row_newbcast:0 row_mask:0xf bank_mask:0xf
    v_dot2c_f32_bf16_dpp v15, v52, v109 row_newbcast:0 row_mask:0xf bank_mask:0xf
    v_dot2c_f32_bf16_dpp v16, v27, v110 row_newbcast:0 row_mask:0xf bank_mask:0xf
    v_dot2c_f32_bf16_dpp v17, v52, v110 row_newbcast:0 row_mask:0xf bank_mask:0xf
    v_dot2c_f32_bf16_dpp v18, v27, v111 row_newbcast:0 row_mask:0xf bank_mask:0xf
    v_dot2c_f32_bf16_dpp v19, v52, v111 row_newbcast:0 row_mask:0xf bank_mask:0xf
    s_add_u32 s6, s56, 507904
    s_and_b32 s6, s6, 0xfffff
    buffer_load_dwordx4 v[92:95], v1, s[12:15], s6 offen nt
    buffer_load_dwordx4 v[96:99], v3, s[20:23], 0 offen
    buffer_load_dwordx4 v[100:103], v3, s[20:23], 0 offen offset:1024
    buffer_load_dwordx4 v[104:107], v3, s[20:23], 0 offen offset:2048
    buffer_load_dwordx4 v[108:111], v3, s[20:23], 0 offen offset:3072
    v_dot2c_f32_bf16_dpp v12, v35, v204 row_newbcast:3 row_mask:0xf bank_mask:0xf
    v_dot2c_f32_bf16_dpp v13, v54, v204 row_newbcast:3 row_mask:0xf bank_mask:0xf
    v_dot2c_f32_bf16_dpp v14, v35, v205 row_newbcast:3 row_mask:0xf bank_mask:0xf
    v_dot2c_f32_bf16_dpp v15, v54, v205 row_newbcast:3 row_mask:0xf bank_mask:0xf
    v_dot2c_f32_bf16_dpp v16, v35, v206 row_newbcast:3 row_mask:0xf bank_mask:0xf
    v_dot2c_f32_bf16_dpp v17, v54, v206 row_newbcast:3 row_mask:0xf bank_mask:0xf
    v_dot2c_f32_bf16_dpp v18, v35, v207 row_newbcast:3 row_mask:0xf bank_mask:0xf
    v_dot2c_f32_bf16_dpp v19, v54, v207 row_newbcast:3 row_mask:0xf bank_mask:0xf
    s_waitcnt vmcnt(15)
    v_dot2c_f32_bf16_dpp v12, v27, v112 row_newbcast:1 row_mask:0xf bank_mask:0xf
    v_dot2c_f32_bf16_dpp v13, v52, v112 row_newbcast:1 row_mask:0xf bank_mask:0xf
    v_dot2c_f32_bf16_dpp v14, v27, v113 row_newbcast:1 row_mask:0xf bank_mask:0xf
    v_dot2c_f32_bf16_dpp v15, v52, v113 row_newbcast:1 row_mask:0xf bank_mask:0xf
    v_dot2c_f32_bf16_dpp v16, v27, v114 row_newbcast:1 row_mask:0xf bank_mask:0xf
    v_dot2c_f32_bf16_dpp v17, v52, v114 row_newbcast:1 row_mask:0xf bank_mask:0xf
    v_dot2c_f32_bf16_dpp v18, v27, v115 row_newbcast:1 row_mask:0xf bank_mask:0xf
    v_dot2c_f32_bf16_dpp v19, v52, v115 row_newbcast:1 row_mask:0xf bank_mask:0xf
    s_mov_b32 s6, 4096
    buffer_load_dwordx4 v[112:115], v3, s[20:23], s6 offen
    v_dot2c_f32_bf16_dpp v12, v35, v208 row_newbcast:4 row_mask:0xf bank_mask:0xf
    v_dot2c_f32_bf16_dpp v13, v54, v208 row_newbcast:4 row_mask:0xf bank_mask:0xf
    v_dot2c_f32_bf16_dpp v14, v35, v209 row_newbcast:4 row_mask:0xf bank_mask:0xf
    v_dot2c_f32_bf16_dpp v15, v54, v209 row_newbcast:4 row_mask:0xf bank_mask:0xf
    v_dot2c_f32_bf16_dpp v16, v35, v210 row_newbcast:4 row_mask:0xf bank_mask:0xf
    v_dot2c_f32_bf16_dpp v17, v54, v210 row_newbcast:4 row_mask:0xf bank_mask:0xf
    v_dot2c_f32_bf16_dpp v18, v35, v211 row_newbcast:4 row_mask:0xf bank_mask:0xf
    v_dot2c_f32_bf16_dpp v19, v54, v211 row_newbcast:4 row_mask:0xf bank_mask:0xf
    s_waitcnt vmcnt(15)
    v_dot2c_f32_bf16_dpp v12, v27, v116 row_newbcast:2 row_mask:0xf bank_mask:0xf
    v_dot2c_f32_bf16_dpp v13, v52, v116 row_newbcast:2 row_mask:0xf bank_mask:0xf
    v_dot2c_f32_bf16_dpp v14, v27, v117 row_newbcast:2 row_mask:0xf bank_mask:0xf
    v_dot2c_f32_bf16_dpp v15, v52, v117 row_newbcast:2 row_mask:0xf bank_mask:0xf
    v_dot2c_f32_bf16_dpp v16, v27, v118 row_newbcast:2 row_mask:0xf bank_mask:0xf
    v_dot2c_f32_bf16_dpp v17, v52, v118 row_newbcast:2 row_mask:0xf bank_mask:0xf
    v_dot2c_f32_bf16_dpp v18, v27, v119 row_newbcast:2 row_mask:0xf bank_mask:0xf
    v_dot2c_f32_bf16_dpp v19, v52, v119 row_newbcast:2 row_mask:0xf bank_mask:0xf
    buffer_load_dwordx4 v[116:119], v3, s[20:23], s6 offen offset:1024
    v_dot2c_f32_bf16_dpp v12, v35, v212 row_newbcast:5 row_mask:0xf bank_mask:0xf
    v_dot2c_f32_bf16_dpp v13, v54, v212 row_newbcast:5 row_mask:0xf bank_mask:0xf
    v_dot2c_f32_bf16_dpp v14, v35, v213 row_newbcast:5 row_mask:0xf bank_mask:0xf
    v_dot2c_f32_bf16_dpp v15, v54, v213 row_newbcast:5 row_mask:0xf bank_mask:0xf
    v_dot2c_f32_bf16_dpp v16, v35, v214 row_newbcast:5 row_mask:0xf bank_mask:0xf
    v_dot2c_f32_bf16_dpp v17, v54, v214 row_newbcast:5 row_mask:0xf bank_mask:0xf
    v_dot2c_f32_bf16_dpp v18, v35, v215 row_newbcast:5 row_mask:0xf bank_mask:0xf
    v_dot2c_f32_bf16_dpp v19, v54, v215 row_newbcast:5 row_mask:0xf bank_mask:0xf
    s_waitcnt vmcnt(15)
    v_dot2c_f32_bf16_dpp v12, v27, v120 row_newbcast:3 row_mask:0xf bank_mask:0xf
    v_dot2c_f32_bf16_dpp v13, v52, v120 row_newbcast:3 row_mask:0xf bank_mask:0xf
    v_dot2c_f32_bf16_dpp v14, v27, v121 row_newbcast:3 row_mask:0xf bank_mask:0xf
    v_dot2c_f32_bf16_dpp v15, v52, v121 row_newbcast:3 row_mask:0xf bank_mask:0xf
    v_dot2c_f32_bf16_dpp v16, v27, v122 row_newbcast:3 row_mask:0xf bank_mask:0xf
    v_dot2c_f32_bf16_dpp v17, v52, v122 row_newbcast:3 row_mask:0xf bank_mask:0xf
    v_dot2c_f32_bf16_dpp v18, v27, v123 row_newbcast:3 row_mask:0xf bank_mask:0xf
    v_dot2c_f32_bf16_dpp v19, v52, v123 row_newbcast:3 row_mask:0xf bank_mask:0xf
    buffer_load_dwordx4 v[120:123], v3, s[20:23], s6 offen offset:2048
    v_dot2c_f32_bf16_dpp v12, v35, v216 row_newbcast:6 row_mask:0xf bank_mask:0xf
    v_dot2c_f32_bf16_dpp v13, v54, v216 row_newbcast:6 row_mask:0xf bank_mask:0xf
    v_dot2c_f32_bf16_dpp v14, v35, v217 row_newbcast:6 row_mask:0xf bank_mask:0xf
    v_dot2c_f32_bf16_dpp v15, v54, v217 row_newbcast:6 row_mask:0xf bank_mask:0xf
    v_dot2c_f32_bf16_dpp v16, v35, v218 row_newbcast:6 row_mask:0xf bank_mask:0xf
    v_dot2c_f32_bf16_dpp v17, v54, v218 row_newbcast:6 row_mask:0xf bank_mask:0xf
    v_dot2c_f32_bf16_dpp v18, v35, v219 row_newbcast:6 row_mask:0xf bank_mask:0xf
    v_dot2c_f32_bf16_dpp v19, v54, v219 row_newbcast:6 row_mask:0xf bank_mask:0xf
    s_waitcnt vmcnt(15)
    v_dot2c_f32_bf16_dpp v12, v27, v124 row_newbcast:4 row_mask:0xf bank_mask:0xf
    v_dot2c_f32_bf16_dpp v13, v52, v124 row_newbcast:4 row_mask:0xf bank_mask:0xf
    v_dot2c_f32_bf16_dpp v14, v27, v125 row_newbcast:4 row_mask:0xf bank_mask:0xf
    v_dot2c_f32_bf16_dpp v15, v52, v125 row_newbcast:4 row_mask:0xf bank_mask:0xf
    v_dot2c_f32_bf16_dpp v16, v27, v126 row_newbcast:4 row_mask:0xf bank_mask:0xf
    v_dot2c_f32_bf16_dpp v17, v52, v126 row_newbcast:4 row_mask:0xf bank_mask:0xf
    v_dot2c_f32_bf16_dpp v18, v27, v127 row_newbcast:4 row_mask:0xf bank_mask:0xf
    v_dot2c_f32_bf16_dpp v19, v52, v127 row_newbcast:4 row_mask:0xf bank_mask:0xf
    buffer_load_dwordx4 v[124:127], v3, s[20:23], s6 offen offset:3072
    v_dot2c_f32_bf16_dpp v12, v35, v220 row_newbcast:7 row_mask:0xf bank_mask:0xf
    v_dot2c_f32_bf16_dpp v13, v54, v220 row_newbcast:7 row_mask:0xf bank_mask:0xf
    v_dot2c_f32_bf16_dpp v14, v35, v221 row_newbcast:7 row_mask:0xf bank_mask:0xf
    v_dot2c_f32_bf16_dpp v15, v54, v221 row_newbcast:7 row_mask:0xf bank_mask:0xf
    v_dot2c_f32_bf16_dpp v16, v35, v222 row_newbcast:7 row_mask:0xf bank_mask:0xf
    v_dot2c_f32_bf16_dpp v17, v54, v222 row_newbcast:7 row_mask:0xf bank_mask:0xf
    v_dot2c_f32_bf16_dpp v18, v35, v223 row_newbcast:7 row_mask:0xf bank_mask:0xf
    v_dot2c_f32_bf16_dpp v19, v54, v223 row_newbcast:7 row_mask:0xf bank_mask:0xf
    s_waitcnt vmcnt(15)
    v_dot2c_f32_bf16_dpp v12, v27, v64 row_newbcast:5 row_mask:0xf bank_mask:0xf
    v_dot2c_f32_bf16_dpp v13, v52, v64 row_newbcast:5 row_mask:0xf bank_mask:0xf
    v_dot2c_f32_bf16_dpp v14, v27, v65 row_newbcast:5 row_mask:0xf bank_mask:0xf
    v_dot2c_f32_bf16_dpp v15, v52, v65 row_newbcast:5 row_mask:0xf bank_mask:0xf
    v_dot2c_f32_bf16_dpp v16, v27, v66 row_newbcast:5 row_mask:0xf bank_mask:0xf
    v_dot2c_f32_bf16_dpp v17, v52, v66 row_newbcast:5 row_mask:0xf bank_mask:0xf
    v_dot2c_f32_bf16_dpp v18, v27, v67 row_newbcast:5 row_mask:0xf bank_mask:0xf
    v_dot2c_f32_bf16_dpp v19, v52, v67 row_newbcast:5 row_mask:0xf bank_mask:0xf
    s_mov_b32 s6, 8192
    buffer_load_dwordx4 v[64:67], v3, s[20:23], s6 offen
    v_dot2c_f32_bf16_dpp v12, v35, v224 row_newbcast:8 row_mask:0xf bank_mask:0xf
    v_dot2c_f32_bf16_dpp v13, v54, v224 row_newbcast:8 row_mask:0xf bank_mask:0xf
    v_dot2c_f32_bf16_dpp v14, v35, v225 row_newbcast:8 row_mask:0xf bank_mask:0xf
    v_dot2c_f32_bf16_dpp v15, v54, v225 row_newbcast:8 row_mask:0xf bank_mask:0xf
    v_dot2c_f32_bf16_dpp v16, v35, v226 row_newbcast:8 row_mask:0xf bank_mask:0xf
    v_dot2c_f32_bf16_dpp v17, v54, v226 row_newbcast:8 row_mask:0xf bank_mask:0xf
    v_dot2c_f32_bf16_dpp v18, v35, v227 row_newbcast:8 row_mask:0xf bank_mask:0xf
    v_dot2c_f32_bf16_dpp v19, v54, v227 row_newbcast:8 row_mask:0xf bank_mask:0xf
    s_waitcnt vmcnt(15)
    v_dot2c_f32_bf16_dpp v12, v27, v68 row_newbcast:6 row_mask:0xf bank_mask:0xf
    v_dot2c_f32_bf16_dpp v13, v52, v68 row_newbcast:6 row_mask:0xf bank_mask:0xf
    v_dot2c_f32_bf16_dpp v14, v27, v69 row_newbcast:6 row_mask:0xf bank_mask:0xf
    v_dot2c_f32_bf16_dpp v15, v52, v69 row_newbcast:6 row_mask:0xf bank_mask:0xf
    v_dot2c_f32_bf16_dpp v16, v27, v70 row_newbcast:6 row_mask:0xf bank_mask:0xf
    v_dot2c_f32_bf16_dpp v17, v52, v70 row_newbcast:6 row_mask:0xf bank_mask:0xf
    v_dot2c_f32_bf16_dpp v18, v27, v71 row_newbcast:6 row_mask:0xf bank_mask:0xf
    v_dot2c_f32_bf16_dpp v19, v52, v71 row_newbcast:6 row_mask:0xf bank_mask:0xf
    buffer_load_dwordx4 v[68:71], v3, s[20:23], s6 offen offset:1024
    v_dot2c_f32_bf16_dpp v12, v35, v228 row_newbcast:9 row_mask:0xf bank_mask:0xf
    v_dot2c_f32_bf16_dpp v13, v54, v228 row_newbcast:9 row_mask:0xf bank_mask:0xf
    v_dot2c_f32_bf16_dpp v14, v35, v229 row_newbcast:9 row_mask:0xf bank_mask:0xf
    v_dot2c_f32_bf16_dpp v15, v54, v229 row_newbcast:9 row_mask:0xf bank_mask:0xf
    v_dot2c_f32_bf16_dpp v16, v35, v230 row_newbcast:9 row_mask:0xf bank_mask:0xf
    v_dot2c_f32_bf16_dpp v17, v54, v230 row_newbcast:9 row_mask:0xf bank_mask:0xf
    v_dot2c_f32_bf16_dpp v18, v35, v231 row_newbcast:9 row_mask:0xf bank_mask:0xf
    v_dot2c_f32_bf16_dpp v19, v54, v231 row_newbcast:9 row_mask:0xf bank_mask:0xf
    s_waitcnt vmcnt(15)
    v_dot2c_f32_bf16_dpp v12, v27, v72 row_newbcast:7 row_mask:0xf bank_mask:0xf
    v_dot2c_f32_bf16_dpp v13, v52, v72 row_newbcast:7 row_mask:0xf bank_mask:0xf
    v_dot2c_f32_bf16_dpp v14, v27, v73 row_newbcast:7 row_mask:0xf bank_mask:0xf
    v_dot2c_f32_bf16_dpp v15, v52, v73 row_newbcast:7 row_mask:0xf bank_mask:0xf
    v_dot2c_f32_bf16_dpp v16, v27, v74 row_newbcast:7 row_mask:0xf bank_mask:0xf
    v_dot2c_f32_bf16_dpp v17, v52, v74 row_newbcast:7 row_mask:0xf bank_mask:0xf
    v_dot2c_f32_bf16_dpp v18, v27, v75 row_newbcast:7 row_mask:0xf bank_mask:0xf
    v_dot2c_f32_bf16_dpp v19, v52, v75 row_newbcast:7 row_mask:0xf bank_mask:0xf
    buffer_load_dwordx4 v[72:75], v3, s[20:23], s6 offen offset:2048
    v_dot2c_f32_bf16_dpp v12, v35, v232 row_newbcast:10 row_mask:0xf bank_mask:0xf
    v_dot2c_f32_bf16_dpp v13, v54, v232 row_newbcast:10 row_mask:0xf bank_mask:0xf
    v_dot2c_f32_bf16_dpp v14, v35, v233 row_newbcast:10 row_mask:0xf bank_mask:0xf
    v_dot2c_f32_bf16_dpp v15, v54, v233 row_newbcast:10 row_mask:0xf bank_mask:0xf
    v_dot2c_f32_bf16_dpp v16, v35, v234 row_newbcast:10 row_mask:0xf bank_mask:0xf
    v_dot2c_f32_bf16_dpp v17, v54, v234 row_newbcast:10 row_mask:0xf bank_mask:0xf
    v_dot2c_f32_bf16_dpp v18, v35, v235 row_newbcast:10 row_mask:0xf bank_mask:0xf
    v_dot2c_f32_bf16_dpp v19, v54, v235 row_newbcast:10 row_mask:0xf bank_mask:0xf
    s_waitcnt vmcnt(15)
    v_dot2c_f32_bf16_dpp v12, v27, v76 row_newbcast:8 row_mask:0xf bank_mask:0xf
    v_dot2c_f32_bf16_dpp v13, v52, v76 row_newbcast:8 row_mask:0xf bank_mask:0xf
    v_dot2c_f32_bf16_dpp v14, v27, v77 row_newbcast:8 row_mask:0xf bank_mask:0xf
    v_dot2c_f32_bf16_dpp v15, v52, v77 row_newbcast:8 row_mask:0xf bank_mask:0xf
    v_dot2c_f32_bf16_dpp v16, v27, v78 row_newbcast:8 row_mask:0xf bank_mask:0xf
    v_dot2c_f32_bf16_dpp v17, v52, v78 row_newbcast:8 row_mask:0xf bank_mask:0xf
    v_dot2c_f32_bf16_dpp v18, v27, v79 row_newbcast:8 row_mask:0xf bank_mask:0xf
    v_dot2c_f32_bf16_dpp v19, v52, v79 row_newbcast:8 row_mask:0xf bank_mask:0xf
    buffer_load_dwordx4 v[76:79], v3, s[20:23], s6 offen offset:3072
    v_dot2c_f32_bf16_dpp v12, v35, v236 row_newbcast:11 row_mask:0xf bank_mask:0xf
    v_dot2c_f32_bf16_dpp v13, v54, v236 row_newbcast:11 row_mask:0xf bank_mask:0xf
    v_dot2c_f32_bf16_dpp v14, v35, v237 row_newbcast:11 row_mask:0xf bank_mask:0xf
    v_dot2c_f32_bf16_dpp v15, v54, v237 row_newbcast:11 row_mask:0xf bank_mask:0xf
    v_dot2c_f32_bf16_dpp v16, v35, v238 row_newbcast:11 row_mask:0xf bank_mask:0xf
    v_dot2c_f32_bf16_dpp v17, v54, v238 row_newbcast:11 row_mask:0xf bank_mask:0xf
    v_dot2c_f32_bf16_dpp v18, v35, v239 row_newbcast:11 row_mask:0xf bank_mask:0xf
    v_dot2c_f32_bf16_dpp v19, v54, v239 row_newbcast:11 row_mask:0xf bank_mask:0xf
    s_waitcnt vmcnt(15)
    v_dot2c_f32_bf16_dpp v12, v27, v80 row_newbcast:9 row_mask:0xf bank_mask:0xf
    v_dot2c_f32_bf16_dpp v13, v52, v80 row_newbcast:9 row_mask:0xf bank_mask:0xf
    v_dot2c_f32_bf16_dpp v14, v27, v81 row_newbcast:9 row_mask:0xf bank_mask:0xf
    v_dot2c_f32_bf16_dpp v15, v52, v81 row_newbcast:9 row_mask:0xf bank_mask:0xf
    v_dot2c_f32_bf16_dpp v16, v27, v82 row_newbcast:9 row_mask:0xf bank_mask:0xf
    v_dot2c_f32_bf16_dpp v17, v52, v82 row_newbcast:9 row_mask:0xf bank_mask:0xf
    v_dot2c_f32_bf16_dpp v18, v27, v83 row_newbcast:9 row_mask:0xf bank_mask:0xf
    v_dot2c_f32_bf16_dpp v19, v52, v83 row_newbcast:9 row_mask:0xf bank_mask:0xf
    s_mov_b32 s6, 12288
    buffer_load_dwordx4 v[80:83], v3, s[20:23], s6 offen
    v_dot2c_f32_bf16_dpp v12, v35, v240 row_newbcast:12 row_mask:0xf bank_mask:0xf
    v_dot2c_f32_bf16_dpp v13, v54, v240 row_newbcast:12 row_mask:0xf bank_mask:0xf
    v_dot2c_f32_bf16_dpp v14, v35, v241 row_newbcast:12 row_mask:0xf bank_mask:0xf
    v_dot2c_f32_bf16_dpp v15, v54, v241 row_newbcast:12 row_mask:0xf bank_mask:0xf
    v_dot2c_f32_bf16_dpp v16, v35, v242 row_newbcast:12 row_mask:0xf bank_mask:0xf
    v_dot2c_f32_bf16_dpp v17, v54, v242 row_newbcast:12 row_mask:0xf bank_mask:0xf
    v_dot2c_f32_bf16_dpp v18, v35, v243 row_newbcast:12 row_mask:0xf bank_mask:0xf
    v_dot2c_f32_bf16_dpp v19, v54, v243 row_newbcast:12 row_mask:0xf bank_mask:0xf
    s_waitcnt vmcnt(15)
    v_dot2c_f32_bf16_dpp v12, v27, v84 row_newbcast:10 row_mask:0xf bank_mask:0xf
    v_dot2c_f32_bf16_dpp v13, v52, v84 row_newbcast:10 row_mask:0xf bank_mask:0xf
    v_dot2c_f32_bf16_dpp v14, v27, v85 row_newbcast:10 row_mask:0xf bank_mask:0xf
    v_dot2c_f32_bf16_dpp v15, v52, v85 row_newbcast:10 row_mask:0xf bank_mask:0xf
    v_dot2c_f32_bf16_dpp v16, v27, v86 row_newbcast:10 row_mask:0xf bank_mask:0xf
    v_dot2c_f32_bf16_dpp v17, v52, v86 row_newbcast:10 row_mask:0xf bank_mask:0xf
    v_dot2c_f32_bf16_dpp v18, v27, v87 row_newbcast:10 row_mask:0xf bank_mask:0xf
    v_dot2c_f32_bf16_dpp v19, v52, v87 row_newbcast:10 row_mask:0xf bank_mask:0xf
    buffer_load_dwordx4 v[84:87], v3, s[20:23], s6 offen offset:1024
    v_dot2c_f32_bf16_dpp v12, v35, v244 row_newbcast:13 row_mask:0xf bank_mask:0xf
    v_dot2c_f32_bf16_dpp v13, v54, v244 row_newbcast:13 row_mask:0xf bank_mask:0xf
    v_dot2c_f32_bf16_dpp v14, v35, v245 row_newbcast:13 row_mask:0xf bank_mask:0xf
    v_dot2c_f32_bf16_dpp v15, v54, v245 row_newbcast:13 row_mask:0xf bank_mask:0xf
    v_dot2c_f32_bf16_dpp v16, v35, v246 row_newbcast:13 row_mask:0xf bank_mask:0xf
    v_dot2c_f32_bf16_dpp v17, v54, v246 row_newbcast:13 row_mask:0xf bank_mask:0xf
    v_dot2c_f32_bf16_dpp v18, v35, v247 row_newbcast:13 row_mask:0xf bank_mask:0xf
    v_dot2c_f32_bf16_dpp v19, v54, v247 row_newbcast:13 row_mask:0xf bank_mask:0xf
    s_waitcnt vmcnt(15)
    v_dot2c_f32_bf16_dpp v12, v27, v88 row_newbcast:11 row_mask:0xf bank_mask:0xf
    v_dot2c_f32_bf16_dpp v13, v52, v88 row_newbcast:11 row_mask:0xf bank_mask:0xf
    v_dot2c_f32_bf16_dpp v14, v27, v89 row_newbcast:11 row_mask:0xf bank_mask:0xf
    v_dot2c_f32_bf16_dpp v15, v52, v89 row_newbcast:11 row_mask:0xf bank_mask:0xf
    v_dot2c_f32_bf16_dpp v16, v27, v90 row_newbcast:11 row_mask:0xf bank_mask:0xf
    v_dot2c_f32_bf16_dpp v17, v52, v90 row_newbcast:11 row_mask:0xf bank_mask:0xf
    v_dot2c_f32_bf16_dpp v18, v27, v91 row_newbcast:11 row_mask:0xf bank_mask:0xf
    v_dot2c_f32_bf16_dpp v19, v52, v91 row_newbcast:11 row_mask:0xf bank_mask:0xf
    buffer_load_dwordx4 v[88:91], v3, s[20:23], s6 offen offset:2048
    v_dot2c_f32_bf16_dpp v12, v35, v248 row_newbcast:14 row_mask:0xf bank_mask:0xf
    v_dot2c_f32_bf16_dpp v13, v54, v248 row_newbcast:14 row_mask:0xf bank_mask:0xf
    v_dot2c_f32_bf16_dpp v14, v35, v249 row_newbcast:14 row_mask:0xf bank_mask:0xf
    v_dot2c_f32_bf16_dpp v15, v54, v249 row_newbcast:14 row_mask:0xf bank_mask:0xf
    v_dot2c_f32_bf16_dpp v16, v35, v250 row_newbcast:14 row_mask:0xf bank_mask:0xf
    v_dot2c_f32_bf16_dpp v17, v54, v250 row_newbcast:14 row_mask:0xf bank_mask:0xf
    v_dot2c_f32_bf16_dpp v18, v35, v251 row_newbcast:14 row_mask:0xf bank_mask:0xf
    v_dot2c_f32_bf16_dpp v19, v54, v251 row_newbcast:14 row_mask:0xf bank_mask:0xf
    s_waitcnt vmcnt(15)
    v_dot2c_f32_bf16_dpp v12, v27, v92 row_newbcast:12 row_mask:0xf bank_mask:0xf
    v_dot2c_f32_bf16_dpp v13, v52, v92 row_newbcast:12 row_mask:0xf bank_mask:0xf
    v_dot2c_f32_bf16_dpp v14, v27, v93 row_newbcast:12 row_mask:0xf bank_mask:0xf
    v_dot2c_f32_bf16_dpp v15, v52, v93 row_newbcast:12 row_mask:0xf bank_mask:0xf
    v_dot2c_f32_bf16_dpp v16, v27, v94 row_newbcast:12 row_mask:0xf bank_mask:0xf
    v_dot2c_f32_bf16_dpp v17, v52, v94 row_newbcast:12 row_mask:0xf bank_mask:0xf
    v_dot2c_f32_bf16_dpp v18, v27, v95 row_newbcast:12 row_mask:0xf bank_mask:0xf
    v_dot2c_f32_bf16_dpp v19, v52, v95 row_newbcast:12 row_mask:0xf bank_mask:0xf
    buffer_load_dwordx4 v[92:95], v3, s[20:23], s6 offen offset:3072
    v_dot2c_f32_bf16_dpp v12, v35, v252 row_newbcast:15 row_mask:0xf bank_mask:0xf
    v_dot2c_f32_bf16_dpp v13, v54, v252 row_newbcast:15 row_mask:0xf bank_mask:0xf
    v_dot2c_f32_bf16_dpp v14, v35, v253 row_newbcast:15 row_mask:0xf bank_mask:0xf
    v_dot2c_f32_bf16_dpp v15, v54, v253 row_newbcast:15 row_mask:0xf bank_mask:0xf
    v_dot2c_f32_bf16_dpp v16, v35, v254 row_newbcast:15 row_mask:0xf bank_mask:0xf
    v_dot2c_f32_bf16_dpp v17, v54, v254 row_newbcast:15 row_mask:0xf bank_mask:0xf
    v_dot2c_f32_bf16_dpp v18, v35, v255 row_newbcast:15 row_mask:0xf bank_mask:0xf
    v_dot2c_f32_bf16_dpp v19, v54, v255 row_newbcast:15 row_mask:0xf bank_mask:0xf
    s_nop 2
    ds_write_b128 v6, v[12:15] offset:0
    ds_write_b128 v6, v[16:19] offset:16
    s_lshl_b32 s7, s5, 3
    v_mov_b32 v7, s7
    s_mov_b64 exec, 1
    ds_write_b64 v7, v[60:61] offset:18432
    s_mov_b64 exec, -1
    s_waitcnt lgkmcnt(0)
    s_barrier
    v_lshrrev_b32 v55, 4, v0
    v_lshlrev_b32 v7, 3, v55
    ds_read_b64 v[60:61], v7 offset:18432
    v_lshlrev_b32 v7, 11, v55
    v_and_b32 v55, 15, v0
    v_lshl_add_u32 v7, v55, 2, v7
    s_lshl_b32 s7, s5, 7
    v_add_u32 v7, s7, v7
    ds_read_b32 v36, v7 offset:0
    ds_read_b32 v37, v7 offset:512
    ds_read_b32 v38, v7 offset:1024
    ds_read_b32 v39, v7 offset:1536
    ds_read_b32 v40, v7 offset:64
    ds_read_b32 v41, v7 offset:576
    ds_read_b32 v42, v7 offset:1088
    ds_read_b32 v43, v7 offset:1600
    s_waitcnt lgkmcnt(0)
    v_mov_b32 v62, v60
    v_mov_b32 v63, v62
    s_nop 1
    v_permlane16_swap_b32 v63, v62
    s_nop 1
    v_max_f32 v62, v62, v63
    v_mov_b32 v63, v62
    s_nop 1
    v_permlane32_swap_b32 v63, v62
    s_nop 1
    v_max_f32 v62, v62, v63
    v_sub_f32 v60, v60, v62
    v_exp_f32 v60, v60
    s_nop 0
    v_mul_f32 v61, v61, v60
    v_add_f32 v36, v36, v37
    v_add_f32 v38, v38, v39
    v_add_f32 v36, v36, v38
    v_mul_f32 v36, v36, v60
    v_add_f32 v40, v40, v41
    v_add_f32 v42, v42, v43
    v_add_f32 v40, v40, v42
    v_mul_f32 v40, v40, v60
    v_mov_b32 v63, v61
    v_mov_b32 v44, v36
    v_mov_b32 v45, v40
    s_nop 1
    v_permlane16_swap_b32 v63, v61
    v_permlane16_swap_b32 v44, v36
    v_permlane16_swap_b32 v45, v40
    s_nop 1
    v_add_f32 v61, v61, v63
    v_add_f32 v36, v36, v44
    v_add_f32 v40, v40, v45
    v_mov_b32 v63, v61
    v_mov_b32 v44, v36
    v_mov_b32 v45, v40
    s_nop 1
    v_permlane32_swap_b32 v63, v61
    v_permlane32_swap_b32 v44, v36
    v_permlane32_swap_b32 v45, v40
    s_nop 1
    v_add_f32 v61, v61, v63
    v_add_f32 v36, v36, v44
    v_add_f32 v40, v40, v45
    v_rcp_f32 v61, v61
    s_nop 0
    v_mul_f32 v36, v36, v61
    v_mul_f32 v40, v40, v61
    v_cvt_pk_bf16_f32 v60, v36, 0
    v_cvt_pk_bf16_f32 v61, v40, 0
    v_lshlrev_b32 v62, 16, v60
    v_lshlrev_b32 v63, 16, v61
    v_mov_b32 v12, 0
    v_mov_b32 v13, 0
    v_mov_b32 v14, 0
    v_mov_b32 v15, 0
    v_mov_b32 v16, 0
    v_mov_b32 v17, 0
    v_mov_b32 v18, 0
    v_mov_b32 v19, 0
    s_waitcnt vmcnt(15)
    v_dot2c_f32_bf16_dpp v12, v60, v96 row_newbcast:0 row_mask:0xf bank_mask:0xf
    v_dot2c_f32_bf16_dpp v13, v62, v96 row_newbcast:0 row_mask:0xf bank_mask:0xf
    v_dot2c_f32_bf16_dpp v14, v60, v97 row_newbcast:0 row_mask:0xf bank_mask:0xf
    v_dot2c_f32_bf16_dpp v15, v62, v97 row_newbcast:0 row_mask:0xf bank_mask:0xf
    v_dot2c_f32_bf16_dpp v16, v60, v98 row_newbcast:0 row_mask:0xf bank_mask:0xf
    v_dot2c_f32_bf16_dpp v17, v62, v98 row_newbcast:0 row_mask:0xf bank_mask:0xf
    v_dot2c_f32_bf16_dpp v18, v60, v99 row_newbcast:0 row_mask:0xf bank_mask:0xf
    v_dot2c_f32_bf16_dpp v19, v62, v99 row_newbcast:0 row_mask:0xf bank_mask:0xf
    s_mov_b32 s6, 16384
    buffer_load_dwordx4 v[96:99], v3, s[20:23], s6 offen
    s_waitcnt vmcnt(15)
    v_dot2c_f32_bf16_dpp v12, v60, v100 row_newbcast:1 row_mask:0xf bank_mask:0xf
    v_dot2c_f32_bf16_dpp v13, v62, v100 row_newbcast:1 row_mask:0xf bank_mask:0xf
    v_dot2c_f32_bf16_dpp v14, v60, v101 row_newbcast:1 row_mask:0xf bank_mask:0xf
    v_dot2c_f32_bf16_dpp v15, v62, v101 row_newbcast:1 row_mask:0xf bank_mask:0xf
    v_dot2c_f32_bf16_dpp v16, v60, v102 row_newbcast:1 row_mask:0xf bank_mask:0xf
    v_dot2c_f32_bf16_dpp v17, v62, v102 row_newbcast:1 row_mask:0xf bank_mask:0xf
    v_dot2c_f32_bf16_dpp v18, v60, v103 row_newbcast:1 row_mask:0xf bank_mask:0xf
    v_dot2c_f32_bf16_dpp v19, v62, v103 row_newbcast:1 row_mask:0xf bank_mask:0xf
    buffer_load_dwordx4 v[100:103], v3, s[20:23], s6 offen offset:1024
    s_waitcnt vmcnt(15)
    v_dot2c_f32_bf16_dpp v12, v60, v104 row_newbcast:2 row_mask:0xf bank_mask:0xf
    v_dot2c_f32_bf16_dpp v13, v62, v104 row_newbcast:2 row_mask:0xf bank_mask:0xf
    v_dot2c_f32_bf16_dpp v14, v60, v105 row_newbcast:2 row_mask:0xf bank_mask:0xf
    v_dot2c_f32_bf16_dpp v15, v62, v105 row_newbcast:2 row_mask:0xf bank_mask:0xf
    v_dot2c_f32_bf16_dpp v16, v60, v106 row_newbcast:2 row_mask:0xf bank_mask:0xf
    v_dot2c_f32_bf16_dpp v17, v62, v106 row_newbcast:2 row_mask:0xf bank_mask:0xf
    v_dot2c_f32_bf16_dpp v18, v60, v107 row_newbcast:2 row_mask:0xf bank_mask:0xf
    v_dot2c_f32_bf16_dpp v19, v62, v107 row_newbcast:2 row_mask:0xf bank_mask:0xf
    buffer_load_dwordx4 v[104:107], v3, s[20:23], s6 offen offset:2048
    s_waitcnt vmcnt(15)
    v_dot2c_f32_bf16_dpp v12, v60, v108 row_newbcast:3 row_mask:0xf bank_mask:0xf
    v_dot2c_f32_bf16_dpp v13, v62, v108 row_newbcast:3 row_mask:0xf bank_mask:0xf
    v_dot2c_f32_bf16_dpp v14, v60, v109 row_newbcast:3 row_mask:0xf bank_mask:0xf
    v_dot2c_f32_bf16_dpp v15, v62, v109 row_newbcast:3 row_mask:0xf bank_mask:0xf
    v_dot2c_f32_bf16_dpp v16, v60, v110 row_newbcast:3 row_mask:0xf bank_mask:0xf
    v_dot2c_f32_bf16_dpp v17, v62, v110 row_newbcast:3 row_mask:0xf bank_mask:0xf
    v_dot2c_f32_bf16_dpp v18, v60, v111 row_newbcast:3 row_mask:0xf bank_mask:0xf
    v_dot2c_f32_bf16_dpp v19, v62, v111 row_newbcast:3 row_mask:0xf bank_mask:0xf
    buffer_load_dwordx4 v[108:111], v3, s[20:23], s6 offen offset:3072
    s_waitcnt vmcnt(15)
    v_dot2c_f32_bf16_dpp v12, v60, v112 row_newbcast:4 row_mask:0xf bank_mask:0xf
    v_dot2c_f32_bf16_dpp v13, v62, v112 row_newbcast:4 row_mask:0xf bank_mask:0xf
    v_dot2c_f32_bf16_dpp v14, v60, v113 row_newbcast:4 row_mask:0xf bank_mask:0xf
    v_dot2c_f32_bf16_dpp v15, v62, v113 row_newbcast:4 row_mask:0xf bank_mask:0xf
    v_dot2c_f32_bf16_dpp v16, v60, v114 row_newbcast:4 row_mask:0xf bank_mask:0xf
    v_dot2c_f32_bf16_dpp v17, v62, v114 row_newbcast:4 row_mask:0xf bank_mask:0xf
    v_dot2c_f32_bf16_dpp v18, v60, v115 row_newbcast:4 row_mask:0xf bank_mask:0xf
    v_dot2c_f32_bf16_dpp v19, v62, v115 row_newbcast:4 row_mask:0xf bank_mask:0xf
    s_mov_b32 s6, 20480
    buffer_load_dwordx4 v[112:115], v3, s[20:23], s6 offen
    s_waitcnt vmcnt(15)
    v_dot2c_f32_bf16_dpp v12, v60, v116 row_newbcast:5 row_mask:0xf bank_mask:0xf
    v_dot2c_f32_bf16_dpp v13, v62, v116 row_newbcast:5 row_mask:0xf bank_mask:0xf
    v_dot2c_f32_bf16_dpp v14, v60, v117 row_newbcast:5 row_mask:0xf bank_mask:0xf
    v_dot2c_f32_bf16_dpp v15, v62, v117 row_newbcast:5 row_mask:0xf bank_mask:0xf
    v_dot2c_f32_bf16_dpp v16, v60, v118 row_newbcast:5 row_mask:0xf bank_mask:0xf
    v_dot2c_f32_bf16_dpp v17, v62, v118 row_newbcast:5 row_mask:0xf bank_mask:0xf
    v_dot2c_f32_bf16_dpp v18, v60, v119 row_newbcast:5 row_mask:0xf bank_mask:0xf
    v_dot2c_f32_bf16_dpp v19, v62, v119 row_newbcast:5 row_mask:0xf bank_mask:0xf
    buffer_load_dwordx4 v[116:119], v3, s[20:23], s6 offen offset:1024
    s_waitcnt vmcnt(15)
    v_dot2c_f32_bf16_dpp v12, v60, v120 row_newbcast:6 row_mask:0xf bank_mask:0xf
    v_dot2c_f32_bf16_dpp v13, v62, v120 row_newbcast:6 row_mask:0xf bank_mask:0xf
    v_dot2c_f32_bf16_dpp v14, v60, v121 row_newbcast:6 row_mask:0xf bank_mask:0xf
    v_dot2c_f32_bf16_dpp v15, v62, v121 row_newbcast:6 row_mask:0xf bank_mask:0xf
    v_dot2c_f32_bf16_dpp v16, v60, v122 row_newbcast:6 row_mask:0xf bank_mask:0xf
    v_dot2c_f32_bf16_dpp v17, v62, v122 row_newbcast:6 row_mask:0xf bank_mask:0xf
    v_dot2c_f32_bf16_dpp v18, v60, v123 row_newbcast:6 row_mask:0xf bank_mask:0xf
    v_dot2c_f32_bf16_dpp v19, v62, v123 row_newbcast:6 row_mask:0xf bank_mask:0xf
    buffer_load_dwordx4 v[120:123], v3, s[20:23], s6 offen offset:2048
    s_waitcnt vmcnt(15)
    v_dot2c_f32_bf16_dpp v12, v60, v124 row_newbcast:7 row_mask:0xf bank_mask:0xf
    v_dot2c_f32_bf16_dpp v13, v62, v124 row_newbcast:7 row_mask:0xf bank_mask:0xf
    v_dot2c_f32_bf16_dpp v14, v60, v125 row_newbcast:7 row_mask:0xf bank_mask:0xf
    v_dot2c_f32_bf16_dpp v15, v62, v125 row_newbcast:7 row_mask:0xf bank_mask:0xf
    v_dot2c_f32_bf16_dpp v16, v60, v126 row_newbcast:7 row_mask:0xf bank_mask:0xf
    v_dot2c_f32_bf16_dpp v17, v62, v126 row_newbcast:7 row_mask:0xf bank_mask:0xf
    v_dot2c_f32_bf16_dpp v18, v60, v127 row_newbcast:7 row_mask:0xf bank_mask:0xf
    v_dot2c_f32_bf16_dpp v19, v62, v127 row_newbcast:7 row_mask:0xf bank_mask:0xf
    buffer_load_dwordx4 v[124:127], v3, s[20:23], s6 offen offset:3072
    s_waitcnt vmcnt(15)
    v_dot2c_f32_bf16_dpp v12, v60, v64 row_newbcast:8 row_mask:0xf bank_mask:0xf
    v_dot2c_f32_bf16_dpp v13, v62, v64 row_newbcast:8 row_mask:0xf bank_mask:0xf
    v_dot2c_f32_bf16_dpp v14, v60, v65 row_newbcast:8 row_mask:0xf bank_mask:0xf
    v_dot2c_f32_bf16_dpp v15, v62, v65 row_newbcast:8 row_mask:0xf bank_mask:0xf
    v_dot2c_f32_bf16_dpp v16, v60, v66 row_newbcast:8 row_mask:0xf bank_mask:0xf
    v_dot2c_f32_bf16_dpp v17, v62, v66 row_newbcast:8 row_mask:0xf bank_mask:0xf
    v_dot2c_f32_bf16_dpp v18, v60, v67 row_newbcast:8 row_mask:0xf bank_mask:0xf
    v_dot2c_f32_bf16_dpp v19, v62, v67 row_newbcast:8 row_mask:0xf bank_mask:0xf
    s_mov_b32 s6, 24576
    buffer_load_dwordx4 v[64:67], v3, s[20:23], s6 offen
    s_waitcnt vmcnt(15)
    v_dot2c_f32_bf16_dpp v12, v60, v68 row_newbcast:9 row_mask:0xf bank_mask:0xf
    v_dot2c_f32_bf16_dpp v13, v62, v68 row_newbcast:9 row_mask:0xf bank_mask:0xf
    v_dot2c_f32_bf16_dpp v14, v60, v69 row_newbcast:9 row_mask:0xf bank_mask:0xf
    v_dot2c_f32_bf16_dpp v15, v62, v69 row_newbcast:9 row_mask:0xf bank_mask:0xf
    v_dot2c_f32_bf16_dpp v16, v60, v70 row_newbcast:9 row_mask:0xf bank_mask:0xf
    v_dot2c_f32_bf16_dpp v17, v62, v70 row_newbcast:9 row_mask:0xf bank_mask:0xf
    v_dot2c_f32_bf16_dpp v18, v60, v71 row_newbcast:9 row_mask:0xf bank_mask:0xf
    v_dot2c_f32_bf16_dpp v19, v62, v71 row_newbcast:9 row_mask:0xf bank_mask:0xf
    buffer_load_dwordx4 v[68:71], v3, s[20:23], s6 offen offset:1024
    s_waitcnt vmcnt(15)
    v_dot2c_f32_bf16_dpp v12, v60, v72 row_newbcast:10 row_mask:0xf bank_mask:0xf
    v_dot2c_f32_bf16_dpp v13, v62, v72 row_newbcast:10 row_mask:0xf bank_mask:0xf
    v_dot2c_f32_bf16_dpp v14, v60, v73 row_newbcast:10 row_mask:0xf bank_mask:0xf
    v_dot2c_f32_bf16_dpp v15, v62, v73 row_newbcast:10 row_mask:0xf bank_mask:0xf
    v_dot2c_f32_bf16_dpp v16, v60, v74 row_newbcast:10 row_mask:0xf bank_mask:0xf
    v_dot2c_f32_bf16_dpp v17, v62, v74 row_newbcast:10 row_mask:0xf bank_mask:0xf
    v_dot2c_f32_bf16_dpp v18, v60, v75 row_newbcast:10 row_mask:0xf bank_mask:0xf
    v_dot2c_f32_bf16_dpp v19, v62, v75 row_newbcast:10 row_mask:0xf bank_mask:0xf
    buffer_load_dwordx4 v[72:75], v3, s[20:23], s6 offen offset:2048
    s_waitcnt vmcnt(15)
    v_dot2c_f32_bf16_dpp v12, v60, v76 row_newbcast:11 row_mask:0xf bank_mask:0xf
    v_dot2c_f32_bf16_dpp v13, v62, v76 row_newbcast:11 row_mask:0xf bank_mask:0xf
    v_dot2c_f32_bf16_dpp v14, v60, v77 row_newbcast:11 row_mask:0xf bank_mask:0xf
    v_dot2c_f32_bf16_dpp v15, v62, v77 row_newbcast:11 row_mask:0xf bank_mask:0xf
    v_dot2c_f32_bf16_dpp v16, v60, v78 row_newbcast:11 row_mask:0xf bank_mask:0xf
    v_dot2c_f32_bf16_dpp v17, v62, v78 row_newbcast:11 row_mask:0xf bank_mask:0xf
    v_dot2c_f32_bf16_dpp v18, v60, v79 row_newbcast:11 row_mask:0xf bank_mask:0xf
    v_dot2c_f32_bf16_dpp v19, v62, v79 row_newbcast:11 row_mask:0xf bank_mask:0xf
    buffer_load_dwordx4 v[76:79], v3, s[20:23], s6 offen offset:3072
    s_waitcnt vmcnt(15)
    v_dot2c_f32_bf16_dpp v12, v60, v80 row_newbcast:12 row_mask:0xf bank_mask:0xf
    v_dot2c_f32_bf16_dpp v13, v62, v80 row_newbcast:12 row_mask:0xf bank_mask:0xf
    v_dot2c_f32_bf16_dpp v14, v60, v81 row_newbcast:12 row_mask:0xf bank_mask:0xf
    v_dot2c_f32_bf16_dpp v15, v62, v81 row_newbcast:12 row_mask:0xf bank_mask:0xf
    v_dot2c_f32_bf16_dpp v16, v60, v82 row_newbcast:12 row_mask:0xf bank_mask:0xf
    v_dot2c_f32_bf16_dpp v17, v62, v82 row_newbcast:12 row_mask:0xf bank_mask:0xf
    v_dot2c_f32_bf16_dpp v18, v60, v83 row_newbcast:12 row_mask:0xf bank_mask:0xf
    v_dot2c_f32_bf16_dpp v19, v62, v83 row_newbcast:12 row_mask:0xf bank_mask:0xf
    s_mov_b32 s6, 28672
    buffer_load_dwordx4 v[80:83], v3, s[20:23], s6 offen
    s_waitcnt vmcnt(15)
    v_dot2c_f32_bf16_dpp v12, v60, v84 row_newbcast:13 row_mask:0xf bank_mask:0xf
    v_dot2c_f32_bf16_dpp v13, v62, v84 row_newbcast:13 row_mask:0xf bank_mask:0xf
    v_dot2c_f32_bf16_dpp v14, v60, v85 row_newbcast:13 row_mask:0xf bank_mask:0xf
    v_dot2c_f32_bf16_dpp v15, v62, v85 row_newbcast:13 row_mask:0xf bank_mask:0xf
    v_dot2c_f32_bf16_dpp v16, v60, v86 row_newbcast:13 row_mask:0xf bank_mask:0xf
    v_dot2c_f32_bf16_dpp v17, v62, v86 row_newbcast:13 row_mask:0xf bank_mask:0xf
    v_dot2c_f32_bf16_dpp v18, v60, v87 row_newbcast:13 row_mask:0xf bank_mask:0xf
    v_dot2c_f32_bf16_dpp v19, v62, v87 row_newbcast:13 row_mask:0xf bank_mask:0xf
    buffer_load_dwordx4 v[84:87], v3, s[20:23], s6 offen offset:1024
    s_waitcnt vmcnt(15)
    v_dot2c_f32_bf16_dpp v12, v60, v88 row_newbcast:14 row_mask:0xf bank_mask:0xf
    v_dot2c_f32_bf16_dpp v13, v62, v88 row_newbcast:14 row_mask:0xf bank_mask:0xf
    v_dot2c_f32_bf16_dpp v14, v60, v89 row_newbcast:14 row_mask:0xf bank_mask:0xf
    v_dot2c_f32_bf16_dpp v15, v62, v89 row_newbcast:14 row_mask:0xf bank_mask:0xf
    v_dot2c_f32_bf16_dpp v16, v60, v90 row_newbcast:14 row_mask:0xf bank_mask:0xf
    v_dot2c_f32_bf16_dpp v17, v62, v90 row_newbcast:14 row_mask:0xf bank_mask:0xf
    v_dot2c_f32_bf16_dpp v18, v60, v91 row_newbcast:14 row_mask:0xf bank_mask:0xf
    v_dot2c_f32_bf16_dpp v19, v62, v91 row_newbcast:14 row_mask:0xf bank_mask:0xf
    buffer_load_dwordx4 v[88:91], v3, s[20:23], s6 offen offset:2048
    s_waitcnt vmcnt(15)
    v_dot2c_f32_bf16_dpp v12, v60, v92 row_newbcast:15 row_mask:0xf bank_mask:0xf
    v_dot2c_f32_bf16_dpp v13, v62, v92 row_newbcast:15 row_mask:0xf bank_mask:0xf
    v_dot2c_f32_bf16_dpp v14, v60, v93 row_newbcast:15 row_mask:0xf bank_mask:0xf
    v_dot2c_f32_bf16_dpp v15, v62, v93 row_newbcast:15 row_mask:0xf bank_mask:0xf
    v_dot2c_f32_bf16_dpp v16, v60, v94 row_newbcast:15 row_mask:0xf bank_mask:0xf
    v_dot2c_f32_bf16_dpp v17, v62, v94 row_newbcast:15 row_mask:0xf bank_mask:0xf
    v_dot2c_f32_bf16_dpp v18, v60, v95 row_newbcast:15 row_mask:0xf bank_mask:0xf
    v_dot2c_f32_bf16_dpp v19, v62, v95 row_newbcast:15 row_mask:0xf bank_mask:0xf
    buffer_load_dwordx4 v[92:95], v3, s[20:23], s6 offen offset:3072
    s_waitcnt vmcnt(15)
    v_dot2c_f32_bf16_dpp v12, v61, v96 row_newbcast:0 row_mask:0xf bank_mask:0xf
    v_dot2c_f32_bf16_dpp v13, v63, v96 row_newbcast:0 row_mask:0xf bank_mask:0xf
    v_dot2c_f32_bf16_dpp v14, v61, v97 row_newbcast:0 row_mask:0xf bank_mask:0xf
    v_dot2c_f32_bf16_dpp v15, v63, v97 row_newbcast:0 row_mask:0xf bank_mask:0xf
    v_dot2c_f32_bf16_dpp v16, v61, v98 row_newbcast:0 row_mask:0xf bank_mask:0xf
    v_dot2c_f32_bf16_dpp v17, v63, v98 row_newbcast:0 row_mask:0xf bank_mask:0xf
    v_dot2c_f32_bf16_dpp v18, v61, v99 row_newbcast:0 row_mask:0xf bank_mask:0xf
    v_dot2c_f32_bf16_dpp v19, v63, v99 row_newbcast:0 row_mask:0xf bank_mask:0xf
    buffer_load_dwordx4 v[96:99], v4, s[24:27], 0 offen
    s_waitcnt vmcnt(15)
    v_dot2c_f32_bf16_dpp v12, v61, v100 row_newbcast:1 row_mask:0xf bank_mask:0xf
    v_dot2c_f32_bf16_dpp v13, v63, v100 row_newbcast:1 row_mask:0xf bank_mask:0xf
    v_dot2c_f32_bf16_dpp v14, v61, v101 row_newbcast:1 row_mask:0xf bank_mask:0xf
    v_dot2c_f32_bf16_dpp v15, v63, v101 row_newbcast:1 row_mask:0xf bank_mask:0xf
    v_dot2c_f32_bf16_dpp v16, v61, v102 row_newbcast:1 row_mask:0xf bank_mask:0xf
    v_dot2c_f32_bf16_dpp v17, v63, v102 row_newbcast:1 row_mask:0xf bank_mask:0xf
    v_dot2c_f32_bf16_dpp v18, v61, v103 row_newbcast:1 row_mask:0xf bank_mask:0xf
    v_dot2c_f32_bf16_dpp v19, v63, v103 row_newbcast:1 row_mask:0xf bank_mask:0xf
    s_mov_b32 s6, 3584
    buffer_load_dwordx4 v[100:103], v4, s[24:27], s6 offen
    s_waitcnt vmcnt(15)
    v_dot2c_f32_bf16_dpp v12, v61, v104 row_newbcast:2 row_mask:0xf bank_mask:0xf
    v_dot2c_f32_bf16_dpp v13, v63, v104 row_newbcast:2 row_mask:0xf bank_mask:0xf
    v_dot2c_f32_bf16_dpp v14, v61, v105 row_newbcast:2 row_mask:0xf bank_mask:0xf
    v_dot2c_f32_bf16_dpp v15, v63, v105 row_newbcast:2 row_mask:0xf bank_mask:0xf
    v_dot2c_f32_bf16_dpp v16, v61, v106 row_newbcast:2 row_mask:0xf bank_mask:0xf
    v_dot2c_f32_bf16_dpp v17, v63, v106 row_newbcast:2 row_mask:0xf bank_mask:0xf
    v_dot2c_f32_bf16_dpp v18, v61, v107 row_newbcast:2 row_mask:0xf bank_mask:0xf
    v_dot2c_f32_bf16_dpp v19, v63, v107 row_newbcast:2 row_mask:0xf bank_mask:0xf
    s_mov_b32 s6, 7168
    buffer_load_dwordx4 v[104:107], v4, s[24:27], s6 offen
    s_waitcnt vmcnt(15)
    v_dot2c_f32_bf16_dpp v12, v61, v108 row_newbcast:3 row_mask:0xf bank_mask:0xf
    v_dot2c_f32_bf16_dpp v13, v63, v108 row_newbcast:3 row_mask:0xf bank_mask:0xf
    v_dot2c_f32_bf16_dpp v14, v61, v109 row_newbcast:3 row_mask:0xf bank_mask:0xf
    v_dot2c_f32_bf16_dpp v15, v63, v109 row_newbcast:3 row_mask:0xf bank_mask:0xf
    v_dot2c_f32_bf16_dpp v16, v61, v110 row_newbcast:3 row_mask:0xf bank_mask:0xf
    v_dot2c_f32_bf16_dpp v17, v63, v110 row_newbcast:3 row_mask:0xf bank_mask:0xf
    v_dot2c_f32_bf16_dpp v18, v61, v111 row_newbcast:3 row_mask:0xf bank_mask:0xf
    v_dot2c_f32_bf16_dpp v19, v63, v111 row_newbcast:3 row_mask:0xf bank_mask:0xf
    s_mov_b32 s6, 10752
    buffer_load_dwordx4 v[108:111], v4, s[24:27], s6 offen
    s_waitcnt vmcnt(15)
    v_dot2c_f32_bf16_dpp v12, v61, v112 row_newbcast:4 row_mask:0xf bank_mask:0xf
    v_dot2c_f32_bf16_dpp v13, v63, v112 row_newbcast:4 row_mask:0xf bank_mask:0xf
    v_dot2c_f32_bf16_dpp v14, v61, v113 row_newbcast:4 row_mask:0xf bank_mask:0xf
    v_dot2c_f32_bf16_dpp v15, v63, v113 row_newbcast:4 row_mask:0xf bank_mask:0xf
    v_dot2c_f32_bf16_dpp v16, v61, v114 row_newbcast:4 row_mask:0xf bank_mask:0xf
    v_dot2c_f32_bf16_dpp v17, v63, v114 row_newbcast:4 row_mask:0xf bank_mask:0xf
    v_dot2c_f32_bf16_dpp v18, v61, v115 row_newbcast:4 row_mask:0xf bank_mask:0xf
    v_dot2c_f32_bf16_dpp v19, v63, v115 row_newbcast:4 row_mask:0xf bank_mask:0xf
    s_mov_b32 s6, 14336
    buffer_load_dwordx4 v[112:115], v4, s[24:27], s6 offen
    s_waitcnt vmcnt(15)
    v_dot2c_f32_bf16_dpp v12, v61, v116 row_newbcast:5 row_mask:0xf bank_mask:0xf
    v_dot2c_f32_bf16_dpp v13, v63, v116 row_newbcast:5 row_mask:0xf bank_mask:0xf
    v_dot2c_f32_bf16_dpp v14, v61, v117 row_newbcast:5 row_mask:0xf bank_mask:0xf
    v_dot2c_f32_bf16_dpp v15, v63, v117 row_newbcast:5 row_mask:0xf bank_mask:0xf
    v_dot2c_f32_bf16_dpp v16, v61, v118 row_newbcast:5 row_mask:0xf bank_mask:0xf
    v_dot2c_f32_bf16_dpp v17, v63, v118 row_newbcast:5 row_mask:0xf bank_mask:0xf
    v_dot2c_f32_bf16_dpp v18, v61, v119 row_newbcast:5 row_mask:0xf bank_mask:0xf
    v_dot2c_f32_bf16_dpp v19, v63, v119 row_newbcast:5 row_mask:0xf bank_mask:0xf
    s_mov_b32 s6, 17920
    buffer_load_dwordx4 v[116:119], v4, s[24:27], s6 offen
    s_waitcnt vmcnt(15)
    v_dot2c_f32_bf16_dpp v12, v61, v120 row_newbcast:6 row_mask:0xf bank_mask:0xf
    v_dot2c_f32_bf16_dpp v13, v63, v120 row_newbcast:6 row_mask:0xf bank_mask:0xf
    v_dot2c_f32_bf16_dpp v14, v61, v121 row_newbcast:6 row_mask:0xf bank_mask:0xf
    v_dot2c_f32_bf16_dpp v15, v63, v121 row_newbcast:6 row_mask:0xf bank_mask:0xf
    v_dot2c_f32_bf16_dpp v16, v61, v122 row_newbcast:6 row_mask:0xf bank_mask:0xf
    v_dot2c_f32_bf16_dpp v17, v63, v122 row_newbcast:6 row_mask:0xf bank_mask:0xf
    v_dot2c_f32_bf16_dpp v18, v61, v123 row_newbcast:6 row_mask:0xf bank_mask:0xf
    v_dot2c_f32_bf16_dpp v19, v63, v123 row_newbcast:6 row_mask:0xf bank_mask:0xf
    s_mov_b32 s6, 21504
    buffer_load_dwordx4 v[120:123], v4, s[24:27], s6 offen
    s_waitcnt vmcnt(15)
    v_dot2c_f32_bf16_dpp v12, v61, v124 row_newbcast:7 row_mask:0xf bank_mask:0xf
    v_dot2c_f32_bf16_dpp v13, v63, v124 row_newbcast:7 row_mask:0xf bank_mask:0xf
    v_dot2c_f32_bf16_dpp v14, v61, v125 row_newbcast:7 row_mask:0xf bank_mask:0xf
    v_dot2c_f32_bf16_dpp v15, v63, v125 row_newbcast:7 row_mask:0xf bank_mask:0xf
    v_dot2c_f32_bf16_dpp v16, v61, v126 row_newbcast:7 row_mask:0xf bank_mask:0xf
    v_dot2c_f32_bf16_dpp v17, v63, v126 row_newbcast:7 row_mask:0xf bank_mask:0xf
    v_dot2c_f32_bf16_dpp v18, v61, v127 row_newbcast:7 row_mask:0xf bank_mask:0xf
    v_dot2c_f32_bf16_dpp v19, v63, v127 row_newbcast:7 row_mask:0xf bank_mask:0xf
    s_mov_b32 s6, 25088
    buffer_load_dwordx4 v[124:127], v4, s[24:27], s6 offen
    s_waitcnt vmcnt(15)
    v_dot2c_f32_bf16_dpp v12, v61, v64 row_newbcast:8 row_mask:0xf bank_mask:0xf
    v_dot2c_f32_bf16_dpp v13, v63, v64 row_newbcast:8 row_mask:0xf bank_mask:0xf
    v_dot2c_f32_bf16_dpp v14, v61, v65 row_newbcast:8 row_mask:0xf bank_mask:0xf
    v_dot2c_f32_bf16_dpp v15, v63, v65 row_newbcast:8 row_mask:0xf bank_mask:0xf
    v_dot2c_f32_bf16_dpp v16, v61, v66 row_newbcast:8 row_mask:0xf bank_mask:0xf
    v_dot2c_f32_bf16_dpp v17, v63, v66 row_newbcast:8 row_mask:0xf bank_mask:0xf
    v_dot2c_f32_bf16_dpp v18, v61, v67 row_newbcast:8 row_mask:0xf bank_mask:0xf
    v_dot2c_f32_bf16_dpp v19, v63, v67 row_newbcast:8 row_mask:0xf bank_mask:0xf
    s_mov_b32 s6, 28672
    buffer_load_dwordx4 v[64:67], v4, s[24:27], s6 offen
    s_waitcnt vmcnt(15)
    v_dot2c_f32_bf16_dpp v12, v61, v68 row_newbcast:9 row_mask:0xf bank_mask:0xf
    v_dot2c_f32_bf16_dpp v13, v63, v68 row_newbcast:9 row_mask:0xf bank_mask:0xf
    v_dot2c_f32_bf16_dpp v14, v61, v69 row_newbcast:9 row_mask:0xf bank_mask:0xf
    v_dot2c_f32_bf16_dpp v15, v63, v69 row_newbcast:9 row_mask:0xf bank_mask:0xf
    v_dot2c_f32_bf16_dpp v16, v61, v70 row_newbcast:9 row_mask:0xf bank_mask:0xf
    v_dot2c_f32_bf16_dpp v17, v63, v70 row_newbcast:9 row_mask:0xf bank_mask:0xf
    v_dot2c_f32_bf16_dpp v18, v61, v71 row_newbcast:9 row_mask:0xf bank_mask:0xf
    v_dot2c_f32_bf16_dpp v19, v63, v71 row_newbcast:9 row_mask:0xf bank_mask:0xf
    s_mov_b32 s6, 32256
    buffer_load_dwordx4 v[68:71], v4, s[24:27], s6 offen
    s_waitcnt vmcnt(15)
    v_dot2c_f32_bf16_dpp v12, v61, v72 row_newbcast:10 row_mask:0xf bank_mask:0xf
    v_dot2c_f32_bf16_dpp v13, v63, v72 row_newbcast:10 row_mask:0xf bank_mask:0xf
    v_dot2c_f32_bf16_dpp v14, v61, v73 row_newbcast:10 row_mask:0xf bank_mask:0xf
    v_dot2c_f32_bf16_dpp v15, v63, v73 row_newbcast:10 row_mask:0xf bank_mask:0xf
    v_dot2c_f32_bf16_dpp v16, v61, v74 row_newbcast:10 row_mask:0xf bank_mask:0xf
    v_dot2c_f32_bf16_dpp v17, v63, v74 row_newbcast:10 row_mask:0xf bank_mask:0xf
    v_dot2c_f32_bf16_dpp v18, v61, v75 row_newbcast:10 row_mask:0xf bank_mask:0xf
    v_dot2c_f32_bf16_dpp v19, v63, v75 row_newbcast:10 row_mask:0xf bank_mask:0xf
    s_mov_b32 s6, 35840
    buffer_load_dwordx4 v[72:75], v4, s[24:27], s6 offen
    s_waitcnt vmcnt(15)
    v_dot2c_f32_bf16_dpp v12, v61, v76 row_newbcast:11 row_mask:0xf bank_mask:0xf
    v_dot2c_f32_bf16_dpp v13, v63, v76 row_newbcast:11 row_mask:0xf bank_mask:0xf
    v_dot2c_f32_bf16_dpp v14, v61, v77 row_newbcast:11 row_mask:0xf bank_mask:0xf
    v_dot2c_f32_bf16_dpp v15, v63, v77 row_newbcast:11 row_mask:0xf bank_mask:0xf
    v_dot2c_f32_bf16_dpp v16, v61, v78 row_newbcast:11 row_mask:0xf bank_mask:0xf
    v_dot2c_f32_bf16_dpp v17, v63, v78 row_newbcast:11 row_mask:0xf bank_mask:0xf
    v_dot2c_f32_bf16_dpp v18, v61, v79 row_newbcast:11 row_mask:0xf bank_mask:0xf
    v_dot2c_f32_bf16_dpp v19, v63, v79 row_newbcast:11 row_mask:0xf bank_mask:0xf
    s_mov_b32 s6, 39424
    buffer_load_dwordx4 v[76:79], v4, s[24:27], s6 offen
    s_waitcnt vmcnt(15)
    v_dot2c_f32_bf16_dpp v12, v61, v80 row_newbcast:12 row_mask:0xf bank_mask:0xf
    v_dot2c_f32_bf16_dpp v13, v63, v80 row_newbcast:12 row_mask:0xf bank_mask:0xf
    v_dot2c_f32_bf16_dpp v14, v61, v81 row_newbcast:12 row_mask:0xf bank_mask:0xf
    v_dot2c_f32_bf16_dpp v15, v63, v81 row_newbcast:12 row_mask:0xf bank_mask:0xf
    v_dot2c_f32_bf16_dpp v16, v61, v82 row_newbcast:12 row_mask:0xf bank_mask:0xf
    v_dot2c_f32_bf16_dpp v17, v63, v82 row_newbcast:12 row_mask:0xf bank_mask:0xf
    v_dot2c_f32_bf16_dpp v18, v61, v83 row_newbcast:12 row_mask:0xf bank_mask:0xf
    v_dot2c_f32_bf16_dpp v19, v63, v83 row_newbcast:12 row_mask:0xf bank_mask:0xf
    s_mov_b32 s6, 43008
    buffer_load_dwordx4 v[80:83], v4, s[24:27], s6 offen
    s_waitcnt vmcnt(15)
    v_dot2c_f32_bf16_dpp v12, v61, v84 row_newbcast:13 row_mask:0xf bank_mask:0xf
    v_dot2c_f32_bf16_dpp v13, v63, v84 row_newbcast:13 row_mask:0xf bank_mask:0xf
    v_dot2c_f32_bf16_dpp v14, v61, v85 row_newbcast:13 row_mask:0xf bank_mask:0xf
    v_dot2c_f32_bf16_dpp v15, v63, v85 row_newbcast:13 row_mask:0xf bank_mask:0xf
    v_dot2c_f32_bf16_dpp v16, v61, v86 row_newbcast:13 row_mask:0xf bank_mask:0xf
    v_dot2c_f32_bf16_dpp v17, v63, v86 row_newbcast:13 row_mask:0xf bank_mask:0xf
    v_dot2c_f32_bf16_dpp v18, v61, v87 row_newbcast:13 row_mask:0xf bank_mask:0xf
    v_dot2c_f32_bf16_dpp v19, v63, v87 row_newbcast:13 row_mask:0xf bank_mask:0xf
    s_mov_b32 s6, 46592
    buffer_load_dwordx4 v[84:87], v4, s[24:27], s6 offen
    s_waitcnt vmcnt(15)
    v_dot2c_f32_bf16_dpp v12, v61, v88 row_newbcast:14 row_mask:0xf bank_mask:0xf
    v_dot2c_f32_bf16_dpp v13, v63, v88 row_newbcast:14 row_mask:0xf bank_mask:0xf
    v_dot2c_f32_bf16_dpp v14, v61, v89 row_newbcast:14 row_mask:0xf bank_mask:0xf
    v_dot2c_f32_bf16_dpp v15, v63, v89 row_newbcast:14 row_mask:0xf bank_mask:0xf
    v_dot2c_f32_bf16_dpp v16, v61, v90 row_newbcast:14 row_mask:0xf bank_mask:0xf
    v_dot2c_f32_bf16_dpp v17, v63, v90 row_newbcast:14 row_mask:0xf bank_mask:0xf
    v_dot2c_f32_bf16_dpp v18, v61, v91 row_newbcast:14 row_mask:0xf bank_mask:0xf
    v_dot2c_f32_bf16_dpp v19, v63, v91 row_newbcast:14 row_mask:0xf bank_mask:0xf
    s_mov_b32 s6, 50176
    buffer_load_dwordx4 v[88:91], v4, s[24:27], s6 offen
    s_waitcnt vmcnt(15)
    v_dot2c_f32_bf16_dpp v12, v61, v92 row_newbcast:15 row_mask:0xf bank_mask:0xf
    v_dot2c_f32_bf16_dpp v13, v63, v92 row_newbcast:15 row_mask:0xf bank_mask:0xf
    v_dot2c_f32_bf16_dpp v14, v61, v93 row_newbcast:15 row_mask:0xf bank_mask:0xf
    v_dot2c_f32_bf16_dpp v15, v63, v93 row_newbcast:15 row_mask:0xf bank_mask:0xf
    v_dot2c_f32_bf16_dpp v16, v61, v94 row_newbcast:15 row_mask:0xf bank_mask:0xf
    v_dot2c_f32_bf16_dpp v17, v63, v94 row_newbcast:15 row_mask:0xf bank_mask:0xf
    v_dot2c_f32_bf16_dpp v18, v61, v95 row_newbcast:15 row_mask:0xf bank_mask:0xf
    v_dot2c_f32_bf16_dpp v19, v63, v95 row_newbcast:15 row_mask:0xf bank_mask:0xf
    s_mov_b32 s6, 53760
    buffer_load_dwordx4 v[92:95], v4, s[24:27], s6 offen
    s_nop 2
    ds_write_b128 v6, v[12:15] offset:8192
    ds_write_b128 v6, v[16:19] offset:8208
    s_waitcnt lgkmcnt(0)
    s_barrier
    s_cmp_ge_u32 s5, 2
    s_cbranch_scc1 NOPUB_430
    s_lshl_b32 s7, s5, 10
    v_lshl_add_u32 v7, v0, 4, s7
    ds_read_b128 v[36:39], v7 offset:8192
    ds_read_b128 v[40:43], v7 offset:10240
    ds_read_b128 v[44:47], v7 offset:12288
    ds_read_b128 v[48:51], v7 offset:14336
    v_lshrrev_b32 v55, 6, v7
    v_lshlrev_b32 v55, 11, v55
    v_and_b32 v7, 48, v7
    v_add_u32 v55, v55, v7
    s_lshl_b32 s7, s3, 16
    s_lshl_b32 s6, s4, 6
    s_add_u32 s7, s7, s6
    s_add_u32 s7, s7, 1048576
    s_waitcnt lgkmcnt(0)
    v_add_f32 v36, v36, v40
    v_add_f32 v44, v44, v48
    v_add_f32 v37, v37, v41
    v_add_f32 v45, v45, v49
    v_add_f32 v38, v38, v42
    v_add_f32 v46, v46, v50
    v_add_f32 v39, v39, v43
    v_add_f32 v47, v47, v51
    v_add_f32 v36, v36, v44
    v_add_f32 v37, v37, v45
    v_add_f32 v38, v38, v46
    v_add_f32 v39, v39, v47
    buffer_store_dwordx4 v[36:39], v55, s[32:35], s7 offen sc0 sc1
NOPUB_430:
    s_cmp_lg_u32 s5, 0
    s_cbranch_scc1 NOHOP_431
    s_lshl_b32 s7, s3, 16
    s_lshl_b32 s6, s4, 11
    s_add_u32 s7, s7, s6
    s_add_u32 s7, s7, 1048576
    v_lshlrev_b32 v7, 4, v0
    s_mov_b32 s78, 0x20000
HA_433:
    buffer_load_dwordx4 v[36:39], v7, s[32:35], s7 offen sc0 sc1
    buffer_load_dwordx4 v[40:43], v7, s[32:35], s7 offen offset:1024 sc0 sc1
    s_waitcnt vmcnt(0)
    v_max3_u32 v63, v36, v37, v38
    v_max3_u32 v63, v63, v39, v40
    v_max3_u32 v63, v63, v41, v42
    v_max_u32 v63, v63, v43
    v_cmp_eq_u32 vcc, -1, v63
    s_cbranch_vccz HAOK_434
    s_sub_u32 s78, s78, 1
    s_cmp_eq_u32 s78, 0
    s_cbranch_scc0 HA_433
HAOK_434:
    v_add_f32 v36, v36, v40
    v_add_f32 v37, v37, v41
    v_add_f32 v38, v38, v42
    v_add_f32 v39, v39, v43
    s_nop 1
    v_add_f32_dpp v36, v36, v36 row_ror:4 row_mask:0xf bank_mask:0xf
    v_add_f32_dpp v37, v37, v37 row_ror:4 row_mask:0xf bank_mask:0xf
    v_add_f32_dpp v38, v38, v38 row_ror:4 row_mask:0xf bank_mask:0xf
    v_add_f32_dpp v39, v39, v39 row_ror:4 row_mask:0xf bank_mask:0xf
    s_nop 1
    v_add_f32_dpp v36, v36, v36 row_ror:8 row_mask:0xf bank_mask:0xf
    v_add_f32_dpp v37, v37, v37 row_ror:8 row_mask:0xf bank_mask:0xf
    v_add_f32_dpp v38, v38, v38 row_ror:8 row_mask:0xf bank_mask:0xf
    v_add_f32_dpp v39, v39, v39 row_ror:8 row_mask:0xf bank_mask:0xf
    v_mov_b32 v40, v36
    v_mov_b32 v41, v37
    v_mov_b32 v42, v38
    v_mov_b32 v43, v39
    s_nop 1
    v_permlane16_swap_b32 v40, v36
    v_permlane16_swap_b32 v41, v37
    v_permlane16_swap_b32 v42, v38
    v_permlane16_swap_b32 v43, v39
    s_nop 1
    v_add_f32 v36, v36, v40
    v_add_f32 v37, v37, v41
    v_add_f32 v38, v38, v42
    v_add_f32 v39, v39, v43
    v_mov_b32 v40, v36
    v_mov_b32 v41, v37
    v_mov_b32 v42, v38
    v_mov_b32 v43, v39
    s_nop 1
    v_permlane32_swap_b32 v40, v36
    v_permlane32_swap_b32 v41, v37
    v_permlane32_swap_b32 v42, v38
    v_permlane32_swap_b32 v43, v39
    s_nop 1
    v_add_f32 v36, v36, v40
    v_add_f32 v37, v37, v41
    v_add_f32 v38, v38, v42
    v_add_f32 v39, v39, v43
    v_cvt_pk_bf16_f32 v40, v36, v37
    v_cvt_pk_bf16_f32 v41, v38, v39
    v_lshlrev_b32 v36, 16, v40
    v_and_b32 v37, 0xffff0000, v40
    v_lshlrev_b32 v38, 16, v41
    v_and_b32 v39, 0xffff0000, v41
    v_add_f32 v36, v36, v56
    v_add_f32 v37, v37, v57
    v_add_f32 v38, v38, v58
    v_add_f32 v39, v39, v59
    v_cvt_pk_bf16_f32 v40, v36, v37
    v_cvt_pk_bf16_f32 v41, v38, v39
    v_lshlrev_b32 v56, 16, v40
    v_and_b32 v57, 0xffff0000, v40
    v_lshlrev_b32 v58, 16, v41
    v_and_b32 v59, 0xffff0000, v41
    v_lshrrev_b32 v55, 2, v0
    v_lshlrev_b32 v55, 11, v55
    v_and_b32 v7, 3, v0
    v_lshl_add_u32 v55, v7, 4, v55
    s_lshl_b32 s7, s3, 16
    s_lshl_b32 s6, s4, 6
    s_add_u32 s7, s7, s6
    s_add_u32 s7, s7, 3145728
    s_add_u32 s6, s7, 32768
    buffer_store_dwordx4 v[56:59], v55, s[32:35], s7 offen sc0 sc1
    buffer_store_dwordx4 v[56:59], v55, s[32:35], s6 offen sc0 sc1
    s_lshl_b32 s7, s3, 16
    s_lshl_b32 s6, s4, 11
    s_add_u32 s7, s7, s6
    s_add_u32 s7, s7, 3145728
    v_lshlrev_b32 v7, 5, v0
    s_mov_b32 s78, 0x20000
HB_435:
    buffer_load_dwordx4 v[36:39], v7, s[32:35], s7 offen sc0 sc1
    buffer_load_dwordx4 v[40:43], v7, s[32:35], s7 offen offset:16 sc0 sc1
    s_waitcnt vmcnt(0)
    v_max3_u32 v63, v36, v37, v38
    v_max3_u32 v63, v63, v39, v40
    v_max3_u32 v63, v63, v41, v42
    v_max_u32 v63, v63, v43
    v_cmp_eq_u32 vcc, -1, v63
    s_cbranch_vccz HBOK_436
    s_sub_u32 s78, s78, 1
    s_cmp_eq_u32 s78, 0
    s_cbranch_scc0 HB_435
HBOK_436:
    v_add_f32 v60, v36, v37
    v_add_f32 v60, v60, v38
    v_add_f32 v60, v60, v39
    v_add_f32 v60, v60, v40
    v_add_f32 v60, v60, v41
    v_add_f32 v60, v60, v42
    v_add_f32 v60, v60, v43
    s_nop 1
    v_add_f32_dpp v60, v60, v60 row_ror:8 row_mask:0xf bank_mask:0xf
    s_nop 1
    v_add_f32_dpp v60, v60, v60 row_ror:4 row_mask:0xf bank_mask:0xf
    s_nop 1
    v_add_f32_dpp v60, v60, v60 row_ror:2 row_mask:0xf bank_mask:0xf
    s_nop 1
    v_add_f32_dpp v60, v60, v60 row_ror:1 row_mask:0xf bank_mask:0xf
    v_mov_b32 v61, v60
    s_nop 1
    v_permlane16_swap_b32 v61, v60
    s_nop 1
    v_add_f32 v60, v60, v61
    v_mov_b32 v61, v60
    s_nop 1
    v_permlane32_swap_b32 v61, v60
    s_nop 1
    v_add_f32 v60, v60, v61
    v_mul_f32 v60, 0x3b000000, v60
    v_sub_f32 v36, v36, v60
    v_sub_f32 v37, v37, v60
    v_sub_f32 v38, v38, v60
    v_sub_f32 v39, v39, v60
    v_sub_f32 v40, v40, v60
    v_sub_f32 v41, v41, v60
    v_sub_f32 v42, v42, v60
    v_sub_f32 v43, v43, v60
    v_mul_f32 v60, v36, v36
    v_fma_f32 v60, v37, v37, v60
    v_fma_f32 v60, v38, v38, v60
    v_fma_f32 v60, v39, v39, v60
    v_fma_f32 v60, v40, v40, v60
    v_fma_f32 v60, v41, v41, v60
    v_fma_f32 v60, v42, v42, v60
    v_fma_f32 v60, v43, v43, v60
    s_nop 1
    v_add_f32_dpp v60, v60, v60 row_ror:8 row_mask:0xf bank_mask:0xf
    s_nop 1
    v_add_f32_dpp v60, v60, v60 row_ror:4 row_mask:0xf bank_mask:0xf
    s_nop 1
    v_add_f32_dpp v60, v60, v60 row_ror:2 row_mask:0xf bank_mask:0xf
    s_nop 1
    v_add_f32_dpp v60, v60, v60 row_ror:1 row_mask:0xf bank_mask:0xf
    v_mov_b32 v61, v60
    s_nop 1
    v_permlane16_swap_b32 v61, v60
    s_nop 1
    v_add_f32 v60, v60, v61
    v_mov_b32 v61, v60
    s_nop 1
    v_permlane32_swap_b32 v61, v60
    s_nop 1
    v_add_f32 v60, v60, v61
    v_mov_b32 v61, 0x3727c5ac
    v_fmac_f32 v61, 0x3b000000, v60
    v_rsq_f32 v60, v61
    s_nop 0
    v_mul_f32 v36, v36, v60
    v_mul_f32 v37, v37, v60
    v_mul_f32 v38, v38, v60
    v_mul_f32 v39, v39, v60
    v_mul_f32 v40, v40, v60
    v_mul_f32 v41, v41, v60
    v_mul_f32 v42, v42, v60
    v_mul_f32 v43, v43, v60
    v_cvt_pk_bf16_f32 v36, v36, 0
    v_cvt_pk_bf16_f32 v37, v37, 0
    v_cvt_pk_bf16_f32 v38, v38, 0
    v_cvt_pk_bf16_f32 v39, v39, 0
    v_cvt_pk_bf16_f32 v40, v40, 0
    v_cvt_pk_bf16_f32 v41, v41, 0
    v_cvt_pk_bf16_f32 v42, v42, 0
    v_cvt_pk_bf16_f32 v43, v43, 0
    v_lshlrev_b32 v7, 5, v0
    ds_write_b128 v7, v[36:39] offset:16384
    ds_write_b128 v7, v[40:43] offset:16400
    s_waitcnt lgkmcnt(0)
    s_branch HOPJOIN_432
NOHOP_431:
HOPJOIN_432:
    s_waitcnt lgkmcnt(0)
    s_barrier
    v_lshrrev_b32 v7, 3, v0
    v_lshlrev_b32 v7, 6, v7
    s_lshl_b32 s7, s5, 9
    v_add_u32 v7, s7, v7
    ds_read_b128 v[20:23], v7 offset:16384
    ds_read_b128 v[24:27], v7 offset:16400
    ds_read_b128 v[28:31], v7 offset:16416
    ds_read_b128 v[32:35], v7 offset:16432
    v_mov_b32 v12, 0
    v_mov_b32 v13, 0
    v_mov_b32 v14, 0
    v_mov_b32 v15, 0
    v_mov_b32 v16, 0
    v_mov_b32 v17, 0
    v_mov_b32 v18, 0
    v_mov_b32 v19, 0
    s_waitcnt lgkmcnt(0)
    v_lshlrev_b32 v52, 16, v20
    s_waitcnt vmcnt(15)
    v_dot2c_f32_bf16 v12, v20, v96
    v_dot2c_f32_bf16 v13, v52, v96
    v_dot2c_f32_bf16 v14, v20, v97
    v_dot2c_f32_bf16 v15, v52, v97
    v_dot2c_f32_bf16 v16, v20, v98
    v_dot2c_f32_bf16 v17, v52, v98
    v_dot2c_f32_bf16 v18, v20, v99
    v_dot2c_f32_bf16 v19, v52, v99
    buffer_load_dwordx4 v[96:99], v5, s[28:31], 0 offen
    v_lshlrev_b32 v54, 16, v21
    s_waitcnt vmcnt(15)
    v_dot2c_f32_bf16 v12, v21, v100
    v_dot2c_f32_bf16 v13, v54, v100
    v_dot2c_f32_bf16 v14, v21, v101
    v_dot2c_f32_bf16 v15, v54, v101
    v_dot2c_f32_bf16 v16, v21, v102
    v_dot2c_f32_bf16 v17, v54, v102
    v_dot2c_f32_bf16 v18, v21, v103
    v_dot2c_f32_bf16 v19, v54, v103
    buffer_load_dwordx4 v[100:103], v5, s[28:31], 0 offen offset:1024
    v_lshlrev_b32 v52, 16, v22
    s_waitcnt vmcnt(15)
    v_dot2c_f32_bf16 v12, v22, v104
    v_dot2c_f32_bf16 v13, v52, v104
    v_dot2c_f32_bf16 v14, v22, v105
    v_dot2c_f32_bf16 v15, v52, v105
    v_dot2c_f32_bf16 v16, v22, v106
    v_dot2c_f32_bf16 v17, v52, v106
    v_dot2c_f32_bf16 v18, v22, v107
    v_dot2c_f32_bf16 v19, v52, v107
    buffer_load_dwordx4 v[104:107], v5, s[28:31], 0 offen offset:2048
    v_lshlrev_b32 v54, 16, v23
    s_waitcnt vmcnt(15)
    v_dot2c_f32_bf16 v12, v23, v108
    v_dot2c_f32_bf16 v13, v54, v108
    v_dot2c_f32_bf16 v14, v23, v109
    v_dot2c_f32_bf16 v15, v54, v109
    v_dot2c_f32_bf16 v16, v23, v110
    v_dot2c_f32_bf16 v17, v54, v110
    v_dot2c_f32_bf16 v18, v23, v111
    v_dot2c_f32_bf16 v19, v54, v111
    buffer_load_dwordx4 v[108:111], v5, s[28:31], 0 offen offset:3072
    v_lshlrev_b32 v52, 16, v24
    s_waitcnt vmcnt(15)
    v_dot2c_f32_bf16 v12, v24, v112
    v_dot2c_f32_bf16 v13, v52, v112
    v_dot2c_f32_bf16 v14, v24, v113
    v_dot2c_f32_bf16 v15, v52, v113
    v_dot2c_f32_bf16 v16, v24, v114
    v_dot2c_f32_bf16 v17, v52, v114
    v_dot2c_f32_bf16 v18, v24, v115
    v_dot2c_f32_bf16 v19, v52, v115
    s_mov_b32 s6, 4096
    buffer_load_dwordx4 v[112:115], v5, s[28:31], s6 offen
    v_lshlrev_b32 v54, 16, v25
    s_waitcnt vmcnt(15)
    v_dot2c_f32_bf16 v12, v25, v116
    v_dot2c_f32_bf16 v13, v54, v116
    v_dot2c_f32_bf16 v14, v25, v117
    v_dot2c_f32_bf16 v15, v54, v117
    v_dot2c_f32_bf16 v16, v25, v118
    v_dot2c_f32_bf16 v17, v54, v118
    v_dot2c_f32_bf16 v18, v25, v119
    v_dot2c_f32_bf16 v19, v54, v119
    buffer_load_dwordx4 v[116:119], v5, s[28:31], s6 offen offset:1024
    v_lshlrev_b32 v52, 16, v26
    s_waitcnt vmcnt(15)
    v_dot2c_f32_bf16 v12, v26, v120
    v_dot2c_f32_bf16 v13, v52, v120
    v_dot2c_f32_bf16 v14, v26, v121
    v_dot2c_f32_bf16 v15, v52, v121
    v_dot2c_f32_bf16 v16, v26, v122
    v_dot2c_f32_bf16 v17, v52, v122
    v_dot2c_f32_bf16 v18, v26, v123
    v_dot2c_f32_bf16 v19, v52, v123
    buffer_load_dwordx4 v[120:123], v5, s[28:31], s6 offen offset:2048
    v_lshlrev_b32 v54, 16, v27
    s_waitcnt vmcnt(15)
    v_dot2c_f32_bf16 v12, v27, v124
    v_dot2c_f32_bf16 v13, v54, v124
    v_dot2c_f32_bf16 v14, v27, v125
    v_dot2c_f32_bf16 v15, v54, v125
    v_dot2c_f32_bf16 v16, v27, v126
    v_dot2c_f32_bf16 v17, v54, v126
    v_dot2c_f32_bf16 v18, v27, v127
    v_dot2c_f32_bf16 v19, v54, v127
    buffer_load_dwordx4 v[124:127], v5, s[28:31], s6 offen offset:3072
    v_lshlrev_b32 v52, 16, v28
    s_waitcnt vmcnt(15)
    v_dot2c_f32_bf16 v12, v28, v64
    v_dot2c_f32_bf16 v13, v52, v64
    v_dot2c_f32_bf16 v14, v28, v65
    v_dot2c_f32_bf16 v15, v52, v65
    v_dot2c_f32_bf16 v16, v28, v66
    v_dot2c_f32_bf16 v17, v52, v66
    v_dot2c_f32_bf16 v18, v28, v67
    v_dot2c_f32_bf16 v19, v52, v67
    s_mov_b32 s6, 8192
    buffer_load_dwordx4 v[64:67], v5, s[28:31], s6 offen
    v_lshlrev_b32 v54, 16, v29
    s_waitcnt vmcnt(15)
    v_dot2c_f32_bf16 v12, v29, v68
    v_dot2c_f32_bf16 v13, v54, v68
    v_dot2c_f32_bf16 v14, v29, v69
    v_dot2c_f32_bf16 v15, v54, v69
    v_dot2c_f32_bf16 v16, v29, v70
    v_dot2c_f32_bf16 v17, v54, v70
    v_dot2c_f32_bf16 v18, v29, v71
    v_dot2c_f32_bf16 v19, v54, v71
    buffer_load_dwordx4 v[68:71], v5, s[28:31], s6 offen offset:1024
    v_lshlrev_b32 v52, 16, v30
    s_waitcnt vmcnt(15)
    v_dot2c_f32_bf16 v12, v30, v72
    v_dot2c_f32_bf16 v13, v52, v72
    v_dot2c_f32_bf16 v14, v30, v73
    v_dot2c_f32_bf16 v15, v52, v73
    v_dot2c_f32_bf16 v16, v30, v74
    v_dot2c_f32_bf16 v17, v52, v74
    v_dot2c_f32_bf16 v18, v30, v75
    v_dot2c_f32_bf16 v19, v52, v75
    buffer_load_dwordx4 v[72:75], v5, s[28:31], s6 offen offset:2048
    v_lshlrev_b32 v54, 16, v31
    s_waitcnt vmcnt(15)
    v_dot2c_f32_bf16 v12, v31, v76
    v_dot2c_f32_bf16 v13, v54, v76
    v_dot2c_f32_bf16 v14, v31, v77
    v_dot2c_f32_bf16 v15, v54, v77
    v_dot2c_f32_bf16 v16, v31, v78
    v_dot2c_f32_bf16 v17, v54, v78
    v_dot2c_f32_bf16 v18, v31, v79
    v_dot2c_f32_bf16 v19, v54, v79
    buffer_load_dwordx4 v[76:79], v5, s[28:31], s6 offen offset:3072
    v_lshlrev_b32 v52, 16, v32
    s_waitcnt vmcnt(15)
    v_dot2c_f32_bf16 v12, v32, v80
    v_dot2c_f32_bf16 v13, v52, v80
    v_dot2c_f32_bf16 v14, v32, v81
    v_dot2c_f32_bf16 v15, v52, v81
    v_dot2c_f32_bf16 v16, v32, v82
    v_dot2c_f32_bf16 v17, v52, v82
    v_dot2c_f32_bf16 v18, v32, v83
    v_dot2c_f32_bf16 v19, v52, v83
    s_mov_b32 s6, 12288
    buffer_load_dwordx4 v[80:83], v5, s[28:31], s6 offen
    v_lshlrev_b32 v54, 16, v33
    s_waitcnt vmcnt(15)
    v_dot2c_f32_bf16 v12, v33, v84
    v_dot2c_f32_bf16 v13, v54, v84
    v_dot2c_f32_bf16 v14, v33, v85
    v_dot2c_f32_bf16 v15, v54, v85
    v_dot2c_f32_bf16 v16, v33, v86
    v_dot2c_f32_bf16 v17, v54, v86
    v_dot2c_f32_bf16 v18, v33, v87
    v_dot2c_f32_bf16 v19, v54, v87
    buffer_load_dwordx4 v[84:87], v5, s[28:31], s6 offen offset:1024
    v_lshlrev_b32 v52, 16, v34
    s_waitcnt vmcnt(15)
    v_dot2c_f32_bf16 v12, v34, v88
    v_dot2c_f32_bf16 v13, v52, v88
    v_dot2c_f32_bf16 v14, v34, v89
    v_dot2c_f32_bf16 v15, v52, v89
    v_dot2c_f32_bf16 v16, v34, v90
    v_dot2c_f32_bf16 v17, v52, v90
    v_dot2c_f32_bf16 v18, v34, v91
    v_dot2c_f32_bf16 v19, v52, v91
    v_lshlrev_b32 v54, 16, v35
    s_waitcnt vmcnt(14)
    v_dot2c_f32_bf16 v12, v35, v92
    v_dot2c_f32_bf16 v13, v54, v92
    v_dot2c_f32_bf16 v14, v35, v93
    v_dot2c_f32_bf16 v15, v54, v93
    v_dot2c_f32_bf16 v16, v35, v94
    v_dot2c_f32_bf16 v17, v54, v94
    v_dot2c_f32_bf16 v18, v35, v95
    v_dot2c_f32_bf16 v19, v54, v95
    s_nop 2
    ds_write_b128 v6, v[12:15] offset:0
    ds_write_b128 v6, v[16:19] offset:16
    s_waitcnt lgkmcnt(0)
    s_barrier
    v_lshrrev_b32 v7, 4, v0
    v_lshlrev_b32 v7, 11, v7
    v_and_b32 v55, 15, v0
    v_lshl_add_u32 v7, v55, 2, v7
    s_mul_i32 s7, s5, 56
    v_add_u32 v7, s7, v7
    ds_read_b32 v36, v7 offset:0
    ds_read_b32 v37, v7 offset:256
    ds_read_b32 v38, v7 offset:512
    ds_read_b32 v39, v7 offset:768
    ds_read_b32 v40, v7 offset:1024
    ds_read_b32 v41, v7 offset:1280
    ds_read_b32 v42, v7 offset:1536
    ds_read_b32 v43, v7 offset:1792
    s_waitcnt lgkmcnt(0)
    v_add_f32 v36, v36, v40
    v_add_f32 v37, v37, v41
    v_add_f32 v38, v38, v42
    v_add_f32 v39, v39, v43
    v_add_f32 v36, v36, v37
    v_add_f32 v38, v38, v39
    v_add_f32 v36, v36, v38
    v_mov_b32 v37, v36
    s_nop 1
    v_permlane16_swap_b32 v37, v36
    s_nop 1
    v_add_f32 v36, v36, v37
    v_mov_b32 v37, v36
    s_nop 1
    v_permlane32_swap_b32 v37, v36
    s_nop 1
    v_add_f32 v36, v36, v37
    v_cvt_pk_bf16_f32 v36, v36, 0
    v_lshlrev_b32 v36, 16, v36
    v_mul_f32 v37, 0xbfb8aa3b, v36
    v_exp_f32 v37, v37
    s_nop 0
    v_add_f32 v37, 1.0, v37
    v_rcp_f32 v37, v37
    s_nop 0
    v_mul_f32 v36, v36, v37
    v_cvt_pk_bf16_f32 v60, v36, 0
    v_lshlrev_b32 v62, 16, v60
    v_mov_b32 v12, 0
    v_mov_b32 v13, 0
    v_mov_b32 v14, 0
    v_mov_b32 v15, 0
    v_mov_b32 v16, 0
    v_mov_b32 v17, 0
    v_mov_b32 v18, 0
    v_mov_b32 v19, 0
    s_waitcnt vmcnt(13)
    v_dot2c_f32_bf16_dpp v12, v60, v96 row_newbcast:0 row_mask:0xf bank_mask:0xf
    v_dot2c_f32_bf16_dpp v13, v62, v96 row_newbcast:0 row_mask:0xf bank_mask:0xf
    v_dot2c_f32_bf16_dpp v14, v60, v97 row_newbcast:0 row_mask:0xf bank_mask:0xf
    v_dot2c_f32_bf16_dpp v15, v62, v97 row_newbcast:0 row_mask:0xf bank_mask:0xf
    v_dot2c_f32_bf16_dpp v16, v60, v98 row_newbcast:0 row_mask:0xf bank_mask:0xf
    v_dot2c_f32_bf16_dpp v17, v62, v98 row_newbcast:0 row_mask:0xf bank_mask:0xf
    v_dot2c_f32_bf16_dpp v18, v60, v99 row_newbcast:0 row_mask:0xf bank_mask:0xf
    v_dot2c_f32_bf16_dpp v19, v62, v99 row_newbcast:0 row_mask:0xf bank_mask:0xf
    s_waitcnt vmcnt(12)
    v_dot2c_f32_bf16_dpp v12, v60, v100 row_newbcast:1 row_mask:0xf bank_mask:0xf
    v_dot2c_f32_bf16_dpp v13, v62, v100 row_newbcast:1 row_mask:0xf bank_mask:0xf
    v_dot2c_f32_bf16_dpp v14, v60, v101 row_newbcast:1 row_mask:0xf bank_mask:0xf
    v_dot2c_f32_bf16_dpp v15, v62, v101 row_newbcast:1 row_mask:0xf bank_mask:0xf
    v_dot2c_f32_bf16_dpp v16, v60, v102 row_newbcast:1 row_mask:0xf bank_mask:0xf
    v_dot2c_f32_bf16_dpp v17, v62, v102 row_newbcast:1 row_mask:0xf bank_mask:0xf
    v_dot2c_f32_bf16_dpp v18, v60, v103 row_newbcast:1 row_mask:0xf bank_mask:0xf
    v_dot2c_f32_bf16_dpp v19, v62, v103 row_newbcast:1 row_mask:0xf bank_mask:0xf
    s_waitcnt vmcnt(11)
    v_dot2c_f32_bf16_dpp v12, v60, v104 row_newbcast:2 row_mask:0xf bank_mask:0xf
    v_dot2c_f32_bf16_dpp v13, v62, v104 row_newbcast:2 row_mask:0xf bank_mask:0xf
    v_dot2c_f32_bf16_dpp v14, v60, v105 row_newbcast:2 row_mask:0xf bank_mask:0xf
    v_dot2c_f32_bf16_dpp v15, v62, v105 row_newbcast:2 row_mask:0xf bank_mask:0xf
    v_dot2c_f32_bf16_dpp v16, v60, v106 row_newbcast:2 row_mask:0xf bank_mask:0xf
    v_dot2c_f32_bf16_dpp v17, v62, v106 row_newbcast:2 row_mask:0xf bank_mask:0xf
    v_dot2c_f32_bf16_dpp v18, v60, v107 row_newbcast:2 row_mask:0xf bank_mask:0xf
    v_dot2c_f32_bf16_dpp v19, v62, v107 row_newbcast:2 row_mask:0xf bank_mask:0xf
    s_waitcnt vmcnt(10)
    v_dot2c_f32_bf16_dpp v12, v60, v108 row_newbcast:3 row_mask:0xf bank_mask:0xf
    v_dot2c_f32_bf16_dpp v13, v62, v108 row_newbcast:3 row_mask:0xf bank_mask:0xf
    v_dot2c_f32_bf16_dpp v14, v60, v109 row_newbcast:3 row_mask:0xf bank_mask:0xf
    v_dot2c_f32_bf16_dpp v15, v62, v109 row_newbcast:3 row_mask:0xf bank_mask:0xf
    v_dot2c_f32_bf16_dpp v16, v60, v110 row_newbcast:3 row_mask:0xf bank_mask:0xf
    v_dot2c_f32_bf16_dpp v17, v62, v110 row_newbcast:3 row_mask:0xf bank_mask:0xf
    v_dot2c_f32_bf16_dpp v18, v60, v111 row_newbcast:3 row_mask:0xf bank_mask:0xf
    v_dot2c_f32_bf16_dpp v19, v62, v111 row_newbcast:3 row_mask:0xf bank_mask:0xf
    s_waitcnt vmcnt(9)
    v_dot2c_f32_bf16_dpp v12, v60, v112 row_newbcast:4 row_mask:0xf bank_mask:0xf
    v_dot2c_f32_bf16_dpp v13, v62, v112 row_newbcast:4 row_mask:0xf bank_mask:0xf
    v_dot2c_f32_bf16_dpp v14, v60, v113 row_newbcast:4 row_mask:0xf bank_mask:0xf
    v_dot2c_f32_bf16_dpp v15, v62, v113 row_newbcast:4 row_mask:0xf bank_mask:0xf
    v_dot2c_f32_bf16_dpp v16, v60, v114 row_newbcast:4 row_mask:0xf bank_mask:0xf
    v_dot2c_f32_bf16_dpp v17, v62, v114 row_newbcast:4 row_mask:0xf bank_mask:0xf
    v_dot2c_f32_bf16_dpp v18, v60, v115 row_newbcast:4 row_mask:0xf bank_mask:0xf
    v_dot2c_f32_bf16_dpp v19, v62, v115 row_newbcast:4 row_mask:0xf bank_mask:0xf
    s_waitcnt vmcnt(8)
    v_dot2c_f32_bf16_dpp v12, v60, v116 row_newbcast:5 row_mask:0xf bank_mask:0xf
    v_dot2c_f32_bf16_dpp v13, v62, v116 row_newbcast:5 row_mask:0xf bank_mask:0xf
    v_dot2c_f32_bf16_dpp v14, v60, v117 row_newbcast:5 row_mask:0xf bank_mask:0xf
    v_dot2c_f32_bf16_dpp v15, v62, v117 row_newbcast:5 row_mask:0xf bank_mask:0xf
    v_dot2c_f32_bf16_dpp v16, v60, v118 row_newbcast:5 row_mask:0xf bank_mask:0xf
    v_dot2c_f32_bf16_dpp v17, v62, v118 row_newbcast:5 row_mask:0xf bank_mask:0xf
    v_dot2c_f32_bf16_dpp v18, v60, v119 row_newbcast:5 row_mask:0xf bank_mask:0xf
    v_dot2c_f32_bf16_dpp v19, v62, v119 row_newbcast:5 row_mask:0xf bank_mask:0xf
    s_waitcnt vmcnt(7)
    v_dot2c_f32_bf16_dpp v12, v60, v120 row_newbcast:6 row_mask:0xf bank_mask:0xf
    v_dot2c_f32_bf16_dpp v13, v62, v120 row_newbcast:6 row_mask:0xf bank_mask:0xf
    v_dot2c_f32_bf16_dpp v14, v60, v121 row_newbcast:6 row_mask:0xf bank_mask:0xf
    v_dot2c_f32_bf16_dpp v15, v62, v121 row_newbcast:6 row_mask:0xf bank_mask:0xf
    v_dot2c_f32_bf16_dpp v16, v60, v122 row_newbcast:6 row_mask:0xf bank_mask:0xf
    v_dot2c_f32_bf16_dpp v17, v62, v122 row_newbcast:6 row_mask:0xf bank_mask:0xf
    v_dot2c_f32_bf16_dpp v18, v60, v123 row_newbcast:6 row_mask:0xf bank_mask:0xf
    v_dot2c_f32_bf16_dpp v19, v62, v123 row_newbcast:6 row_mask:0xf bank_mask:0xf
    s_waitcnt vmcnt(6)
    v_dot2c_f32_bf16_dpp v12, v60, v124 row_newbcast:7 row_mask:0xf bank_mask:0xf
    v_dot2c_f32_bf16_dpp v13, v62, v124 row_newbcast:7 row_mask:0xf bank_mask:0xf
    v_dot2c_f32_bf16_dpp v14, v60, v125 row_newbcast:7 row_mask:0xf bank_mask:0xf
    v_dot2c_f32_bf16_dpp v15, v62, v125 row_newbcast:7 row_mask:0xf bank_mask:0xf
    v_dot2c_f32_bf16_dpp v16, v60, v126 row_newbcast:7 row_mask:0xf bank_mask:0xf
    v_dot2c_f32_bf16_dpp v17, v62, v126 row_newbcast:7 row_mask:0xf bank_mask:0xf
    v_dot2c_f32_bf16_dpp v18, v60, v127 row_newbcast:7 row_mask:0xf bank_mask:0xf
    v_dot2c_f32_bf16_dpp v19, v62, v127 row_newbcast:7 row_mask:0xf bank_mask:0xf
    s_waitcnt vmcnt(5)
    v_dot2c_f32_bf16_dpp v12, v60, v64 row_newbcast:8 row_mask:0xf bank_mask:0xf
    v_dot2c_f32_bf16_dpp v13, v62, v64 row_newbcast:8 row_mask:0xf bank_mask:0xf
    v_dot2c_f32_bf16_dpp v14, v60, v65 row_newbcast:8 row_mask:0xf bank_mask:0xf
    v_dot2c_f32_bf16_dpp v15, v62, v65 row_newbcast:8 row_mask:0xf bank_mask:0xf
    v_dot2c_f32_bf16_dpp v16, v60, v66 row_newbcast:8 row_mask:0xf bank_mask:0xf
    v_dot2c_f32_bf16_dpp v17, v62, v66 row_newbcast:8 row_mask:0xf bank_mask:0xf
    v_dot2c_f32_bf16_dpp v18, v60, v67 row_newbcast:8 row_mask:0xf bank_mask:0xf
    v_dot2c_f32_bf16_dpp v19, v62, v67 row_newbcast:8 row_mask:0xf bank_mask:0xf
    s_waitcnt vmcnt(4)
    v_dot2c_f32_bf16_dpp v12, v60, v68 row_newbcast:9 row_mask:0xf bank_mask:0xf
    v_dot2c_f32_bf16_dpp v13, v62, v68 row_newbcast:9 row_mask:0xf bank_mask:0xf
    v_dot2c_f32_bf16_dpp v14, v60, v69 row_newbcast:9 row_mask:0xf bank_mask:0xf
    v_dot2c_f32_bf16_dpp v15, v62, v69 row_newbcast:9 row_mask:0xf bank_mask:0xf
    v_dot2c_f32_bf16_dpp v16, v60, v70 row_newbcast:9 row_mask:0xf bank_mask:0xf
    v_dot2c_f32_bf16_dpp v17, v62, v70 row_newbcast:9 row_mask:0xf bank_mask:0xf
    v_dot2c_f32_bf16_dpp v18, v60, v71 row_newbcast:9 row_mask:0xf bank_mask:0xf
    v_dot2c_f32_bf16_dpp v19, v62, v71 row_newbcast:9 row_mask:0xf bank_mask:0xf
    s_waitcnt vmcnt(3)
    v_dot2c_f32_bf16_dpp v12, v60, v72 row_newbcast:10 row_mask:0xf bank_mask:0xf
    v_dot2c_f32_bf16_dpp v13, v62, v72 row_newbcast:10 row_mask:0xf bank_mask:0xf
    v_dot2c_f32_bf16_dpp v14, v60, v73 row_newbcast:10 row_mask:0xf bank_mask:0xf
    v_dot2c_f32_bf16_dpp v15, v62, v73 row_newbcast:10 row_mask:0xf bank_mask:0xf
    v_dot2c_f32_bf16_dpp v16, v60, v74 row_newbcast:10 row_mask:0xf bank_mask:0xf
    v_dot2c_f32_bf16_dpp v17, v62, v74 row_newbcast:10 row_mask:0xf bank_mask:0xf
    v_dot2c_f32_bf16_dpp v18, v60, v75 row_newbcast:10 row_mask:0xf bank_mask:0xf
    v_dot2c_f32_bf16_dpp v19, v62, v75 row_newbcast:10 row_mask:0xf bank_mask:0xf
    s_waitcnt vmcnt(2)
    v_dot2c_f32_bf16_dpp v12, v60, v76 row_newbcast:11 row_mask:0xf bank_mask:0xf
    v_dot2c_f32_bf16_dpp v13, v62, v76 row_newbcast:11 row_mask:0xf bank_mask:0xf
    v_dot2c_f32_bf16_dpp v14, v60, v77 row_newbcast:11 row_mask:0xf bank_mask:0xf
    v_dot2c_f32_bf16_dpp v15, v62, v77 row_newbcast:11 row_mask:0xf bank_mask:0xf
    v_dot2c_f32_bf16_dpp v16, v60, v78 row_newbcast:11 row_mask:0xf bank_mask:0xf
    v_dot2c_f32_bf16_dpp v17, v62, v78 row_newbcast:11 row_mask:0xf bank_mask:0xf
    v_dot2c_f32_bf16_dpp v18, v60, v79 row_newbcast:11 row_mask:0xf bank_mask:0xf
    v_dot2c_f32_bf16_dpp v19, v62, v79 row_newbcast:11 row_mask:0xf bank_mask:0xf
    s_waitcnt vmcnt(1)
    v_dot2c_f32_bf16_dpp v12, v60, v80 row_newbcast:12 row_mask:0xf bank_mask:0xf
    v_dot2c_f32_bf16_dpp v13, v62, v80 row_newbcast:12 row_mask:0xf bank_mask:0xf
    v_dot2c_f32_bf16_dpp v14, v60, v81 row_newbcast:12 row_mask:0xf bank_mask:0xf
    v_dot2c_f32_bf16_dpp v15, v62, v81 row_newbcast:12 row_mask:0xf bank_mask:0xf
    v_dot2c_f32_bf16_dpp v16, v60, v82 row_newbcast:12 row_mask:0xf bank_mask:0xf
    v_dot2c_f32_bf16_dpp v17, v62, v82 row_newbcast:12 row_mask:0xf bank_mask:0xf
    v_dot2c_f32_bf16_dpp v18, v60, v83 row_newbcast:12 row_mask:0xf bank_mask:0xf
    v_dot2c_f32_bf16_dpp v19, v62, v83 row_newbcast:12 row_mask:0xf bank_mask:0xf
    s_waitcnt vmcnt(0)
    v_dot2c_f32_bf16_dpp v12, v60, v84 row_newbcast:13 row_mask:0xf bank_mask:0xf
    v_dot2c_f32_bf16_dpp v13, v62, v84 row_newbcast:13 row_mask:0xf bank_mask:0xf
    v_dot2c_f32_bf16_dpp v14, v60, v85 row_newbcast:13 row_mask:0xf bank_mask:0xf
    v_dot2c_f32_bf16_dpp v15, v62, v85 row_newbcast:13 row_mask:0xf bank_mask:0xf
    v_dot2c_f32_bf16_dpp v16, v60, v86 row_newbcast:13 row_mask:0xf bank_mask:0xf
    v_dot2c_f32_bf16_dpp v17, v62, v86 row_newbcast:13 row_mask:0xf bank_mask:0xf
    v_dot2c_f32_bf16_dpp v18, v60, v87 row_newbcast:13 row_mask:0xf bank_mask:0xf
    v_dot2c_f32_bf16_dpp v19, v62, v87 row_newbcast:13 row_mask:0xf bank_mask:0xf
    s_nop 2
    ds_write_b128 v6, v[12:15] offset:8192
    ds_write_b128 v6, v[16:19] offset:8208
    s_waitcnt lgkmcnt(0)
    s_barrier
    s_cmp_ge_u32 s5, 2
    s_cbranch_scc1 NOPUB_437
    s_lshl_b32 s7, s5, 10
    v_lshl_add_u32 v7, v0, 4, s7
    ds_read_b128 v[36:39], v7 offset:8192
    ds_read_b128 v[40:43], v7 offset:10240
    ds_read_b128 v[44:47], v7 offset:12288
    ds_read_b128 v[48:51], v7 offset:14336
    v_lshrrev_b32 v55, 6, v7
    v_lshlrev_b32 v55, 11, v55
    v_and_b32 v7, 48, v7
    v_add_u32 v55, v55, v7
    s_lshl_b32 s7, s3, 16
    s_lshl_b32 s6, s4, 6
    s_add_u32 s7, s7, s6
    s_add_u32 s7, s7, 1572864
    s_waitcnt lgkmcnt(0)
    v_add_f32 v36, v36, v40
    v_add_f32 v44, v44, v48
    v_add_f32 v37, v37, v41
    v_add_f32 v45, v45, v49
    v_add_f32 v38, v38, v42
    v_add_f32 v46, v46, v50
    v_add_f32 v39, v39, v43
    v_add_f32 v47, v47, v51
    v_add_f32 v36, v36, v44
    v_add_f32 v37, v37, v45
    v_add_f32 v38, v38, v46
    v_add_f32 v39, v39, v47
    buffer_store_dwordx4 v[36:39], v55, s[32:35], s7 offen sc0 sc1
NOPUB_437:
    s_cmp_lg_u32 s5, 0
    s_cbranch_scc1 NOHOP_438
    s_lshl_b32 s7, s3, 16
    s_lshl_b32 s6, s4, 11
    s_add_u32 s7, s7, s6
    s_add_u32 s7, s7, 1572864
    v_lshlrev_b32 v7, 4, v0
    s_mov_b32 s78, 0x20000
HA_440:
    buffer_load_dwordx4 v[36:39], v7, s[32:35], s7 offen sc0 sc1
    buffer_load_dwordx4 v[40:43], v7, s[32:35], s7 offen offset:1024 sc0 sc1
    s_waitcnt vmcnt(0)
    v_max3_u32 v63, v36, v37, v38
    v_max3_u32 v63, v63, v39, v40
    v_max3_u32 v63, v63, v41, v42
    v_max_u32 v63, v63, v43
    v_cmp_eq_u32 vcc, -1, v63
    s_cbranch_vccz HAOK_441
    s_sub_u32 s78, s78, 1
    s_cmp_eq_u32 s78, 0
    s_cbranch_scc0 HA_440
HAOK_441:
    v_add_f32 v36, v36, v40
    v_add_f32 v37, v37, v41
    v_add_f32 v38, v38, v42
    v_add_f32 v39, v39, v43
    s_nop 1
    v_add_f32_dpp v36, v36, v36 row_ror:4 row_mask:0xf bank_mask:0xf
    v_add_f32_dpp v37, v37, v37 row_ror:4 row_mask:0xf bank_mask:0xf
    v_add_f32_dpp v38, v38, v38 row_ror:4 row_mask:0xf bank_mask:0xf
    v_add_f32_dpp v39, v39, v39 row_ror:4 row_mask:0xf bank_mask:0xf
    s_nop 1
    v_add_f32_dpp v36, v36, v36 row_ror:8 row_mask:0xf bank_mask:0xf
    v_add_f32_dpp v37, v37, v37 row_ror:8 row_mask:0xf bank_mask:0xf
    v_add_f32_dpp v38, v38, v38 row_ror:8 row_mask:0xf bank_mask:0xf
    v_add_f32_dpp v39, v39, v39 row_ror:8 row_mask:0xf bank_mask:0xf
    v_mov_b32 v40, v36
    v_mov_b32 v41, v37
    v_mov_b32 v42, v38
    v_mov_b32 v43, v39
    s_nop 1
    v_permlane16_swap_b32 v40, v36
    v_permlane16_swap_b32 v41, v37
    v_permlane16_swap_b32 v42, v38
    v_permlane16_swap_b32 v43, v39
    s_nop 1
    v_add_f32 v36, v36, v40
    v_add_f32 v37, v37, v41
    v_add_f32 v38, v38, v42
    v_add_f32 v39, v39, v43
    v_mov_b32 v40, v36
    v_mov_b32 v41, v37
    v_mov_b32 v42, v38
    v_mov_b32 v43, v39
    s_nop 1
    v_permlane32_swap_b32 v40, v36
    v_permlane32_swap_b32 v41, v37
    v_permlane32_swap_b32 v42, v38
    v_permlane32_swap_b32 v43, v39
    s_nop 1
    v_add_f32 v36, v36, v40
    v_add_f32 v37, v37, v41
    v_add_f32 v38, v38, v42
    v_add_f32 v39, v39, v43
    v_cvt_pk_bf16_f32 v40, v36, v37
    v_cvt_pk_bf16_f32 v41, v38, v39
    v_lshlrev_b32 v36, 16, v40
    v_and_b32 v37, 0xffff0000, v40
    v_lshlrev_b32 v38, 16, v41
    v_and_b32 v39, 0xffff0000, v41
    v_add_f32 v36, v36, v56
    v_add_f32 v37, v37, v57
    v_add_f32 v38, v38, v58
    v_add_f32 v39, v39, v59
    v_cvt_pk_bf16_f32 v40, v36, v37
    v_cvt_pk_bf16_f32 v41, v38, v39
    v_lshlrev_b32 v7, 3, v0
    s_mov_b64 exec, 15
    buffer_store_dwordx2 v[40:41], v7, s[40:43], 0 offen
    s_mov_b64 exec, -1
NOHOP_438:
    s_waitcnt vmcnt(0)
L_END:
    s_endpgm
.section .rodata,"a"
.p2align 6
.amdhsa_kernel interleave_layers__mha_block_cached__dense_activation_silu__decode_kernel
  .amdhsa_next_free_vgpr 512
  .amdhsa_next_free_sgpr 102
  .amdhsa_accum_offset 256
  .amdhsa_group_segment_fixed_size 0
  .amdhsa_kernarg_size 88
  .amdhsa_user_sgpr_count 2
  .amdhsa_user_sgpr_kernarg_segment_ptr 1
  .amdhsa_system_sgpr_workgroup_id_x 1
.end_amdhsa_kernel
```
